```python
import torch

def _softmax(x, axis=-1):
    return torch.softmax(x, dim=axis)

def _gelu(x):
    return torch.nn.functional.gelu(x, approximate='tanh')

def _silu(x):
    return torch.nn.functional.silu(x)

def _sigmoid(x):
    return torch.sigmoid(x)

def _layernorm(x, axis=-1, eps=1e-05):
    m = x.mean(dim=axis, keepdim=True)
    v = x.var(dim=axis, keepdim=True, unbiased=False)
    return (x - m) / torch.sqrt(v + eps)

def _scatter_add(tgt, idx, src, axis=0):
    return tgt.clone().index_add_(axis, idx, src)

def _segment_sum(src, seg, n):
    out = torch.zeros((n,) + src.shape[1:], dtype=src.dtype)
    return out.index_add_(0, seg, src)

def _pad(x, pw):
    flat = tuple((v for pair in reversed(pw) for v in pair))
    return torch.nn.functional.pad(x, flat)
kernel_name = 'adaLN_cond__sliding_block_cached__geglu_ffn__prompt'

def setup_inputs():

    _w = lambda a: (lambda t: t.to(torch.bfloat16) if t.is_floating_point() else t)(torch.as_tensor(a))

    def _A_setup():
        B, Sq, D = (1, 2048, 640)
        Hq, Hkv, Sk, Dh = (32, 32, 2048, 192)
        assert Hq % Hkv == 0, (Hq, Hkv)
        return {'x': _w((lambda *s: torch.randn(*s, dtype=torch.bfloat16) * 0.05)(B, Sq, D)), 'k_cache': _w((lambda *s: torch.randn(*s, dtype=torch.bfloat16) * 3.2)(B, Hkv, Sk, Dh)), 'v_cache': _w((lambda *s: torch.randn(*s, dtype=torch.bfloat16) * 0.4)(B, Hkv, Sk, Dh)), 'wq': _w((lambda *s: torch.randn(*s, dtype=torch.bfloat16) * 3.2)(D, Hq * Dh) * D ** (-0.5)), 'wo': _w((lambda *s: torch.randn(*s, dtype=torch.bfloat16) * 0.4)(Hq * Dh, D) * (Hq * Dh) ** (-0.5))}
    _A_in = _A_setup()

    def _B_setup():
        B, S, D, F = (1, 2048, 640, 1536)
        return {'x': _w((lambda *s: torch.randn(*s, dtype=torch.bfloat16) * 0.05)(B, S, D)), 'w_gate': _w((lambda *s: torch.randn(*s, dtype=torch.bfloat16) * 0.05)(D, F)), 'w_up': _w((lambda *s: torch.randn(*s, dtype=torch.bfloat16) * 0.05)(D, F)), 'w_down': _w((lambda *s: torch.randn(*s, dtype=torch.bfloat16) * 0.05)(F, D))}
    _B_in = _B_setup()
    return {'A_x': _A_in['x'], 'A_k_cache': _A_in['k_cache'], 'A_v_cache': _A_in['v_cache'], 'A_wq': _A_in['wq'], 'A_wo': _A_in['wo'], 'B_x': _B_in['x'], 'B_w_gate': _B_in['w_gate'], 'B_w_up': _B_in['w_up'], 'B_w_down': _B_in['w_down'], 'c': _w((lambda *s: torch.randn(*s, dtype=torch.bfloat16) * 0.1)(1, 640) * 8.0), 'w_mod': _w((lambda *s: torch.randn(*s, dtype=torch.bfloat16) * 0.1)(640, 6 * 640) * 640 ** (-0.5) * 8.0)}

def reference(A_x, A_k_cache, A_v_cache, A_wq, A_wo, B_x, B_w_gate, B_w_up, B_w_down, c, w_mod):

    def _A_ref(x, k_cache, v_cache, wq, wo):
        B, Sq, D = x.shape
        Hq, Dh = (32, 192)
        Hkv, Sk = (k_cache.shape[1], k_cache.shape[2])
        W = min(4096, max(256, Sk // 4))
        rep = Hq // Hkv
        q = (lambda x, *d: x.permute(*d))((x @ wq).reshape(B, Sq, Hq, Dh), 0, 2, 1, 3)
        k = (lambda x, n, axis: torch.repeat_interleave(x, n, dim=axis))(k_cache[:, :, Sk - W:, :], rep, axis=1)
        v = (lambda x, n, axis: torch.repeat_interleave(x, n, dim=axis))(v_cache[:, :, Sk - W:, :], rep, axis=1)
        scores = torch.einsum('bhqd,bhkd->bhqk', q, k) * Dh ** (-0.5)
        p = _softmax(scores, axis=-1)
        o = torch.einsum('bhqk,bhkd->bhqd', p, v)
        return (lambda x, *d: x.permute(*d))(o, 0, 2, 1, 3).reshape(B, Sq, Hq * Dh) @ wo

    def _B_ref(x, w_gate, w_up, w_down):
        return _gelu(x @ w_gate) * (x @ w_up) @ w_down
    x = A_x
    mod = (_silu(c) @ w_mod).reshape(c.shape[0], 6, 1, -1)
    sa, ca, ga, sb, cb, gb = (mod[:, 0].clone(), mod[:, 1].clone(), mod[:, 2].clone(), mod[:, 3].clone(), mod[:, 4].clone(), mod[:, 5].clone())
    h = _layernorm(x, axis=-1) * (1 + ca) + sa
    x = x + ga * _A_ref(h, A_k_cache, A_v_cache, A_wq, A_wo)
    h = _layernorm(x, axis=-1) * (1 + cb) + sb
    x = x + gb * _B_ref(h, B_w_gate, B_w_up, B_w_down)
    return x
```

```asm
; @launch grid=(256,1,1) block=(256,1,1) lds=160512
.amdgcn_target "amdgcn-amd-amdhsa--gfx950"
.text
.globl adaLN_cond__sliding_block_cached__geglu_ffn__prompt_kernel
.p2align 8
.type adaLN_cond__sliding_block_cached__geglu_ffn__prompt_kernel,@function
adaLN_cond__sliding_block_cached__geglu_ffn__prompt_kernel:
    s_cmpk_ge_u32 s2, 256
    s_cbranch_scc1 M_end
    s_load_dwordx16 s[64:79], s[0:1], 0
    s_load_dwordx8 s[84:91], s[0:1], 64
    s_load_dwordx4 s[8:11], s[0:1], 96
    s_getpc_b64 s[46:47]
P0_pc:
    v_lshlrev_b32 v1, 4, v0
    s_lshl_b32 s3, s2, 9
    s_and_b32 s3, s3, 0x1f000
    s_min_u32 s3, s3, M_last-P0_pc-4096
    s_add_u32 s46, s46, s3
    s_addc_u32 s47, s47, 0
    global_load_dwordx4 v[44:47], v1, s[46:47] offset:-36
    v_lshrrev_b32 v21, 3, v0
    v_and_b32 v13, 7, v0
    v_mul_u32_u24 v22, 7680, v21
    v_lshl_add_u32 v22, v13, 4, v22
    v_and_b32 v14, 8, v21
    v_add_u32 v13, v13, v14
    v_mul_u32_u24 v13, 80, v13
    v_lshrrev_b32 v12, 7, v0
    v_mad_u32_u24 v13, v12, 40, v13
    v_and_b32 v14, 7, v21
    v_add_lshl_u32 v13, v13, v14, 4
    v_lshrrev_b32 v12, 6, v0
    s_and_b32 s46, s2, 3
    s_mulk_i32 s46, 160
    v_add_lshl_u32 v21, v21, s46, 1
    s_mulk_i32 s46, 7680
    s_lshr_b32 s61, s2, 2
    s_lshl_b32 s61, s61, 7
    s_add_u32 s61, s61, s46
    s_and_b32 s47, s2, 127
    s_mulk_i32 s47, 20480
    s_cmpk_lt_u32 s2, 80
    s_cselect_b64 vcc, -1, 0
    s_cselect_b32 s46, s61, s47
    s_movk_i32 s3, 128
    s_cselect_b32 s3, 245760, s3
    v_cndmask_b32 v16, v13, v22, vcc
    v_add_u32 v16, s46, v16
    v_add_u32 v17, s3, v16
    v_add_u32 v18, s3, v17
    v_add_u32 v19, s3, v18
    v_add_u32 v20, s3, v19
    v_readfirstlane_b32 s32, v12
    s_sub_u32 s6, s2, 80
    s_andn2_b32 s5, s6, 11
    s_or_b32 s5, s5, s32
    v_cmp_eq_u32 vcc, 0, s5
    s_cmpk_lt_u32 s2, 80
    s_waitcnt lgkmcnt(0)
    s_cbranch_vccz P0_nz
    v_min_u32 v13, 35, v0
    s_and_b32 s4, s6, 3
    s_lshr_b32 s5, s6, 1
    s_and_b32 s5, s5, 4
    s_or_b32 s5, s5, s4
    s_mul_i32 s4, s5, 36
    s_addk_i32 s4, 256
    v_add_lshl_u32 v13, v13, s4, 8
    v_mov_b32 v90, 0
    global_store_dword v13, v90, s[10:11] sc1
    s_lshl_b32 s4, s5, 2
    v_mov_b32 v13, s4
    v_mov_b32 v14, 1
    s_waitcnt vmcnt(0)
    global_store_dword v13, v14, s[8:9] sc1
P0_nz:
    s_cselect_b64 s[4:5], s[88:89], s[64:65]
    global_load_ushort v84, v21, s[86:87] offset:0
    global_load_ushort v85, v21, s[86:87] offset:64
    global_load_ushort v86, v21, s[86:87] offset:128
    global_load_ushort v87, v21, s[86:87] offset:192
    global_load_ushort v88, v21, s[86:87] offset:256
    s_cmp_lt_u32 s6, 48
    s_cbranch_scc1 P0_nm
    global_load_dwordx4 v[24:27], v16, s[4:5] nt
    global_load_dwordx4 v[28:31], v17, s[4:5] nt
    global_load_dwordx4 v[32:35], v18, s[4:5] nt
    global_load_dwordx4 v[36:39], v19, s[4:5] nt
    global_load_dwordx4 v[40:43], v20, s[4:5] nt
P0_nm:
    v_and_b32 v0, 63, v0
    s_and_b32 s3, s2, 7
    s_lshr_b32 s46, s2, 3
    s_and_b32 s48, s46, 3
    s_lshl_b32 s3, s3, 2
    s_add_u32 s33, s3, s48
    s_lshr_b32 s34, s46, 2
    v_lshlrev_b32 v8, 4, v0
    v_lshrrev_b32 v13, 3, v0
    v_lshl_add_u32 v13, v12, 3, v13
    v_and_b32 v14, 7, v0
    v_and_b32 v15, 2, v13
    v_lshlrev_b32 v15, 1, v15
    v_xor_b32 v15, v14, v15
    v_lshlrev_b32 v15, 4, v15
    v_mul_u32_u24 v16, 12288, v13
    v_add_u32 v9, v16, v15
    v_mul_u32_u24 v16, 384, v13
    v_and_b32 v15, 6, v13
    v_xor_b32 v15, v14, v15
    v_lshl_add_u32 v11, v15, 4, v16
    v_bfe_u32 v15, v13, 1, 3
    v_xor_b32 v15, v14, v15
    v_lshl_add_u32 v10, v15, 4, v16
    s_mul_i32 s46, s33, 384
    s_add_u32 s12, s70, s46
    s_addc_u32 s13, s71, 0
    s_mov_b32 s14, 0
    s_mov_b32 s15, 0x00020000
    s_sub_u32 s14, 7864320, s46
    s_and_b32 s40, s32, 1
    s_mul_i32 s40, s40, 24584
    s_lshr_b32 s3, s32, 1
    s_lshl_b32 s3, s3, 10
    s_add_u32 s40, s40, s3
    s_mov_b32 s35, 0
    s_cmp_lt_u32 s6, 48
    s_cbranch_scc1 P0_we
P0_wer:
    s_mov_b64 s[100:101], s[64:65]
    s_mov_b64 s[62:63], s[90:91]
    s_mov_b64 s[50:51], s[8:9]
    s_mov_b64 s[96:97], s[72:73]
    s_mov_b64 s[98:99], s[84:85]
    s_mov_b64 s[4:5], s[76:77]
    s_mov_b64 s[6:7], s[78:79]
    s_add_u32 s8, s88, s61
    s_addc_u32 s9, s89, 0
    s_lshr_b32 s20, s32, 1
    s_and_b32 s21, s32, 1
    s_mul_i32 s3, s20, 10240
    s_lshl_b32 s21, s21, 7
    s_add_u32 s3, s3, s21
    s_add_u32 s3, s3, s47
    s_add_u32 s3, s3, 1048576
    s_add_u32 s16, s10, s3
    s_addc_u32 s17, s11, 0
    s_mov_b32 s18, 10112
    s_mov_b32 s19, 0x00020000
    v_and_b32 v14, 0x70, v8
    v_and_b32 v13, 0x380, v8
    v_lshl_add_u32 v13, v13, 1, v14
    s_add_u32 s21, s21, 151040
    v_add_u32 v14, s21, v14
    s_lshl_b32 s3, s20, 3
    v_add_u32 v15, s3, v14
    s_movk_i32 s21, 4096
    s_movk_i32 s22, 8192
    s_mov_b32 s20, 0x3f803f80
    v_accvgpr_write_b32 a57, v22
    v_mov_b32 v16, 0
    v_mov_b32 v17, 0
    v_mov_b32 v18, 0
    v_mov_b32 v19, 0
    v_mov_b32 v20, 0
    v_mov_b32 v21, 0
    v_mov_b32 v22, 0
    v_mov_b32 v23, 0
    v_mov_b32 v96, 0
    v_mov_b32 v97, 0
    v_mov_b32 v98, 0
    v_mov_b32 v99, 0
    v_mov_b32 v100, 0
    v_mov_b32 v101, 0
    v_mov_b32 v102, 0
    v_mov_b32 v103, 0
    v_mov_b32 v104, 0
    v_mov_b32 v105, 0
    v_mov_b32 v106, 0
    v_mov_b32 v107, 0
    v_mov_b32 v108, 0
    v_mov_b32 v109, 0
    v_mov_b32 v110, 0
    v_mov_b32 v111, 0
    v_mov_b32 v112, 0
    v_mov_b32 v113, 0
    v_mov_b32 v114, 0
    v_mov_b32 v115, 0
    v_mov_b32 v116, 0
    v_mov_b32 v117, 0
    v_mov_b32 v118, 0
    v_mov_b32 v119, 0
    v_mov_b32 v120, 0
    v_mov_b32 v121, 0
    v_mov_b32 v122, 0
    v_mov_b32 v123, 0
    v_mov_b32 v124, 0
    v_mov_b32 v125, 0
    v_mov_b32 v126, 0
    v_mov_b32 v127, 0
    v_mov_b32 v128, 0
    v_mov_b32 v129, 0
    v_mov_b32 v130, 0
    v_mov_b32 v131, 0
    v_mov_b32 v132, 0
    v_mov_b32 v133, 0
    v_mov_b32 v134, 0
    v_mov_b32 v135, 0
    v_mov_b32 v136, 0
    v_mov_b32 v137, 0
    v_mov_b32 v138, 0
    v_mov_b32 v139, 0
    v_mov_b32 v140, 0
    v_mov_b32 v141, 0
    v_mov_b32 v142, 0
    v_mov_b32 v143, 0
    v_mov_b32 v144, 0
    v_mov_b32 v145, 0
    v_mov_b32 v146, 0
    v_mov_b32 v147, 0
    v_mov_b32 v148, 0
    v_mov_b32 v149, 0
    v_mov_b32 v150, 0
    v_mov_b32 v151, 0
    v_mov_b32 v152, 0
    v_mov_b32 v153, 0
    v_mov_b32 v154, 0
    v_mov_b32 v155, 0
    v_mov_b32 v156, 0
    v_mov_b32 v157, 0
    v_mov_b32 v158, 0
    v_mov_b32 v159, 0
    v_mov_b32 v160, 0
    v_mov_b32 v161, 0
    v_mov_b32 v162, 0
    v_mov_b32 v163, 0
    v_mov_b32 v164, 0
    v_mov_b32 v165, 0
    v_mov_b32 v166, 0
    v_mov_b32 v167, 0
    v_mov_b32 v168, 0
    v_mov_b32 v169, 0
    v_mov_b32 v170, 0
    v_mov_b32 v171, 0
    v_mov_b32 v172, 0
    v_mov_b32 v173, 0
    v_mov_b32 v174, 0
    v_mov_b32 v175, 0
    v_mov_b32 v176, 0
    v_mov_b32 v177, 0
    v_mov_b32 v178, 0
    v_mov_b32 v179, 0
    v_mov_b32 v180, 0
    v_mov_b32 v181, 0
    v_mov_b32 v182, 0
    v_mov_b32 v183, 0
    v_mov_b32 v184, 0
    v_mov_b32 v185, 0
    v_mov_b32 v186, 0
    v_mov_b32 v187, 0
    v_mov_b32 v188, 0
    v_mov_b32 v189, 0
    v_mov_b32 v190, 0
    v_mov_b32 v191, 0
    v_mov_b32 v192, 0
    v_mov_b32 v193, 0
    v_mov_b32 v194, 0
    v_mov_b32 v195, 0
    s_waitcnt vmcnt(5)
    v_lshlrev_b32 v84, 16, v84
    v_lshlrev_b32 v85, 16, v85
    v_lshlrev_b32 v86, 16, v86
    v_lshlrev_b32 v87, 16, v87
    v_lshlrev_b32 v88, 16, v88
    v_mul_f32 v91, 0xbfb8aa3b, v84
    v_mul_f32 v92, 0xbfb8aa3b, v85
    v_mul_f32 v93, 0xbfb8aa3b, v86
    v_mul_f32 v94, 0xbfb8aa3b, v87
    v_mul_f32 v95, 0xbfb8aa3b, v88
    v_exp_f32 v91, v91
    v_exp_f32 v92, v92
    v_exp_f32 v93, v93
    v_exp_f32 v94, v94
    v_exp_f32 v95, v95
    s_nop 0
    v_add_f32 v91, 1.0, v91
    v_add_f32 v92, 1.0, v92
    v_add_f32 v93, 1.0, v93
    v_add_f32 v94, 1.0, v94
    v_add_f32 v95, 1.0, v95
    v_rcp_f32 v91, v91
    v_rcp_f32 v92, v92
    v_rcp_f32 v93, v93
    v_rcp_f32 v94, v94
    v_rcp_f32 v95, v95
    s_cmpk_lt_u32 s2, 128
    v_mul_f32 v84, v84, v91
    v_mul_f32 v85, v85, v92
    v_mul_f32 v86, v86, v93
    v_mul_f32 v87, v87, v94
    v_mul_f32 v88, v88, v95
    v_cvt_pk_bf16_f32 v84, v84, 0
    v_cvt_pk_bf16_f32 v85, v85, 0
    v_cvt_pk_bf16_f32 v86, v86, 0
    v_cvt_pk_bf16_f32 v87, v87, 0
    v_cvt_pk_bf16_f32 v88, v88, 0
    s_cbranch_scc1 P0_g
    s_waitcnt vmcnt(4)
    v_dot2c_f32_bf16 v16, s20, v24
    v_dot2c_f32_bf16 v17, v24, v24
    v_dot2c_f32_bf16 v18, s20, v25
    v_dot2c_f32_bf16 v19, v25, v25
    v_dot2c_f32_bf16 v20, s20, v26
    v_dot2c_f32_bf16 v21, v26, v26
    v_dot2c_f32_bf16 v22, s20, v27
    v_dot2c_f32_bf16 v23, v27, v27
    s_waitcnt vmcnt(3)
    v_dot2c_f32_bf16 v16, s20, v28
    v_dot2c_f32_bf16 v17, v28, v28
    v_dot2c_f32_bf16 v18, s20, v29
    v_dot2c_f32_bf16 v19, v29, v29
    v_dot2c_f32_bf16 v20, s20, v30
    v_dot2c_f32_bf16 v21, v30, v30
    v_dot2c_f32_bf16 v22, s20, v31
    v_dot2c_f32_bf16 v23, v31, v31
    s_waitcnt vmcnt(2)
    v_dot2c_f32_bf16 v16, s20, v32
    v_dot2c_f32_bf16 v17, v32, v32
    v_dot2c_f32_bf16 v18, s20, v33
    v_dot2c_f32_bf16 v19, v33, v33
    v_dot2c_f32_bf16 v20, s20, v34
    v_dot2c_f32_bf16 v21, v34, v34
    v_dot2c_f32_bf16 v22, s20, v35
    v_dot2c_f32_bf16 v23, v35, v35
    s_waitcnt vmcnt(1)
    v_dot2c_f32_bf16 v16, s20, v36
    v_dot2c_f32_bf16 v17, v36, v36
    v_dot2c_f32_bf16 v18, s20, v37
    v_dot2c_f32_bf16 v19, v37, v37
    v_dot2c_f32_bf16 v20, s20, v38
    v_dot2c_f32_bf16 v21, v38, v38
    v_dot2c_f32_bf16 v22, s20, v39
    v_dot2c_f32_bf16 v23, v39, v39
    s_waitcnt vmcnt(0)
    v_dot2c_f32_bf16 v16, s20, v40
    v_dot2c_f32_bf16 v17, v40, v40
    v_dot2c_f32_bf16 v18, s20, v41
    v_dot2c_f32_bf16 v19, v41, v41
    v_dot2c_f32_bf16 v20, s20, v42
    v_dot2c_f32_bf16 v21, v42, v42
    v_dot2c_f32_bf16 v22, s20, v43
    v_dot2c_f32_bf16 v23, v43, v43
    v_lshlrev_b32 v44, 16, v24
    v_and_b32 v45, 0xffff0000, v24
    v_pk_add_f32 v[16:17], v[16:17], v[18:19]
    v_pk_add_f32 v[20:21], v[20:21], v[22:23]
    v_pk_add_f32 v[16:17], v[16:17], v[20:21]
    v_lshlrev_b32 v46, 16, v25
    v_and_b32 v47, 0xffff0000, v25
    v_add_f32_dpp v16, v16, v16 row_ror:8 row_mask:0xf bank_mask:0xf
    v_add_f32_dpp v17, v17, v17 row_ror:8 row_mask:0xf bank_mask:0xf
    v_mov_b32 v18, v16
    v_mov_b32 v19, v17
    v_lshlrev_b32 v48, 16, v26
    v_permlane16_swap_b32 v16, v18
    v_permlane16_swap_b32 v17, v19
    v_add_f32 v16, v16, v18
    v_add_f32 v17, v17, v19
    v_mov_b32 v18, v16
    v_mov_b32 v19, v17
    v_and_b32 v49, 0xffff0000, v26
    v_permlane32_swap_b32 v16, v18
    v_permlane32_swap_b32 v17, v19
    v_add_f32 v16, v16, v18
    v_add_f32 v17, v17, v19
    ds_write_b64 v15, v[16:17]
    v_lshlrev_b32 v50, 16, v27
    v_and_b32 v51, 0xffff0000, v27
    v_lshlrev_b32 v52, 16, v28
    v_and_b32 v53, 0xffff0000, v28
    v_lshlrev_b32 v54, 16, v29
    v_and_b32 v55, 0xffff0000, v29
    v_lshlrev_b32 v56, 16, v30
    v_and_b32 v57, 0xffff0000, v30
    v_lshlrev_b32 v58, 16, v31
    v_and_b32 v59, 0xffff0000, v31
    v_lshlrev_b32 v60, 16, v32
    v_and_b32 v61, 0xffff0000, v32
    v_lshlrev_b32 v62, 16, v33
    v_and_b32 v63, 0xffff0000, v33
    s_waitcnt lgkmcnt(0)
    s_barrier
    ds_read_b128 v[16:19], v14
    v_lshlrev_b32 v64, 16, v34
    v_and_b32 v65, 0xffff0000, v34
    v_lshlrev_b32 v66, 16, v35
    v_and_b32 v67, 0xffff0000, v35
    v_lshlrev_b32 v68, 16, v36
    v_and_b32 v69, 0xffff0000, v36
    v_lshlrev_b32 v70, 16, v37
    v_and_b32 v71, 0xffff0000, v37
    v_lshlrev_b32 v72, 16, v38
    v_and_b32 v73, 0xffff0000, v38
    v_lshlrev_b32 v74, 16, v39
    v_and_b32 v75, 0xffff0000, v39
    v_lshlrev_b32 v76, 16, v40
    v_and_b32 v77, 0xffff0000, v40
    v_lshlrev_b32 v78, 16, v41
    v_and_b32 v79, 0xffff0000, v41
    v_lshlrev_b32 v80, 16, v42
    v_and_b32 v81, 0xffff0000, v42
    v_lshlrev_b32 v82, 16, v43
    v_and_b32 v83, 0xffff0000, v43
    v_mov_b32 v12, 0x3acccccd
    s_waitcnt lgkmcnt(0)
    v_pk_add_f32 v[16:17], v[16:17], v[18:19]
    v_mul_f32 v16, 0xbacccccd, v16
    v_mul_f32 v18, v16, v16
    v_fma_f32 v17, v17, v12, -v18
    v_max_f32 v17, 0, v17
    v_add_f32 v17, 0x3727c5ac, v17
    v_rsq_f32 v18, v17
    s_nop 0
    v_mul_f32 v16, v16, v18
    v_pk_fma_f32 v[44:45], v[44:45], v[18:19], v[16:17] op_sel_hi:[1,0,0]
    v_pk_fma_f32 v[46:47], v[46:47], v[18:19], v[16:17] op_sel_hi:[1,0,0]
    v_pk_fma_f32 v[48:49], v[48:49], v[18:19], v[16:17] op_sel_hi:[1,0,0]
    v_pk_fma_f32 v[50:51], v[50:51], v[18:19], v[16:17] op_sel_hi:[1,0,0]
    v_cvt_pk_f16_f32 v24, v44, v45
    v_cvt_pk_f16_f32 v25, v46, v47
    v_cvt_pk_f16_f32 v26, v48, v49
    v_cvt_pk_f16_f32 v27, v50, v51
    buffer_store_dwordx4 v[24:27], v13, s[16:19], 0 offen offset:0 sc1
    v_pk_fma_f32 v[52:53], v[52:53], v[18:19], v[16:17] op_sel_hi:[1,0,0]
    v_pk_fma_f32 v[54:55], v[54:55], v[18:19], v[16:17] op_sel_hi:[1,0,0]
    v_pk_fma_f32 v[56:57], v[56:57], v[18:19], v[16:17] op_sel_hi:[1,0,0]
    v_pk_fma_f32 v[58:59], v[58:59], v[18:19], v[16:17] op_sel_hi:[1,0,0]
    v_cvt_pk_f16_f32 v28, v52, v53
    v_cvt_pk_f16_f32 v29, v54, v55
    v_cvt_pk_f16_f32 v30, v56, v57
    v_cvt_pk_f16_f32 v31, v58, v59
    buffer_store_dwordx4 v[28:31], v13, s[16:19], 0 offen offset:2048 sc1
    v_pk_fma_f32 v[60:61], v[60:61], v[18:19], v[16:17] op_sel_hi:[1,0,0]
    v_pk_fma_f32 v[62:63], v[62:63], v[18:19], v[16:17] op_sel_hi:[1,0,0]
    v_pk_fma_f32 v[64:65], v[64:65], v[18:19], v[16:17] op_sel_hi:[1,0,0]
    v_pk_fma_f32 v[66:67], v[66:67], v[18:19], v[16:17] op_sel_hi:[1,0,0]
    v_cvt_pk_f16_f32 v32, v60, v61
    v_cvt_pk_f16_f32 v33, v62, v63
    v_cvt_pk_f16_f32 v34, v64, v65
    v_cvt_pk_f16_f32 v35, v66, v67
    buffer_store_dwordx4 v[32:35], v13, s[16:19], s21 offen offset:0 sc1
    v_pk_fma_f32 v[68:69], v[68:69], v[18:19], v[16:17] op_sel_hi:[1,0,0]
    v_pk_fma_f32 v[70:71], v[70:71], v[18:19], v[16:17] op_sel_hi:[1,0,0]
    v_pk_fma_f32 v[72:73], v[72:73], v[18:19], v[16:17] op_sel_hi:[1,0,0]
    v_pk_fma_f32 v[74:75], v[74:75], v[18:19], v[16:17] op_sel_hi:[1,0,0]
    v_cvt_pk_f16_f32 v36, v68, v69
    v_cvt_pk_f16_f32 v37, v70, v71
    v_cvt_pk_f16_f32 v38, v72, v73
    v_cvt_pk_f16_f32 v39, v74, v75
    buffer_store_dwordx4 v[36:39], v13, s[16:19], s21 offen offset:2048 sc1
    v_pk_fma_f32 v[76:77], v[76:77], v[18:19], v[16:17] op_sel_hi:[1,0,0]
    v_pk_fma_f32 v[78:79], v[78:79], v[18:19], v[16:17] op_sel_hi:[1,0,0]
    v_pk_fma_f32 v[80:81], v[80:81], v[18:19], v[16:17] op_sel_hi:[1,0,0]
    v_pk_fma_f32 v[82:83], v[82:83], v[18:19], v[16:17] op_sel_hi:[1,0,0]
    v_cvt_pk_f16_f32 v40, v76, v77
    v_cvt_pk_f16_f32 v41, v78, v79
    v_cvt_pk_f16_f32 v42, v80, v81
    v_cvt_pk_f16_f32 v43, v82, v83
    buffer_store_dwordx4 v[40:43], v13, s[16:19], s22 offen offset:0 sc1
P0_gr:
    v_lshrrev_b32 v90, 2, v8
    v_min_u32 v90, 28, v90
    global_load_dword v89, v90, s[50:51] sc1
    v_accvgpr_write_b32 a52, v84
    v_accvgpr_write_b32 a53, v85
    v_accvgpr_write_b32 a54, v86
    v_accvgpr_write_b32 a55, v87
    v_accvgpr_write_b32 a56, v88
    s_add_u32 s76, s10, 65536
    s_addc_u32 s77, s11, 0
    s_mov_b32 s78, 73728
    s_mov_b32 s79, 0x00020000
    v_or_b32 v91, s32, v8
    v_min_u32 v91, 1, v91
    v_lshlrev_b32 v91, 30, v91
    v_mov_b32 v92, 1
    s_lshl_b32 s0, s2, 8
    s_add_u32 s0, s0, 8192
    s_mul_i32 s3, s32, 5
    s_lshr_b32 s3, s3, 1
    s_lshl_b32 s3, s3, 2
    v_bfe_u32 v12, v8, 4, 4
    v_min_u32 v12, 11, v12
    v_bfe_u32 v13, v8, 8, 1
    v_mul_u32_u24 v13, 40, v13
    v_add3_u32 v12, v12, v13, s3
    s_lshl_b32 s3, s34, 2
    s_add_u32 s3, s3, s32
    s_lshl_b32 s3, s3, 2
    s_add_u32 s3, s3, 128
    v_bfe_u32 v13, v8, 4, 2
    v_add_u32 v13, s3, v13
    v_cmp_gt_u32 vcc, 512, v8
    s_mul_i32 s46, s32, 640
    s_mov_b32 s1, 8192
    v_cndmask_b32 v12, v13, v12, vcc
    v_cndmask_b32 v95, 0, v92, vcc
    v_lshlrev_b32 v93, 8, v12
    v_cmp_lt_u32 vcc, 639, v8
    v_add_u32 v12, s46, v8
    v_mov_b32 v13, 0x40000000
    v_add_u32 v14, 147968, v12
    v_mov_b32 v15, 150528
    v_cndmask_b32 v12, v12, v13, vcc
    v_cndmask_b32 v14, v14, v15, vcc
    v_mov_b32 v196, 0
    v_mov_b32 v197, 0
    v_mov_b32 v198, 0
    v_mov_b32 v199, 0
    v_mov_b32 v200, 0
    v_mov_b32 v201, 0
    v_mov_b32 v202, 0
    v_mov_b32 v203, 0
    v_mov_b32 v204, 0
    v_mov_b32 v205, 0
    v_mov_b32 v206, 0
    v_mov_b32 v207, 0
    v_mov_b32 v208, 0
    v_mov_b32 v209, 0
    v_mov_b32 v210, 0
    v_mov_b32 v211, 0
    v_mov_b32 v212, 0
    v_mov_b32 v213, 0
    v_mov_b32 v214, 0
    v_mov_b32 v215, 0
    v_mov_b32 v216, 0
    v_mov_b32 v217, 0
    v_mov_b32 v218, 0
    v_mov_b32 v219, 0
    v_mov_b32 v220, 0
    v_mov_b32 v221, 0
    v_mov_b32 v222, 0
    v_mov_b32 v223, 0
    v_mov_b32 v224, 0
    v_mov_b32 v225, 0
    v_mov_b32 v226, 0
    v_mov_b32 v227, 0
    v_mov_b32 v228, 0
    v_mov_b32 v229, 0
    v_mov_b32 v230, 0
    v_mov_b32 v231, 0
    v_mov_b32 v232, 0
    v_mov_b32 v233, 0
    v_mov_b32 v234, 0
    v_mov_b32 v235, 0
    v_mov_b32 v236, 0
    v_mov_b32 v237, 0
    v_mov_b32 v238, 0
    v_mov_b32 v239, 0
    v_mov_b32 v240, 0
    v_mov_b32 v241, 0
    v_mov_b32 v242, 0
    v_mov_b32 v243, 0
    v_mov_b32 v244, 0
    v_mov_b32 v245, 0
    v_mov_b32 v246, 0
    v_mov_b32 v247, 0
    v_mov_b32 v248, 0
    v_mov_b32 v249, 0
    v_mov_b32 v250, 0
    v_mov_b32 v251, 0
    v_mov_b32 v252, 0
    v_mov_b32 v253, 0
    v_mov_b32 v254, 0
    v_mov_b32 v255, 0
    s_waitcnt vmcnt(0)
    v_cmp_eq_u32 vcc, 0, v89
    s_cbranch_vccnz P0R_spin
P0R_ok:
    s_barrier
    buffer_store_dword v92, v91, s[76:79], s0 offen sc1
    s_sub_u32 s3, s2, 96
    s_cmp_lt_u32 s3, 32
    s_cbranch_scc1 P0_sk0
    s_add_u32 m0, s40, 0
    s_nop 0
    buffer_load_dwordx4 v9, s[12:15], s35 offen offset:0 nt lds
    s_add_u32 m0, s40, 1920
    s_nop 0
    buffer_load_dwordx4 v9, s[12:15], s35 offen offset:128 nt lds
    s_add_u32 m0, s40, 3840
    s_nop 0
    buffer_load_dwordx4 v9, s[12:15], s35 offen offset:256 nt lds
    s_add_u32 s35, s35, 393216
    s_add_u32 m0, s40, 6144
    s_nop 0
    buffer_load_dwordx4 v9, s[12:15], s35 offen offset:0 nt lds
    s_add_u32 m0, s40, 8064
    s_nop 0
    buffer_load_dwordx4 v9, s[12:15], s35 offen offset:128 nt lds
    s_add_u32 m0, s40, 9984
    s_nop 0
    buffer_load_dwordx4 v9, s[12:15], s35 offen offset:256 nt lds
    s_add_u32 s35, s35, 393216
    s_add_u32 m0, s40, 12288
    s_nop 0
    buffer_load_dwordx4 v9, s[12:15], s35 offen offset:0 nt lds
    s_add_u32 m0, s40, 14208
    s_nop 0
    buffer_load_dwordx4 v9, s[12:15], s35 offen offset:128 nt lds
    s_add_u32 m0, s40, 16128
    s_nop 0
    buffer_load_dwordx4 v9, s[12:15], s35 offen offset:256 nt lds
    s_add_u32 s35, s35, 393216
    s_add_u32 m0, s40, 18432
    s_nop 0
    buffer_load_dwordx4 v9, s[12:15], s35 offen offset:0 nt lds
    s_add_u32 m0, s40, 20352
    s_nop 0
    buffer_load_dwordx4 v9, s[12:15], s35 offen offset:128 nt lds
    s_add_u32 m0, s40, 22272
    s_nop 0
    buffer_load_dwordx4 v9, s[12:15], s35 offen offset:256 nt lds
    s_add_u32 s35, s35, 393216
P0_skr0:
    s_add_u32 s40, s40, 49408
    buffer_load_dword v89, v93, s[76:79], s1 offen sc1
    v_mov_b32 v16, 0x3f803f80
    v_accvgpr_write_b32 a48, v16
    v_accvgpr_write_b32 a49, v16
    v_accvgpr_write_b32 a50, v16
    v_accvgpr_write_b32 a51, v16
    s_lshl_b32 s47, s34, 2
    s_add_u32 s47, s47, s32
    s_mul_i32 s46, s47, 81920
    s_add_u32 s46, s46, 1048576
    s_add_u32 s24, s10, s46
    s_addc_u32 s25, s11, 0
    s_mov_b32 s26, 81920
    s_mov_b32 s27, 0x00020000
    s_mov_b32 s36, 0
    s_movk_i32 s37, 20480
    s_mov_b32 s38, 40960
    s_mov_b32 s39, 61440
    s_mov_b32 s52, 49408
    s_mov_b32 s53, 24576
    s_mul_i32 s46, s33, 786432
    s_add_u32 s46, s46, 589824
    s_add_u32 s16, s66, s46
    s_addc_u32 s17, s67, 0
    s_mov_b32 s18, 196608
    s_mov_b32 s19, 0x00020000
    s_add_u32 s20, s68, s46
    s_addc_u32 s21, s69, 0
    s_mov_b32 s22, 196608
    s_mov_b32 s23, 0x00020000
    s_mul_i32 s46, s47, 98304
    s_lshr_b32 s48, s33, 2
    s_mul_i32 s48, s48, 3145728
    s_add_u32 s46, s46, s48
    s_and_b32 s48, s33, 3
    s_mulk_i32 s48, 6144
    s_add_u32 s46, s46, s48
    s_add_u32 s46, s46, 4194304
    s_add_u32 s28, s10, s46
    s_addc_u32 s29, s11, 0
    s_mov_b32 s30, 79872
    s_mov_b32 s31, 0x00020000
    v_bfe_u32 v16, v0, 4, 1
    v_mul_u32_u24 v16, 24584, v16
    v_lshrrev_b32 v17, 5, v0
    v_lshl_add_u32 v16, v17, 10, v16
    v_bfe_u32 v17, v0, 2, 2
    v_lshl_add_u32 v16, v17, 7, v16
    v_and_b32 v17, 3, v0
    v_lshl_add_u32 v16, v17, 4, v16
    v_bfe_u32 v17, v0, 3, 1
    v_lshl_add_u32 v1, v17, 6, v16
    v_xor_b32 v2, 64, v1
    v_lshrrev_b32 v17, 4, v0
    v_lshlrev_b32 v17, 5, v17
    v_add_u32 v7, 147968, v17
    v_and_b32 v16, 15, v0
    v_lshlrev_b32 v16, 7, v16
    v_bfe_u32 v17, v0, 1, 3
    v_lshlrev_b32 v17, 4, v17
    v_add_u32 v16, v16, v17
    v_and_b32 v17, 48, v0
    v_xor_b32 v16, v16, v17
    v_add_u32 v5, 98816, v16
    v_xor_b32 v16, 64, v16
    v_add_u32 v6, 98816, v16
    s_lshl_b32 s3, s2, 2
    s_add_u32 s3, s3, s32
    s_mul_i32 s48, s3, 3277
    s_lshr_b32 s48, s48, 16
    s_mul_i32 s49, s48, 20
    s_sub_u32 s41, s3, s49
    s_mul_i32 s49, s48, 163840
    s_lshl_b32 s44, s41, 6
    s_add_u32 s49, s49, s44
    s_add_u32 s84, s96, s49
    s_addc_u32 s85, s97, 0
    s_sub_u32 s44, 163840, s44
    s_cmp_lt_u32 s3, 960
    s_cselect_b32 s86, s44, 0
    s_cselect_b32 s90, 31744, 0
    s_mov_b32 s94, s90
    s_mov_b32 s87, 0x00020000
    s_mov_b32 s91, 0x00020000
    s_mov_b32 s95, 0x00020000
    s_mul_i32 s44, s41, 13108
    s_lshr_b32 s44, s44, 16
    s_mul_i32 s49, s44, 1955840
    s_lshl_b32 s41, s41, 11
    s_add_u32 s49, s49, s41
    s_mul_i32 s48, s48, 40960
    s_add_u32 s49, s49, s48
    s_add_u32 s49, s49, 75497472
    s_add_u32 s88, s10, s49
    s_addc_u32 s89, s11, 0
    s_add_u32 s92, s88, 1024
    s_addc_u32 s93, s89, 0
    s_mov_b32 s54, 40960
    s_movk_i32 s55, 10240
    s_movk_i32 s56, 20480
    s_mov_b32 s64, s98
    s_mov_b32 s65, s99
    s_movk_i32 s74, 1280
    s_sub_u32 s41, s3, 0
    s_movk_i32 s42, 20
    s_movk_i32 s43, 3277
    s_movk_i32 s44, 5
    s_mov_b32 s45, 13108
    s_movk_i32 s46, 48
    s_movk_i32 s73, 5120
    s_mov_b32 s47, 88080384
    s_cmp_lt_u32 s3, 320
    s_cbranch_scc1 K2rp_c
    s_mov_b32 s64, s4
    s_mov_b32 s65, s5
    s_movk_i32 s74, 3072
    s_sub_u32 s41, s3, 320
    s_movk_i32 s42, 48
    s_movk_i32 s43, 1366
    s_movk_i32 s44, 2
    s_mov_b32 s45, 32769
    s_movk_i32 s46, 20
    s_movk_i32 s73, 4096
    s_mov_b32 s47, 83886080
    s_cmp_lt_u32 s3, 656
    s_cbranch_scc1 K2rp_c
    s_mov_b32 s64, s6
    s_mov_b32 s65, s7
    s_sub_u32 s41, s3, 656
    s_mov_b32 s47, 83888128
K2rp_c:
    s_mul_i32 s48, s41, s43
    s_lshr_b32 s48, s48, 16
    s_mul_i32 s49, s48, s42
    s_sub_u32 s41, s41, s49
    s_mul_i32 s48, s48, 3
    s_sub_i32 s42, s46, s48
    s_max_i32 s42, s42, 0
    s_min_i32 s42, s42, 3
    s_lshl_b32 s72, s74, 5
    s_mul_i32 s49, s48, s72
    s_lshl_b32 s43, s41, 6
    s_add_u32 s49, s49, s43
    s_add_u32 s64, s64, s49
    s_addc_u32 s65, s65, 0
    s_mul_i32 s49, s42, s72
    s_sub_i32 s49, s49, s43
    s_max_i32 s66, s49, 0
    s_mul_i32 s48, s48, s73
    s_add_u32 s47, s47, s48
    s_mul_i32 s46, s46, s73
    s_mul_i32 s42, s42, s73
    s_sub_i32 s42, s42, s73
    s_add_i32 s42, s42, 1024
    s_max_i32 s71, s42, 0
    s_lshl_b32 s41, s41, 1
    s_mul_i32 s48, s41, s45
    s_lshr_b32 s48, s48, 16
    s_mul_i32 s49, s48, s44
    s_sub_u32 s49, s41, s49
    s_lshl_b32 s49, s49, 10
    s_mul_i32 s48, s48, s46
    s_add_u32 s49, s49, s48
    s_add_u32 s49, s49, s47
    s_add_u32 s67, s10, s49
    s_addc_u32 s68, s11, 0
    s_add_u32 s41, s41, 1
    s_mul_i32 s48, s41, s45
    s_lshr_b32 s48, s48, 16
    s_mul_i32 s49, s48, s44
    s_sub_u32 s49, s41, s49
    s_lshl_b32 s49, s49, 10
    s_mul_i32 s48, s48, s46
    s_add_u32 s49, s49, s48
    s_add_u32 s49, s49, s47
    s_add_u32 s69, s10, s49
    s_addc_u32 s70, s11, 0
    s_add_u32 s41, s41, 1
    s_lshl_b32 s74, s74, 4
    s_mov_b32 s57, 0
    s_mov_b32 s58, 0
    s_lshl_b32 s59, s32, 11
    s_add_u32 s59, s59, 151040
    v_lshrrev_b32 v16, 2, v0
    v_mul_u32_u24 v16, 1280, v16
    v_and_b32 v17, 3, v0
    v_lshl_add_u32 v0, v17, 4, v16
    s_and_b32 s75, s2, 15
    s_lshl_b32 s75, s75, 8
    s_lshl_b32 s46, s32, 10
    s_add_u32 s44, s46, 98816
    s_add_u32 s45, s46, 49408
    s_mov_b32 s42, 0
    s_mov_b32 s43, 0
    s_mov_b32 s41, 2
    s_add_u32 s96, s10, 262144
    s_addc_u32 s97, s11, 0
    s_mov_b32 s98, 61440
    s_mov_b32 s99, 0x00020000
    s_mov_b32 s4, 15360
    s_mov_b32 s5, 30720
    s_mov_b32 s6, 46080
    v_accvgpr_write_b32 a64, 0
    v_accvgpr_write_b32 a65, 0
    v_accvgpr_write_b32 a66, 0
    v_accvgpr_write_b32 a67, 0
    v_accvgpr_write_b32 a68, 0
    v_accvgpr_write_b32 a69, 0
    v_accvgpr_write_b32 a70, 0
    v_accvgpr_write_b32 a71, 0
    v_accvgpr_write_b32 a72, 0
    v_accvgpr_write_b32 a73, 0
    v_accvgpr_write_b32 a74, 0
    v_accvgpr_write_b32 a75, 0
    v_accvgpr_write_b32 a76, 0
    v_accvgpr_write_b32 a77, 0
    v_accvgpr_write_b32 a78, 0
    v_accvgpr_write_b32 a79, 0
    v_accvgpr_write_b32 a80, 0
    v_accvgpr_write_b32 a81, 0
    v_accvgpr_write_b32 a82, 0
    v_accvgpr_write_b32 a83, 0
    v_accvgpr_write_b32 a84, 0
    v_accvgpr_write_b32 a85, 0
    v_accvgpr_write_b32 a86, 0
    v_accvgpr_write_b32 a87, 0
    v_accvgpr_write_b32 a88, 0
    v_accvgpr_write_b32 a89, 0
    v_accvgpr_write_b32 a90, 0
    v_accvgpr_write_b32 a91, 0
    v_accvgpr_write_b32 a92, 0
    v_accvgpr_write_b32 a93, 0
    v_accvgpr_write_b32 a94, 0
    v_accvgpr_write_b32 a95, 0
    v_accvgpr_write_b32 a32, 0
    v_accvgpr_write_b32 a33, 0
    v_accvgpr_write_b32 a34, 0
    v_accvgpr_write_b32 a35, 0
    v_accvgpr_write_b32 a36, 0
    v_accvgpr_write_b32 a37, 0
    v_accvgpr_write_b32 a38, 0
    v_accvgpr_write_b32 a39, 0
    v_accvgpr_write_b32 a40, 0
    v_accvgpr_write_b32 a41, 0
    v_accvgpr_write_b32 a42, 0
    v_accvgpr_write_b32 a43, 0
    v_accvgpr_write_b32 a44, 0
    v_accvgpr_write_b32 a45, 0
    v_accvgpr_write_b32 a46, 0
    v_accvgpr_write_b32 a47, 0
    v_accvgpr_write_b32 a192, 0
    v_accvgpr_write_b32 a193, 0
    v_accvgpr_write_b32 a194, 0
    v_accvgpr_write_b32 a195, 0
    v_accvgpr_write_b32 a196, 0
    v_accvgpr_write_b32 a197, 0
    v_accvgpr_write_b32 a198, 0
    v_accvgpr_write_b32 a199, 0
    v_accvgpr_write_b32 a200, 0
    v_accvgpr_write_b32 a201, 0
    v_accvgpr_write_b32 a202, 0
    v_accvgpr_write_b32 a203, 0
    v_accvgpr_write_b32 a204, 0
    v_accvgpr_write_b32 a205, 0
    v_accvgpr_write_b32 a206, 0
    v_accvgpr_write_b32 a207, 0
    v_accvgpr_write_b32 a208, 0
    v_accvgpr_write_b32 a209, 0
    v_accvgpr_write_b32 a210, 0
    v_accvgpr_write_b32 a211, 0
    v_accvgpr_write_b32 a212, 0
    v_accvgpr_write_b32 a213, 0
    v_accvgpr_write_b32 a214, 0
    v_accvgpr_write_b32 a215, 0
    v_accvgpr_write_b32 a216, 0
    v_accvgpr_write_b32 a217, 0
    v_accvgpr_write_b32 a218, 0
    v_accvgpr_write_b32 a219, 0
    v_accvgpr_write_b32 a220, 0
    v_accvgpr_write_b32 a221, 0
    v_accvgpr_write_b32 a222, 0
    v_accvgpr_write_b32 a223, 0
    v_accvgpr_write_b32 a224, 0
    v_accvgpr_write_b32 a225, 0
    v_accvgpr_write_b32 a226, 0
    v_accvgpr_write_b32 a227, 0
    v_accvgpr_write_b32 a228, 0
    v_accvgpr_write_b32 a229, 0
    v_accvgpr_write_b32 a230, 0
    v_accvgpr_write_b32 a231, 0
    v_accvgpr_write_b32 a232, 0
    v_accvgpr_write_b32 a233, 0
    v_accvgpr_write_b32 a234, 0
    v_accvgpr_write_b32 a235, 0
    v_accvgpr_write_b32 a236, 0
    v_accvgpr_write_b32 a237, 0
    v_accvgpr_write_b32 a238, 0
    v_accvgpr_write_b32 a239, 0
    v_accvgpr_write_b32 a240, 0
    v_accvgpr_write_b32 a241, 0
    v_accvgpr_write_b32 a242, 0
    v_accvgpr_write_b32 a243, 0
    v_accvgpr_write_b32 a244, 0
    v_accvgpr_write_b32 a245, 0
    v_accvgpr_write_b32 a246, 0
    v_accvgpr_write_b32 a247, 0
    v_accvgpr_write_b32 a248, 0
    v_accvgpr_write_b32 a249, 0
    v_accvgpr_write_b32 a250, 0
    v_accvgpr_write_b32 a251, 0
    v_accvgpr_write_b32 a252, 0
    v_accvgpr_write_b32 a253, 0
    v_accvgpr_write_b32 a254, 0
    v_accvgpr_write_b32 a255, 0
    s_waitcnt vmcnt(0)
    v_cmp_gt_u32 vcc, v95, v89
    s_cbranch_vccnz P0M_spin
P0M_ok:
    buffer_load_dwordx4 v[16:19], v12, s[96:99], 0 offen offset:0 sc1
    buffer_load_dwordx4 v[20:23], v12, s[96:99], 0 offen offset:2560 sc1
    buffer_load_dwordx4 v[72:75], v12, s[96:99], s4 offen offset:0 sc1
    buffer_load_dwordx4 v[76:79], v12, s[96:99], s4 offen offset:2560 sc1
    buffer_load_dwordx4 v[80:83], v12, s[96:99], s5 offen offset:0 sc1
    buffer_load_dwordx4 v[84:87], v12, s[96:99], s5 offen offset:2560 sc1
    buffer_load_dwordx4 v[64:67], v12, s[96:99], s6 offen offset:0 sc1
    buffer_load_dwordx4 v[68:71], v12, s[96:99], s6 offen offset:2560 sc1
    v_cmp_eq_u32 vcc, 0, v89
    s_cbranch_vccnz P0X_spin
P0X_ok:
    buffer_load_dwordx4 v[24:27], v8, s[24:27], s36 offen offset:0 sc1
    buffer_load_dwordx4 v[28:31], v8, s[24:27], s37 offen offset:0 sc1
    buffer_load_dwordx4 v[32:35], v8, s[24:27], s38 offen offset:0 sc1
    buffer_load_dwordx4 v[36:39], v8, s[24:27], s39 offen offset:0 sc1
    buffer_load_dwordx4 v[40:43], v8, s[24:27], s36 offen offset:1024 sc1
    buffer_load_dwordx4 v[44:47], v8, s[24:27], s37 offen offset:1024 sc1
    buffer_load_dwordx4 v[48:51], v8, s[24:27], s38 offen offset:1024 sc1
    buffer_load_dwordx4 v[52:55], v8, s[24:27], s39 offen offset:1024 sc1
    s_mov_b64 s[96:97], s[8:9]
    s_sub_u32 s3, s2, 80
    s_sub_u32 s98, 4915200, s61
    s_cmp_lt_u32 s3, 160
    s_cselect_b32 s98, s98, 0
    v_mov_b32 v12, 0x3dd53b95
    s_waitcnt vmcnt(12)
    v_pk_add_f32 v[16:17], v[16:17], v[72:73]
    v_pk_add_f32 v[18:19], v[18:19], v[74:75]
    v_pk_add_f32 v[20:21], v[20:21], v[76:77]
    v_pk_add_f32 v[22:23], v[22:23], v[78:79]
    s_waitcnt vmcnt(8)
    v_pk_add_f32 v[80:81], v[80:81], v[64:65]
    v_pk_add_f32 v[82:83], v[82:83], v[66:67]
    v_pk_add_f32 v[84:85], v[84:85], v[68:69]
    v_pk_add_f32 v[86:87], v[86:87], v[70:71]
    buffer_load_dwordx4 v[56:59], v8, s[24:27], s36 offen offset:2048 sc1
    buffer_load_dwordx4 v[60:63], v8, s[24:27], s37 offen offset:2048 sc1
    buffer_load_dwordx4 v[64:67], v8, s[24:27], s38 offen offset:2048 sc1
    buffer_load_dwordx4 v[68:71], v8, s[24:27], s39 offen offset:2048 sc1
    s_and_b32 s3, s2, 31
    s_lshr_b32 s46, s3, 1
    s_and_b32 s47, s3, 1
    s_mul_i32 s47, s47, 40960
    s_lshl_b32 s48, s46, 10
    s_add_u32 s47, s47, s48
    s_add_u32 s47, s47, 7168
    s_cmp_lt_u32 s3, 26
    s_cselect_b32 s47, s47, 0x40000000
    s_cselect_b32 s46, s46, 0
    s_add_u32 s48, s47, 20480
    s_lshl_b32 s46, s46, 7
    buffer_load_dwordx4 v[88:91], v8, s[24:27], s47 offen sc1
    buffer_load_dwordx4 v[92:95], v8, s[24:27], s48 offen sc1
    v_add_u32 v3, s46, v7
    v_pk_add_f32 v[16:17], v[16:17], v[80:81]
    v_pk_add_f32 v[18:19], v[18:19], v[82:83]
    v_pk_add_f32 v[20:21], v[20:21], v[84:85]
    v_pk_add_f32 v[22:23], v[22:23], v[86:87]
    v_cvt_pk_bf16_f32 v16, 0, v16
    v_cvt_pk_bf16_f32 v17, 0, v17
    v_cvt_pk_bf16_f32 v18, 0, v18
    v_cvt_pk_bf16_f32 v19, 0, v19
    v_cvt_pk_bf16_f32 v20, 0, v20
    v_cvt_pk_bf16_f32 v21, 0, v21
    v_cvt_pk_bf16_f32 v22, 0, v22
    v_cvt_pk_bf16_f32 v23, 0, v23
    v_add_f32 v20, 1.0, v20
    v_add_f32 v21, 1.0, v21
    v_add_f32 v22, 1.0, v22
    v_add_f32 v23, 1.0, v23
    v_cvt_pk_bf16_f32 v20, 0, v20
    v_cvt_pk_bf16_f32 v21, 0, v21
    v_cvt_pk_bf16_f32 v22, 0, v22
    v_cvt_pk_bf16_f32 v23, 0, v23
    v_pk_mul_f32 v[16:17], v[16:17], v[12:13] op_sel_hi:[1,0]
    v_pk_mul_f32 v[18:19], v[18:19], v[12:13] op_sel_hi:[1,0]
    v_pk_mul_f32 v[20:21], v[20:21], v[12:13] op_sel_hi:[1,0]
    v_pk_mul_f32 v[22:23], v[22:23], v[12:13] op_sel_hi:[1,0]
    v_cvt_pk_f16_f32 v72, v20, v21
    v_cvt_pk_f16_f32 v73, v22, v23
    v_cvt_pk_f16_f32 v74, v16, v17
    v_cvt_pk_f16_f32 v75, v18, v19
    ds_write_b128 v14, v[72:75]
    s_waitcnt lgkmcnt(0)
    s_barrier
    ds_read_b128 v[16:19], v7 offset:0
    ds_read_b128 v[20:23], v7 offset:16
    s_waitcnt vmcnt(10) lgkmcnt(1)
    v_fma_mix_f32 v12, v24, v16, v18 op_sel_hi:[1,1,1]
    v_fma_mix_f32 v13, v24, v16, v18 op_sel:[1,1,1] op_sel_hi:[1,1,1]
    v_cvt_pk_bf16_f32 v24, v12, v13
    v_fma_mix_f32 v14, v28, v16, v18 op_sel_hi:[1,1,1]
    v_fma_mix_f32 v15, v28, v16, v18 op_sel:[1,1,1] op_sel_hi:[1,1,1]
    v_cvt_pk_bf16_f32 v28, v14, v15
    v_fma_mix_f32 v12, v32, v16, v18 op_sel_hi:[1,1,1]
    v_fma_mix_f32 v13, v32, v16, v18 op_sel:[1,1,1] op_sel_hi:[1,1,1]
    v_cvt_pk_bf16_f32 v32, v12, v13
    v_fma_mix_f32 v14, v36, v16, v18 op_sel_hi:[1,1,1]
    v_fma_mix_f32 v15, v36, v16, v18 op_sel:[1,1,1] op_sel_hi:[1,1,1]
    v_cvt_pk_bf16_f32 v36, v14, v15
    v_fma_mix_f32 v12, v25, v17, v19 op_sel_hi:[1,1,1]
    v_fma_mix_f32 v13, v25, v17, v19 op_sel:[1,1,1] op_sel_hi:[1,1,1]
    v_cvt_pk_bf16_f32 v25, v12, v13
    v_fma_mix_f32 v14, v29, v17, v19 op_sel_hi:[1,1,1]
    v_fma_mix_f32 v15, v29, v17, v19 op_sel:[1,1,1] op_sel_hi:[1,1,1]
    v_cvt_pk_bf16_f32 v29, v14, v15
    v_fma_mix_f32 v12, v33, v17, v19 op_sel_hi:[1,1,1]
    v_fma_mix_f32 v13, v33, v17, v19 op_sel:[1,1,1] op_sel_hi:[1,1,1]
    v_cvt_pk_bf16_f32 v33, v12, v13
    v_fma_mix_f32 v14, v37, v17, v19 op_sel_hi:[1,1,1]
    v_fma_mix_f32 v15, v37, v17, v19 op_sel:[1,1,1] op_sel_hi:[1,1,1]
    v_cvt_pk_bf16_f32 v37, v14, v15
    ds_read_b128 v[16:19], v7 offset:128
    s_waitcnt lgkmcnt(1)
    ds_read_b64_tr_b16 a[0:1], v1 offset:0
    ds_read_b64_tr_b16 a[2:3], v1 offset:512
    ds_read_b64_tr_b16 a[4:5], v1 offset:8
    ds_read_b64_tr_b16 a[6:7], v1 offset:520
    ds_read_b64_tr_b16 a[8:9], v2 offset:0
    ds_read_b64_tr_b16 a[10:11], v2 offset:512
    ds_read_b64_tr_b16 a[12:13], v2 offset:8
    ds_read_b64_tr_b16 a[14:15], v2 offset:520
    v_fma_mix_f32 v12, v26, v20, v22 op_sel_hi:[1,1,1]
    v_fma_mix_f32 v13, v26, v20, v22 op_sel:[1,1,1] op_sel_hi:[1,1,1]
    v_cvt_pk_bf16_f32 v26, v12, v13
    v_fma_mix_f32 v14, v30, v20, v22 op_sel_hi:[1,1,1]
    v_fma_mix_f32 v15, v30, v20, v22 op_sel:[1,1,1] op_sel_hi:[1,1,1]
    v_cvt_pk_bf16_f32 v30, v14, v15
    v_fma_mix_f32 v12, v34, v20, v22 op_sel_hi:[1,1,1]
    v_fma_mix_f32 v13, v34, v20, v22 op_sel:[1,1,1] op_sel_hi:[1,1,1]
    v_cvt_pk_bf16_f32 v34, v12, v13
    v_fma_mix_f32 v14, v38, v20, v22 op_sel_hi:[1,1,1]
    v_fma_mix_f32 v15, v38, v20, v22 op_sel:[1,1,1] op_sel_hi:[1,1,1]
    v_cvt_pk_bf16_f32 v38, v14, v15
    v_fma_mix_f32 v12, v27, v21, v23 op_sel_hi:[1,1,1]
    v_fma_mix_f32 v13, v27, v21, v23 op_sel:[1,1,1] op_sel_hi:[1,1,1]
    v_cvt_pk_bf16_f32 v27, v12, v13
    v_fma_mix_f32 v14, v31, v21, v23 op_sel_hi:[1,1,1]
    v_fma_mix_f32 v15, v31, v21, v23 op_sel:[1,1,1] op_sel_hi:[1,1,1]
    v_cvt_pk_bf16_f32 v31, v14, v15
    v_fma_mix_f32 v12, v35, v21, v23 op_sel_hi:[1,1,1]
    v_fma_mix_f32 v13, v35, v21, v23 op_sel:[1,1,1] op_sel_hi:[1,1,1]
    v_cvt_pk_bf16_f32 v35, v12, v13
    v_fma_mix_f32 v14, v39, v21, v23 op_sel_hi:[1,1,1]
    v_fma_mix_f32 v15, v39, v21, v23 op_sel:[1,1,1] op_sel_hi:[1,1,1]
    v_cvt_pk_bf16_f32 v39, v14, v15
    ds_read_b128 v[20:23], v7 offset:144
    s_waitcnt lgkmcnt(7)
    v_mfma_f32_16x16x32_bf16 v[96:99], a[0:3], v[24:27], v[96:99]
    ds_read_b64_tr_b16 a[16:17], v1 offset:2048
    ds_read_b128 v[80:83], v3 offset:896
    ds_read_b128 v[84:87], v3 offset:912
    s_waitcnt vmcnt(6)
    v_mfma_f32_16x16x32_bf16 v[104:107], a[0:3], v[28:31], v[104:107]
    buffer_load_dwordx4 v[72:75], v8, s[24:27], s36 offen offset:3072 sc1
    v_mfma_f32_16x16x32_bf16 v[112:115], a[0:3], v[32:35], v[112:115]
    ds_read_b64_tr_b16 a[18:19], v1 offset:2560
    v_fma_mix_f32 v12, v40, v16, v18 op_sel_hi:[1,1,1]
    v_fma_mix_f32 v13, v40, v16, v18 op_sel:[1,1,1] op_sel_hi:[1,1,1]
    v_mfma_f32_16x16x32_bf16 v[120:123], a[0:3], v[36:39], v[120:123]
    v_cvt_pk_bf16_f32 v40, v12, v13
    v_fma_mix_f32 v14, v44, v16, v18 op_sel_hi:[1,1,1]
    s_waitcnt lgkmcnt(9)
    v_mfma_f32_16x16x32_bf16 v[100:103], a[4:7], v[24:27], v[100:103]
    ds_read_b64_tr_b16 a[20:21], v1 offset:2056
    v_fma_mix_f32 v15, v44, v16, v18 op_sel:[1,1,1] op_sel_hi:[1,1,1]
    v_cvt_pk_bf16_f32 v44, v14, v15
    v_mfma_f32_16x16x32_bf16 v[108:111], a[4:7], v[28:31], v[108:111]
    v_fma_mix_f32 v12, v48, v16, v18 op_sel_hi:[1,1,1]
    v_fma_mix_f32 v13, v48, v16, v18 op_sel:[1,1,1] op_sel_hi:[1,1,1]
    v_mfma_f32_16x16x32_bf16 v[116:119], a[4:7], v[32:35], v[116:119]
    ds_read_b64_tr_b16 a[22:23], v1 offset:2568
    s_add_u32 m0, s40, 0
    v_cvt_pk_bf16_f32 v48, v12, v13
    v_fma_mix_f32 v14, v52, v16, v18 op_sel_hi:[1,1,1]
    v_mfma_f32_16x16x32_bf16 v[124:127], a[4:7], v[36:39], v[124:127]
    buffer_load_dwordx4 v9, s[12:15], s35 offen offset:0 nt lds
    v_fma_mix_f32 v15, v52, v16, v18 op_sel:[1,1,1] op_sel_hi:[1,1,1]
    s_waitcnt lgkmcnt(9)
    v_mfma_f32_16x16x32_bf16 v[128:131], a[8:11], v[24:27], v[128:131]
    ds_read_b64_tr_b16 a[24:25], v2 offset:2048
    v_cvt_pk_bf16_f32 v52, v14, v15
    v_mfma_f32_16x16x32_bf16 v[136:139], a[8:11], v[28:31], v[136:139]
    v_fma_mix_f32 v12, v41, v17, v19 op_sel_hi:[1,1,1]
    v_fma_mix_f32 v13, v41, v17, v19 op_sel:[1,1,1] op_sel_hi:[1,1,1]
    v_cvt_pk_bf16_f32 v41, v12, v13
    v_mfma_f32_16x16x32_bf16 v[144:147], a[8:11], v[32:35], v[144:147]
    ds_read_b64_tr_b16 a[26:27], v2 offset:2560
    v_fma_mix_f32 v14, v45, v17, v19 op_sel_hi:[1,1,1]
    v_mfma_f32_16x16x32_bf16 v[152:155], a[8:11], v[36:39], v[152:155]
    v_fma_mix_f32 v15, v45, v17, v19 op_sel:[1,1,1] op_sel_hi:[1,1,1]
    v_cvt_pk_bf16_f32 v45, v14, v15
    v_fma_mix_f32 v12, v49, v17, v19 op_sel_hi:[1,1,1]
    s_waitcnt lgkmcnt(9)
    v_mfma_f32_16x16x32_bf16 v[132:135], a[12:15], v[24:27], v[132:135]
    ds_read_b64_tr_b16 a[28:29], v2 offset:2056
    v_fma_mix_f32 v13, v49, v17, v19 op_sel:[1,1,1] op_sel_hi:[1,1,1]
    v_mfma_f32_16x16x32_bf16 v[140:143], a[12:15], v[28:31], v[140:143]
    buffer_load_dwordx4 v[76:79], v8, s[24:27], s37 offen offset:3072 sc1
    v_cvt_pk_bf16_f32 v49, v12, v13
    v_mfma_f32_16x16x32_bf16 v[148:151], a[12:15], v[32:35], v[148:151]
    ds_read_b64_tr_b16 a[30:31], v2 offset:2568
    v_fma_mix_f32 v14, v53, v17, v19 op_sel_hi:[1,1,1]
    v_mfma_f32_16x16x32_bf16 v[156:159], a[12:15], v[36:39], v[156:159]
    v_fma_mix_f32 v15, v53, v17, v19 op_sel:[1,1,1] op_sel_hi:[1,1,1]
    v_cvt_pk_bf16_f32 v53, v14, v15
    ds_read_b128 v[16:19], v7 offset:256
    s_waitcnt vmcnt(3) lgkmcnt(7)
    v_mfma_f32_16x16x32_bf16 v[160:163], a[16:19], v[24:27], v[160:163]
    ds_read_b64_tr_b16 a[0:1], v1 offset:4096
    v_fma_mix_f32 v12, v88, v80, v82 op_sel_hi:[1,1,1]
    v_fma_mix_f32 v13, v88, v80, v82 op_sel:[1,1,1] op_sel_hi:[1,1,1]
    v_mfma_f32_16x16x32_bf16 v[168:171], a[16:19], v[28:31], v[168:171]
    v_cvt_pk_bf16_f32 v88, v12, v13
    v_fma_mix_f32 v14, v92, v80, v82 op_sel_hi:[1,1,1]
    v_mfma_f32_16x16x32_bf16 v[176:179], a[16:19], v[32:35], v[176:179]
    ds_read_b64_tr_b16 a[2:3], v1 offset:4608
    s_add_u32 m0, s40, 1920
    v_fma_mix_f32 v15, v92, v80, v82 op_sel:[1,1,1] op_sel_hi:[1,1,1]
    v_cvt_pk_bf16_f32 v92, v14, v15
    v_mfma_f32_16x16x32_bf16 v[184:187], a[16:19], v[36:39], v[184:187]
    buffer_load_dwordx4 v9, s[12:15], s35 offen offset:128 nt lds
    s_waitcnt lgkmcnt(7)
    v_mfma_f32_16x16x32_bf16 v[164:167], a[20:23], v[24:27], v[164:167]
    ds_read_b64_tr_b16 a[4:5], v1 offset:4104
    v_fma_mix_f32 v12, v89, v81, v83 op_sel_hi:[1,1,1]
    v_fma_mix_f32 v13, v89, v81, v83 op_sel:[1,1,1] op_sel_hi:[1,1,1]
    v_mfma_f32_16x16x32_bf16 v[172:175], a[20:23], v[28:31], v[172:175]
    v_cvt_pk_bf16_f32 v89, v12, v13
    v_fma_mix_f32 v14, v93, v81, v83 op_sel_hi:[1,1,1]
    v_mfma_f32_16x16x32_bf16 v[180:183], a[20:23], v[32:35], v[180:183]
    ds_read_b64_tr_b16 a[6:7], v1 offset:4616
    v_fma_mix_f32 v15, v93, v81, v83 op_sel:[1,1,1] op_sel_hi:[1,1,1]
    v_cvt_pk_bf16_f32 v93, v14, v15
    v_mfma_f32_16x16x32_bf16 v[188:191], a[20:23], v[36:39], v[188:191]
    v_fma_mix_f32 v12, v90, v84, v86 op_sel_hi:[1,1,1]
    v_fma_mix_f32 v13, v90, v84, v86 op_sel:[1,1,1] op_sel_hi:[1,1,1]
    v_cvt_pk_bf16_f32 v90, v12, v13
    s_waitcnt lgkmcnt(7)
    v_mfma_f32_16x16x32_bf16 v[192:195], a[24:27], v[24:27], v[192:195]
    ds_read_b64_tr_b16 a[8:9], v2 offset:4096
    v_fma_mix_f32 v14, v94, v84, v86 op_sel_hi:[1,1,1]
    v_mfma_f32_16x16x32_bf16 v[200:203], a[24:27], v[28:31], v[200:203]
    v_fma_mix_f32 v15, v94, v84, v86 op_sel:[1,1,1] op_sel_hi:[1,1,1]
    v_cvt_pk_bf16_f32 v94, v14, v15
    v_fma_mix_f32 v12, v91, v85, v87 op_sel_hi:[1,1,1]
    v_mfma_f32_16x16x32_bf16 v[208:211], a[24:27], v[32:35], v[208:211]
    ds_read_b64_tr_b16 a[10:11], v2 offset:4608
    v_fma_mix_f32 v13, v91, v85, v87 op_sel:[1,1,1] op_sel_hi:[1,1,1]
    v_mfma_f32_16x16x32_bf16 v[216:219], a[24:27], v[36:39], v[216:219]
    v_cvt_pk_bf16_f32 v91, v12, v13
    v_fma_mix_f32 v14, v95, v85, v87 op_sel_hi:[1,1,1]
    v_fma_mix_f32 v15, v95, v85, v87 op_sel:[1,1,1] op_sel_hi:[1,1,1]
    s_waitcnt lgkmcnt(7)
    v_mfma_f32_16x16x32_bf16 v[196:199], a[28:31], v[24:27], v[196:199]
    ds_read_b64_tr_b16 a[12:13], v2 offset:4104
    v_cvt_pk_bf16_f32 v95, v14, v15
    v_mfma_f32_16x16x32_bf16 v[204:207], a[28:31], v[28:31], v[204:207]
    buffer_store_dwordx4 v[88:91], v8, s[24:27], s47 offen sc1
    v_mfma_f32_16x16x32_bf16 v[212:215], a[28:31], v[32:35], v[212:215]
    ds_read_b64_tr_b16 a[14:15], v2 offset:4616
    s_add_u32 m0, s40, 3840
    buffer_store_dwordx4 v[92:95], v8, s[24:27], s48 offen sc1
    v_mfma_f32_16x16x32_bf16 v[220:223], a[28:31], v[36:39], v[220:223]
    buffer_load_dwordx4 v9, s[12:15], s35 offen offset:256 nt lds
    s_add_u32 s35, s35, 393216
    v_fma_mix_f32 v12, v42, v20, v22 op_sel_hi:[1,1,1]
    s_waitcnt lgkmcnt(6)
    v_mfma_f32_16x16x32_bf16 v[224:227], a[0:3], v[24:27], v[224:227]
    ds_read_b64_tr_b16 a[16:17], v1 offset:6144
    v_fma_mix_f32 v13, v42, v20, v22 op_sel:[1,1,1] op_sel_hi:[1,1,1]
    v_cvt_pk_bf16_f32 v42, v12, v13
    v_mfma_f32_16x16x32_bf16 v[232:235], a[0:3], v[28:31], v[232:235]
    v_fma_mix_f32 v14, v46, v20, v22 op_sel_hi:[1,1,1]
    v_fma_mix_f32 v15, v46, v20, v22 op_sel:[1,1,1] op_sel_hi:[1,1,1]
    v_mfma_f32_16x16x32_bf16 v[240:243], a[0:3], v[32:35], v[240:243]
    ds_read_b64_tr_b16 a[18:19], v1 offset:6656
    v_cvt_pk_bf16_f32 v46, v14, v15
    v_fma_mix_f32 v12, v50, v20, v22 op_sel_hi:[1,1,1]
    v_mfma_f32_16x16x32_bf16 v[248:251], a[0:3], v[36:39], v[248:251]
    v_fma_mix_f32 v13, v50, v20, v22 op_sel:[1,1,1] op_sel_hi:[1,1,1]
    v_cvt_pk_bf16_f32 v50, v12, v13
    s_waitcnt lgkmcnt(6)
    v_mfma_f32_16x16x32_bf16 v[228:231], a[4:7], v[24:27], v[228:231]
    ds_read_b64_tr_b16 a[20:21], v1 offset:6152
    v_fma_mix_f32 v14, v54, v20, v22 op_sel_hi:[1,1,1]
    v_fma_mix_f32 v15, v54, v20, v22 op_sel:[1,1,1] op_sel_hi:[1,1,1]
    v_mfma_f32_16x16x32_bf16 v[236:239], a[4:7], v[28:31], v[236:239]
    v_cvt_pk_bf16_f32 v54, v14, v15
    v_fma_mix_f32 v12, v43, v21, v23 op_sel_hi:[1,1,1]
    v_mfma_f32_16x16x32_bf16 v[244:247], a[4:7], v[32:35], v[244:247]
    ds_read_b64_tr_b16 a[22:23], v1 offset:6664
    v_fma_mix_f32 v13, v43, v21, v23 op_sel:[1,1,1] op_sel_hi:[1,1,1]
    v_cvt_pk_bf16_f32 v43, v12, v13
    v_mfma_f32_16x16x32_bf16 v[252:255], a[4:7], v[36:39], v[252:255]
    v_fma_mix_f32 v14, v47, v21, v23 op_sel_hi:[1,1,1]
    v_fma_mix_f32 v15, v47, v21, v23 op_sel:[1,1,1] op_sel_hi:[1,1,1]
    v_cvt_pk_bf16_f32 v47, v14, v15
    s_waitcnt lgkmcnt(6)
    v_mfma_f32_16x16x32_bf16 a[64:67], a[8:11], v[24:27], a[64:67]
    ds_read_b64_tr_b16 a[24:25], v2 offset:6144
    v_fma_mix_f32 v12, v51, v21, v23 op_sel_hi:[1,1,1]
    v_mfma_f32_16x16x32_bf16 a[72:75], a[8:11], v[28:31], a[72:75]
    buffer_load_dwordx4 v[80:83], v8, s[24:27], s38 offen offset:3072 sc1
    v_fma_mix_f32 v13, v51, v21, v23 op_sel:[1,1,1] op_sel_hi:[1,1,1]
    v_mfma_f32_16x16x32_bf16 a[80:83], a[8:11], v[32:35], a[80:83]
    ds_read_b64_tr_b16 a[26:27], v2 offset:6656
    s_add_u32 m0, s40, 6144
    v_cvt_pk_bf16_f32 v51, v12, v13
    v_mfma_f32_16x16x32_bf16 a[88:91], a[8:11], v[36:39], a[88:91]
    buffer_load_dwordx4 v9, s[12:15], s35 offen offset:0 nt lds
    v_fma_mix_f32 v14, v55, v21, v23 op_sel_hi:[1,1,1]
    s_waitcnt lgkmcnt(6)
    v_mfma_f32_16x16x32_bf16 a[68:71], a[12:15], v[24:27], a[68:71]
    ds_read_b64_tr_b16 a[28:29], v2 offset:6152
    v_fma_mix_f32 v15, v55, v21, v23 op_sel:[1,1,1] op_sel_hi:[1,1,1]
    v_mfma_f32_16x16x32_bf16 a[76:79], a[12:15], v[28:31], a[76:79]
    buffer_load_dwordx4 v[84:87], v8, s[24:27], s39 offen offset:3072 sc1
    v_cvt_pk_bf16_f32 v55, v14, v15
    v_mfma_f32_16x16x32_bf16 a[84:87], a[12:15], v[32:35], a[84:87]
    ds_read_b64_tr_b16 a[30:31], v2 offset:6664
    v_mfma_f32_16x16x32_bf16 a[92:95], a[12:15], v[36:39], a[92:95]
    ds_read_b128 v[20:23], v7 offset:272
    s_waitcnt lgkmcnt(7)
    v_mfma_f32_16x16x32_bf16 v[96:99], a[16:19], v[40:43], v[96:99]
    ds_read_b64_tr_b16 a[0:1], v1 offset:8192
    v_fma_mix_f32 v12, v56, v16, v18 op_sel_hi:[1,1,1]
    v_mfma_f32_16x16x32_bf16 v[104:107], a[16:19], v[44:47], v[104:107]
    s_add_u32 s36, s36, 4096
    s_add_u32 s37, s37, 4096
    s_add_u32 s38, s38, 4096
    s_add_u32 s39, s39, 4096
    buffer_load_dwordx4 v[24:27], v8, s[24:27], s36 offen offset:0 sc1
    v_mfma_f32_16x16x32_bf16 v[112:115], a[16:19], v[48:51], v[112:115]
    ds_read_b64_tr_b16 a[2:3], v1 offset:8704
    v_fma_mix_f32 v13, v56, v16, v18 op_sel:[1,1,1] op_sel_hi:[1,1,1]
    v_mfma_f32_16x16x32_bf16 v[120:123], a[16:19], v[52:55], v[120:123]
    v_cvt_pk_bf16_f32 v56, v12, v13
    s_waitcnt lgkmcnt(7)
    v_mfma_f32_16x16x32_bf16 v[100:103], a[20:23], v[40:43], v[100:103]
    ds_read_b64_tr_b16 a[4:5], v1 offset:8200
    v_fma_mix_f32 v14, v60, v16, v18 op_sel_hi:[1,1,1]
    v_mfma_f32_16x16x32_bf16 v[108:111], a[20:23], v[44:47], v[108:111]
    v_fma_mix_f32 v15, v60, v16, v18 op_sel:[1,1,1] op_sel_hi:[1,1,1]
    v_cvt_pk_bf16_f32 v60, v14, v15
    v_mfma_f32_16x16x32_bf16 v[116:119], a[20:23], v[48:51], v[116:119]
    ds_read_b64_tr_b16 a[6:7], v1 offset:8712
    s_add_u32 m0, s40, 8064
    v_fma_mix_f32 v12, v64, v16, v18 op_sel_hi:[1,1,1]
    v_mfma_f32_16x16x32_bf16 v[124:127], a[20:23], v[52:55], v[124:127]
    buffer_load_dwordx4 v9, s[12:15], s35 offen offset:128 nt lds
    s_waitcnt lgkmcnt(7)
    v_mfma_f32_16x16x32_bf16 v[128:131], a[24:27], v[40:43], v[128:131]
    ds_read_b64_tr_b16 a[8:9], v2 offset:8192
    v_fma_mix_f32 v13, v64, v16, v18 op_sel:[1,1,1] op_sel_hi:[1,1,1]
    v_mfma_f32_16x16x32_bf16 v[136:139], a[24:27], v[44:47], v[136:139]
    v_cvt_pk_bf16_f32 v64, v12, v13
    v_mfma_f32_16x16x32_bf16 v[144:147], a[24:27], v[48:51], v[144:147]
    ds_read_b64_tr_b16 a[10:11], v2 offset:8704
    v_fma_mix_f32 v14, v68, v16, v18 op_sel_hi:[1,1,1]
    v_mfma_f32_16x16x32_bf16 v[152:155], a[24:27], v[52:55], v[152:155]
    v_fma_mix_f32 v15, v68, v16, v18 op_sel:[1,1,1] op_sel_hi:[1,1,1]
    v_cvt_pk_bf16_f32 v68, v14, v15
    s_waitcnt lgkmcnt(7)
    v_mfma_f32_16x16x32_bf16 v[132:135], a[28:31], v[40:43], v[132:135]
    ds_read_b64_tr_b16 a[12:13], v2 offset:8200
    v_fma_mix_f32 v12, v57, v17, v19 op_sel_hi:[1,1,1]
    v_mfma_f32_16x16x32_bf16 v[140:143], a[28:31], v[44:47], v[140:143]
    buffer_load_dwordx4 v[28:31], v8, s[24:27], s37 offen offset:0 sc1
    v_mfma_f32_16x16x32_bf16 v[148:151], a[28:31], v[48:51], v[148:151]
    ds_read_b64_tr_b16 a[14:15], v2 offset:8712
    v_fma_mix_f32 v13, v57, v17, v19 op_sel:[1,1,1] op_sel_hi:[1,1,1]
    v_mfma_f32_16x16x32_bf16 v[156:159], a[28:31], v[52:55], v[156:159]
    v_cvt_pk_bf16_f32 v57, v12, v13
    v_fma_mix_f32 v14, v61, v17, v19 op_sel_hi:[1,1,1]
    s_waitcnt lgkmcnt(6)
    v_mfma_f32_16x16x32_bf16 v[160:163], a[0:3], v[40:43], v[160:163]
    ds_read_b64_tr_b16 a[16:17], v1 offset:10240
    v_mfma_f32_16x16x32_bf16 v[168:171], a[0:3], v[44:47], v[168:171]
    v_fma_mix_f32 v15, v61, v17, v19 op_sel:[1,1,1] op_sel_hi:[1,1,1]
    v_cvt_pk_bf16_f32 v61, v14, v15
    v_mfma_f32_16x16x32_bf16 v[176:179], a[0:3], v[48:51], v[176:179]
    ds_read_b64_tr_b16 a[18:19], v1 offset:10752
    s_add_u32 m0, s40, 9984
    v_fma_mix_f32 v12, v65, v17, v19 op_sel_hi:[1,1,1]
    v_mfma_f32_16x16x32_bf16 v[184:187], a[0:3], v[52:55], v[184:187]
    buffer_load_dwordx4 v9, s[12:15], s35 offen offset:256 nt lds
    s_add_u32 s35, s35, 393216
    s_waitcnt lgkmcnt(6)
    v_mfma_f32_16x16x32_bf16 v[164:167], a[4:7], v[40:43], v[164:167]
    ds_read_b64_tr_b16 a[20:21], v1 offset:10248
    v_fma_mix_f32 v13, v65, v17, v19 op_sel:[1,1,1] op_sel_hi:[1,1,1]
    v_mfma_f32_16x16x32_bf16 v[172:175], a[4:7], v[44:47], v[172:175]
    v_cvt_pk_bf16_f32 v65, v12, v13
    v_fma_mix_f32 v14, v69, v17, v19 op_sel_hi:[1,1,1]
    v_mfma_f32_16x16x32_bf16 v[180:183], a[4:7], v[48:51], v[180:183]
    ds_read_b64_tr_b16 a[22:23], v1 offset:10760
    v_fma_mix_f32 v15, v69, v17, v19 op_sel:[1,1,1] op_sel_hi:[1,1,1]
    v_mfma_f32_16x16x32_bf16 v[188:191], a[4:7], v[52:55], v[188:191]
    v_cvt_pk_bf16_f32 v69, v14, v15
    s_waitcnt lgkmcnt(6)
    v_mfma_f32_16x16x32_bf16 v[192:195], a[8:11], v[40:43], v[192:195]
    ds_read_b64_tr_b16 a[24:25], v2 offset:10240
    ds_read_b128 v[16:19], v7 offset:384
    v_mfma_f32_16x16x32_bf16 v[200:203], a[8:11], v[44:47], v[200:203]
    buffer_load_dwordx4 v[32:35], v8, s[24:27], s38 offen offset:0 sc1
    v_mfma_f32_16x16x32_bf16 v[208:211], a[8:11], v[48:51], v[208:211]
    ds_read_b64_tr_b16 a[26:27], v2 offset:10752
    v_fma_mix_f32 v12, v58, v20, v22 op_sel_hi:[1,1,1]
    v_mfma_f32_16x16x32_bf16 v[216:219], a[8:11], v[52:55], v[216:219]
    v_fma_mix_f32 v13, v58, v20, v22 op_sel:[1,1,1] op_sel_hi:[1,1,1]
    v_cvt_pk_bf16_f32 v58, v12, v13
    s_waitcnt lgkmcnt(7)
    v_mfma_f32_16x16x32_bf16 v[196:199], a[12:15], v[40:43], v[196:199]
    ds_read_b64_tr_b16 a[28:29], v2 offset:10248
    v_fma_mix_f32 v14, v62, v20, v22 op_sel_hi:[1,1,1]
    v_mfma_f32_16x16x32_bf16 v[204:207], a[12:15], v[44:47], v[204:207]
    v_fma_mix_f32 v15, v62, v20, v22 op_sel:[1,1,1] op_sel_hi:[1,1,1]
    v_mfma_f32_16x16x32_bf16 v[212:215], a[12:15], v[48:51], v[212:215]
    ds_read_b64_tr_b16 a[30:31], v2 offset:10760
    v_cvt_pk_bf16_f32 v62, v14, v15
    v_mfma_f32_16x16x32_bf16 v[220:223], a[12:15], v[52:55], v[220:223]
    v_fma_mix_f32 v12, v66, v20, v22 op_sel_hi:[1,1,1]
    v_fma_mix_f32 v13, v66, v20, v22 op_sel:[1,1,1] op_sel_hi:[1,1,1]
    s_waitcnt lgkmcnt(7)
    v_mfma_f32_16x16x32_bf16 v[224:227], a[16:19], v[40:43], v[224:227]
    s_barrier
    ds_read_b64_tr_b16 a[0:1], v1 offset:12288
    v_cvt_pk_bf16_f32 v66, v12, v13
    v_mfma_f32_16x16x32_bf16 v[232:235], a[16:19], v[44:47], v[232:235]
    v_fma_mix_f32 v14, v70, v20, v22 op_sel_hi:[1,1,1]
    v_fma_mix_f32 v15, v70, v20, v22 op_sel:[1,1,1] op_sel_hi:[1,1,1]
    v_mfma_f32_16x16x32_bf16 v[240:243], a[16:19], v[48:51], v[240:243]
    ds_read_b64_tr_b16 a[2:3], v1 offset:12800
    v_cvt_pk_bf16_f32 v70, v14, v15
    v_mfma_f32_16x16x32_bf16 v[248:251], a[16:19], v[52:55], v[248:251]
    v_fma_mix_f32 v12, v59, v21, v23 op_sel_hi:[1,1,1]
    v_fma_mix_f32 v13, v59, v21, v23 op_sel:[1,1,1] op_sel_hi:[1,1,1]
    s_waitcnt lgkmcnt(7)
    v_mfma_f32_16x16x32_bf16 v[228:231], a[20:23], v[40:43], v[228:231]
    ds_read_b64_tr_b16 a[4:5], v1 offset:12296
    v_mfma_f32_16x16x32_bf16 v[236:239], a[20:23], v[44:47], v[236:239]
    buffer_load_dwordx4 v[36:39], v8, s[24:27], s39 offen offset:0 sc1
    v_mfma_f32_16x16x32_bf16 v[244:247], a[20:23], v[48:51], v[244:247]
    ds_read_b64_tr_b16 a[6:7], v1 offset:12808
    v_cvt_pk_bf16_f32 v59, v12, v13
    v_mfma_f32_16x16x32_bf16 v[252:255], a[20:23], v[52:55], v[252:255]
    v_fma_mix_f32 v14, v63, v21, v23 op_sel_hi:[1,1,1]
    v_fma_mix_f32 v15, v63, v21, v23 op_sel:[1,1,1] op_sel_hi:[1,1,1]
    s_waitcnt lgkmcnt(6)
    v_mfma_f32_16x16x32_bf16 a[64:67], a[24:27], v[40:43], a[64:67]
    ds_read_b64_tr_b16 a[8:9], v2 offset:12288
    v_cvt_pk_bf16_f32 v63, v14, v15
    v_mfma_f32_16x16x32_bf16 a[72:75], a[24:27], v[44:47], a[72:75]
    v_fma_mix_f32 v12, v67, v21, v23 op_sel_hi:[1,1,1]
    v_fma_mix_f32 v13, v67, v21, v23 op_sel:[1,1,1] op_sel_hi:[1,1,1]
    v_mfma_f32_16x16x32_bf16 a[80:83], a[24:27], v[48:51], a[80:83]
    ds_read_b64_tr_b16 a[10:11], v2 offset:12800
    v_mfma_f32_16x16x32_bf16 a[88:91], a[24:27], v[52:55], a[88:91]
    v_cvt_pk_bf16_f32 v67, v12, v13
    v_fma_mix_f32 v14, v71, v21, v23 op_sel_hi:[1,1,1]
    s_waitcnt lgkmcnt(6)
    v_mfma_f32_16x16x32_bf16 a[68:71], a[28:31], v[40:43], a[68:71]
    ds_read_b64_tr_b16 a[12:13], v2 offset:12296
    v_or_b32 v88, s32, v8
    v_mfma_f32_16x16x32_bf16 a[76:79], a[28:31], v[44:47], a[76:79]
    v_fma_mix_f32 v15, v71, v21, v23 op_sel:[1,1,1] op_sel_hi:[1,1,1]
    v_cvt_pk_bf16_f32 v71, v14, v15
    v_mfma_f32_16x16x32_bf16 a[84:87], a[28:31], v[48:51], a[84:87]
    ds_read_b64_tr_b16 a[14:15], v2 offset:12808
    v_min_u32 v88, 1, v88
    v_mov_b32 v89, 2
    v_mfma_f32_16x16x32_bf16 a[92:95], a[28:31], v[52:55], a[92:95]
    ds_read_b128 v[20:23], v7 offset:400
    s_waitcnt lgkmcnt(7)
    v_mfma_f32_16x16x32_bf16 v[96:99], a[0:3], v[56:59], v[96:99]
    ds_read_b64_tr_b16 a[16:17], v1 offset:14336
    s_waitcnt vmcnt(6)
    v_fma_mix_f32 v12, v72, v16, v18 op_sel_hi:[1,1,1]
    v_mfma_f32_16x16x32_bf16 v[104:107], a[0:3], v[60:63], v[104:107]
    v_lshlrev_b32 v88, 30, v88
    buffer_load_dwordx4 v[40:43], v8, s[24:27], s36 offen offset:1024 sc1
    v_mfma_f32_16x16x32_bf16 v[112:115], a[0:3], v[64:67], v[112:115]
    ds_read_b64_tr_b16 a[18:19], v1 offset:14848
    v_mfma_f32_16x16x32_bf16 v[120:123], a[0:3], v[68:71], v[120:123]
    v_fma_mix_f32 v13, v72, v16, v18 op_sel:[1,1,1] op_sel_hi:[1,1,1]
    v_cvt_pk_bf16_f32 v72, v12, v13
    s_waitcnt lgkmcnt(7)
    v_mfma_f32_16x16x32_bf16 v[100:103], a[4:7], v[56:59], v[100:103]
    ds_read_b64_tr_b16 a[20:21], v1 offset:14344
    s_barrier
    buffer_store_dword v89, v88, s[76:79], s0 offen sc1
    v_mfma_f32_16x16x32_bf16 v[108:111], a[4:7], v[60:63], v[108:111]
    v_fma_mix_f32 v14, v76, v16, v18 op_sel_hi:[1,1,1]
    v_mfma_f32_16x16x32_bf16 v[116:119], a[4:7], v[64:67], v[116:119]
    ds_read_b64_tr_b16 a[22:23], v1 offset:14856
    s_add_u32 m0, s40, 12288
    v_fma_mix_f32 v15, v76, v16, v18 op_sel:[1,1,1] op_sel_hi:[1,1,1]
    v_mfma_f32_16x16x32_bf16 v[124:127], a[4:7], v[68:71], v[124:127]
    buffer_load_dwordx4 v9, s[12:15], s35 offen offset:0 nt lds
    s_waitcnt lgkmcnt(7)
    v_mfma_f32_16x16x32_bf16 v[128:131], a[8:11], v[56:59], v[128:131]
    ds_read_b64_tr_b16 a[24:25], v2 offset:14336
    v_cvt_pk_bf16_f32 v76, v14, v15
    v_mfma_f32_16x16x32_bf16 v[136:139], a[8:11], v[60:63], v[136:139]
    v_fma_mix_f32 v12, v80, v16, v18 op_sel_hi:[1,1,1]
    v_fma_mix_f32 v13, v80, v16, v18 op_sel:[1,1,1] op_sel_hi:[1,1,1]
    v_mfma_f32_16x16x32_bf16 v[144:147], a[8:11], v[64:67], v[144:147]
    ds_read_b64_tr_b16 a[26:27], v2 offset:14848
    v_cvt_pk_bf16_f32 v80, v12, v13
    v_mfma_f32_16x16x32_bf16 v[152:155], a[8:11], v[68:71], v[152:155]
    v_fma_mix_f32 v14, v84, v16, v18 op_sel_hi:[1,1,1]
    v_fma_mix_f32 v15, v84, v16, v18 op_sel:[1,1,1] op_sel_hi:[1,1,1]
    s_waitcnt lgkmcnt(7)
    v_mfma_f32_16x16x32_bf16 v[132:135], a[12:15], v[56:59], v[132:135]
    ds_read_b64_tr_b16 a[28:29], v2 offset:14344
    v_cvt_pk_bf16_f32 v84, v14, v15
    v_mfma_f32_16x16x32_bf16 v[140:143], a[12:15], v[60:63], v[140:143]
    buffer_load_dwordx4 v[44:47], v8, s[24:27], s37 offen offset:1024 sc1
    v_mfma_f32_16x16x32_bf16 v[148:151], a[12:15], v[64:67], v[148:151]
    ds_read_b64_tr_b16 a[30:31], v2 offset:14856
    v_fma_mix_f32 v12, v73, v17, v19 op_sel_hi:[1,1,1]
    v_mfma_f32_16x16x32_bf16 v[156:159], a[12:15], v[68:71], v[156:159]
    v_fma_mix_f32 v13, v73, v17, v19 op_sel:[1,1,1] op_sel_hi:[1,1,1]
    v_cvt_pk_bf16_f32 v73, v12, v13
    s_waitcnt lgkmcnt(6)
    v_mfma_f32_16x16x32_bf16 v[160:163], a[16:19], v[56:59], v[160:163]
    ds_read_b64_tr_b16 a[0:1], v1 offset:16384
    v_fma_mix_f32 v14, v77, v17, v19 op_sel_hi:[1,1,1]
    v_mfma_f32_16x16x32_bf16 v[168:171], a[16:19], v[60:63], v[168:171]
    v_fma_mix_f32 v15, v77, v17, v19 op_sel:[1,1,1] op_sel_hi:[1,1,1]
    v_cvt_pk_bf16_f32 v77, v14, v15
    v_mfma_f32_16x16x32_bf16 v[176:179], a[16:19], v[64:67], v[176:179]
    ds_read_b64_tr_b16 a[2:3], v1 offset:16896
    s_add_u32 m0, s40, 14208
    v_fma_mix_f32 v12, v81, v17, v19 op_sel_hi:[1,1,1]
    v_mfma_f32_16x16x32_bf16 v[184:187], a[16:19], v[68:71], v[184:187]
    buffer_load_dwordx4 v9, s[12:15], s35 offen offset:128 nt lds
    s_waitcnt lgkmcnt(6)
    v_mfma_f32_16x16x32_bf16 v[164:167], a[20:23], v[56:59], v[164:167]
    ds_read_b64_tr_b16 a[4:5], v1 offset:16392
    v_fma_mix_f32 v13, v81, v17, v19 op_sel:[1,1,1] op_sel_hi:[1,1,1]
    v_mfma_f32_16x16x32_bf16 v[172:175], a[20:23], v[60:63], v[172:175]
    v_cvt_pk_bf16_f32 v81, v12, v13
    v_fma_mix_f32 v14, v85, v17, v19 op_sel_hi:[1,1,1]
    v_mfma_f32_16x16x32_bf16 v[180:183], a[20:23], v[64:67], v[180:183]
    ds_read_b64_tr_b16 a[6:7], v1 offset:16904
    v_fma_mix_f32 v15, v85, v17, v19 op_sel:[1,1,1] op_sel_hi:[1,1,1]
    v_mfma_f32_16x16x32_bf16 v[188:191], a[20:23], v[68:71], v[188:191]
    v_cvt_pk_bf16_f32 v85, v14, v15
    v_add_u32 v7, 512, v7
    s_waitcnt lgkmcnt(6)
    v_mfma_f32_16x16x32_bf16 v[192:195], a[24:27], v[56:59], v[192:195]
    ds_read_b64_tr_b16 a[8:9], v2 offset:16384
    ds_read_b128 v[16:19], v7 offset:0
    v_mfma_f32_16x16x32_bf16 v[200:203], a[24:27], v[60:63], v[200:203]
    buffer_load_dwordx4 v[48:51], v8, s[24:27], s38 offen offset:1024 sc1
    v_mfma_f32_16x16x32_bf16 v[208:211], a[24:27], v[64:67], v[208:211]
    ds_read_b64_tr_b16 a[10:11], v2 offset:16896
    v_fma_mix_f32 v12, v74, v20, v22 op_sel_hi:[1,1,1]
    v_mfma_f32_16x16x32_bf16 v[216:219], a[24:27], v[68:71], v[216:219]
    v_fma_mix_f32 v13, v74, v20, v22 op_sel:[1,1,1] op_sel_hi:[1,1,1]
    v_cvt_pk_bf16_f32 v74, v12, v13
    s_waitcnt lgkmcnt(7)
    v_mfma_f32_16x16x32_bf16 v[196:199], a[28:31], v[56:59], v[196:199]
    ds_read_b64_tr_b16 a[12:13], v2 offset:16392
    v_fma_mix_f32 v14, v78, v20, v22 op_sel_hi:[1,1,1]
    v_mfma_f32_16x16x32_bf16 v[204:207], a[28:31], v[60:63], v[204:207]
    v_fma_mix_f32 v15, v78, v20, v22 op_sel:[1,1,1] op_sel_hi:[1,1,1]
    v_cvt_pk_bf16_f32 v78, v14, v15
    v_mfma_f32_16x16x32_bf16 v[212:215], a[28:31], v[64:67], v[212:215]
    ds_read_b64_tr_b16 a[14:15], v2 offset:16904
    s_add_u32 m0, s40, 16128
    v_fma_mix_f32 v12, v82, v20, v22 op_sel_hi:[1,1,1]
    v_mfma_f32_16x16x32_bf16 v[220:223], a[28:31], v[68:71], v[220:223]
    buffer_load_dwordx4 v9, s[12:15], s35 offen offset:256 nt lds
    s_add_u32 s35, s35, 393216
    s_waitcnt lgkmcnt(7)
    v_mfma_f32_16x16x32_bf16 v[224:227], a[0:3], v[56:59], v[224:227]
    ds_read_b64_tr_b16 a[16:17], v1 offset:18432
    v_fma_mix_f32 v13, v82, v20, v22 op_sel:[1,1,1] op_sel_hi:[1,1,1]
    v_mfma_f32_16x16x32_bf16 v[232:235], a[0:3], v[60:63], v[232:235]
    v_cvt_pk_bf16_f32 v82, v12, v13
    v_fma_mix_f32 v14, v86, v20, v22 op_sel_hi:[1,1,1]
    v_mfma_f32_16x16x32_bf16 v[240:243], a[0:3], v[64:67], v[240:243]
    ds_read_b64_tr_b16 a[18:19], v1 offset:18944
    v_fma_mix_f32 v15, v86, v20, v22 op_sel:[1,1,1] op_sel_hi:[1,1,1]
    v_mfma_f32_16x16x32_bf16 v[248:251], a[0:3], v[68:71], v[248:251]
    v_cvt_pk_bf16_f32 v86, v14, v15
    v_fma_mix_f32 v12, v75, v21, v23 op_sel_hi:[1,1,1]
    s_waitcnt lgkmcnt(7)
    v_mfma_f32_16x16x32_bf16 v[228:231], a[4:7], v[56:59], v[228:231]
    ds_read_b64_tr_b16 a[20:21], v1 offset:18440
    v_fma_mix_f32 v13, v75, v21, v23 op_sel:[1,1,1] op_sel_hi:[1,1,1]
    v_mfma_f32_16x16x32_bf16 v[236:239], a[4:7], v[60:63], v[236:239]
    buffer_load_dwordx4 v[52:55], v8, s[24:27], s39 offen offset:1024 sc1
    v_mfma_f32_16x16x32_bf16 v[244:247], a[4:7], v[64:67], v[244:247]
    ds_read_b64_tr_b16 a[22:23], v1 offset:18952
    v_cvt_pk_bf16_f32 v75, v12, v13
    v_mfma_f32_16x16x32_bf16 v[252:255], a[4:7], v[68:71], v[252:255]
    v_fma_mix_f32 v14, v79, v21, v23 op_sel_hi:[1,1,1]
    v_fma_mix_f32 v15, v79, v21, v23 op_sel:[1,1,1] op_sel_hi:[1,1,1]
    s_waitcnt lgkmcnt(6)
    v_mfma_f32_16x16x32_bf16 a[64:67], a[8:11], v[56:59], a[64:67]
    ds_read_b64_tr_b16 a[24:25], v2 offset:18432
    v_cvt_pk_bf16_f32 v79, v14, v15
    v_mfma_f32_16x16x32_bf16 a[72:75], a[8:11], v[60:63], a[72:75]
    v_fma_mix_f32 v12, v83, v21, v23 op_sel_hi:[1,1,1]
    v_fma_mix_f32 v13, v83, v21, v23 op_sel:[1,1,1] op_sel_hi:[1,1,1]
    v_mfma_f32_16x16x32_bf16 a[80:83], a[8:11], v[64:67], a[80:83]
    ds_read_b64_tr_b16 a[26:27], v2 offset:18944
    s_add_u32 m0, s40, 18432
    v_cvt_pk_bf16_f32 v83, v12, v13
    v_mfma_f32_16x16x32_bf16 a[88:91], a[8:11], v[68:71], a[88:91]
    buffer_load_dwordx4 v9, s[12:15], s35 offen offset:0 nt lds
    s_waitcnt lgkmcnt(6)
    v_mfma_f32_16x16x32_bf16 a[68:71], a[12:15], v[56:59], a[68:71]
    ds_read_b64_tr_b16 a[28:29], v2 offset:18440
    v_fma_mix_f32 v14, v87, v21, v23 op_sel_hi:[1,1,1]
    v_mfma_f32_16x16x32_bf16 a[76:79], a[12:15], v[60:63], a[76:79]
    v_fma_mix_f32 v15, v87, v21, v23 op_sel:[1,1,1] op_sel_hi:[1,1,1]
    v_cvt_pk_bf16_f32 v87, v14, v15
    v_mfma_f32_16x16x32_bf16 a[84:87], a[12:15], v[64:67], a[84:87]
    ds_read_b64_tr_b16 a[30:31], v2 offset:18952
    v_mfma_f32_16x16x32_bf16 a[92:95], a[12:15], v[68:71], a[92:95]
    ds_read_b128 v[20:23], v7 offset:16
    s_waitcnt lgkmcnt(7)
    v_mfma_f32_16x16x32_bf16 v[96:99], a[16:19], v[72:75], v[96:99]
    ds_read_b64_tr_b16 a[0:1], v1 offset:20480
    s_waitcnt vmcnt(9)
    v_fma_mix_f32 v12, v24, v16, v18 op_sel_hi:[1,1,1]
    v_mfma_f32_16x16x32_bf16 v[104:107], a[16:19], v[76:79], v[104:107]
    buffer_load_dwordx4 v[56:59], v8, s[24:27], s36 offen offset:2048 sc1
    v_mfma_f32_16x16x32_bf16 v[112:115], a[16:19], v[80:83], v[112:115]
    ds_read_b64_tr_b16 a[2:3], v1 offset:20992
    v_fma_mix_f32 v13, v24, v16, v18 op_sel:[1,1,1] op_sel_hi:[1,1,1]
    v_mfma_f32_16x16x32_bf16 v[120:123], a[16:19], v[84:87], v[120:123]
    v_cvt_pk_bf16_f32 v24, v12, v13
    s_waitcnt lgkmcnt(7)
    v_mfma_f32_16x16x32_bf16 v[100:103], a[20:23], v[72:75], v[100:103]
    ds_read_b64_tr_b16 a[4:5], v1 offset:20488
    v_fma_mix_f32 v14, v28, v16, v18 op_sel_hi:[1,1,1]
    v_mfma_f32_16x16x32_bf16 v[108:111], a[20:23], v[76:79], v[108:111]
    v_fma_mix_f32 v15, v28, v16, v18 op_sel:[1,1,1] op_sel_hi:[1,1,1]
    v_cvt_pk_bf16_f32 v28, v14, v15
    v_mfma_f32_16x16x32_bf16 v[116:119], a[20:23], v[80:83], v[116:119]
    ds_read_b64_tr_b16 a[6:7], v1 offset:21000
    s_add_u32 m0, s40, 20352
    v_fma_mix_f32 v12, v32, v16, v18 op_sel_hi:[1,1,1]
    v_mfma_f32_16x16x32_bf16 v[124:127], a[20:23], v[84:87], v[124:127]
    buffer_load_dwordx4 v9, s[12:15], s35 offen offset:128 nt lds
    s_waitcnt lgkmcnt(7)
    v_mfma_f32_16x16x32_bf16 v[128:131], a[24:27], v[72:75], v[128:131]
    ds_read_b64_tr_b16 a[8:9], v2 offset:20480
    v_fma_mix_f32 v13, v32, v16, v18 op_sel:[1,1,1] op_sel_hi:[1,1,1]
    v_mfma_f32_16x16x32_bf16 v[136:139], a[24:27], v[76:79], v[136:139]
    v_cvt_pk_bf16_f32 v32, v12, v13
    v_fma_mix_f32 v14, v36, v16, v18 op_sel_hi:[1,1,1]
    v_mfma_f32_16x16x32_bf16 v[144:147], a[24:27], v[80:83], v[144:147]
    ds_read_b64_tr_b16 a[10:11], v2 offset:20992
    v_fma_mix_f32 v15, v36, v16, v18 op_sel:[1,1,1] op_sel_hi:[1,1,1]
    v_mfma_f32_16x16x32_bf16 v[152:155], a[24:27], v[84:87], v[152:155]
    v_cvt_pk_bf16_f32 v36, v14, v15
    s_waitcnt lgkmcnt(7)
    v_mfma_f32_16x16x32_bf16 v[132:135], a[28:31], v[72:75], v[132:135]
    ds_read_b64_tr_b16 a[12:13], v2 offset:20488
    v_fma_mix_f32 v12, v25, v17, v19 op_sel_hi:[1,1,1]
    v_mfma_f32_16x16x32_bf16 v[140:143], a[28:31], v[76:79], v[140:143]
    buffer_load_dwordx4 v[60:63], v8, s[24:27], s37 offen offset:2048 sc1
    v_mfma_f32_16x16x32_bf16 v[148:151], a[28:31], v[80:83], v[148:151]
    ds_read_b64_tr_b16 a[14:15], v2 offset:21000
    v_fma_mix_f32 v13, v25, v17, v19 op_sel:[1,1,1] op_sel_hi:[1,1,1]
    v_mfma_f32_16x16x32_bf16 v[156:159], a[28:31], v[84:87], v[156:159]
    v_cvt_pk_bf16_f32 v25, v12, v13
    v_fma_mix_f32 v14, v29, v17, v19 op_sel_hi:[1,1,1]
    s_waitcnt lgkmcnt(6)
    v_mfma_f32_16x16x32_bf16 v[160:163], a[0:3], v[72:75], v[160:163]
    ds_read_b64_tr_b16 a[16:17], v1 offset:22528
    v_fma_mix_f32 v15, v29, v17, v19 op_sel:[1,1,1] op_sel_hi:[1,1,1]
    v_mfma_f32_16x16x32_bf16 v[168:171], a[0:3], v[76:79], v[168:171]
    v_cvt_pk_bf16_f32 v29, v14, v15
    v_fma_mix_f32 v12, v33, v17, v19 op_sel_hi:[1,1,1]
    v_mfma_f32_16x16x32_bf16 v[176:179], a[0:3], v[80:83], v[176:179]
    ds_read_b64_tr_b16 a[18:19], v1 offset:23040
    s_add_u32 m0, s40, 22272
    v_fma_mix_f32 v13, v33, v17, v19 op_sel:[1,1,1] op_sel_hi:[1,1,1]
    v_mfma_f32_16x16x32_bf16 v[184:187], a[0:3], v[84:87], v[184:187]
    buffer_load_dwordx4 v9, s[12:15], s35 offen offset:256 nt lds
    s_add_u32 s35, s35, 393216
    s_sub_u32 s40, s40, s52
    s_waitcnt lgkmcnt(6)
    v_mfma_f32_16x16x32_bf16 v[164:167], a[4:7], v[72:75], v[164:167]
    ds_read_b64_tr_b16 a[20:21], v1 offset:22536
    v_mfma_f32_16x16x32_bf16 v[172:175], a[4:7], v[76:79], v[172:175]
    v_cvt_pk_bf16_f32 v33, v12, v13
    v_fma_mix_f32 v14, v37, v17, v19 op_sel_hi:[1,1,1]
    v_mfma_f32_16x16x32_bf16 v[180:183], a[4:7], v[80:83], v[180:183]
    ds_read_b64_tr_b16 a[22:23], v1 offset:23048
    v_fma_mix_f32 v15, v37, v17, v19 op_sel:[1,1,1] op_sel_hi:[1,1,1]
    v_mfma_f32_16x16x32_bf16 v[188:191], a[4:7], v[84:87], v[188:191]
    v_cvt_pk_bf16_f32 v37, v14, v15
    ds_read_b128 v[16:19], v7 offset:128
    s_waitcnt lgkmcnt(7)
    v_mfma_f32_16x16x32_bf16 v[192:195], a[8:11], v[72:75], v[192:195]
    ds_read_b64_tr_b16 a[24:25], v2 offset:22528
    v_fma_mix_f32 v12, v26, v20, v22 op_sel_hi:[1,1,1]
    v_mfma_f32_16x16x32_bf16 v[200:203], a[8:11], v[76:79], v[200:203]
    buffer_load_dwordx4 v[64:67], v8, s[24:27], s38 offen offset:2048 sc1
    v_mfma_f32_16x16x32_bf16 v[208:211], a[8:11], v[80:83], v[208:211]
    ds_read_b64_tr_b16 a[26:27], v2 offset:23040
    v_mfma_f32_16x16x32_bf16 v[216:219], a[8:11], v[84:87], v[216:219]
    v_fma_mix_f32 v13, v26, v20, v22 op_sel:[1,1,1] op_sel_hi:[1,1,1]
    v_cvt_pk_bf16_f32 v26, v12, v13
    s_waitcnt lgkmcnt(7)
    v_mfma_f32_16x16x32_bf16 v[196:199], a[12:15], v[72:75], v[196:199]
    ds_read_b64_tr_b16 a[28:29], v2 offset:22536
    v_fma_mix_f32 v14, v30, v20, v22 op_sel_hi:[1,1,1]
    v_mfma_f32_16x16x32_bf16 v[204:207], a[12:15], v[76:79], v[204:207]
    v_fma_mix_f32 v15, v30, v20, v22 op_sel:[1,1,1] op_sel_hi:[1,1,1]
    v_cvt_pk_bf16_f32 v30, v14, v15
    v_mfma_f32_16x16x32_bf16 v[212:215], a[12:15], v[80:83], v[212:215]
    ds_read_b64_tr_b16 a[30:31], v2 offset:23048
    v_fma_mix_f32 v12, v34, v20, v22 op_sel_hi:[1,1,1]
    v_mfma_f32_16x16x32_bf16 v[220:223], a[12:15], v[84:87], v[220:223]
    v_fma_mix_f32 v13, v34, v20, v22 op_sel:[1,1,1] op_sel_hi:[1,1,1]
    v_cvt_pk_bf16_f32 v34, v12, v13
    s_waitcnt lgkmcnt(7)
    v_mfma_f32_16x16x32_bf16 v[224:227], a[16:19], v[72:75], v[224:227]
    s_barrier
    v_add_u32 v1, s52, v1
    v_add_u32 v2, s52, v2
    s_sub_u32 s52, 0, s52
    ds_read_b64_tr_b16 a[0:1], v1 offset:0
    v_mfma_f32_16x16x32_bf16 v[232:235], a[16:19], v[76:79], v[232:235]
    v_fma_mix_f32 v14, v38, v20, v22 op_sel_hi:[1,1,1]
    v_mfma_f32_16x16x32_bf16 v[240:243], a[16:19], v[80:83], v[240:243]
    ds_read_b64_tr_b16 a[2:3], v1 offset:512
    v_mfma_f32_16x16x32_bf16 v[248:251], a[16:19], v[84:87], v[248:251]
    v_fma_mix_f32 v15, v38, v20, v22 op_sel:[1,1,1] op_sel_hi:[1,1,1]
    v_cvt_pk_bf16_f32 v38, v14, v15
    s_waitcnt lgkmcnt(7)
    v_mfma_f32_16x16x32_bf16 v[228:231], a[20:23], v[72:75], v[228:231]
    ds_read_b64_tr_b16 a[4:5], v1 offset:8
    v_fma_mix_f32 v12, v27, v21, v23 op_sel_hi:[1,1,1]
    v_mfma_f32_16x16x32_bf16 v[236:239], a[20:23], v[76:79], v[236:239]
    buffer_load_dwordx4 v[68:71], v8, s[24:27], s39 offen offset:2048 sc1
    v_mfma_f32_16x16x32_bf16 v[244:247], a[20:23], v[80:83], v[244:247]
    ds_read_b64_tr_b16 a[6:7], v1 offset:520
    v_fma_mix_f32 v13, v27, v21, v23 op_sel:[1,1,1] op_sel_hi:[1,1,1]
    v_mfma_f32_16x16x32_bf16 v[252:255], a[20:23], v[84:87], v[252:255]
    v_cvt_pk_bf16_f32 v27, v12, v13
    v_fma_mix_f32 v14, v31, v21, v23 op_sel_hi:[1,1,1]
    s_waitcnt lgkmcnt(6)
    v_mfma_f32_16x16x32_bf16 a[64:67], a[24:27], v[72:75], a[64:67]
    ds_read_b64_tr_b16 a[8:9], v2 offset:0
    v_fma_mix_f32 v15, v31, v21, v23 op_sel:[1,1,1] op_sel_hi:[1,1,1]
    v_mfma_f32_16x16x32_bf16 a[72:75], a[24:27], v[76:79], a[72:75]
    v_cvt_pk_bf16_f32 v31, v14, v15
    v_fma_mix_f32 v12, v35, v21, v23 op_sel_hi:[1,1,1]
    v_mfma_f32_16x16x32_bf16 a[80:83], a[24:27], v[80:83], a[80:83]
    ds_read_b64_tr_b16 a[10:11], v2 offset:512
    v_mfma_f32_16x16x32_bf16 a[88:91], a[24:27], v[84:87], a[88:91]
    v_fma_mix_f32 v13, v35, v21, v23 op_sel:[1,1,1] op_sel_hi:[1,1,1]
    v_cvt_pk_bf16_f32 v35, v12, v13
    s_waitcnt lgkmcnt(6)
    v_mfma_f32_16x16x32_bf16 a[68:71], a[28:31], v[72:75], a[68:71]
    ds_read_b64_tr_b16 a[12:13], v2 offset:8
    v_fma_mix_f32 v14, v39, v21, v23 op_sel_hi:[1,1,1]
    v_mfma_f32_16x16x32_bf16 a[76:79], a[28:31], v[76:79], a[76:79]
    v_fma_mix_f32 v15, v39, v21, v23 op_sel:[1,1,1] op_sel_hi:[1,1,1]
    v_cvt_pk_bf16_f32 v39, v14, v15
    v_mfma_f32_16x16x32_bf16 a[84:87], a[28:31], v[80:83], a[84:87]
    ds_read_b64_tr_b16 a[14:15], v2 offset:520
    v_mfma_f32_16x16x32_bf16 a[92:95], a[28:31], v[84:87], a[92:95]
    v_min_u32 v90, 400, v8
    s_and_b32 s46, s0, 0xffffe000
    ds_read_b128 v[20:23], v7 offset:144
    s_waitcnt lgkmcnt(7)
    v_mfma_f32_16x16x32_bf16 v[96:99], a[0:3], v[24:27], v[96:99]
    ds_read_b64_tr_b16 a[16:17], v1 offset:2048
    s_waitcnt vmcnt(7)
    v_fma_mix_f32 v12, v40, v16, v18 op_sel_hi:[1,1,1]
    v_mfma_f32_16x16x32_bf16 v[104:107], a[0:3], v[28:31], v[104:107]
    v_fma_mix_f32 v13, v40, v16, v18 op_sel:[1,1,1] op_sel_hi:[1,1,1]
    v_cvt_pk_bf16_f32 v40, v12, v13
    v_mfma_f32_16x16x32_bf16 v[112:115], a[0:3], v[32:35], v[112:115]
    ds_read_b64_tr_b16 a[18:19], v1 offset:2560
    v_lshlrev_b32 v90, 4, v90
    v_mfma_f32_16x16x32_bf16 v[120:123], a[0:3], v[36:39], v[120:123]
    v_fma_mix_f32 v14, v44, v16, v18 op_sel_hi:[1,1,1]
    s_waitcnt lgkmcnt(7)
    v_mfma_f32_16x16x32_bf16 v[100:103], a[4:7], v[24:27], v[100:103]
    ds_read_b64_tr_b16 a[20:21], v1 offset:2056
    buffer_load_dword v91, v90, s[76:79], s46 offen sc1
    v_mfma_f32_16x16x32_bf16 v[108:111], a[4:7], v[28:31], v[108:111]
    v_fma_mix_f32 v15, v44, v16, v18 op_sel:[1,1,1] op_sel_hi:[1,1,1]
    v_mfma_f32_16x16x32_bf16 v[116:119], a[4:7], v[32:35], v[116:119]
    ds_read_b64_tr_b16 a[22:23], v1 offset:2568
    s_add_u32 m0, s40, 0
    v_cvt_pk_bf16_f32 v44, v14, v15
    v_mfma_f32_16x16x32_bf16 v[124:127], a[4:7], v[36:39], v[124:127]
    buffer_load_dwordx4 v9, s[12:15], s35 offen offset:0 nt lds
    s_waitcnt lgkmcnt(7)
    v_mfma_f32_16x16x32_bf16 v[128:131], a[8:11], v[24:27], v[128:131]
    ds_read_b64_tr_b16 a[24:25], v2 offset:2048
    v_fma_mix_f32 v12, v48, v16, v18 op_sel_hi:[1,1,1]
    v_mfma_f32_16x16x32_bf16 v[136:139], a[8:11], v[28:31], v[136:139]
    v_fma_mix_f32 v13, v48, v16, v18 op_sel:[1,1,1] op_sel_hi:[1,1,1]
    v_cvt_pk_bf16_f32 v48, v12, v13
    v_mfma_f32_16x16x32_bf16 v[144:147], a[8:11], v[32:35], v[144:147]
    ds_read_b64_tr_b16 a[26:27], v2 offset:2560
    v_fma_mix_f32 v14, v52, v16, v18 op_sel_hi:[1,1,1]
    v_mfma_f32_16x16x32_bf16 v[152:155], a[8:11], v[36:39], v[152:155]
    v_fma_mix_f32 v15, v52, v16, v18 op_sel:[1,1,1] op_sel_hi:[1,1,1]
    s_waitcnt lgkmcnt(7)
    v_mfma_f32_16x16x32_bf16 v[132:135], a[12:15], v[24:27], v[132:135]
    ds_read_b64_tr_b16 a[28:29], v2 offset:2056
    v_cvt_pk_bf16_f32 v52, v14, v15
    v_mfma_f32_16x16x32_bf16 v[140:143], a[12:15], v[28:31], v[140:143]
    v_fma_mix_f32 v12, v41, v17, v19 op_sel_hi:[1,1,1]
    v_fma_mix_f32 v13, v41, v17, v19 op_sel:[1,1,1] op_sel_hi:[1,1,1]
    v_mfma_f32_16x16x32_bf16 v[148:151], a[12:15], v[32:35], v[148:151]
    ds_read_b64_tr_b16 a[30:31], v2 offset:2568
    v_cvt_pk_bf16_f32 v41, v12, v13
    v_mfma_f32_16x16x32_bf16 v[156:159], a[12:15], v[36:39], v[156:159]
    v_fma_mix_f32 v14, v45, v17, v19 op_sel_hi:[1,1,1]
    v_fma_mix_f32 v15, v45, v17, v19 op_sel:[1,1,1] op_sel_hi:[1,1,1]
    s_waitcnt lgkmcnt(6)
    v_mfma_f32_16x16x32_bf16 v[160:163], a[16:19], v[24:27], v[160:163]
    ds_read_b64_tr_b16 a[0:1], v1 offset:4096
    v_cvt_pk_bf16_f32 v45, v14, v15
    v_mfma_f32_16x16x32_bf16 v[168:171], a[16:19], v[28:31], v[168:171]
    v_fma_mix_f32 v12, v49, v17, v19 op_sel_hi:[1,1,1]
    v_fma_mix_f32 v13, v49, v17, v19 op_sel:[1,1,1] op_sel_hi:[1,1,1]
    v_mfma_f32_16x16x32_bf16 v[176:179], a[16:19], v[32:35], v[176:179]
    ds_read_b64_tr_b16 a[2:3], v1 offset:4608
    s_add_u32 m0, s40, 1920
    v_cvt_pk_bf16_f32 v49, v12, v13
    v_mfma_f32_16x16x32_bf16 v[184:187], a[16:19], v[36:39], v[184:187]
    buffer_load_dwordx4 v9, s[12:15], s35 offen offset:128 nt lds
    s_waitcnt lgkmcnt(6)
    v_mfma_f32_16x16x32_bf16 v[164:167], a[20:23], v[24:27], v[164:167]
    ds_read_b64_tr_b16 a[4:5], v1 offset:4104
    v_mfma_f32_16x16x32_bf16 v[172:175], a[20:23], v[28:31], v[172:175]
    v_fma_mix_f32 v14, v53, v17, v19 op_sel_hi:[1,1,1]
    v_fma_mix_f32 v15, v53, v17, v19 op_sel:[1,1,1] op_sel_hi:[1,1,1]
    v_mfma_f32_16x16x32_bf16 v[180:183], a[20:23], v[32:35], v[180:183]
    ds_read_b64_tr_b16 a[6:7], v1 offset:4616
    v_cvt_pk_bf16_f32 v53, v14, v15
    v_mfma_f32_16x16x32_bf16 v[188:191], a[20:23], v[36:39], v[188:191]
    ds_read_b128 v[16:19], v7 offset:256
    v_fma_mix_f32 v12, v42, v20, v22 op_sel_hi:[1,1,1]
    s_waitcnt lgkmcnt(7)
    v_mfma_f32_16x16x32_bf16 v[192:195], a[24:27], v[24:27], v[192:195]
    ds_read_b64_tr_b16 a[8:9], v2 offset:4096
    v_fma_mix_f32 v13, v42, v20, v22 op_sel:[1,1,1] op_sel_hi:[1,1,1]
    v_mfma_f32_16x16x32_bf16 v[200:203], a[24:27], v[28:31], v[200:203]
    v_cvt_pk_bf16_f32 v42, v12, v13
    v_fma_mix_f32 v14, v46, v20, v22 op_sel_hi:[1,1,1]
    v_mfma_f32_16x16x32_bf16 v[208:211], a[24:27], v[32:35], v[208:211]
    ds_read_b64_tr_b16 a[10:11], v2 offset:4608
    v_mfma_f32_16x16x32_bf16 v[216:219], a[24:27], v[36:39], v[216:219]
    v_fma_mix_f32 v15, v46, v20, v22 op_sel:[1,1,1] op_sel_hi:[1,1,1]
    v_cvt_pk_bf16_f32 v46, v14, v15
    s_waitcnt lgkmcnt(7)
    v_mfma_f32_16x16x32_bf16 v[196:199], a[28:31], v[24:27], v[196:199]
    ds_read_b64_tr_b16 a[12:13], v2 offset:4104
    v_fma_mix_f32 v12, v50, v20, v22 op_sel_hi:[1,1,1]
    v_mfma_f32_16x16x32_bf16 v[204:207], a[28:31], v[28:31], v[204:207]
    v_fma_mix_f32 v13, v50, v20, v22 op_sel:[1,1,1] op_sel_hi:[1,1,1]
    v_cvt_pk_bf16_f32 v50, v12, v13
    v_mfma_f32_16x16x32_bf16 v[212:215], a[28:31], v[32:35], v[212:215]
    ds_read_b64_tr_b16 a[14:15], v2 offset:4616
    s_add_u32 m0, s40, 3840
    v_fma_mix_f32 v14, v54, v20, v22 op_sel_hi:[1,1,1]
    v_mfma_f32_16x16x32_bf16 v[220:223], a[28:31], v[36:39], v[220:223]
    buffer_load_dwordx4 v9, s[12:15], s35 offen offset:256 nt lds
    s_add_u32 s35, s35, 393216
    s_waitcnt lgkmcnt(7)
    v_mfma_f32_16x16x32_bf16 v[224:227], a[0:3], v[24:27], v[224:227]
    ds_read_b64_tr_b16 a[16:17], v1 offset:6144
    v_fma_mix_f32 v15, v54, v20, v22 op_sel:[1,1,1] op_sel_hi:[1,1,1]
    v_mfma_f32_16x16x32_bf16 v[232:235], a[0:3], v[28:31], v[232:235]
    v_cvt_pk_bf16_f32 v54, v14, v15
    v_fma_mix_f32 v12, v43, v21, v23 op_sel_hi:[1,1,1]
    v_mfma_f32_16x16x32_bf16 v[240:243], a[0:3], v[32:35], v[240:243]
    ds_read_b64_tr_b16 a[18:19], v1 offset:6656
    v_mfma_f32_16x16x32_bf16 v[248:251], a[0:3], v[36:39], v[248:251]
    v_fma_mix_f32 v13, v43, v21, v23 op_sel:[1,1,1] op_sel_hi:[1,1,1]
    v_cvt_pk_bf16_f32 v43, v12, v13
    s_waitcnt lgkmcnt(7)
    v_mfma_f32_16x16x32_bf16 v[228:231], a[4:7], v[24:27], v[228:231]
    ds_read_b64_tr_b16 a[20:21], v1 offset:6152
    v_fma_mix_f32 v14, v47, v21, v23 op_sel_hi:[1,1,1]
    v_mfma_f32_16x16x32_bf16 v[236:239], a[4:7], v[28:31], v[236:239]
    v_fma_mix_f32 v15, v47, v21, v23 op_sel:[1,1,1] op_sel_hi:[1,1,1]
    v_cvt_pk_bf16_f32 v47, v14, v15
    v_mfma_f32_16x16x32_bf16 v[244:247], a[4:7], v[32:35], v[244:247]
    ds_read_b64_tr_b16 a[22:23], v1 offset:6664
    v_fma_mix_f32 v12, v51, v21, v23 op_sel_hi:[1,1,1]
    v_mfma_f32_16x16x32_bf16 v[252:255], a[4:7], v[36:39], v[252:255]
    s_waitcnt vmcnt(3)
    v_cmp_gt_u32 vcc, 2, v91
    s_cbranch_vccnz QH_spin
QH_ok:
    v_fma_mix_f32 v13, v51, v21, v23 op_sel:[1,1,1] op_sel_hi:[1,1,1]
    s_waitcnt lgkmcnt(6)
    v_mfma_f32_16x16x32_bf16 a[64:67], a[8:11], v[24:27], a[64:67]
    ds_read_b64_tr_b16 a[24:25], v2 offset:6144
    v_cvt_pk_bf16_f32 v51, v12, v13
    v_mfma_f32_16x16x32_bf16 a[72:75], a[8:11], v[28:31], a[72:75]
    buffer_load_dwordx4 v[72:75], v8, s[24:27], s36 offen offset:3072 sc1
    v_mfma_f32_16x16x32_bf16 a[80:83], a[8:11], v[32:35], a[80:83]
    ds_read_b64_tr_b16 a[26:27], v2 offset:6656
    s_add_u32 m0, s40, 6144
    v_mfma_f32_16x16x32_bf16 a[88:91], a[8:11], v[36:39], a[88:91]
    buffer_load_dwordx4 v9, s[12:15], s35 offen offset:0 nt lds
    s_waitcnt lgkmcnt(6)
    v_mfma_f32_16x16x32_bf16 a[68:71], a[12:15], v[24:27], a[68:71]
    ds_read_b64_tr_b16 a[28:29], v2 offset:6152
    v_fma_mix_f32 v14, v55, v21, v23 op_sel_hi:[1,1,1]
    v_mfma_f32_16x16x32_bf16 a[76:79], a[12:15], v[28:31], a[76:79]
    v_fma_mix_f32 v15, v55, v21, v23 op_sel:[1,1,1] op_sel_hi:[1,1,1]
    v_cvt_pk_bf16_f32 v55, v14, v15
    v_mfma_f32_16x16x32_bf16 a[84:87], a[12:15], v[32:35], a[84:87]
    ds_read_b64_tr_b16 a[30:31], v2 offset:6664
    v_mfma_f32_16x16x32_bf16 a[92:95], a[12:15], v[36:39], a[92:95]
    buffer_load_dwordx4 v[76:79], v8, s[24:27], s37 offen offset:3072 sc1
    ds_read_b128 v[20:23], v7 offset:272
    s_waitcnt lgkmcnt(7)
    v_mfma_f32_16x16x32_bf16 v[96:99], a[16:19], v[40:43], v[96:99]
    ds_read_b64_tr_b16 a[0:1], v1 offset:8192
    v_fma_mix_f32 v12, v56, v16, v18 op_sel_hi:[1,1,1]
    v_mfma_f32_16x16x32_bf16 v[104:107], a[16:19], v[44:47], v[104:107]
    v_fma_mix_f32 v13, v56, v16, v18 op_sel:[1,1,1] op_sel_hi:[1,1,1]
    v_cvt_pk_bf16_f32 v56, v12, v13
    v_mfma_f32_16x16x32_bf16 v[112:115], a[16:19], v[48:51], v[112:115]
    ds_read_b64_tr_b16 a[2:3], v1 offset:8704
    v_fma_mix_f32 v14, v60, v16, v18 op_sel_hi:[1,1,1]
    v_mfma_f32_16x16x32_bf16 v[120:123], a[16:19], v[52:55], v[120:123]
    v_fma_mix_f32 v15, v60, v16, v18 op_sel:[1,1,1] op_sel_hi:[1,1,1]
    v_cvt_pk_bf16_f32 v60, v14, v15
    s_waitcnt lgkmcnt(7)
    v_mfma_f32_16x16x32_bf16 v[100:103], a[20:23], v[40:43], v[100:103]
    ds_read_b64_tr_b16 a[4:5], v1 offset:8200
    v_mfma_f32_16x16x32_bf16 v[108:111], a[20:23], v[44:47], v[108:111]
    buffer_load_dwordx4 v[80:83], v8, s[24:27], s38 offen offset:3072 sc1
    v_mfma_f32_16x16x32_bf16 v[116:119], a[20:23], v[48:51], v[116:119]
    ds_read_b64_tr_b16 a[6:7], v1 offset:8712
    s_add_u32 m0, s40, 8064
    v_fma_mix_f32 v12, v64, v16, v18 op_sel_hi:[1,1,1]
    v_mfma_f32_16x16x32_bf16 v[124:127], a[20:23], v[52:55], v[124:127]
    buffer_load_dwordx4 v9, s[12:15], s35 offen offset:128 nt lds
    s_waitcnt lgkmcnt(7)
    v_mfma_f32_16x16x32_bf16 v[128:131], a[24:27], v[40:43], v[128:131]
    ds_read_b64_tr_b16 a[8:9], v2 offset:8192
    v_fma_mix_f32 v13, v64, v16, v18 op_sel:[1,1,1] op_sel_hi:[1,1,1]
    v_mfma_f32_16x16x32_bf16 v[136:139], a[24:27], v[44:47], v[136:139]
    v_cvt_pk_bf16_f32 v64, v12, v13
    v_fma_mix_f32 v14, v68, v16, v18 op_sel_hi:[1,1,1]
    v_mfma_f32_16x16x32_bf16 v[144:147], a[24:27], v[48:51], v[144:147]
    ds_read_b64_tr_b16 a[10:11], v2 offset:8704
    v_fma_mix_f32 v15, v68, v16, v18 op_sel:[1,1,1] op_sel_hi:[1,1,1]
    v_mfma_f32_16x16x32_bf16 v[152:155], a[24:27], v[52:55], v[152:155]
    buffer_load_dwordx4 v[84:87], v8, s[24:27], s39 offen offset:3072 sc1
    s_waitcnt lgkmcnt(7)
    v_mfma_f32_16x16x32_bf16 v[132:135], a[28:31], v[40:43], v[132:135]
    ds_read_b64_tr_b16 a[12:13], v2 offset:8200
    v_cvt_pk_bf16_f32 v68, v14, v15
    v_mfma_f32_16x16x32_bf16 v[140:143], a[28:31], v[44:47], v[140:143]
    v_fma_mix_f32 v12, v57, v17, v19 op_sel_hi:[1,1,1]
    v_mfma_f32_16x16x32_bf16 v[148:151], a[28:31], v[48:51], v[148:151]
    ds_read_b64_tr_b16 a[14:15], v2 offset:8712
    v_fma_mix_f32 v13, v57, v17, v19 op_sel:[1,1,1] op_sel_hi:[1,1,1]
    v_mfma_f32_16x16x32_bf16 v[156:159], a[28:31], v[52:55], v[156:159]
    v_cvt_pk_bf16_f32 v57, v12, v13
    v_fma_mix_f32 v14, v61, v17, v19 op_sel_hi:[1,1,1]
    s_waitcnt lgkmcnt(6)
    v_mfma_f32_16x16x32_bf16 v[160:163], a[0:3], v[40:43], v[160:163]
    ds_read_b64_tr_b16 a[16:17], v1 offset:10240
    v_fma_mix_f32 v15, v61, v17, v19 op_sel:[1,1,1] op_sel_hi:[1,1,1]
    v_mfma_f32_16x16x32_bf16 v[168:171], a[0:3], v[44:47], v[168:171]
    s_add_u32 s36, s36, 4096
    s_add_u32 s37, s37, 4096
    s_add_u32 s38, s38, 4096
    s_add_u32 s39, s39, 4096
    buffer_load_dwordx4 v[24:27], v8, s[24:27], s36 offen offset:0 sc1
    v_mfma_f32_16x16x32_bf16 v[176:179], a[0:3], v[48:51], v[176:179]
    ds_read_b64_tr_b16 a[18:19], v1 offset:10752
    s_add_u32 m0, s40, 9984
    v_cvt_pk_bf16_f32 v61, v14, v15
    v_mfma_f32_16x16x32_bf16 v[184:187], a[0:3], v[52:55], v[184:187]
    buffer_load_dwordx4 v9, s[12:15], s35 offen offset:256 nt lds
    s_add_u32 s35, s35, 393216
    s_waitcnt lgkmcnt(6)
    v_mfma_f32_16x16x32_bf16 v[164:167], a[4:7], v[40:43], v[164:167]
    ds_read_b64_tr_b16 a[20:21], v1 offset:10248
    v_fma_mix_f32 v12, v65, v17, v19 op_sel_hi:[1,1,1]
    v_mfma_f32_16x16x32_bf16 v[172:175], a[4:7], v[44:47], v[172:175]
    v_fma_mix_f32 v13, v65, v17, v19 op_sel:[1,1,1] op_sel_hi:[1,1,1]
    v_cvt_pk_bf16_f32 v65, v12, v13
    v_mfma_f32_16x16x32_bf16 v[180:183], a[4:7], v[48:51], v[180:183]
    ds_read_b64_tr_b16 a[22:23], v1 offset:10760
    v_fma_mix_f32 v14, v69, v17, v19 op_sel_hi:[1,1,1]
    v_mfma_f32_16x16x32_bf16 v[188:191], a[4:7], v[52:55], v[188:191]
    buffer_load_dwordx4 v[28:31], v8, s[24:27], s37 offen offset:0 sc1
    s_waitcnt lgkmcnt(6)
    v_mfma_f32_16x16x32_bf16 v[192:195], a[8:11], v[40:43], v[192:195]
    ds_read_b64_tr_b16 a[24:25], v2 offset:10240
    v_mfma_f32_16x16x32_bf16 v[200:203], a[8:11], v[44:47], v[200:203]
    v_fma_mix_f32 v15, v69, v17, v19 op_sel:[1,1,1] op_sel_hi:[1,1,1]
    v_cvt_pk_bf16_f32 v69, v14, v15
    v_mfma_f32_16x16x32_bf16 v[208:211], a[8:11], v[48:51], v[208:211]
    ds_read_b64_tr_b16 a[26:27], v2 offset:10752
    v_fma_mix_f32 v12, v58, v20, v22 op_sel_hi:[1,1,1]
    v_mfma_f32_16x16x32_bf16 v[216:219], a[8:11], v[52:55], v[216:219]
    v_fma_mix_f32 v13, v58, v20, v22 op_sel:[1,1,1] op_sel_hi:[1,1,1]
    v_cvt_pk_bf16_f32 v58, v12, v13
    s_waitcnt lgkmcnt(6)
    v_mfma_f32_16x16x32_bf16 v[196:199], a[12:15], v[40:43], v[196:199]
    ds_read_b64_tr_b16 a[28:29], v2 offset:10248
    v_fma_mix_f32 v14, v62, v20, v22 op_sel_hi:[1,1,1]
    v_mfma_f32_16x16x32_bf16 v[204:207], a[12:15], v[44:47], v[204:207]
    buffer_load_dwordx4 v[32:35], v8, s[24:27], s38 offen offset:0 sc1
    v_mfma_f32_16x16x32_bf16 v[212:215], a[12:15], v[48:51], v[212:215]
    ds_read_b64_tr_b16 a[30:31], v2 offset:10760
    v_fma_mix_f32 v15, v62, v20, v22 op_sel:[1,1,1] op_sel_hi:[1,1,1]
    v_mfma_f32_16x16x32_bf16 v[220:223], a[12:15], v[52:55], v[220:223]
    v_cvt_pk_bf16_f32 v62, v14, v15
    v_fma_mix_f32 v12, v66, v20, v22 op_sel_hi:[1,1,1]
    s_waitcnt lgkmcnt(6)
    v_mfma_f32_16x16x32_bf16 v[224:227], a[16:19], v[40:43], v[224:227]
    s_barrier
    ds_read_b64_tr_b16 a[0:1], v1 offset:12288
    v_mfma_f32_16x16x32_bf16 v[232:235], a[16:19], v[44:47], v[232:235]
    v_fma_mix_f32 v13, v66, v20, v22 op_sel:[1,1,1] op_sel_hi:[1,1,1]
    v_cvt_pk_bf16_f32 v66, v12, v13
    v_mfma_f32_16x16x32_bf16 v[240:243], a[16:19], v[48:51], v[240:243]
    ds_read_b64_tr_b16 a[2:3], v1 offset:12800
    v_fma_mix_f32 v14, v70, v20, v22 op_sel_hi:[1,1,1]
    v_mfma_f32_16x16x32_bf16 v[248:251], a[16:19], v[52:55], v[248:251]
    v_fma_mix_f32 v15, v70, v20, v22 op_sel:[1,1,1] op_sel_hi:[1,1,1]
    v_cvt_pk_bf16_f32 v70, v14, v15
    s_waitcnt lgkmcnt(6)
    v_mfma_f32_16x16x32_bf16 v[228:231], a[20:23], v[40:43], v[228:231]
    ds_read_b64_tr_b16 a[4:5], v1 offset:12296
    v_fma_mix_f32 v12, v59, v21, v23 op_sel_hi:[1,1,1]
    v_mfma_f32_16x16x32_bf16 v[236:239], a[20:23], v[44:47], v[236:239]
    buffer_load_dwordx4 v[36:39], v8, s[24:27], s39 offen offset:0 sc1
    v_mfma_f32_16x16x32_bf16 v[244:247], a[20:23], v[48:51], v[244:247]
    ds_read_b64_tr_b16 a[6:7], v1 offset:12808
    v_fma_mix_f32 v13, v59, v21, v23 op_sel:[1,1,1] op_sel_hi:[1,1,1]
    v_mfma_f32_16x16x32_bf16 v[252:255], a[20:23], v[52:55], v[252:255]
    v_cvt_pk_bf16_f32 v59, v12, v13
    v_fma_mix_f32 v14, v63, v21, v23 op_sel_hi:[1,1,1]
    s_waitcnt lgkmcnt(6)
    v_mfma_f32_16x16x32_bf16 a[64:67], a[24:27], v[40:43], a[64:67]
    ds_read_b64_tr_b16 a[8:9], v2 offset:12288
    v_fma_mix_f32 v15, v63, v21, v23 op_sel:[1,1,1] op_sel_hi:[1,1,1]
    v_mfma_f32_16x16x32_bf16 a[72:75], a[24:27], v[44:47], a[72:75]
    v_cvt_pk_bf16_f32 v63, v14, v15
    v_mfma_f32_16x16x32_bf16 a[80:83], a[24:27], v[48:51], a[80:83]
    ds_read_b64_tr_b16 a[10:11], v2 offset:12800
    v_fma_mix_f32 v12, v67, v21, v23 op_sel_hi:[1,1,1]
    v_mfma_f32_16x16x32_bf16 a[88:91], a[24:27], v[52:55], a[88:91]
    v_fma_mix_f32 v13, v67, v21, v23 op_sel:[1,1,1] op_sel_hi:[1,1,1]
    v_cvt_pk_bf16_f32 v67, v12, v13
    s_waitcnt lgkmcnt(6)
    v_mfma_f32_16x16x32_bf16 a[68:71], a[28:31], v[40:43], a[68:71]
    ds_read_b64_tr_b16 a[12:13], v2 offset:12296
    v_fma_mix_f32 v14, v71, v21, v23 op_sel_hi:[1,1,1]
    v_mfma_f32_16x16x32_bf16 a[76:79], a[28:31], v[44:47], a[76:79]
    v_fma_mix_f32 v15, v71, v21, v23 op_sel:[1,1,1] op_sel_hi:[1,1,1]
    v_cvt_pk_bf16_f32 v71, v14, v15
    v_mfma_f32_16x16x32_bf16 a[84:87], a[28:31], v[48:51], a[84:87]
    ds_read_b64_tr_b16 a[14:15], v2 offset:12808
    v_mfma_f32_16x16x32_bf16 a[92:95], a[28:31], v[52:55], a[92:95]
    s_waitcnt lgkmcnt(6)
    v_mfma_f32_16x16x32_bf16 v[96:99], a[0:3], v[56:59], v[96:99]
    ds_read_b64_tr_b16 a[16:17], v1 offset:14336
    v_mfma_f32_16x16x32_bf16 v[104:107], a[0:3], v[60:63], v[104:107]
    buffer_load_dwordx4 v[40:43], v8, s[24:27], s36 offen offset:1024 sc1
    v_mfma_f32_16x16x32_bf16 v[112:115], a[0:3], v[64:67], v[112:115]
    ds_read_b64_tr_b16 a[18:19], v1 offset:14848
    v_mfma_f32_16x16x32_bf16 v[120:123], a[0:3], v[68:71], v[120:123]
    s_waitcnt lgkmcnt(6)
    v_mfma_f32_16x16x32_bf16 v[100:103], a[4:7], v[56:59], v[100:103]
    ds_read_b64_tr_b16 a[20:21], v1 offset:14344
    v_mfma_f32_16x16x32_bf16 v[108:111], a[4:7], v[60:63], v[108:111]
    v_mfma_f32_16x16x32_bf16 v[116:119], a[4:7], v[64:67], v[116:119]
    ds_read_b64_tr_b16 a[22:23], v1 offset:14856
    s_add_u32 m0, s40, 12288
    v_mfma_f32_16x16x32_bf16 v[124:127], a[4:7], v[68:71], v[124:127]
    buffer_load_dwordx4 v9, s[12:15], s35 offen offset:0 nt lds
    s_waitcnt lgkmcnt(6)
    v_mfma_f32_16x16x32_bf16 v[128:131], a[8:11], v[56:59], v[128:131]
    ds_read_b64_tr_b16 a[24:25], v2 offset:14336
    v_mfma_f32_16x16x32_bf16 v[136:139], a[8:11], v[60:63], v[136:139]
    v_mfma_f32_16x16x32_bf16 v[144:147], a[8:11], v[64:67], v[144:147]
    ds_read_b64_tr_b16 a[26:27], v2 offset:14848
    v_mfma_f32_16x16x32_bf16 v[152:155], a[8:11], v[68:71], v[152:155]
    s_waitcnt lgkmcnt(6)
    v_mfma_f32_16x16x32_bf16 v[132:135], a[12:15], v[56:59], v[132:135]
    ds_read_b64_tr_b16 a[28:29], v2 offset:14344
    v_mfma_f32_16x16x32_bf16 v[140:143], a[12:15], v[60:63], v[140:143]
    buffer_load_dwordx4 v[44:47], v8, s[24:27], s37 offen offset:1024 sc1
    v_mfma_f32_16x16x32_bf16 v[148:151], a[12:15], v[64:67], v[148:151]
    ds_read_b64_tr_b16 a[30:31], v2 offset:14856
    v_mfma_f32_16x16x32_bf16 v[156:159], a[12:15], v[68:71], v[156:159]
    s_waitcnt lgkmcnt(6)
    v_mfma_f32_16x16x32_bf16 v[160:163], a[16:19], v[56:59], v[160:163]
    ds_read_b64_tr_b16 a[0:1], v1 offset:16384
    v_mfma_f32_16x16x32_bf16 v[168:171], a[16:19], v[60:63], v[168:171]
    v_mfma_f32_16x16x32_bf16 v[176:179], a[16:19], v[64:67], v[176:179]
    ds_read_b64_tr_b16 a[2:3], v1 offset:16896
    s_add_u32 m0, s40, 14208
    v_mfma_f32_16x16x32_bf16 v[184:187], a[16:19], v[68:71], v[184:187]
    buffer_load_dwordx4 v9, s[12:15], s35 offen offset:128 nt lds
    s_waitcnt lgkmcnt(6)
    v_mfma_f32_16x16x32_bf16 v[164:167], a[20:23], v[56:59], v[164:167]
    ds_read_b64_tr_b16 a[4:5], v1 offset:16392
    v_mfma_f32_16x16x32_bf16 v[172:175], a[20:23], v[60:63], v[172:175]
    v_mfma_f32_16x16x32_bf16 v[180:183], a[20:23], v[64:67], v[180:183]
    ds_read_b64_tr_b16 a[6:7], v1 offset:16904
    v_mfma_f32_16x16x32_bf16 v[188:191], a[20:23], v[68:71], v[188:191]
    s_waitcnt lgkmcnt(6)
    v_mfma_f32_16x16x32_bf16 v[192:195], a[24:27], v[56:59], v[192:195]
    ds_read_b64_tr_b16 a[8:9], v2 offset:16384
    v_mfma_f32_16x16x32_bf16 v[200:203], a[24:27], v[60:63], v[200:203]
    buffer_load_dwordx4 v[48:51], v8, s[24:27], s38 offen offset:1024 sc1
    v_mfma_f32_16x16x32_bf16 v[208:211], a[24:27], v[64:67], v[208:211]
    ds_read_b64_tr_b16 a[10:11], v2 offset:16896
    v_mfma_f32_16x16x32_bf16 v[216:219], a[24:27], v[68:71], v[216:219]
    s_waitcnt lgkmcnt(6)
    v_mfma_f32_16x16x32_bf16 v[196:199], a[28:31], v[56:59], v[196:199]
    ds_read_b64_tr_b16 a[12:13], v2 offset:16392
    v_mfma_f32_16x16x32_bf16 v[204:207], a[28:31], v[60:63], v[204:207]
    v_mfma_f32_16x16x32_bf16 v[212:215], a[28:31], v[64:67], v[212:215]
    ds_read_b64_tr_b16 a[14:15], v2 offset:16904
    s_add_u32 m0, s40, 16128
    v_mfma_f32_16x16x32_bf16 v[220:223], a[28:31], v[68:71], v[220:223]
    buffer_load_dwordx4 v9, s[12:15], s35 offen offset:256 nt lds
    s_add_u32 s35, s35, 393216
    s_waitcnt lgkmcnt(6)
    v_mfma_f32_16x16x32_bf16 v[224:227], a[0:3], v[56:59], v[224:227]
    ds_read_b64_tr_b16 a[16:17], v1 offset:18432
    v_mfma_f32_16x16x32_bf16 v[232:235], a[0:3], v[60:63], v[232:235]
    v_mfma_f32_16x16x32_bf16 v[240:243], a[0:3], v[64:67], v[240:243]
    ds_read_b64_tr_b16 a[18:19], v1 offset:18944
    v_mfma_f32_16x16x32_bf16 v[248:251], a[0:3], v[68:71], v[248:251]
    s_waitcnt lgkmcnt(6)
    v_mfma_f32_16x16x32_bf16 v[228:231], a[4:7], v[56:59], v[228:231]
    ds_read_b64_tr_b16 a[20:21], v1 offset:18440
    v_mfma_f32_16x16x32_bf16 v[236:239], a[4:7], v[60:63], v[236:239]
    buffer_load_dwordx4 v[52:55], v8, s[24:27], s39 offen offset:1024 sc1
    v_mfma_f32_16x16x32_bf16 v[244:247], a[4:7], v[64:67], v[244:247]
    ds_read_b64_tr_b16 a[22:23], v1 offset:18952
    v_mfma_f32_16x16x32_bf16 v[252:255], a[4:7], v[68:71], v[252:255]
    s_waitcnt lgkmcnt(6)
    v_mfma_f32_16x16x32_bf16 a[64:67], a[8:11], v[56:59], a[64:67]
    ds_read_b64_tr_b16 a[24:25], v2 offset:18432
    v_mfma_f32_16x16x32_bf16 a[72:75], a[8:11], v[60:63], a[72:75]
    v_mfma_f32_16x16x32_bf16 a[80:83], a[8:11], v[64:67], a[80:83]
    ds_read_b64_tr_b16 a[26:27], v2 offset:18944
    s_add_u32 m0, s40, 18432
    v_mfma_f32_16x16x32_bf16 a[88:91], a[8:11], v[68:71], a[88:91]
    buffer_load_dwordx4 v9, s[12:15], s35 offen offset:0 nt lds
    s_waitcnt lgkmcnt(6)
    v_mfma_f32_16x16x32_bf16 a[68:71], a[12:15], v[56:59], a[68:71]
    ds_read_b64_tr_b16 a[28:29], v2 offset:18440
    v_mfma_f32_16x16x32_bf16 a[76:79], a[12:15], v[60:63], a[76:79]
    v_mfma_f32_16x16x32_bf16 a[84:87], a[12:15], v[64:67], a[84:87]
    ds_read_b64_tr_b16 a[30:31], v2 offset:18952
    v_mfma_f32_16x16x32_bf16 a[92:95], a[12:15], v[68:71], a[92:95]
    s_waitcnt vmcnt(13) lgkmcnt(6)
    v_mfma_f32_16x16x32_bf16 v[96:99], a[16:19], v[72:75], v[96:99]
    ds_read_b64_tr_b16 a[0:1], v1 offset:20480
    v_mfma_f32_16x16x32_bf16 v[104:107], a[16:19], v[76:79], v[104:107]
    buffer_load_dwordx4 v[56:59], v8, s[24:27], s36 offen offset:2048 sc1
    v_mfma_f32_16x16x32_bf16 v[112:115], a[16:19], v[80:83], v[112:115]
    ds_read_b64_tr_b16 a[2:3], v1 offset:20992
    v_mfma_f32_16x16x32_bf16 v[120:123], a[16:19], v[84:87], v[120:123]
    s_waitcnt lgkmcnt(6)
    v_mfma_f32_16x16x32_bf16 v[100:103], a[20:23], v[72:75], v[100:103]
    ds_read_b64_tr_b16 a[4:5], v1 offset:20488
    v_mfma_f32_16x16x32_bf16 v[108:111], a[20:23], v[76:79], v[108:111]
    v_mfma_f32_16x16x32_bf16 v[116:119], a[20:23], v[80:83], v[116:119]
    ds_read_b64_tr_b16 a[6:7], v1 offset:21000
    s_add_u32 m0, s40, 20352
    v_mfma_f32_16x16x32_bf16 v[124:127], a[20:23], v[84:87], v[124:127]
    buffer_load_dwordx4 v9, s[12:15], s35 offen offset:128 nt lds
    s_waitcnt lgkmcnt(6)
    v_mfma_f32_16x16x32_bf16 v[128:131], a[24:27], v[72:75], v[128:131]
    ds_read_b64_tr_b16 a[8:9], v2 offset:20480
    v_mfma_f32_16x16x32_bf16 v[136:139], a[24:27], v[76:79], v[136:139]
    v_mfma_f32_16x16x32_bf16 v[144:147], a[24:27], v[80:83], v[144:147]
    ds_read_b64_tr_b16 a[10:11], v2 offset:20992
    v_mfma_f32_16x16x32_bf16 v[152:155], a[24:27], v[84:87], v[152:155]
    s_waitcnt lgkmcnt(6)
    v_mfma_f32_16x16x32_bf16 v[132:135], a[28:31], v[72:75], v[132:135]
    ds_read_b64_tr_b16 a[12:13], v2 offset:20488
    v_mfma_f32_16x16x32_bf16 v[140:143], a[28:31], v[76:79], v[140:143]
    buffer_load_dwordx4 v[60:63], v8, s[24:27], s37 offen offset:2048 sc1
    v_mfma_f32_16x16x32_bf16 v[148:151], a[28:31], v[80:83], v[148:151]
    ds_read_b64_tr_b16 a[14:15], v2 offset:21000
    v_mfma_f32_16x16x32_bf16 v[156:159], a[28:31], v[84:87], v[156:159]
    s_waitcnt lgkmcnt(6)
    v_mfma_f32_16x16x32_bf16 v[160:163], a[0:3], v[72:75], v[160:163]
    ds_read_b64_tr_b16 a[16:17], v1 offset:22528
    v_mfma_f32_16x16x32_bf16 v[168:171], a[0:3], v[76:79], v[168:171]
    v_mfma_f32_16x16x32_bf16 v[176:179], a[0:3], v[80:83], v[176:179]
    ds_read_b64_tr_b16 a[18:19], v1 offset:23040
    s_add_u32 m0, s40, 22272
    v_mfma_f32_16x16x32_bf16 v[184:187], a[0:3], v[84:87], v[184:187]
    buffer_load_dwordx4 v9, s[12:15], s35 offen offset:256 nt lds
    s_add_u32 s35, s35, 393216
    s_sub_u32 s40, s40, s52
    s_waitcnt lgkmcnt(6)
    v_mfma_f32_16x16x32_bf16 v[164:167], a[4:7], v[72:75], v[164:167]
    ds_read_b64_tr_b16 a[20:21], v1 offset:22536
    v_mfma_f32_16x16x32_bf16 v[172:175], a[4:7], v[76:79], v[172:175]
    v_mfma_f32_16x16x32_bf16 v[180:183], a[4:7], v[80:83], v[180:183]
    ds_read_b64_tr_b16 a[22:23], v1 offset:23048
    v_mfma_f32_16x16x32_bf16 v[188:191], a[4:7], v[84:87], v[188:191]
    s_waitcnt lgkmcnt(6)
    v_mfma_f32_16x16x32_bf16 v[192:195], a[8:11], v[72:75], v[192:195]
    ds_read_b64_tr_b16 a[24:25], v2 offset:22528
    v_mfma_f32_16x16x32_bf16 v[200:203], a[8:11], v[76:79], v[200:203]
    buffer_load_dwordx4 v[64:67], v8, s[24:27], s38 offen offset:2048 sc1
    v_mfma_f32_16x16x32_bf16 v[208:211], a[8:11], v[80:83], v[208:211]
    ds_read_b64_tr_b16 a[26:27], v2 offset:23040
    v_mfma_f32_16x16x32_bf16 v[216:219], a[8:11], v[84:87], v[216:219]
    s_waitcnt lgkmcnt(6)
    v_mfma_f32_16x16x32_bf16 v[196:199], a[12:15], v[72:75], v[196:199]
    ds_read_b64_tr_b16 a[28:29], v2 offset:22536
    v_mfma_f32_16x16x32_bf16 v[204:207], a[12:15], v[76:79], v[204:207]
    v_mfma_f32_16x16x32_bf16 v[212:215], a[12:15], v[80:83], v[212:215]
    ds_read_b64_tr_b16 a[30:31], v2 offset:23048
    v_mfma_f32_16x16x32_bf16 v[220:223], a[12:15], v[84:87], v[220:223]
    s_waitcnt lgkmcnt(6)
    v_mfma_f32_16x16x32_bf16 v[224:227], a[16:19], v[72:75], v[224:227]
    s_waitcnt vmcnt(16)
    s_barrier
    v_add_u32 v1, s52, v1
    v_add_u32 v2, s52, v2
    s_sub_u32 s52, 0, s52
    ds_read_b64_tr_b16 a[0:1], v1 offset:0
    v_mfma_f32_16x16x32_bf16 v[232:235], a[16:19], v[76:79], v[232:235]
    v_mfma_f32_16x16x32_bf16 v[240:243], a[16:19], v[80:83], v[240:243]
    ds_read_b64_tr_b16 a[2:3], v1 offset:512
    v_mfma_f32_16x16x32_bf16 v[248:251], a[16:19], v[84:87], v[248:251]
    s_waitcnt lgkmcnt(6)
    v_mfma_f32_16x16x32_bf16 v[228:231], a[20:23], v[72:75], v[228:231]
    ds_read_b64_tr_b16 a[4:5], v1 offset:8
    v_mfma_f32_16x16x32_bf16 v[236:239], a[20:23], v[76:79], v[236:239]
    buffer_load_dwordx4 v[68:71], v8, s[24:27], s39 offen offset:2048 sc1
    v_mfma_f32_16x16x32_bf16 v[244:247], a[20:23], v[80:83], v[244:247]
    ds_read_b64_tr_b16 a[6:7], v1 offset:520
    v_mfma_f32_16x16x32_bf16 v[252:255], a[20:23], v[84:87], v[252:255]
    s_waitcnt lgkmcnt(6)
    v_mfma_f32_16x16x32_bf16 a[64:67], a[24:27], v[72:75], a[64:67]
    ds_read_b64_tr_b16 a[8:9], v2 offset:0
    v_mfma_f32_16x16x32_bf16 a[72:75], a[24:27], v[76:79], a[72:75]
    v_mfma_f32_16x16x32_bf16 a[80:83], a[24:27], v[80:83], a[80:83]
    ds_read_b64_tr_b16 a[10:11], v2 offset:512
    v_mfma_f32_16x16x32_bf16 a[88:91], a[24:27], v[84:87], a[88:91]
    s_waitcnt lgkmcnt(6)
    v_mfma_f32_16x16x32_bf16 a[68:71], a[28:31], v[72:75], a[68:71]
    ds_read_b64_tr_b16 a[12:13], v2 offset:8
    v_mfma_f32_16x16x32_bf16 a[76:79], a[28:31], v[76:79], a[76:79]
    v_mfma_f32_16x16x32_bf16 a[84:87], a[28:31], v[80:83], a[84:87]
    ds_read_b64_tr_b16 a[14:15], v2 offset:520
    v_mfma_f32_16x16x32_bf16 a[92:95], a[28:31], v[84:87], a[92:95]
    s_waitcnt vmcnt(14) lgkmcnt(6)
    v_mfma_f32_16x16x32_bf16 v[96:99], a[0:3], v[24:27], v[96:99]
    ds_read_b64_tr_b16 a[16:17], v1 offset:2048
    v_mfma_f32_16x16x32_bf16 v[104:107], a[0:3], v[28:31], v[104:107]
    buffer_load_dwordx4 v[72:75], v8, s[24:27], s36 offen offset:3072 sc1
    v_mfma_f32_16x16x32_bf16 v[112:115], a[0:3], v[32:35], v[112:115]
    ds_read_b64_tr_b16 a[18:19], v1 offset:2560
    v_mfma_f32_16x16x32_bf16 v[120:123], a[0:3], v[36:39], v[120:123]
    s_waitcnt lgkmcnt(6)
    v_mfma_f32_16x16x32_bf16 v[100:103], a[4:7], v[24:27], v[100:103]
    ds_read_b64_tr_b16 a[20:21], v1 offset:2056
    v_mfma_f32_16x16x32_bf16 v[108:111], a[4:7], v[28:31], v[108:111]
    v_mfma_f32_16x16x32_bf16 v[116:119], a[4:7], v[32:35], v[116:119]
    ds_read_b64_tr_b16 a[22:23], v1 offset:2568
    s_add_u32 m0, s40, 0
    v_mfma_f32_16x16x32_bf16 v[124:127], a[4:7], v[36:39], v[124:127]
    buffer_load_dwordx4 v9, s[12:15], s35 offen offset:0 nt lds
    s_waitcnt lgkmcnt(6)
    v_mfma_f32_16x16x32_bf16 v[128:131], a[8:11], v[24:27], v[128:131]
    ds_read_b64_tr_b16 a[24:25], v2 offset:2048
    v_mfma_f32_16x16x32_bf16 v[136:139], a[8:11], v[28:31], v[136:139]
    v_mfma_f32_16x16x32_bf16 v[144:147], a[8:11], v[32:35], v[144:147]
    ds_read_b64_tr_b16 a[26:27], v2 offset:2560
    v_mfma_f32_16x16x32_bf16 v[152:155], a[8:11], v[36:39], v[152:155]
    s_waitcnt lgkmcnt(6)
    v_mfma_f32_16x16x32_bf16 v[132:135], a[12:15], v[24:27], v[132:135]
    ds_read_b64_tr_b16 a[28:29], v2 offset:2056
    v_mfma_f32_16x16x32_bf16 v[140:143], a[12:15], v[28:31], v[140:143]
    buffer_load_dwordx4 v[76:79], v8, s[24:27], s37 offen offset:3072 sc1
    v_mfma_f32_16x16x32_bf16 v[148:151], a[12:15], v[32:35], v[148:151]
    ds_read_b64_tr_b16 a[30:31], v2 offset:2568
    v_mfma_f32_16x16x32_bf16 v[156:159], a[12:15], v[36:39], v[156:159]
    s_waitcnt lgkmcnt(6)
    v_mfma_f32_16x16x32_bf16 v[160:163], a[16:19], v[24:27], v[160:163]
    ds_read_b64_tr_b16 a[0:1], v1 offset:4096
    v_mfma_f32_16x16x32_bf16 v[168:171], a[16:19], v[28:31], v[168:171]
    v_mfma_f32_16x16x32_bf16 v[176:179], a[16:19], v[32:35], v[176:179]
    ds_read_b64_tr_b16 a[2:3], v1 offset:4608
    s_add_u32 m0, s40, 1920
    v_mfma_f32_16x16x32_bf16 v[184:187], a[16:19], v[36:39], v[184:187]
    buffer_load_dwordx4 v9, s[12:15], s35 offen offset:128 nt lds
    s_waitcnt lgkmcnt(6)
    v_mfma_f32_16x16x32_bf16 v[164:167], a[20:23], v[24:27], v[164:167]
    ds_read_b64_tr_b16 a[4:5], v1 offset:4104
    v_mfma_f32_16x16x32_bf16 v[172:175], a[20:23], v[28:31], v[172:175]
    v_mfma_f32_16x16x32_bf16 v[180:183], a[20:23], v[32:35], v[180:183]
    ds_read_b64_tr_b16 a[6:7], v1 offset:4616
    v_mfma_f32_16x16x32_bf16 v[188:191], a[20:23], v[36:39], v[188:191]
    s_waitcnt lgkmcnt(6)
    v_mfma_f32_16x16x32_bf16 v[192:195], a[24:27], v[24:27], v[192:195]
    ds_read_b64_tr_b16 a[8:9], v2 offset:4096
    v_mfma_f32_16x16x32_bf16 v[200:203], a[24:27], v[28:31], v[200:203]
    buffer_load_dwordx4 v[80:83], v8, s[24:27], s38 offen offset:3072 sc1
    v_mfma_f32_16x16x32_bf16 v[208:211], a[24:27], v[32:35], v[208:211]
    ds_read_b64_tr_b16 a[10:11], v2 offset:4608
    v_mfma_f32_16x16x32_bf16 v[216:219], a[24:27], v[36:39], v[216:219]
    s_waitcnt lgkmcnt(6)
    v_mfma_f32_16x16x32_bf16 v[196:199], a[28:31], v[24:27], v[196:199]
    ds_read_b64_tr_b16 a[12:13], v2 offset:4104
    v_mfma_f32_16x16x32_bf16 v[204:207], a[28:31], v[28:31], v[204:207]
    v_mfma_f32_16x16x32_bf16 v[212:215], a[28:31], v[32:35], v[212:215]
    ds_read_b64_tr_b16 a[14:15], v2 offset:4616
    s_add_u32 m0, s40, 3840
    v_mfma_f32_16x16x32_bf16 v[220:223], a[28:31], v[36:39], v[220:223]
    buffer_load_dwordx4 v9, s[12:15], s35 offen offset:256 nt lds
    s_add_u32 s35, s35, 393216
    s_waitcnt lgkmcnt(6)
    v_mfma_f32_16x16x32_bf16 v[224:227], a[0:3], v[24:27], v[224:227]
    ds_read_b64_tr_b16 a[16:17], v1 offset:6144
    v_mfma_f32_16x16x32_bf16 v[232:235], a[0:3], v[28:31], v[232:235]
    v_mfma_f32_16x16x32_bf16 v[240:243], a[0:3], v[32:35], v[240:243]
    ds_read_b64_tr_b16 a[18:19], v1 offset:6656
    v_mfma_f32_16x16x32_bf16 v[248:251], a[0:3], v[36:39], v[248:251]
    s_waitcnt lgkmcnt(6)
    v_mfma_f32_16x16x32_bf16 v[228:231], a[4:7], v[24:27], v[228:231]
    ds_read_b64_tr_b16 a[20:21], v1 offset:6152
    v_mfma_f32_16x16x32_bf16 v[236:239], a[4:7], v[28:31], v[236:239]
    buffer_load_dwordx4 v[84:87], v8, s[24:27], s39 offen offset:3072 sc1
    v_mfma_f32_16x16x32_bf16 v[244:247], a[4:7], v[32:35], v[244:247]
    ds_read_b64_tr_b16 a[22:23], v1 offset:6664
    v_mfma_f32_16x16x32_bf16 v[252:255], a[4:7], v[36:39], v[252:255]
    s_waitcnt lgkmcnt(6)
    v_mfma_f32_16x16x32_bf16 a[64:67], a[8:11], v[24:27], a[64:67]
    ds_read_b64_tr_b16 a[24:25], v2 offset:6144
    v_mfma_f32_16x16x32_bf16 a[72:75], a[8:11], v[28:31], a[72:75]
    v_mfma_f32_16x16x32_bf16 a[80:83], a[8:11], v[32:35], a[80:83]
    ds_read_b64_tr_b16 a[26:27], v2 offset:6656
    s_add_u32 m0, s40, 6144
    v_mfma_f32_16x16x32_bf16 a[88:91], a[8:11], v[36:39], a[88:91]
    buffer_load_dwordx4 v9, s[12:15], s35 offen offset:0 nt lds
    s_waitcnt lgkmcnt(6)
    v_mfma_f32_16x16x32_bf16 a[68:71], a[12:15], v[24:27], a[68:71]
    ds_read_b64_tr_b16 a[28:29], v2 offset:6152
    v_mfma_f32_16x16x32_bf16 a[76:79], a[12:15], v[28:31], a[76:79]
    v_mfma_f32_16x16x32_bf16 a[84:87], a[12:15], v[32:35], a[84:87]
    ds_read_b64_tr_b16 a[30:31], v2 offset:6664
    v_mfma_f32_16x16x32_bf16 a[92:95], a[12:15], v[36:39], a[92:95]
    s_waitcnt vmcnt(15) lgkmcnt(6)
    v_mfma_f32_16x16x32_bf16 v[96:99], a[16:19], v[40:43], v[96:99]
    ds_read_b64_tr_b16 a[0:1], v1 offset:8192
    v_mfma_f32_16x16x32_bf16 v[104:107], a[16:19], v[44:47], v[104:107]
    s_add_u32 s36, s36, 4096
    s_add_u32 s37, s37, 4096
    s_add_u32 s38, s38, 4096
    s_add_u32 s39, s39, 4096
    buffer_load_dwordx4 v[24:27], v8, s[24:27], s36 offen offset:0 sc1
    v_mfma_f32_16x16x32_bf16 v[112:115], a[16:19], v[48:51], v[112:115]
    ds_read_b64_tr_b16 a[2:3], v1 offset:8704
    v_mfma_f32_16x16x32_bf16 v[120:123], a[16:19], v[52:55], v[120:123]
    s_waitcnt lgkmcnt(6)
    v_mfma_f32_16x16x32_bf16 v[100:103], a[20:23], v[40:43], v[100:103]
    ds_read_b64_tr_b16 a[4:5], v1 offset:8200
    v_mfma_f32_16x16x32_bf16 v[108:111], a[20:23], v[44:47], v[108:111]
    v_mfma_f32_16x16x32_bf16 v[116:119], a[20:23], v[48:51], v[116:119]
    ds_read_b64_tr_b16 a[6:7], v1 offset:8712
    s_add_u32 m0, s40, 8064
    v_mfma_f32_16x16x32_bf16 v[124:127], a[20:23], v[52:55], v[124:127]
    buffer_load_dwordx4 v9, s[12:15], s35 offen offset:128 nt lds
    s_waitcnt lgkmcnt(6)
    v_mfma_f32_16x16x32_bf16 v[128:131], a[24:27], v[40:43], v[128:131]
    ds_read_b64_tr_b16 a[8:9], v2 offset:8192
    v_mfma_f32_16x16x32_bf16 v[136:139], a[24:27], v[44:47], v[136:139]
    v_mfma_f32_16x16x32_bf16 v[144:147], a[24:27], v[48:51], v[144:147]
    ds_read_b64_tr_b16 a[10:11], v2 offset:8704
    v_mfma_f32_16x16x32_bf16 v[152:155], a[24:27], v[52:55], v[152:155]
    s_waitcnt lgkmcnt(6)
    v_mfma_f32_16x16x32_bf16 v[132:135], a[28:31], v[40:43], v[132:135]
    ds_read_b64_tr_b16 a[12:13], v2 offset:8200
    v_mfma_f32_16x16x32_bf16 v[140:143], a[28:31], v[44:47], v[140:143]
    buffer_load_dwordx4 v[28:31], v8, s[24:27], s37 offen offset:0 sc1
    v_mfma_f32_16x16x32_bf16 v[148:151], a[28:31], v[48:51], v[148:151]
    ds_read_b64_tr_b16 a[14:15], v2 offset:8712
    v_mfma_f32_16x16x32_bf16 v[156:159], a[28:31], v[52:55], v[156:159]
    s_waitcnt lgkmcnt(6)
    v_mfma_f32_16x16x32_bf16 v[160:163], a[0:3], v[40:43], v[160:163]
    ds_read_b64_tr_b16 a[16:17], v1 offset:10240
    v_mfma_f32_16x16x32_bf16 v[168:171], a[0:3], v[44:47], v[168:171]
    v_mfma_f32_16x16x32_bf16 v[176:179], a[0:3], v[48:51], v[176:179]
    ds_read_b64_tr_b16 a[18:19], v1 offset:10752
    s_add_u32 m0, s40, 9984
    v_mfma_f32_16x16x32_bf16 v[184:187], a[0:3], v[52:55], v[184:187]
    buffer_load_dwordx4 v9, s[12:15], s35 offen offset:256 nt lds
    s_add_u32 s35, s35, 393216
    s_waitcnt lgkmcnt(6)
    v_mfma_f32_16x16x32_bf16 v[164:167], a[4:7], v[40:43], v[164:167]
    ds_read_b64_tr_b16 a[20:21], v1 offset:10248
    v_mfma_f32_16x16x32_bf16 v[172:175], a[4:7], v[44:47], v[172:175]
    v_mfma_f32_16x16x32_bf16 v[180:183], a[4:7], v[48:51], v[180:183]
    ds_read_b64_tr_b16 a[22:23], v1 offset:10760
    v_mfma_f32_16x16x32_bf16 v[188:191], a[4:7], v[52:55], v[188:191]
    s_waitcnt lgkmcnt(6)
    v_mfma_f32_16x16x32_bf16 v[192:195], a[8:11], v[40:43], v[192:195]
    ds_read_b64_tr_b16 a[24:25], v2 offset:10240
    v_mfma_f32_16x16x32_bf16 v[200:203], a[8:11], v[44:47], v[200:203]
    buffer_load_dwordx4 v[32:35], v8, s[24:27], s38 offen offset:0 sc1
    v_mfma_f32_16x16x32_bf16 v[208:211], a[8:11], v[48:51], v[208:211]
    ds_read_b64_tr_b16 a[26:27], v2 offset:10752
    v_mfma_f32_16x16x32_bf16 v[216:219], a[8:11], v[52:55], v[216:219]
    s_waitcnt lgkmcnt(6)
    v_mfma_f32_16x16x32_bf16 v[196:199], a[12:15], v[40:43], v[196:199]
    ds_read_b64_tr_b16 a[28:29], v2 offset:10248
    v_mfma_f32_16x16x32_bf16 v[204:207], a[12:15], v[44:47], v[204:207]
    v_mfma_f32_16x16x32_bf16 v[212:215], a[12:15], v[48:51], v[212:215]
    ds_read_b64_tr_b16 a[30:31], v2 offset:10760
    v_mfma_f32_16x16x32_bf16 v[220:223], a[12:15], v[52:55], v[220:223]
    s_waitcnt lgkmcnt(6)
    v_mfma_f32_16x16x32_bf16 v[224:227], a[16:19], v[40:43], v[224:227]
    s_waitcnt vmcnt(15)
    s_barrier
    ds_read_b64_tr_b16 a[0:1], v1 offset:12288
    v_mfma_f32_16x16x32_bf16 v[232:235], a[16:19], v[44:47], v[232:235]
    v_mfma_f32_16x16x32_bf16 v[240:243], a[16:19], v[48:51], v[240:243]
    ds_read_b64_tr_b16 a[2:3], v1 offset:12800
    v_mfma_f32_16x16x32_bf16 v[248:251], a[16:19], v[52:55], v[248:251]
    s_waitcnt lgkmcnt(6)
    v_mfma_f32_16x16x32_bf16 v[228:231], a[20:23], v[40:43], v[228:231]
    ds_read_b64_tr_b16 a[4:5], v1 offset:12296
    v_mfma_f32_16x16x32_bf16 v[236:239], a[20:23], v[44:47], v[236:239]
    buffer_load_dwordx4 v[36:39], v8, s[24:27], s39 offen offset:0 sc1
    v_mfma_f32_16x16x32_bf16 v[244:247], a[20:23], v[48:51], v[244:247]
    ds_read_b64_tr_b16 a[6:7], v1 offset:12808
    v_mfma_f32_16x16x32_bf16 v[252:255], a[20:23], v[52:55], v[252:255]
    s_waitcnt lgkmcnt(6)
    v_mfma_f32_16x16x32_bf16 a[64:67], a[24:27], v[40:43], a[64:67]
    ds_read_b64_tr_b16 a[8:9], v2 offset:12288
    v_mfma_f32_16x16x32_bf16 a[72:75], a[24:27], v[44:47], a[72:75]
    v_mfma_f32_16x16x32_bf16 a[80:83], a[24:27], v[48:51], a[80:83]
    ds_read_b64_tr_b16 a[10:11], v2 offset:12800
    v_mfma_f32_16x16x32_bf16 a[88:91], a[24:27], v[52:55], a[88:91]
    s_waitcnt lgkmcnt(6)
    v_mfma_f32_16x16x32_bf16 a[68:71], a[28:31], v[40:43], a[68:71]
    ds_read_b64_tr_b16 a[12:13], v2 offset:12296
    v_mfma_f32_16x16x32_bf16 a[76:79], a[28:31], v[44:47], a[76:79]
    v_mfma_f32_16x16x32_bf16 a[84:87], a[28:31], v[48:51], a[84:87]
    ds_read_b64_tr_b16 a[14:15], v2 offset:12808
    v_mfma_f32_16x16x32_bf16 a[92:95], a[28:31], v[52:55], a[92:95]
    s_waitcnt vmcnt(14) lgkmcnt(6)
    v_mfma_f32_16x16x32_bf16 v[96:99], a[0:3], v[56:59], v[96:99]
    ds_read_b64_tr_b16 a[16:17], v1 offset:14336
    v_mfma_f32_16x16x32_bf16 v[104:107], a[0:3], v[60:63], v[104:107]
    buffer_load_dwordx4 v[40:43], v8, s[24:27], s36 offen offset:1024 sc1
    v_mfma_f32_16x16x32_bf16 v[112:115], a[0:3], v[64:67], v[112:115]
    ds_read_b64_tr_b16 a[18:19], v1 offset:14848
    v_mfma_f32_16x16x32_bf16 v[120:123], a[0:3], v[68:71], v[120:123]
    s_waitcnt lgkmcnt(6)
    v_mfma_f32_16x16x32_bf16 v[100:103], a[4:7], v[56:59], v[100:103]
    ds_read_b64_tr_b16 a[20:21], v1 offset:14344
    v_mfma_f32_16x16x32_bf16 v[108:111], a[4:7], v[60:63], v[108:111]
    v_mfma_f32_16x16x32_bf16 v[116:119], a[4:7], v[64:67], v[116:119]
    ds_read_b64_tr_b16 a[22:23], v1 offset:14856
    s_add_u32 m0, s40, 12288
    v_mfma_f32_16x16x32_bf16 v[124:127], a[4:7], v[68:71], v[124:127]
    buffer_load_dwordx4 v9, s[12:15], s35 offen offset:0 nt lds
    s_waitcnt lgkmcnt(6)
    v_mfma_f32_16x16x32_bf16 v[128:131], a[8:11], v[56:59], v[128:131]
    ds_read_b64_tr_b16 a[24:25], v2 offset:14336
    v_mfma_f32_16x16x32_bf16 v[136:139], a[8:11], v[60:63], v[136:139]
    v_mfma_f32_16x16x32_bf16 v[144:147], a[8:11], v[64:67], v[144:147]
    ds_read_b64_tr_b16 a[26:27], v2 offset:14848
    v_mfma_f32_16x16x32_bf16 v[152:155], a[8:11], v[68:71], v[152:155]
    s_waitcnt lgkmcnt(6)
    v_mfma_f32_16x16x32_bf16 v[132:135], a[12:15], v[56:59], v[132:135]
    ds_read_b64_tr_b16 a[28:29], v2 offset:14344
    v_mfma_f32_16x16x32_bf16 v[140:143], a[12:15], v[60:63], v[140:143]
    buffer_load_dwordx4 v[44:47], v8, s[24:27], s37 offen offset:1024 sc1
    v_mfma_f32_16x16x32_bf16 v[148:151], a[12:15], v[64:67], v[148:151]
    ds_read_b64_tr_b16 a[30:31], v2 offset:14856
    v_mfma_f32_16x16x32_bf16 v[156:159], a[12:15], v[68:71], v[156:159]
    s_waitcnt lgkmcnt(6)
    v_mfma_f32_16x16x32_bf16 v[160:163], a[16:19], v[56:59], v[160:163]
    ds_read_b64_tr_b16 a[0:1], v1 offset:16384
    v_mfma_f32_16x16x32_bf16 v[168:171], a[16:19], v[60:63], v[168:171]
    v_mfma_f32_16x16x32_bf16 v[176:179], a[16:19], v[64:67], v[176:179]
    ds_read_b64_tr_b16 a[2:3], v1 offset:16896
    s_add_u32 m0, s40, 14208
    v_mfma_f32_16x16x32_bf16 v[184:187], a[16:19], v[68:71], v[184:187]
    buffer_load_dwordx4 v9, s[12:15], s35 offen offset:128 nt lds
    s_waitcnt lgkmcnt(6)
    v_mfma_f32_16x16x32_bf16 v[164:167], a[20:23], v[56:59], v[164:167]
    ds_read_b64_tr_b16 a[4:5], v1 offset:16392
    v_mfma_f32_16x16x32_bf16 v[172:175], a[20:23], v[60:63], v[172:175]
    v_mfma_f32_16x16x32_bf16 v[180:183], a[20:23], v[64:67], v[180:183]
    ds_read_b64_tr_b16 a[6:7], v1 offset:16904
    v_mfma_f32_16x16x32_bf16 v[188:191], a[20:23], v[68:71], v[188:191]
    s_waitcnt lgkmcnt(6)
    v_mfma_f32_16x16x32_bf16 v[192:195], a[24:27], v[56:59], v[192:195]
    ds_read_b64_tr_b16 a[8:9], v2 offset:16384
    v_mfma_f32_16x16x32_bf16 v[200:203], a[24:27], v[60:63], v[200:203]
    buffer_load_dwordx4 v[48:51], v8, s[24:27], s38 offen offset:1024 sc1
    v_mfma_f32_16x16x32_bf16 v[208:211], a[24:27], v[64:67], v[208:211]
    ds_read_b64_tr_b16 a[10:11], v2 offset:16896
    v_mfma_f32_16x16x32_bf16 v[216:219], a[24:27], v[68:71], v[216:219]
    s_waitcnt lgkmcnt(6)
    v_mfma_f32_16x16x32_bf16 v[196:199], a[28:31], v[56:59], v[196:199]
    ds_read_b64_tr_b16 a[12:13], v2 offset:16392
    v_mfma_f32_16x16x32_bf16 v[204:207], a[28:31], v[60:63], v[204:207]
    v_mfma_f32_16x16x32_bf16 v[212:215], a[28:31], v[64:67], v[212:215]
    ds_read_b64_tr_b16 a[14:15], v2 offset:16904
    s_add_u32 m0, s40, 16128
    v_mfma_f32_16x16x32_bf16 v[220:223], a[28:31], v[68:71], v[220:223]
    buffer_load_dwordx4 v9, s[12:15], s35 offen offset:256 nt lds
    s_add_u32 s35, s35, 393216
    s_waitcnt lgkmcnt(6)
    v_mfma_f32_16x16x32_bf16 v[224:227], a[0:3], v[56:59], v[224:227]
    ds_read_b64_tr_b16 a[16:17], v1 offset:18432
    v_mfma_f32_16x16x32_bf16 v[232:235], a[0:3], v[60:63], v[232:235]
    v_mfma_f32_16x16x32_bf16 v[240:243], a[0:3], v[64:67], v[240:243]
    ds_read_b64_tr_b16 a[18:19], v1 offset:18944
    v_mfma_f32_16x16x32_bf16 v[248:251], a[0:3], v[68:71], v[248:251]
    s_waitcnt lgkmcnt(6)
    v_mfma_f32_16x16x32_bf16 v[228:231], a[4:7], v[56:59], v[228:231]
    ds_read_b64_tr_b16 a[20:21], v1 offset:18440
    v_mfma_f32_16x16x32_bf16 v[236:239], a[4:7], v[60:63], v[236:239]
    buffer_load_dwordx4 v[52:55], v8, s[24:27], s39 offen offset:1024 sc1
    v_mfma_f32_16x16x32_bf16 v[244:247], a[4:7], v[64:67], v[244:247]
    ds_read_b64_tr_b16 a[22:23], v1 offset:18952
    v_mfma_f32_16x16x32_bf16 v[252:255], a[4:7], v[68:71], v[252:255]
    s_waitcnt lgkmcnt(6)
    v_mfma_f32_16x16x32_bf16 a[64:67], a[8:11], v[56:59], a[64:67]
    ds_read_b64_tr_b16 a[24:25], v2 offset:18432
    v_mfma_f32_16x16x32_bf16 a[72:75], a[8:11], v[60:63], a[72:75]
    v_mfma_f32_16x16x32_bf16 a[80:83], a[8:11], v[64:67], a[80:83]
    ds_read_b64_tr_b16 a[26:27], v2 offset:18944
    s_add_u32 m0, s40, 18432
    v_mfma_f32_16x16x32_bf16 a[88:91], a[8:11], v[68:71], a[88:91]
    buffer_load_dwordx4 v9, s[12:15], s35 offen offset:0 nt lds
    s_waitcnt lgkmcnt(6)
    v_mfma_f32_16x16x32_bf16 a[68:71], a[12:15], v[56:59], a[68:71]
    ds_read_b64_tr_b16 a[28:29], v2 offset:18440
    v_mfma_f32_16x16x32_bf16 a[76:79], a[12:15], v[60:63], a[76:79]
    v_mfma_f32_16x16x32_bf16 a[84:87], a[12:15], v[64:67], a[84:87]
    ds_read_b64_tr_b16 a[30:31], v2 offset:18952
    v_mfma_f32_16x16x32_bf16 a[92:95], a[12:15], v[68:71], a[92:95]
    s_waitcnt vmcnt(15) lgkmcnt(6)
    v_mfma_f32_16x16x32_bf16 v[96:99], a[16:19], v[72:75], v[96:99]
    ds_read_b64_tr_b16 a[0:1], v1 offset:20480
    v_mfma_f32_16x16x32_bf16 v[104:107], a[16:19], v[76:79], v[104:107]
    buffer_load_dwordx4 v[56:59], v8, s[24:27], s36 offen offset:2048 sc1
    v_mfma_f32_16x16x32_bf16 v[112:115], a[16:19], v[80:83], v[112:115]
    ds_read_b64_tr_b16 a[2:3], v1 offset:20992
    v_mfma_f32_16x16x32_bf16 v[120:123], a[16:19], v[84:87], v[120:123]
    s_waitcnt lgkmcnt(6)
    v_mfma_f32_16x16x32_bf16 v[100:103], a[20:23], v[72:75], v[100:103]
    ds_read_b64_tr_b16 a[4:5], v1 offset:20488
    v_mfma_f32_16x16x32_bf16 v[108:111], a[20:23], v[76:79], v[108:111]
    v_mfma_f32_16x16x32_bf16 v[116:119], a[20:23], v[80:83], v[116:119]
    ds_read_b64_tr_b16 a[6:7], v1 offset:21000
    s_add_u32 m0, s40, 20352
    v_mfma_f32_16x16x32_bf16 v[124:127], a[20:23], v[84:87], v[124:127]
    buffer_load_dwordx4 v9, s[12:15], s35 offen offset:128 nt lds
    s_waitcnt lgkmcnt(6)
    v_mfma_f32_16x16x32_bf16 v[128:131], a[24:27], v[72:75], v[128:131]
    ds_read_b64_tr_b16 a[8:9], v2 offset:20480
    v_mfma_f32_16x16x32_bf16 v[136:139], a[24:27], v[76:79], v[136:139]
    v_mfma_f32_16x16x32_bf16 v[144:147], a[24:27], v[80:83], v[144:147]
    ds_read_b64_tr_b16 a[10:11], v2 offset:20992
    v_mfma_f32_16x16x32_bf16 v[152:155], a[24:27], v[84:87], v[152:155]
    s_waitcnt lgkmcnt(6)
    v_mfma_f32_16x16x32_bf16 v[132:135], a[28:31], v[72:75], v[132:135]
    ds_read_b64_tr_b16 a[12:13], v2 offset:20488
    v_mfma_f32_16x16x32_bf16 v[140:143], a[28:31], v[76:79], v[140:143]
    buffer_load_dwordx4 v[60:63], v8, s[24:27], s37 offen offset:2048 sc1
    v_mfma_f32_16x16x32_bf16 v[148:151], a[28:31], v[80:83], v[148:151]
    ds_read_b64_tr_b16 a[14:15], v2 offset:21000
    v_mfma_f32_16x16x32_bf16 v[156:159], a[28:31], v[84:87], v[156:159]
    s_waitcnt lgkmcnt(6)
    v_mfma_f32_16x16x32_bf16 v[160:163], a[0:3], v[72:75], v[160:163]
    ds_read_b64_tr_b16 a[16:17], v1 offset:22528
    v_mfma_f32_16x16x32_bf16 v[168:171], a[0:3], v[76:79], v[168:171]
    v_mfma_f32_16x16x32_bf16 v[176:179], a[0:3], v[80:83], v[176:179]
    ds_read_b64_tr_b16 a[18:19], v1 offset:23040
    s_add_u32 m0, s40, 22272
    v_mfma_f32_16x16x32_bf16 v[184:187], a[0:3], v[84:87], v[184:187]
    buffer_load_dwordx4 v9, s[12:15], s35 offen offset:256 nt lds
    s_add_u32 s35, s35, 393216
    s_sub_u32 s40, s40, s52
    s_waitcnt lgkmcnt(6)
    v_mfma_f32_16x16x32_bf16 v[164:167], a[4:7], v[72:75], v[164:167]
    ds_read_b64_tr_b16 a[20:21], v1 offset:22536
    v_mfma_f32_16x16x32_bf16 v[172:175], a[4:7], v[76:79], v[172:175]
    v_mfma_f32_16x16x32_bf16 v[180:183], a[4:7], v[80:83], v[180:183]
    ds_read_b64_tr_b16 a[22:23], v1 offset:23048
    v_mfma_f32_16x16x32_bf16 v[188:191], a[4:7], v[84:87], v[188:191]
    s_waitcnt lgkmcnt(6)
    v_mfma_f32_16x16x32_bf16 v[192:195], a[8:11], v[72:75], v[192:195]
    ds_read_b64_tr_b16 a[24:25], v2 offset:22528
    v_mfma_f32_16x16x32_bf16 v[200:203], a[8:11], v[76:79], v[200:203]
    buffer_load_dwordx4 v[64:67], v8, s[24:27], s38 offen offset:2048 sc1
    v_mfma_f32_16x16x32_bf16 v[208:211], a[8:11], v[80:83], v[208:211]
    ds_read_b64_tr_b16 a[26:27], v2 offset:23040
    v_mfma_f32_16x16x32_bf16 v[216:219], a[8:11], v[84:87], v[216:219]
    s_waitcnt lgkmcnt(6)
    v_mfma_f32_16x16x32_bf16 v[196:199], a[12:15], v[72:75], v[196:199]
    ds_read_b64_tr_b16 a[28:29], v2 offset:22536
    v_mfma_f32_16x16x32_bf16 v[204:207], a[12:15], v[76:79], v[204:207]
    v_mfma_f32_16x16x32_bf16 v[212:215], a[12:15], v[80:83], v[212:215]
    ds_read_b64_tr_b16 a[30:31], v2 offset:23048
    v_mfma_f32_16x16x32_bf16 v[220:223], a[12:15], v[84:87], v[220:223]
    s_waitcnt lgkmcnt(6)
    v_mfma_f32_16x16x32_bf16 v[224:227], a[16:19], v[72:75], v[224:227]
    s_waitcnt vmcnt(15)
    s_barrier
    v_add_u32 v1, s52, v1
    v_add_u32 v2, s52, v2
    s_sub_u32 s52, 0, s52
    ds_read_b64_tr_b16 a[0:1], v1 offset:0
    v_mfma_f32_16x16x32_bf16 v[232:235], a[16:19], v[76:79], v[232:235]
    v_mfma_f32_16x16x32_bf16 v[240:243], a[16:19], v[80:83], v[240:243]
    ds_read_b64_tr_b16 a[2:3], v1 offset:512
    v_mfma_f32_16x16x32_bf16 v[248:251], a[16:19], v[84:87], v[248:251]
    s_waitcnt lgkmcnt(6)
    v_mfma_f32_16x16x32_bf16 v[228:231], a[20:23], v[72:75], v[228:231]
    ds_read_b64_tr_b16 a[4:5], v1 offset:8
    v_mfma_f32_16x16x32_bf16 v[236:239], a[20:23], v[76:79], v[236:239]
    buffer_load_dwordx4 v[68:71], v8, s[24:27], s39 offen offset:2048 sc1
    v_mfma_f32_16x16x32_bf16 v[244:247], a[20:23], v[80:83], v[244:247]
    ds_read_b64_tr_b16 a[6:7], v1 offset:520
    v_mfma_f32_16x16x32_bf16 v[252:255], a[20:23], v[84:87], v[252:255]
    s_waitcnt lgkmcnt(6)
    v_mfma_f32_16x16x32_bf16 a[64:67], a[24:27], v[72:75], a[64:67]
    ds_read_b64_tr_b16 a[8:9], v2 offset:0
    v_mfma_f32_16x16x32_bf16 a[72:75], a[24:27], v[76:79], a[72:75]
    v_mfma_f32_16x16x32_bf16 a[80:83], a[24:27], v[80:83], a[80:83]
    ds_read_b64_tr_b16 a[10:11], v2 offset:512
    v_mfma_f32_16x16x32_bf16 a[88:91], a[24:27], v[84:87], a[88:91]
    s_waitcnt lgkmcnt(6)
    v_mfma_f32_16x16x32_bf16 a[68:71], a[28:31], v[72:75], a[68:71]
    ds_read_b64_tr_b16 a[12:13], v2 offset:8
    v_mfma_f32_16x16x32_bf16 a[76:79], a[28:31], v[76:79], a[76:79]
    v_mfma_f32_16x16x32_bf16 a[84:87], a[28:31], v[80:83], a[84:87]
    ds_read_b64_tr_b16 a[14:15], v2 offset:520
    v_mfma_f32_16x16x32_bf16 a[92:95], a[28:31], v[84:87], a[92:95]
    s_waitcnt vmcnt(14) lgkmcnt(6)
    v_mfma_f32_16x16x32_bf16 v[96:99], a[0:3], v[24:27], v[96:99]
    ds_read_b64_tr_b16 a[16:17], v1 offset:2048
    v_mfma_f32_16x16x32_bf16 v[104:107], a[0:3], v[28:31], v[104:107]
    buffer_load_dwordx4 v[72:75], v8, s[24:27], s36 offen offset:3072 sc1
    v_mfma_f32_16x16x32_bf16 v[112:115], a[0:3], v[32:35], v[112:115]
    ds_read_b64_tr_b16 a[18:19], v1 offset:2560
    v_mfma_f32_16x16x32_bf16 v[120:123], a[0:3], v[36:39], v[120:123]
    s_waitcnt lgkmcnt(6)
    v_mfma_f32_16x16x32_bf16 v[100:103], a[4:7], v[24:27], v[100:103]
    ds_read_b64_tr_b16 a[20:21], v1 offset:2056
    v_mfma_f32_16x16x32_bf16 v[108:111], a[4:7], v[28:31], v[108:111]
    v_mfma_f32_16x16x32_bf16 v[116:119], a[4:7], v[32:35], v[116:119]
    ds_read_b64_tr_b16 a[22:23], v1 offset:2568
    s_add_u32 m0, s40, 0
    v_mfma_f32_16x16x32_bf16 v[124:127], a[4:7], v[36:39], v[124:127]
    buffer_load_dwordx4 v9, s[12:15], s35 offen offset:0 nt lds
    s_waitcnt lgkmcnt(6)
    v_mfma_f32_16x16x32_bf16 v[128:131], a[8:11], v[24:27], v[128:131]
    ds_read_b64_tr_b16 a[24:25], v2 offset:2048
    v_mfma_f32_16x16x32_bf16 v[136:139], a[8:11], v[28:31], v[136:139]
    v_mfma_f32_16x16x32_bf16 v[144:147], a[8:11], v[32:35], v[144:147]
    ds_read_b64_tr_b16 a[26:27], v2 offset:2560
    v_mfma_f32_16x16x32_bf16 v[152:155], a[8:11], v[36:39], v[152:155]
    s_waitcnt lgkmcnt(6)
    v_mfma_f32_16x16x32_bf16 v[132:135], a[12:15], v[24:27], v[132:135]
    ds_read_b64_tr_b16 a[28:29], v2 offset:2056
    v_mfma_f32_16x16x32_bf16 v[140:143], a[12:15], v[28:31], v[140:143]
    buffer_load_dwordx4 v[76:79], v8, s[24:27], s37 offen offset:3072 sc1
    v_mfma_f32_16x16x32_bf16 v[148:151], a[12:15], v[32:35], v[148:151]
    ds_read_b64_tr_b16 a[30:31], v2 offset:2568
    v_mfma_f32_16x16x32_bf16 v[156:159], a[12:15], v[36:39], v[156:159]
    s_waitcnt lgkmcnt(6)
    v_mfma_f32_16x16x32_bf16 v[160:163], a[16:19], v[24:27], v[160:163]
    ds_read_b64_tr_b16 a[0:1], v1 offset:4096
    v_mfma_f32_16x16x32_bf16 v[168:171], a[16:19], v[28:31], v[168:171]
    v_mfma_f32_16x16x32_bf16 v[176:179], a[16:19], v[32:35], v[176:179]
    ds_read_b64_tr_b16 a[2:3], v1 offset:4608
    s_add_u32 m0, s40, 1920
    v_mfma_f32_16x16x32_bf16 v[184:187], a[16:19], v[36:39], v[184:187]
    buffer_load_dwordx4 v9, s[12:15], s35 offen offset:128 nt lds
    s_waitcnt lgkmcnt(6)
    v_mfma_f32_16x16x32_bf16 v[164:167], a[20:23], v[24:27], v[164:167]
    ds_read_b64_tr_b16 a[4:5], v1 offset:4104
    v_mfma_f32_16x16x32_bf16 v[172:175], a[20:23], v[28:31], v[172:175]
    v_mfma_f32_16x16x32_bf16 v[180:183], a[20:23], v[32:35], v[180:183]
    ds_read_b64_tr_b16 a[6:7], v1 offset:4616
    v_mfma_f32_16x16x32_bf16 v[188:191], a[20:23], v[36:39], v[188:191]
    s_waitcnt lgkmcnt(6)
    v_mfma_f32_16x16x32_bf16 v[192:195], a[24:27], v[24:27], v[192:195]
    ds_read_b64_tr_b16 a[8:9], v2 offset:4096
    v_mfma_f32_16x16x32_bf16 v[200:203], a[24:27], v[28:31], v[200:203]
    buffer_load_dwordx4 v[80:83], v8, s[24:27], s38 offen offset:3072 sc1
    v_mfma_f32_16x16x32_bf16 v[208:211], a[24:27], v[32:35], v[208:211]
    ds_read_b64_tr_b16 a[10:11], v2 offset:4608
    v_mfma_f32_16x16x32_bf16 v[216:219], a[24:27], v[36:39], v[216:219]
    s_waitcnt lgkmcnt(6)
    v_mfma_f32_16x16x32_bf16 v[196:199], a[28:31], v[24:27], v[196:199]
    ds_read_b64_tr_b16 a[12:13], v2 offset:4104
    v_mfma_f32_16x16x32_bf16 v[204:207], a[28:31], v[28:31], v[204:207]
    v_mfma_f32_16x16x32_bf16 v[212:215], a[28:31], v[32:35], v[212:215]
    ds_read_b64_tr_b16 a[14:15], v2 offset:4616
    s_add_u32 m0, s40, 3840
    v_mfma_f32_16x16x32_bf16 v[220:223], a[28:31], v[36:39], v[220:223]
    buffer_load_dwordx4 v9, s[12:15], s35 offen offset:256 nt lds
    s_add_u32 s35, s35, 393216
    s_waitcnt lgkmcnt(6)
    v_mfma_f32_16x16x32_bf16 v[224:227], a[0:3], v[24:27], v[224:227]
    ds_read_b64_tr_b16 a[16:17], v1 offset:6144
    v_mfma_f32_16x16x32_bf16 v[232:235], a[0:3], v[28:31], v[232:235]
    v_mfma_f32_16x16x32_bf16 v[240:243], a[0:3], v[32:35], v[240:243]
    ds_read_b64_tr_b16 a[18:19], v1 offset:6656
    v_mfma_f32_16x16x32_bf16 v[248:251], a[0:3], v[36:39], v[248:251]
    s_waitcnt lgkmcnt(6)
    v_mfma_f32_16x16x32_bf16 v[228:231], a[4:7], v[24:27], v[228:231]
    ds_read_b64_tr_b16 a[20:21], v1 offset:6152
    v_mfma_f32_16x16x32_bf16 v[236:239], a[4:7], v[28:31], v[236:239]
    buffer_load_dwordx4 v[84:87], v8, s[24:27], s39 offen offset:3072 sc1
    v_mfma_f32_16x16x32_bf16 v[244:247], a[4:7], v[32:35], v[244:247]
    ds_read_b64_tr_b16 a[22:23], v1 offset:6664
    v_mfma_f32_16x16x32_bf16 v[252:255], a[4:7], v[36:39], v[252:255]
    s_waitcnt lgkmcnt(6)
    v_mfma_f32_16x16x32_bf16 a[64:67], a[8:11], v[24:27], a[64:67]
    ds_read_b64_tr_b16 a[24:25], v2 offset:6144
    v_mfma_f32_16x16x32_bf16 a[72:75], a[8:11], v[28:31], a[72:75]
    v_mfma_f32_16x16x32_bf16 a[80:83], a[8:11], v[32:35], a[80:83]
    ds_read_b64_tr_b16 a[26:27], v2 offset:6656
    s_add_u32 m0, s40, 6144
    v_mfma_f32_16x16x32_bf16 a[88:91], a[8:11], v[36:39], a[88:91]
    buffer_load_dwordx4 v9, s[12:15], s35 offen offset:0 nt lds
    s_waitcnt lgkmcnt(6)
    v_mfma_f32_16x16x32_bf16 a[68:71], a[12:15], v[24:27], a[68:71]
    ds_read_b64_tr_b16 a[28:29], v2 offset:6152
    v_mfma_f32_16x16x32_bf16 a[76:79], a[12:15], v[28:31], a[76:79]
    v_mfma_f32_16x16x32_bf16 a[84:87], a[12:15], v[32:35], a[84:87]
    ds_read_b64_tr_b16 a[30:31], v2 offset:6664
    v_mfma_f32_16x16x32_bf16 a[92:95], a[12:15], v[36:39], a[92:95]
    s_waitcnt vmcnt(15) lgkmcnt(6)
    v_mfma_f32_16x16x32_bf16 v[96:99], a[16:19], v[40:43], v[96:99]
    ds_read_b64_tr_b16 a[0:1], v1 offset:8192
    v_mfma_f32_16x16x32_bf16 v[104:107], a[16:19], v[44:47], v[104:107]
    s_add_u32 s36, s36, 4096
    s_add_u32 s37, s37, 4096
    s_add_u32 s38, s38, 4096
    s_add_u32 s39, s39, 4096
    buffer_load_dwordx4 v[24:27], v8, s[24:27], s36 offen offset:0 sc1
    v_mfma_f32_16x16x32_bf16 v[112:115], a[16:19], v[48:51], v[112:115]
    ds_read_b64_tr_b16 a[2:3], v1 offset:8704
    v_mfma_f32_16x16x32_bf16 v[120:123], a[16:19], v[52:55], v[120:123]
    s_waitcnt lgkmcnt(6)
    v_mfma_f32_16x16x32_bf16 v[100:103], a[20:23], v[40:43], v[100:103]
    ds_read_b64_tr_b16 a[4:5], v1 offset:8200
    v_mfma_f32_16x16x32_bf16 v[108:111], a[20:23], v[44:47], v[108:111]
    v_mfma_f32_16x16x32_bf16 v[116:119], a[20:23], v[48:51], v[116:119]
    ds_read_b64_tr_b16 a[6:7], v1 offset:8712
    s_add_u32 m0, s40, 8064
    v_mfma_f32_16x16x32_bf16 v[124:127], a[20:23], v[52:55], v[124:127]
    buffer_load_dwordx4 v9, s[12:15], s35 offen offset:128 nt lds
    s_waitcnt lgkmcnt(6)
    v_mfma_f32_16x16x32_bf16 v[128:131], a[24:27], v[40:43], v[128:131]
    ds_read_b64_tr_b16 a[8:9], v2 offset:8192
    v_mfma_f32_16x16x32_bf16 v[136:139], a[24:27], v[44:47], v[136:139]
    v_mfma_f32_16x16x32_bf16 v[144:147], a[24:27], v[48:51], v[144:147]
    ds_read_b64_tr_b16 a[10:11], v2 offset:8704
    v_mfma_f32_16x16x32_bf16 v[152:155], a[24:27], v[52:55], v[152:155]
    s_waitcnt lgkmcnt(6)
    v_mfma_f32_16x16x32_bf16 v[132:135], a[28:31], v[40:43], v[132:135]
    ds_read_b64_tr_b16 a[12:13], v2 offset:8200
    v_mfma_f32_16x16x32_bf16 v[140:143], a[28:31], v[44:47], v[140:143]
    buffer_load_dwordx4 v[28:31], v8, s[24:27], s37 offen offset:0 sc1
    v_mfma_f32_16x16x32_bf16 v[148:151], a[28:31], v[48:51], v[148:151]
    ds_read_b64_tr_b16 a[14:15], v2 offset:8712
    v_mfma_f32_16x16x32_bf16 v[156:159], a[28:31], v[52:55], v[156:159]
    s_waitcnt lgkmcnt(6)
    v_mfma_f32_16x16x32_bf16 v[160:163], a[0:3], v[40:43], v[160:163]
    ds_read_b64_tr_b16 a[16:17], v1 offset:10240
    v_mfma_f32_16x16x32_bf16 v[168:171], a[0:3], v[44:47], v[168:171]
    v_mfma_f32_16x16x32_bf16 v[176:179], a[0:3], v[48:51], v[176:179]
    ds_read_b64_tr_b16 a[18:19], v1 offset:10752
    s_add_u32 m0, s40, 9984
    v_mfma_f32_16x16x32_bf16 v[184:187], a[0:3], v[52:55], v[184:187]
    buffer_load_dwordx4 v9, s[12:15], s35 offen offset:256 nt lds
    s_add_u32 s35, s35, 393216
    s_waitcnt lgkmcnt(6)
    v_mfma_f32_16x16x32_bf16 v[164:167], a[4:7], v[40:43], v[164:167]
    ds_read_b64_tr_b16 a[20:21], v1 offset:10248
    v_mfma_f32_16x16x32_bf16 v[172:175], a[4:7], v[44:47], v[172:175]
    v_mfma_f32_16x16x32_bf16 v[180:183], a[4:7], v[48:51], v[180:183]
    ds_read_b64_tr_b16 a[22:23], v1 offset:10760
    v_mfma_f32_16x16x32_bf16 v[188:191], a[4:7], v[52:55], v[188:191]
    s_waitcnt lgkmcnt(6)
    v_mfma_f32_16x16x32_bf16 v[192:195], a[8:11], v[40:43], v[192:195]
    ds_read_b64_tr_b16 a[24:25], v2 offset:10240
    v_mfma_f32_16x16x32_bf16 v[200:203], a[8:11], v[44:47], v[200:203]
    buffer_load_dwordx4 v[32:35], v8, s[24:27], s38 offen offset:0 sc1
    v_mfma_f32_16x16x32_bf16 v[208:211], a[8:11], v[48:51], v[208:211]
    ds_read_b64_tr_b16 a[26:27], v2 offset:10752
    v_mfma_f32_16x16x32_bf16 v[216:219], a[8:11], v[52:55], v[216:219]
    s_waitcnt lgkmcnt(6)
    v_mfma_f32_16x16x32_bf16 v[196:199], a[12:15], v[40:43], v[196:199]
    ds_read_b64_tr_b16 a[28:29], v2 offset:10248
    v_mfma_f32_16x16x32_bf16 v[204:207], a[12:15], v[44:47], v[204:207]
    v_mfma_f32_16x16x32_bf16 v[212:215], a[12:15], v[48:51], v[212:215]
    ds_read_b64_tr_b16 a[30:31], v2 offset:10760
    v_mfma_f32_16x16x32_bf16 v[220:223], a[12:15], v[52:55], v[220:223]
    s_waitcnt lgkmcnt(6)
    v_mfma_f32_16x16x32_bf16 v[224:227], a[16:19], v[40:43], v[224:227]
    s_waitcnt vmcnt(15)
    s_barrier
    ds_read_b64_tr_b16 a[0:1], v1 offset:12288
    v_mfma_f32_16x16x32_bf16 v[232:235], a[16:19], v[44:47], v[232:235]
    v_mfma_f32_16x16x32_bf16 v[240:243], a[16:19], v[48:51], v[240:243]
    ds_read_b64_tr_b16 a[2:3], v1 offset:12800
    v_mfma_f32_16x16x32_bf16 v[248:251], a[16:19], v[52:55], v[248:251]
    s_waitcnt lgkmcnt(6)
    v_mfma_f32_16x16x32_bf16 v[228:231], a[20:23], v[40:43], v[228:231]
    ds_read_b64_tr_b16 a[4:5], v1 offset:12296
    v_mfma_f32_16x16x32_bf16 v[236:239], a[20:23], v[44:47], v[236:239]
    buffer_load_dwordx4 v[36:39], v8, s[24:27], s39 offen offset:0 sc1
    v_mfma_f32_16x16x32_bf16 v[244:247], a[20:23], v[48:51], v[244:247]
    ds_read_b64_tr_b16 a[6:7], v1 offset:12808
    v_mfma_f32_16x16x32_bf16 v[252:255], a[20:23], v[52:55], v[252:255]
    s_waitcnt lgkmcnt(6)
    v_mfma_f32_16x16x32_bf16 a[64:67], a[24:27], v[40:43], a[64:67]
    ds_read_b64_tr_b16 a[8:9], v2 offset:12288
    v_mfma_f32_16x16x32_bf16 a[72:75], a[24:27], v[44:47], a[72:75]
    v_mfma_f32_16x16x32_bf16 a[80:83], a[24:27], v[48:51], a[80:83]
    ds_read_b64_tr_b16 a[10:11], v2 offset:12800
    v_mfma_f32_16x16x32_bf16 a[88:91], a[24:27], v[52:55], a[88:91]
    s_waitcnt lgkmcnt(6)
    v_mfma_f32_16x16x32_bf16 a[68:71], a[28:31], v[40:43], a[68:71]
    ds_read_b64_tr_b16 a[12:13], v2 offset:12296
    v_mfma_f32_16x16x32_bf16 a[76:79], a[28:31], v[44:47], a[76:79]
    v_mfma_f32_16x16x32_bf16 a[84:87], a[28:31], v[48:51], a[84:87]
    ds_read_b64_tr_b16 a[14:15], v2 offset:12808
    v_mfma_f32_16x16x32_bf16 a[92:95], a[28:31], v[52:55], a[92:95]
    s_waitcnt vmcnt(14) lgkmcnt(6)
    v_mfma_f32_16x16x32_bf16 v[96:99], a[0:3], v[56:59], v[96:99]
    ds_read_b64_tr_b16 a[16:17], v1 offset:14336
    v_mfma_f32_16x16x32_bf16 v[104:107], a[0:3], v[60:63], v[104:107]
    buffer_load_dwordx4 v[40:43], v8, s[24:27], s36 offen offset:1024 sc1
    v_mfma_f32_16x16x32_bf16 v[112:115], a[0:3], v[64:67], v[112:115]
    ds_read_b64_tr_b16 a[18:19], v1 offset:14848
    v_mfma_f32_16x16x32_bf16 v[120:123], a[0:3], v[68:71], v[120:123]
    s_waitcnt lgkmcnt(6)
    v_mfma_f32_16x16x32_bf16 v[100:103], a[4:7], v[56:59], v[100:103]
    ds_read_b64_tr_b16 a[20:21], v1 offset:14344
    v_mfma_f32_16x16x32_bf16 v[108:111], a[4:7], v[60:63], v[108:111]
    v_mfma_f32_16x16x32_bf16 v[116:119], a[4:7], v[64:67], v[116:119]
    ds_read_b64_tr_b16 a[22:23], v1 offset:14856
    s_add_u32 m0, s40, 12288
    v_mfma_f32_16x16x32_bf16 v[124:127], a[4:7], v[68:71], v[124:127]
    buffer_load_dwordx4 v9, s[12:15], s35 offen offset:0 nt lds
    s_waitcnt lgkmcnt(6)
    v_mfma_f32_16x16x32_bf16 v[128:131], a[8:11], v[56:59], v[128:131]
    ds_read_b64_tr_b16 a[24:25], v2 offset:14336
    v_mfma_f32_16x16x32_bf16 v[136:139], a[8:11], v[60:63], v[136:139]
    v_mfma_f32_16x16x32_bf16 v[144:147], a[8:11], v[64:67], v[144:147]
    ds_read_b64_tr_b16 a[26:27], v2 offset:14848
    v_mfma_f32_16x16x32_bf16 v[152:155], a[8:11], v[68:71], v[152:155]
    s_waitcnt lgkmcnt(6)
    v_mfma_f32_16x16x32_bf16 v[132:135], a[12:15], v[56:59], v[132:135]
    ds_read_b64_tr_b16 a[28:29], v2 offset:14344
    v_mfma_f32_16x16x32_bf16 v[140:143], a[12:15], v[60:63], v[140:143]
    buffer_load_dwordx4 v[44:47], v8, s[24:27], s37 offen offset:1024 sc1
    v_mfma_f32_16x16x32_bf16 v[148:151], a[12:15], v[64:67], v[148:151]
    ds_read_b64_tr_b16 a[30:31], v2 offset:14856
    v_mfma_f32_16x16x32_bf16 v[156:159], a[12:15], v[68:71], v[156:159]
    s_waitcnt lgkmcnt(6)
    v_mfma_f32_16x16x32_bf16 v[160:163], a[16:19], v[56:59], v[160:163]
    ds_read_b64_tr_b16 a[0:1], v1 offset:16384
    v_mfma_f32_16x16x32_bf16 v[168:171], a[16:19], v[60:63], v[168:171]
    v_mfma_f32_16x16x32_bf16 v[176:179], a[16:19], v[64:67], v[176:179]
    ds_read_b64_tr_b16 a[2:3], v1 offset:16896
    s_add_u32 m0, s40, 14208
    v_mfma_f32_16x16x32_bf16 v[184:187], a[16:19], v[68:71], v[184:187]
    buffer_load_dwordx4 v9, s[12:15], s35 offen offset:128 nt lds
    s_waitcnt lgkmcnt(6)
    v_mfma_f32_16x16x32_bf16 v[164:167], a[20:23], v[56:59], v[164:167]
    ds_read_b64_tr_b16 a[4:5], v1 offset:16392
    v_mfma_f32_16x16x32_bf16 v[172:175], a[20:23], v[60:63], v[172:175]
    v_mfma_f32_16x16x32_bf16 v[180:183], a[20:23], v[64:67], v[180:183]
    ds_read_b64_tr_b16 a[6:7], v1 offset:16904
    v_mfma_f32_16x16x32_bf16 v[188:191], a[20:23], v[68:71], v[188:191]
    s_waitcnt lgkmcnt(6)
    v_mfma_f32_16x16x32_bf16 v[192:195], a[24:27], v[56:59], v[192:195]
    ds_read_b64_tr_b16 a[8:9], v2 offset:16384
    v_mfma_f32_16x16x32_bf16 v[200:203], a[24:27], v[60:63], v[200:203]
    buffer_load_dwordx4 v[48:51], v8, s[24:27], s38 offen offset:1024 sc1
    v_mfma_f32_16x16x32_bf16 v[208:211], a[24:27], v[64:67], v[208:211]
    ds_read_b64_tr_b16 a[10:11], v2 offset:16896
    v_mfma_f32_16x16x32_bf16 v[216:219], a[24:27], v[68:71], v[216:219]
    s_waitcnt lgkmcnt(6)
    v_mfma_f32_16x16x32_bf16 v[196:199], a[28:31], v[56:59], v[196:199]
    ds_read_b64_tr_b16 a[12:13], v2 offset:16392
    v_mfma_f32_16x16x32_bf16 v[204:207], a[28:31], v[60:63], v[204:207]
    v_mfma_f32_16x16x32_bf16 v[212:215], a[28:31], v[64:67], v[212:215]
    ds_read_b64_tr_b16 a[14:15], v2 offset:16904
    s_add_u32 m0, s40, 16128
    v_mfma_f32_16x16x32_bf16 v[220:223], a[28:31], v[68:71], v[220:223]
    buffer_load_dwordx4 v9, s[12:15], s35 offen offset:256 nt lds
    s_add_u32 s35, s35, 393216
    s_waitcnt lgkmcnt(6)
    v_mfma_f32_16x16x32_bf16 v[224:227], a[0:3], v[56:59], v[224:227]
    ds_read_b64_tr_b16 a[16:17], v1 offset:18432
    v_mfma_f32_16x16x32_bf16 v[232:235], a[0:3], v[60:63], v[232:235]
    v_mfma_f32_16x16x32_bf16 v[240:243], a[0:3], v[64:67], v[240:243]
    ds_read_b64_tr_b16 a[18:19], v1 offset:18944
    v_mfma_f32_16x16x32_bf16 v[248:251], a[0:3], v[68:71], v[248:251]
    s_waitcnt lgkmcnt(6)
    v_mfma_f32_16x16x32_bf16 v[228:231], a[4:7], v[56:59], v[228:231]
    ds_read_b64_tr_b16 a[20:21], v1 offset:18440
    v_mfma_f32_16x16x32_bf16 v[236:239], a[4:7], v[60:63], v[236:239]
    buffer_load_dwordx4 v[52:55], v8, s[24:27], s39 offen offset:1024 sc1
    v_mfma_f32_16x16x32_bf16 v[244:247], a[4:7], v[64:67], v[244:247]
    ds_read_b64_tr_b16 a[22:23], v1 offset:18952
    v_mfma_f32_16x16x32_bf16 v[252:255], a[4:7], v[68:71], v[252:255]
    s_waitcnt lgkmcnt(6)
    v_mfma_f32_16x16x32_bf16 a[64:67], a[8:11], v[56:59], a[64:67]
    ds_read_b64_tr_b16 a[24:25], v2 offset:18432
    v_mfma_f32_16x16x32_bf16 a[72:75], a[8:11], v[60:63], a[72:75]
    v_mfma_f32_16x16x32_bf16 a[80:83], a[8:11], v[64:67], a[80:83]
    ds_read_b64_tr_b16 a[26:27], v2 offset:18944
    s_add_u32 m0, s40, 18432
    v_mfma_f32_16x16x32_bf16 a[88:91], a[8:11], v[68:71], a[88:91]
    buffer_load_dwordx4 v9, s[12:15], s35 offen offset:0 nt lds
    s_waitcnt lgkmcnt(6)
    v_mfma_f32_16x16x32_bf16 a[68:71], a[12:15], v[56:59], a[68:71]
    ds_read_b64_tr_b16 a[28:29], v2 offset:18440
    v_mfma_f32_16x16x32_bf16 a[76:79], a[12:15], v[60:63], a[76:79]
    v_mfma_f32_16x16x32_bf16 a[84:87], a[12:15], v[64:67], a[84:87]
    ds_read_b64_tr_b16 a[30:31], v2 offset:18952
    v_mfma_f32_16x16x32_bf16 a[92:95], a[12:15], v[68:71], a[92:95]
    s_waitcnt vmcnt(15) lgkmcnt(6)
    v_mfma_f32_16x16x32_bf16 v[96:99], a[16:19], v[72:75], v[96:99]
    ds_read_b64_tr_b16 a[0:1], v1 offset:20480
    v_mfma_f32_16x16x32_bf16 v[104:107], a[16:19], v[76:79], v[104:107]
    buffer_load_dwordx4 v[56:59], v8, s[24:27], s36 offen offset:2048 sc1
    v_mfma_f32_16x16x32_bf16 v[112:115], a[16:19], v[80:83], v[112:115]
    ds_read_b64_tr_b16 a[2:3], v1 offset:20992
    v_mfma_f32_16x16x32_bf16 v[120:123], a[16:19], v[84:87], v[120:123]
    s_waitcnt lgkmcnt(6)
    v_mfma_f32_16x16x32_bf16 v[100:103], a[20:23], v[72:75], v[100:103]
    ds_read_b64_tr_b16 a[4:5], v1 offset:20488
    v_mfma_f32_16x16x32_bf16 v[108:111], a[20:23], v[76:79], v[108:111]
    v_mfma_f32_16x16x32_bf16 v[116:119], a[20:23], v[80:83], v[116:119]
    ds_read_b64_tr_b16 a[6:7], v1 offset:21000
    s_add_u32 m0, s40, 20352
    v_mfma_f32_16x16x32_bf16 v[124:127], a[20:23], v[84:87], v[124:127]
    buffer_load_dwordx4 v9, s[12:15], s35 offen offset:128 nt lds
    s_waitcnt lgkmcnt(6)
    v_mfma_f32_16x16x32_bf16 v[128:131], a[24:27], v[72:75], v[128:131]
    ds_read_b64_tr_b16 a[8:9], v2 offset:20480
    v_mfma_f32_16x16x32_bf16 v[136:139], a[24:27], v[76:79], v[136:139]
    v_mfma_f32_16x16x32_bf16 v[144:147], a[24:27], v[80:83], v[144:147]
    ds_read_b64_tr_b16 a[10:11], v2 offset:20992
    v_mfma_f32_16x16x32_bf16 v[152:155], a[24:27], v[84:87], v[152:155]
    s_waitcnt lgkmcnt(6)
    v_mfma_f32_16x16x32_bf16 v[132:135], a[28:31], v[72:75], v[132:135]
    ds_read_b64_tr_b16 a[12:13], v2 offset:20488
    v_mfma_f32_16x16x32_bf16 v[140:143], a[28:31], v[76:79], v[140:143]
    buffer_load_dwordx4 v[60:63], v8, s[24:27], s37 offen offset:2048 sc1
    v_mfma_f32_16x16x32_bf16 v[148:151], a[28:31], v[80:83], v[148:151]
    ds_read_b64_tr_b16 a[14:15], v2 offset:21000
    v_mfma_f32_16x16x32_bf16 v[156:159], a[28:31], v[84:87], v[156:159]
    s_waitcnt lgkmcnt(6)
    v_mfma_f32_16x16x32_bf16 v[160:163], a[0:3], v[72:75], v[160:163]
    ds_read_b64_tr_b16 a[16:17], v1 offset:22528
    v_mfma_f32_16x16x32_bf16 v[168:171], a[0:3], v[76:79], v[168:171]
    v_mfma_f32_16x16x32_bf16 v[176:179], a[0:3], v[80:83], v[176:179]
    ds_read_b64_tr_b16 a[18:19], v1 offset:23040
    s_add_u32 m0, s40, 22272
    v_mfma_f32_16x16x32_bf16 v[184:187], a[0:3], v[84:87], v[184:187]
    buffer_load_dwordx4 v9, s[12:15], s35 offen offset:256 nt lds
    s_add_u32 s35, s35, 393216
    s_sub_u32 s40, s40, s52
    s_waitcnt lgkmcnt(6)
    v_mfma_f32_16x16x32_bf16 v[164:167], a[4:7], v[72:75], v[164:167]
    ds_read_b64_tr_b16 a[20:21], v1 offset:22536
    v_mfma_f32_16x16x32_bf16 v[172:175], a[4:7], v[76:79], v[172:175]
    v_mfma_f32_16x16x32_bf16 v[180:183], a[4:7], v[80:83], v[180:183]
    ds_read_b64_tr_b16 a[22:23], v1 offset:23048
    v_mfma_f32_16x16x32_bf16 v[188:191], a[4:7], v[84:87], v[188:191]
    s_waitcnt lgkmcnt(6)
    v_mfma_f32_16x16x32_bf16 v[192:195], a[8:11], v[72:75], v[192:195]
    ds_read_b64_tr_b16 a[24:25], v2 offset:22528
    v_mfma_f32_16x16x32_bf16 v[200:203], a[8:11], v[76:79], v[200:203]
    buffer_load_dwordx4 v[64:67], v8, s[24:27], s38 offen offset:2048 sc1
    v_mfma_f32_16x16x32_bf16 v[208:211], a[8:11], v[80:83], v[208:211]
    ds_read_b64_tr_b16 a[26:27], v2 offset:23040
    v_mfma_f32_16x16x32_bf16 v[216:219], a[8:11], v[84:87], v[216:219]
    s_waitcnt lgkmcnt(6)
    v_mfma_f32_16x16x32_bf16 v[196:199], a[12:15], v[72:75], v[196:199]
    ds_read_b64_tr_b16 a[28:29], v2 offset:22536
    v_mfma_f32_16x16x32_bf16 v[204:207], a[12:15], v[76:79], v[204:207]
    v_mfma_f32_16x16x32_bf16 v[212:215], a[12:15], v[80:83], v[212:215]
    ds_read_b64_tr_b16 a[30:31], v2 offset:23048
    v_mfma_f32_16x16x32_bf16 v[220:223], a[12:15], v[84:87], v[220:223]
    s_waitcnt lgkmcnt(6)
    v_mfma_f32_16x16x32_bf16 v[224:227], a[16:19], v[72:75], v[224:227]
    s_waitcnt vmcnt(15)
    s_barrier
    v_add_u32 v1, s52, v1
    v_add_u32 v2, s52, v2
    s_sub_u32 s52, 0, s52
    ds_read_b64_tr_b16 a[0:1], v1 offset:0
    v_mfma_f32_16x16x32_bf16 v[232:235], a[16:19], v[76:79], v[232:235]
    v_mfma_f32_16x16x32_bf16 v[240:243], a[16:19], v[80:83], v[240:243]
    ds_read_b64_tr_b16 a[2:3], v1 offset:512
    v_mfma_f32_16x16x32_bf16 v[248:251], a[16:19], v[84:87], v[248:251]
    s_waitcnt lgkmcnt(6)
    v_mfma_f32_16x16x32_bf16 v[228:231], a[20:23], v[72:75], v[228:231]
    ds_read_b64_tr_b16 a[4:5], v1 offset:8
    v_mfma_f32_16x16x32_bf16 v[236:239], a[20:23], v[76:79], v[236:239]
    buffer_load_dwordx4 v[68:71], v8, s[24:27], s39 offen offset:2048 sc1
    v_mfma_f32_16x16x32_bf16 v[244:247], a[20:23], v[80:83], v[244:247]
    ds_read_b64_tr_b16 a[6:7], v1 offset:520
    v_mfma_f32_16x16x32_bf16 v[252:255], a[20:23], v[84:87], v[252:255]
    s_waitcnt lgkmcnt(6)
    v_mfma_f32_16x16x32_bf16 a[64:67], a[24:27], v[72:75], a[64:67]
    ds_read_b64_tr_b16 a[8:9], v2 offset:0
    v_mfma_f32_16x16x32_bf16 a[72:75], a[24:27], v[76:79], a[72:75]
    v_mfma_f32_16x16x32_bf16 a[80:83], a[24:27], v[80:83], a[80:83]
    ds_read_b64_tr_b16 a[10:11], v2 offset:512
    v_mfma_f32_16x16x32_bf16 a[88:91], a[24:27], v[84:87], a[88:91]
    s_waitcnt lgkmcnt(6)
    v_mfma_f32_16x16x32_bf16 a[68:71], a[28:31], v[72:75], a[68:71]
    ds_read_b64_tr_b16 a[12:13], v2 offset:8
    v_mfma_f32_16x16x32_bf16 a[76:79], a[28:31], v[76:79], a[76:79]
    v_mfma_f32_16x16x32_bf16 a[84:87], a[28:31], v[80:83], a[84:87]
    ds_read_b64_tr_b16 a[14:15], v2 offset:520
    v_mfma_f32_16x16x32_bf16 a[92:95], a[28:31], v[84:87], a[92:95]
    s_waitcnt vmcnt(14)
    s_mov_b32 s41, 5
    s_waitcnt lgkmcnt(6)
    v_mfma_f32_16x16x32_bf16 v[96:99], a[0:3], v[24:27], v[96:99]
    ds_read_b64_tr_b16 a[16:17], v1 offset:2048
    v_mfma_f32_16x16x32_bf16 v[104:107], a[0:3], v[28:31], v[104:107]
    buffer_load_dwordx4 v[72:75], v8, s[24:27], s36 offen offset:3072 sc1
    v_mfma_f32_16x16x32_bf16 v[112:115], a[0:3], v[32:35], v[112:115]
    ds_read_b64_tr_b16 a[18:19], v1 offset:2560
    s_mov_b32 m0, s59
    v_mfma_f32_16x16x32_bf16 v[120:123], a[0:3], v[36:39], v[120:123]
    buffer_load_dwordx4 v0, s[84:87], s57 offen nt lds
    s_add_u32 s60, s57, s56
    s_add_u32 s57, s57, s54
    s_waitcnt lgkmcnt(6)
    v_mfma_f32_16x16x32_bf16 v[100:103], a[4:7], v[24:27], v[100:103]
    ds_read_b64_tr_b16 a[20:21], v1 offset:2056
    v_mfma_f32_16x16x32_bf16 v[108:111], a[4:7], v[28:31], v[108:111]
    v_mfma_f32_16x16x32_bf16 v[116:119], a[4:7], v[32:35], v[116:119]
    ds_read_b64_tr_b16 a[22:23], v1 offset:2568
    s_add_u32 m0, s44, 0
    v_mfma_f32_16x16x32_bf16 v[124:127], a[4:7], v[36:39], v[124:127]
    buffer_load_dwordx4 v10, s[16:19], s42 offen offset:0 nt lds
    s_waitcnt lgkmcnt(6)
    v_mfma_f32_16x16x32_bf16 v[128:131], a[8:11], v[24:27], v[128:131]
    ds_read_b64_tr_b16 a[24:25], v2 offset:2048
    v_mfma_f32_16x16x32_bf16 v[136:139], a[8:11], v[28:31], v[136:139]
    v_mfma_f32_16x16x32_bf16 v[144:147], a[8:11], v[32:35], v[144:147]
    ds_read_b64_tr_b16 a[26:27], v2 offset:2560
    s_add_u32 m0, s59, 1024
    v_mfma_f32_16x16x32_bf16 v[152:155], a[8:11], v[36:39], v[152:155]
    buffer_load_dwordx4 v0, s[84:87], s60 offen nt lds
    s_waitcnt lgkmcnt(6)
    v_mfma_f32_16x16x32_bf16 v[132:135], a[12:15], v[24:27], v[132:135]
    ds_read_b64_tr_b16 a[28:29], v2 offset:2056
    v_mfma_f32_16x16x32_bf16 v[140:143], a[12:15], v[28:31], v[140:143]
    buffer_load_dwordx4 v[76:79], v8, s[24:27], s37 offen offset:3072 sc1
    v_mfma_f32_16x16x32_bf16 v[148:151], a[12:15], v[32:35], v[148:151]
    ds_read_b64_tr_b16 a[30:31], v2 offset:2568
    s_add_u32 m0, s44, 3968
    v_mfma_f32_16x16x32_bf16 v[156:159], a[12:15], v[36:39], v[156:159]
    buffer_load_dwordx4 v10, s[16:19], s42 offen offset:128 nt lds
    s_waitcnt lgkmcnt(6)
    v_mfma_f32_16x16x32_bf16 v[160:163], a[16:19], v[24:27], v[160:163]
    ds_read_b64_tr_b16 a[0:1], v1 offset:4096
    v_mfma_f32_16x16x32_bf16 v[168:171], a[16:19], v[28:31], v[168:171]
    v_mfma_f32_16x16x32_bf16 v[176:179], a[16:19], v[32:35], v[176:179]
    ds_read_b64_tr_b16 a[2:3], v1 offset:4608
    v_mfma_f32_16x16x32_bf16 v[184:187], a[16:19], v[36:39], v[184:187]
    s_waitcnt lgkmcnt(6)
    v_mfma_f32_16x16x32_bf16 v[164:167], a[20:23], v[24:27], v[164:167]
    ds_read_b64_tr_b16 a[4:5], v1 offset:4104
    v_mfma_f32_16x16x32_bf16 v[172:175], a[20:23], v[28:31], v[172:175]
    v_mfma_f32_16x16x32_bf16 v[180:183], a[20:23], v[32:35], v[180:183]
    ds_read_b64_tr_b16 a[6:7], v1 offset:4616
    s_add_u32 m0, s44, 7936
    v_mfma_f32_16x16x32_bf16 v[188:191], a[20:23], v[36:39], v[188:191]
    buffer_load_dwordx4 v10, s[16:19], s42 offen offset:256 nt lds
    s_add_u32 s42, s42, 12288
    s_waitcnt lgkmcnt(6)
    v_mfma_f32_16x16x32_bf16 v[192:195], a[24:27], v[24:27], v[192:195]
    ds_read_b64_tr_b16 a[8:9], v2 offset:4096
    v_mfma_f32_16x16x32_bf16 v[200:203], a[24:27], v[28:31], v[200:203]
    buffer_load_dwordx4 v[80:83], v8, s[24:27], s38 offen offset:3072 sc1
    v_mfma_f32_16x16x32_bf16 v[208:211], a[24:27], v[32:35], v[208:211]
    ds_read_b64_tr_b16 a[10:11], v2 offset:4608
    v_mfma_f32_16x16x32_bf16 v[216:219], a[24:27], v[36:39], v[216:219]
    s_waitcnt lgkmcnt(6)
    v_mfma_f32_16x16x32_bf16 v[196:199], a[28:31], v[24:27], v[196:199]
    ds_read_b64_tr_b16 a[12:13], v2 offset:4104
    v_mfma_f32_16x16x32_bf16 v[204:207], a[28:31], v[28:31], v[204:207]
    v_mfma_f32_16x16x32_bf16 v[212:215], a[28:31], v[32:35], v[212:215]
    ds_read_b64_tr_b16 a[14:15], v2 offset:4616
    s_add_u32 m0, s44, 12288
    v_mfma_f32_16x16x32_bf16 v[220:223], a[28:31], v[36:39], v[220:223]
    buffer_load_dwordx4 v10, s[16:19], s42 offen offset:0 nt lds
    s_waitcnt lgkmcnt(6)
    v_mfma_f32_16x16x32_bf16 v[224:227], a[0:3], v[24:27], v[224:227]
    ds_read_b64_tr_b16 a[16:17], v1 offset:6144
    v_mfma_f32_16x16x32_bf16 v[232:235], a[0:3], v[28:31], v[232:235]
    v_mfma_f32_16x16x32_bf16 v[240:243], a[0:3], v[32:35], v[240:243]
    ds_read_b64_tr_b16 a[18:19], v1 offset:6656
    v_mfma_f32_16x16x32_bf16 v[248:251], a[0:3], v[36:39], v[248:251]
    s_waitcnt lgkmcnt(6)
    v_mfma_f32_16x16x32_bf16 v[228:231], a[4:7], v[24:27], v[228:231]
    ds_read_b64_tr_b16 a[20:21], v1 offset:6152
    v_mfma_f32_16x16x32_bf16 v[236:239], a[4:7], v[28:31], v[236:239]
    buffer_load_dwordx4 v[84:87], v8, s[24:27], s39 offen offset:3072 sc1
    v_mfma_f32_16x16x32_bf16 v[244:247], a[4:7], v[32:35], v[244:247]
    ds_read_b64_tr_b16 a[22:23], v1 offset:6664
    s_add_u32 m0, s44, 16256
    v_mfma_f32_16x16x32_bf16 v[252:255], a[4:7], v[36:39], v[252:255]
    buffer_load_dwordx4 v10, s[16:19], s42 offen offset:128 nt lds
    s_waitcnt lgkmcnt(6)
    v_mfma_f32_16x16x32_bf16 a[64:67], a[8:11], v[24:27], a[64:67]
    ds_read_b64_tr_b16 a[24:25], v2 offset:6144
    v_mfma_f32_16x16x32_bf16 a[72:75], a[8:11], v[28:31], a[72:75]
    v_mfma_f32_16x16x32_bf16 a[80:83], a[8:11], v[32:35], a[80:83]
    ds_read_b64_tr_b16 a[26:27], v2 offset:6656
    v_mfma_f32_16x16x32_bf16 a[88:91], a[8:11], v[36:39], a[88:91]
    s_waitcnt lgkmcnt(6)
    v_mfma_f32_16x16x32_bf16 a[68:71], a[12:15], v[24:27], a[68:71]
    ds_read_b64_tr_b16 a[28:29], v2 offset:6152
    v_mfma_f32_16x16x32_bf16 a[76:79], a[12:15], v[28:31], a[76:79]
    v_mfma_f32_16x16x32_bf16 a[84:87], a[12:15], v[32:35], a[84:87]
    ds_read_b64_tr_b16 a[30:31], v2 offset:6664
    s_add_u32 m0, s44, 20224
    v_mfma_f32_16x16x32_bf16 a[92:95], a[12:15], v[36:39], a[92:95]
    buffer_load_dwordx4 v10, s[16:19], s42 offen offset:256 nt lds
    s_add_u32 s42, s42, 12288
    s_lshl_b32 s3, s32, 11
    s_add_u32 s3, s3, 222208
    s_sub_u32 s44, s3, s44
    s_waitcnt vmcnt(19) lgkmcnt(6)
    v_mfma_f32_16x16x32_bf16 v[96:99], a[16:19], v[40:43], v[96:99]
    ds_read_b64_tr_b16 a[0:1], v1 offset:8192
    v_mfma_f32_16x16x32_bf16 v[104:107], a[16:19], v[44:47], v[104:107]
    v_mfma_f32_16x16x32_bf16 v[112:115], a[16:19], v[48:51], v[112:115]
    ds_read_b64_tr_b16 a[2:3], v1 offset:8704
    v_mfma_f32_16x16x32_bf16 v[120:123], a[16:19], v[52:55], v[120:123]
    s_waitcnt lgkmcnt(6)
    v_mfma_f32_16x16x32_bf16 v[100:103], a[20:23], v[40:43], v[100:103]
    ds_read_b64_tr_b16 a[4:5], v1 offset:8200
    v_mfma_f32_16x16x32_bf16 v[108:111], a[20:23], v[44:47], v[108:111]
    v_mfma_f32_16x16x32_bf16 v[116:119], a[20:23], v[48:51], v[116:119]
    ds_read_b64_tr_b16 a[6:7], v1 offset:8712
    s_add_u32 m0, s45, 0
    v_mfma_f32_16x16x32_bf16 v[124:127], a[20:23], v[52:55], v[124:127]
    buffer_load_dwordx4 v11, s[20:23], s43 offen offset:0 nt lds
    s_waitcnt lgkmcnt(6)
    v_mfma_f32_16x16x32_bf16 v[128:131], a[24:27], v[40:43], v[128:131]
    ds_read_b64_tr_b16 a[8:9], v2 offset:8192
    v_mfma_f32_16x16x32_bf16 v[136:139], a[24:27], v[44:47], v[136:139]
    v_mfma_f32_16x16x32_bf16 v[144:147], a[24:27], v[48:51], v[144:147]
    ds_read_b64_tr_b16 a[10:11], v2 offset:8704
    v_mfma_f32_16x16x32_bf16 v[152:155], a[24:27], v[52:55], v[152:155]
    s_waitcnt lgkmcnt(6)
    v_mfma_f32_16x16x32_bf16 v[132:135], a[28:31], v[40:43], v[132:135]
    ds_read_b64_tr_b16 a[12:13], v2 offset:8200
    v_mfma_f32_16x16x32_bf16 v[140:143], a[28:31], v[44:47], v[140:143]
    v_mfma_f32_16x16x32_bf16 v[148:151], a[28:31], v[48:51], v[148:151]
    ds_read_b64_tr_b16 a[14:15], v2 offset:8712
    s_add_u32 m0, s45, 3968
    v_mfma_f32_16x16x32_bf16 v[156:159], a[28:31], v[52:55], v[156:159]
    buffer_load_dwordx4 v11, s[20:23], s43 offen offset:128 nt lds
    s_waitcnt lgkmcnt(6)
    v_mfma_f32_16x16x32_bf16 v[160:163], a[0:3], v[40:43], v[160:163]
    ds_read_b64_tr_b16 a[16:17], v1 offset:10240
    v_mfma_f32_16x16x32_bf16 v[168:171], a[0:3], v[44:47], v[168:171]
    v_mfma_f32_16x16x32_bf16 v[176:179], a[0:3], v[48:51], v[176:179]
    ds_read_b64_tr_b16 a[18:19], v1 offset:10752
    v_mfma_f32_16x16x32_bf16 v[184:187], a[0:3], v[52:55], v[184:187]
    s_waitcnt lgkmcnt(6)
    v_mfma_f32_16x16x32_bf16 v[164:167], a[4:7], v[40:43], v[164:167]
    ds_read_b64_tr_b16 a[20:21], v1 offset:10248
    v_mfma_f32_16x16x32_bf16 v[172:175], a[4:7], v[44:47], v[172:175]
    v_mfma_f32_16x16x32_bf16 v[180:183], a[4:7], v[48:51], v[180:183]
    ds_read_b64_tr_b16 a[22:23], v1 offset:10760
    s_add_u32 m0, s45, 7936
    v_mfma_f32_16x16x32_bf16 v[188:191], a[4:7], v[52:55], v[188:191]
    buffer_load_dwordx4 v11, s[20:23], s43 offen offset:256 nt lds
    s_add_u32 s43, s43, 12288
    s_waitcnt lgkmcnt(6)
    v_mfma_f32_16x16x32_bf16 v[192:195], a[8:11], v[40:43], v[192:195]
    ds_read_b64_tr_b16 a[24:25], v2 offset:10240
    v_mfma_f32_16x16x32_bf16 v[200:203], a[8:11], v[44:47], v[200:203]
    v_mfma_f32_16x16x32_bf16 v[208:211], a[8:11], v[48:51], v[208:211]
    ds_read_b64_tr_b16 a[26:27], v2 offset:10752
    v_mfma_f32_16x16x32_bf16 v[216:219], a[8:11], v[52:55], v[216:219]
    s_waitcnt lgkmcnt(6)
    v_mfma_f32_16x16x32_bf16 v[196:199], a[12:15], v[40:43], v[196:199]
    ds_read_b64_tr_b16 a[28:29], v2 offset:10248
    v_mfma_f32_16x16x32_bf16 v[204:207], a[12:15], v[44:47], v[204:207]
    v_mfma_f32_16x16x32_bf16 v[212:215], a[12:15], v[48:51], v[212:215]
    ds_read_b64_tr_b16 a[30:31], v2 offset:10760
    s_add_u32 m0, s45, 12288
    v_mfma_f32_16x16x32_bf16 v[220:223], a[12:15], v[52:55], v[220:223]
    buffer_load_dwordx4 v11, s[20:23], s43 offen offset:0 nt lds
    s_waitcnt lgkmcnt(6)
    v_mfma_f32_16x16x32_bf16 v[224:227], a[16:19], v[40:43], v[224:227]
    s_waitcnt vmcnt(18)
    s_barrier
    ds_read_b64_tr_b16 a[0:1], v1 offset:12288
    v_mfma_f32_16x16x32_bf16 v[232:235], a[16:19], v[44:47], v[232:235]
    v_mfma_f32_16x16x32_bf16 v[240:243], a[16:19], v[48:51], v[240:243]
    ds_read_b64_tr_b16 a[2:3], v1 offset:12800
    v_mfma_f32_16x16x32_bf16 v[248:251], a[16:19], v[52:55], v[248:251]
    s_waitcnt lgkmcnt(6)
    v_mfma_f32_16x16x32_bf16 v[228:231], a[20:23], v[40:43], v[228:231]
    ds_read_b64_tr_b16 a[4:5], v1 offset:12296
    v_mfma_f32_16x16x32_bf16 v[236:239], a[20:23], v[44:47], v[236:239]
    v_mfma_f32_16x16x32_bf16 v[244:247], a[20:23], v[48:51], v[244:247]
    ds_read_b64_tr_b16 a[6:7], v1 offset:12808
    s_add_u32 m0, s45, 16256
    v_mfma_f32_16x16x32_bf16 v[252:255], a[20:23], v[52:55], v[252:255]
    buffer_load_dwordx4 v11, s[20:23], s43 offen offset:128 nt lds
    s_waitcnt lgkmcnt(6)
    v_mfma_f32_16x16x32_bf16 a[64:67], a[24:27], v[40:43], a[64:67]
    ds_read_b64_tr_b16 a[8:9], v2 offset:12288
    v_mfma_f32_16x16x32_bf16 a[72:75], a[24:27], v[44:47], a[72:75]
    v_mfma_f32_16x16x32_bf16 a[80:83], a[24:27], v[48:51], a[80:83]
    ds_read_b64_tr_b16 a[10:11], v2 offset:12800
    v_mfma_f32_16x16x32_bf16 a[88:91], a[24:27], v[52:55], a[88:91]
    s_waitcnt lgkmcnt(6)
    v_mfma_f32_16x16x32_bf16 a[68:71], a[28:31], v[40:43], a[68:71]
    ds_read_b64_tr_b16 a[12:13], v2 offset:12296
    v_mfma_f32_16x16x32_bf16 a[76:79], a[28:31], v[44:47], a[76:79]
    v_mfma_f32_16x16x32_bf16 a[84:87], a[28:31], v[48:51], a[84:87]
    ds_read_b64_tr_b16 a[14:15], v2 offset:12808
    s_add_u32 m0, s45, 20224
    v_mfma_f32_16x16x32_bf16 a[92:95], a[28:31], v[52:55], a[92:95]
    buffer_load_dwordx4 v11, s[20:23], s43 offen offset:256 nt lds
    s_add_u32 s43, s43, 12288
    s_lshl_b32 s3, s32, 11
    s_add_u32 s3, s3, 123392
    s_sub_u32 s45, s3, s45
    s_waitcnt vmcnt(18) lgkmcnt(6)
    v_mfma_f32_16x16x32_bf16 v[96:99], a[0:3], v[56:59], v[96:99]
    ds_read_b64_tr_b16 a[16:17], v1 offset:14336
    v_mfma_f32_16x16x32_bf16 v[104:107], a[0:3], v[60:63], v[104:107]
    v_mfma_f32_16x16x32_bf16 v[112:115], a[0:3], v[64:67], v[112:115]
    ds_read_b64_tr_b16 a[18:19], v1 offset:14848
    v_mfma_f32_16x16x32_bf16 v[120:123], a[0:3], v[68:71], v[120:123]
    v_and_b32 v88, 0x3c0, v8
    s_waitcnt lgkmcnt(6)
    v_mfma_f32_16x16x32_bf16 v[100:103], a[4:7], v[56:59], v[100:103]
    ds_read_b64_tr_b16 a[20:21], v1 offset:14344
    v_mfma_f32_16x16x32_bf16 v[108:111], a[4:7], v[60:63], v[108:111]
    v_mfma_f32_16x16x32_bf16 v[116:119], a[4:7], v[64:67], v[116:119]
    ds_read_b64_tr_b16 a[22:23], v1 offset:14856
    s_add_u32 m0, s44, 0
    v_mfma_f32_16x16x32_bf16 v[124:127], a[4:7], v[68:71], v[124:127]
    buffer_load_dwordx4 v10, s[16:19], s42 offen offset:0 nt lds
    s_waitcnt lgkmcnt(6)
    v_mfma_f32_16x16x32_bf16 v[128:131], a[8:11], v[56:59], v[128:131]
    ds_read_b64_tr_b16 a[24:25], v2 offset:14336
    v_mfma_f32_16x16x32_bf16 v[136:139], a[8:11], v[60:63], v[136:139]
    v_mfma_f32_16x16x32_bf16 v[144:147], a[8:11], v[64:67], v[144:147]
    ds_read_b64_tr_b16 a[26:27], v2 offset:14848
    v_mfma_f32_16x16x32_bf16 v[152:155], a[8:11], v[68:71], v[152:155]
    v_bfe_u32 v89, v8, 4, 2
    s_waitcnt lgkmcnt(6)
    v_mfma_f32_16x16x32_bf16 v[132:135], a[12:15], v[56:59], v[132:135]
    ds_read_b64_tr_b16 a[28:29], v2 offset:14344
    v_mfma_f32_16x16x32_bf16 v[140:143], a[12:15], v[60:63], v[140:143]
    v_mfma_f32_16x16x32_bf16 v[148:151], a[12:15], v[64:67], v[148:151]
    ds_read_b64_tr_b16 a[30:31], v2 offset:14856
    s_add_u32 m0, s44, 3968
    v_mfma_f32_16x16x32_bf16 v[156:159], a[12:15], v[68:71], v[156:159]
    buffer_load_dwordx4 v10, s[16:19], s42 offen offset:128 nt lds
    s_waitcnt lgkmcnt(6)
    v_mfma_f32_16x16x32_bf16 v[160:163], a[16:19], v[56:59], v[160:163]
    ds_read_b64_tr_b16 a[0:1], v1 offset:16384
    v_mfma_f32_16x16x32_bf16 v[168:171], a[16:19], v[60:63], v[168:171]
    v_mfma_f32_16x16x32_bf16 v[176:179], a[16:19], v[64:67], v[176:179]
    ds_read_b64_tr_b16 a[2:3], v1 offset:16896
    v_mfma_f32_16x16x32_bf16 v[184:187], a[16:19], v[68:71], v[184:187]
    v_lshlrev_b32 v89, 3, v89
    s_waitcnt lgkmcnt(6)
    v_mfma_f32_16x16x32_bf16 v[164:167], a[20:23], v[56:59], v[164:167]
    ds_read_b64_tr_b16 a[4:5], v1 offset:16392
    v_mfma_f32_16x16x32_bf16 v[172:175], a[20:23], v[60:63], v[172:175]
    v_mfma_f32_16x16x32_bf16 v[180:183], a[20:23], v[64:67], v[180:183]
    ds_read_b64_tr_b16 a[6:7], v1 offset:16904
    s_add_u32 m0, s44, 7936
    v_mfma_f32_16x16x32_bf16 v[188:191], a[20:23], v[68:71], v[188:191]
    buffer_load_dwordx4 v10, s[16:19], s42 offen offset:256 nt lds
    s_add_u32 s42, s42, 12288
    s_waitcnt lgkmcnt(6)
    v_mfma_f32_16x16x32_bf16 v[192:195], a[24:27], v[56:59], v[192:195]
    ds_read_b64_tr_b16 a[8:9], v2 offset:16384
    v_mfma_f32_16x16x32_bf16 v[200:203], a[24:27], v[60:63], v[200:203]
    v_mfma_f32_16x16x32_bf16 v[208:211], a[24:27], v[64:67], v[208:211]
    ds_read_b64_tr_b16 a[10:11], v2 offset:16896
    v_mfma_f32_16x16x32_bf16 v[216:219], a[24:27], v[68:71], v[216:219]
    v_add3_u32 v7, v88, v89, s59
    s_waitcnt lgkmcnt(6)
    v_mfma_f32_16x16x32_bf16 v[196:199], a[28:31], v[56:59], v[196:199]
    ds_read_b64_tr_b16 a[12:13], v2 offset:16392
    v_mfma_f32_16x16x32_bf16 v[204:207], a[28:31], v[60:63], v[204:207]
    v_mfma_f32_16x16x32_bf16 v[212:215], a[28:31], v[64:67], v[212:215]
    ds_read_b64_tr_b16 a[14:15], v2 offset:16904
    s_add_u32 m0, s44, 12288
    v_mfma_f32_16x16x32_bf16 v[220:223], a[28:31], v[68:71], v[220:223]
    buffer_load_dwordx4 v10, s[16:19], s42 offen offset:0 nt lds
    s_waitcnt lgkmcnt(6)
    v_mfma_f32_16x16x32_bf16 v[224:227], a[0:3], v[56:59], v[224:227]
    ds_read_b64_tr_b16 a[16:17], v1 offset:18432
    v_mfma_f32_16x16x32_bf16 v[232:235], a[0:3], v[60:63], v[232:235]
    v_mfma_f32_16x16x32_bf16 v[240:243], a[0:3], v[64:67], v[240:243]
    ds_read_b64_tr_b16 a[18:19], v1 offset:18944
    v_mfma_f32_16x16x32_bf16 v[248:251], a[0:3], v[68:71], v[248:251]
    s_waitcnt lgkmcnt(6)
    v_mfma_f32_16x16x32_bf16 v[228:231], a[4:7], v[56:59], v[228:231]
    ds_read_b64_tr_b16 a[20:21], v1 offset:18440
    v_mfma_f32_16x16x32_bf16 v[236:239], a[4:7], v[60:63], v[236:239]
    v_mfma_f32_16x16x32_bf16 v[244:247], a[4:7], v[64:67], v[244:247]
    ds_read_b64_tr_b16 a[22:23], v1 offset:18952
    s_add_u32 m0, s44, 16256
    v_mfma_f32_16x16x32_bf16 v[252:255], a[4:7], v[68:71], v[252:255]
    buffer_load_dwordx4 v10, s[16:19], s42 offen offset:128 nt lds
    s_waitcnt lgkmcnt(6)
    v_mfma_f32_16x16x32_bf16 a[64:67], a[8:11], v[56:59], a[64:67]
    ds_read_b64_tr_b16 a[24:25], v2 offset:18432
    v_mfma_f32_16x16x32_bf16 a[72:75], a[8:11], v[60:63], a[72:75]
    v_mfma_f32_16x16x32_bf16 a[80:83], a[8:11], v[64:67], a[80:83]
    ds_read_b64_tr_b16 a[26:27], v2 offset:18944
    v_mfma_f32_16x16x32_bf16 a[88:91], a[8:11], v[68:71], a[88:91]
    s_waitcnt lgkmcnt(6)
    v_mfma_f32_16x16x32_bf16 a[68:71], a[12:15], v[56:59], a[68:71]
    ds_read_b64_tr_b16 a[28:29], v2 offset:18440
    v_mfma_f32_16x16x32_bf16 a[76:79], a[12:15], v[60:63], a[76:79]
    v_mfma_f32_16x16x32_bf16 a[84:87], a[12:15], v[64:67], a[84:87]
    ds_read_b64_tr_b16 a[30:31], v2 offset:18952
    s_add_u32 m0, s44, 20224
    v_mfma_f32_16x16x32_bf16 a[92:95], a[12:15], v[68:71], a[92:95]
    buffer_load_dwordx4 v10, s[16:19], s42 offen offset:256 nt lds
    s_add_u32 s42, s42, 12288
    s_lshl_b32 s3, s32, 11
    s_add_u32 s3, s3, 222208
    s_sub_u32 s44, s3, s44
    s_waitcnt vmcnt(14) lgkmcnt(6)
    v_mfma_f32_16x16x32_bf16 v[96:99], a[16:19], v[72:75], v[96:99]
    ds_read_b64_tr_b16 a[0:1], v1 offset:20480
    v_mfma_f32_16x16x32_bf16 v[104:107], a[16:19], v[76:79], v[104:107]
    ds_read_b64_tr_b16 v[88:89], v7 offset:0
    v_mfma_f32_16x16x32_bf16 v[112:115], a[16:19], v[80:83], v[112:115]
    ds_read_b64_tr_b16 a[2:3], v1 offset:20992
    v_mfma_f32_16x16x32_bf16 v[120:123], a[16:19], v[84:87], v[120:123]
    ds_read_b64_tr_b16 v[90:91], v7 offset:1024
    s_waitcnt lgkmcnt(8)
    v_mfma_f32_16x16x32_bf16 v[100:103], a[20:23], v[72:75], v[100:103]
    ds_read_b64_tr_b16 a[4:5], v1 offset:20488
    v_mfma_f32_16x16x32_bf16 v[108:111], a[20:23], v[76:79], v[108:111]
    ds_read_b64_tr_b16 v[92:93], v7 offset:32
    v_mfma_f32_16x16x32_bf16 v[116:119], a[20:23], v[80:83], v[116:119]
    ds_read_b64_tr_b16 a[6:7], v1 offset:21000
    v_mfma_f32_16x16x32_bf16 v[124:127], a[20:23], v[84:87], v[124:127]
    ds_read_b64_tr_b16 v[94:95], v7 offset:1056
    s_waitcnt lgkmcnt(10)
    v_mfma_f32_16x16x32_bf16 v[128:131], a[24:27], v[72:75], v[128:131]
    ds_read_b64_tr_b16 a[8:9], v2 offset:20480
    v_mfma_f32_16x16x32_bf16 v[136:139], a[24:27], v[76:79], v[136:139]
    v_mfma_f32_16x16x32_bf16 v[144:147], a[24:27], v[80:83], v[144:147]
    ds_read_b64_tr_b16 a[10:11], v2 offset:20992
    v_mfma_f32_16x16x32_bf16 v[152:155], a[24:27], v[84:87], v[152:155]
    v_cvt_pk_bf16_f32 v96, v96, v97
    v_cvt_pk_bf16_f32 v97, v98, v99
    v_cvt_pk_bf16_f32 v98, v100, v101
    s_waitcnt lgkmcnt(10)
    v_mfma_f32_16x16x32_bf16 v[132:135], a[28:31], v[72:75], v[132:135]
    ds_read_b64_tr_b16 a[12:13], v2 offset:20488
    v_cvt_pk_bf16_f32 v99, v102, v103
    v_mfma_f32_16x16x32_bf16 v[140:143], a[28:31], v[76:79], v[140:143]
    v_cvt_pk_bf16_f32 v100, v104, v105
    v_cvt_pk_bf16_f32 v101, v106, v107
    v_cvt_pk_bf16_f32 v102, v108, v109
    v_mfma_f32_16x16x32_bf16 v[148:151], a[28:31], v[80:83], v[148:151]
    ds_read_b64_tr_b16 a[14:15], v2 offset:21000
    v_cvt_pk_bf16_f32 v103, v110, v111
    v_mfma_f32_16x16x32_bf16 v[156:159], a[28:31], v[84:87], v[156:159]
    v_cvt_pk_bf16_f32 v104, v112, v113
    v_cvt_pk_bf16_f32 v105, v114, v115
    v_cvt_pk_bf16_f32 v106, v116, v117
    s_waitcnt lgkmcnt(9)
    v_mfma_f32_16x16x32_bf16 v[160:163], a[0:3], v[72:75], v[160:163]
    ds_read_b64_tr_b16 a[16:17], v1 offset:22528
    v_cvt_pk_bf16_f32 v107, v118, v119
    v_mfma_f32_16x16x32_bf16 v[168:171], a[0:3], v[76:79], v[168:171]
    v_cvt_pk_bf16_f32 v108, v120, v121
    v_cvt_pk_bf16_f32 v109, v122, v123
    v_cvt_pk_bf16_f32 v110, v124, v125
    v_mfma_f32_16x16x32_bf16 v[176:179], a[0:3], v[80:83], v[176:179]
    ds_read_b64_tr_b16 a[18:19], v1 offset:23040
    v_cvt_pk_bf16_f32 v111, v126, v127
    v_mfma_f32_16x16x32_bf16 v[184:187], a[0:3], v[84:87], v[184:187]
    v_cvt_pk_bf16_f32 v112, v128, v129
    v_cvt_pk_bf16_f32 v113, v130, v131
    v_cvt_pk_bf16_f32 v114, v132, v133
    s_waitcnt lgkmcnt(7)
    v_mfma_f32_16x16x32_bf16 v[164:167], a[4:7], v[72:75], v[164:167]
    ds_read_b64_tr_b16 a[20:21], v1 offset:22536
    v_cvt_pk_bf16_f32 v115, v134, v135
    v_cvt_pk_bf16_f32 v116, v136, v137
    v_mfma_f32_16x16x32_bf16 v[172:175], a[4:7], v[76:79], v[172:175]
    v_cvt_pk_bf16_f32 v117, v138, v139
    v_cvt_pk_bf16_f32 v118, v140, v141
    v_mfma_f32_16x16x32_bf16 v[180:183], a[4:7], v[80:83], v[180:183]
    ds_read_b64_tr_b16 a[22:23], v1 offset:23048
    v_cvt_pk_bf16_f32 v119, v142, v143
    v_cvt_pk_bf16_f32 v120, v144, v145
    v_mfma_f32_16x16x32_bf16 v[188:191], a[4:7], v[84:87], v[188:191]
    v_cvt_pk_bf16_f32 v121, v146, v147
    v_cvt_pk_bf16_f32 v122, v148, v149
    v_cvt_pk_bf16_f32 v123, v150, v151
    s_waitcnt lgkmcnt(6)
    v_mfma_f32_16x16x32_bf16 v[192:195], a[8:11], v[72:75], v[192:195]
    ds_read_b64_tr_b16 a[24:25], v2 offset:22528
    v_cvt_pk_bf16_f32 v124, v152, v153
    v_cvt_pk_bf16_f32 v125, v154, v155
    v_mfma_f32_16x16x32_bf16 v[200:203], a[8:11], v[76:79], v[200:203]
    buffer_store_dwordx4 v[88:91], v8, s[88:91], s58 offen sc1
    v_mfma_f32_16x16x32_bf16 v[208:211], a[8:11], v[80:83], v[208:211]
    ds_read_b64_tr_b16 a[26:27], v2 offset:23040
    v_cvt_pk_bf16_f32 v126, v156, v157
    v_cvt_pk_bf16_f32 v127, v158, v159
    v_mfma_f32_16x16x32_bf16 v[216:219], a[8:11], v[84:87], v[216:219]
    v_cvt_pk_bf16_f32 v128, v160, v161
    v_cvt_pk_bf16_f32 v129, v162, v163
    v_cvt_pk_bf16_f32 v130, v164, v165
    s_waitcnt lgkmcnt(6)
    v_mfma_f32_16x16x32_bf16 v[196:199], a[12:15], v[72:75], v[196:199]
    ds_read_b64_tr_b16 a[28:29], v2 offset:22536
    v_cvt_pk_bf16_f32 v131, v166, v167
    v_cvt_pk_bf16_f32 v132, v168, v169
    v_mfma_f32_16x16x32_bf16 v[204:207], a[12:15], v[76:79], v[204:207]
    buffer_store_dwordx4 v[92:95], v8, s[92:95], s58 offen sc1
    s_add_u32 s58, s58, s55
    v_cvt_pk_bf16_f32 v133, v170, v171
    v_mfma_f32_16x16x32_bf16 v[212:215], a[12:15], v[80:83], v[212:215]
    ds_read_b64_tr_b16 a[30:31], v2 offset:23048
    v_cvt_pk_bf16_f32 v134, v172, v173
    v_cvt_pk_bf16_f32 v135, v174, v175
    v_mfma_f32_16x16x32_bf16 v[220:223], a[12:15], v[84:87], v[220:223]
    v_cvt_pk_bf16_f32 v136, v176, v177
    v_cvt_pk_bf16_f32 v137, v178, v179
    s_waitcnt lgkmcnt(6)
    v_mfma_f32_16x16x32_bf16 v[224:227], a[16:19], v[72:75], v[224:227]
    s_barrier
    ds_read_b128 a[0:3], v5 offset:0
    s_mov_b32 m0, s59
    v_cvt_pk_bf16_f32 v138, v180, v181
    v_cvt_pk_bf16_f32 v139, v182, v183
    v_mfma_f32_16x16x32_bf16 v[232:235], a[16:19], v[76:79], v[232:235]
    buffer_load_dwordx4 v0, s[84:87], s57 offen nt lds
    s_add_u32 s60, s57, s56
    s_add_u32 s57, s57, s54
    v_cvt_pk_bf16_f32 v140, v184, v185
    v_mfma_f32_16x16x32_bf16 v[240:243], a[16:19], v[80:83], v[240:243]
    v_cvt_pk_bf16_f32 v141, v186, v187
    v_cvt_pk_bf16_f32 v142, v188, v189
    v_cvt_pk_bf16_f32 v143, v190, v191
    v_mfma_f32_16x16x32_bf16 v[248:251], a[16:19], v[84:87], v[248:251]
    v_cvt_pk_bf16_f32 v144, v192, v193
    v_cvt_pk_bf16_f32 v145, v194, v195
    v_cvt_pk_bf16_f32 v146, v196, v197
    s_waitcnt lgkmcnt(5)
    v_mfma_f32_16x16x32_bf16 v[228:231], a[20:23], v[72:75], v[228:231]
    ds_read_b128 a[4:7], v6 offset:0
    s_add_u32 m0, s59, 1024
    v_cvt_pk_bf16_f32 v147, v198, v199
    v_mfma_f32_16x16x32_bf16 v[236:239], a[20:23], v[76:79], v[236:239]
    buffer_load_dwordx4 v0, s[84:87], s60 offen nt lds
    v_cvt_pk_bf16_f32 v148, v200, v201
    v_mfma_f32_16x16x32_bf16 v[244:247], a[20:23], v[80:83], v[244:247]
    v_cvt_pk_bf16_f32 v149, v202, v203
    v_cvt_pk_bf16_f32 v150, v204, v205
    v_mfma_f32_16x16x32_bf16 v[252:255], a[20:23], v[84:87], v[252:255]
    v_cvt_pk_bf16_f32 v151, v206, v207
    v_cvt_pk_bf16_f32 v152, v208, v209
    v_cvt_pk_bf16_f32 v153, v210, v211
    s_waitcnt lgkmcnt(4)
    v_mfma_f32_16x16x32_bf16 a[64:67], a[24:27], v[72:75], a[64:67]
    ds_read_b128 a[8:11], v5 offset:4096
    v_cvt_pk_bf16_f32 v154, v212, v213
    v_mfma_f32_16x16x32_bf16 a[72:75], a[24:27], v[76:79], a[72:75]
    v_cvt_pk_bf16_f32 v155, v214, v215
    v_cvt_pk_bf16_f32 v156, v216, v217
    v_cvt_pk_bf16_f32 v157, v218, v219
    v_mfma_f32_16x16x32_bf16 a[80:83], a[24:27], v[80:83], a[80:83]
    v_cvt_pk_bf16_f32 v158, v220, v221
    v_cvt_pk_bf16_f32 v159, v222, v223
    v_mfma_f32_16x16x32_bf16 a[88:91], a[24:27], v[84:87], a[88:91]
    v_cvt_pk_bf16_f32 v160, v224, v225
    v_cvt_pk_bf16_f32 v161, v226, v227
    s_waitcnt lgkmcnt(3)
    v_mfma_f32_16x16x32_bf16 a[68:71], a[28:31], v[72:75], a[68:71]
    ds_read_b128 a[12:15], v6 offset:4096
    v_cvt_pk_bf16_f32 v162, v228, v229
    v_cvt_pk_bf16_f32 v163, v230, v231
    v_mfma_f32_16x16x32_bf16 a[76:79], a[28:31], v[76:79], a[76:79]
    v_cvt_pk_bf16_f32 v164, v232, v233
    v_cvt_pk_bf16_f32 v165, v234, v235
    v_mfma_f32_16x16x32_bf16 a[84:87], a[28:31], v[80:83], a[84:87]
    v_cvt_pk_bf16_f32 v166, v236, v237
    v_cvt_pk_bf16_f32 v167, v238, v239
    v_mfma_f32_16x16x32_bf16 a[92:95], a[28:31], v[84:87], a[92:95]
    v_cvt_pk_bf16_f32 v168, v240, v241
    v_cvt_pk_bf16_f32 v169, v242, v243
    s_waitcnt lgkmcnt(3)
    v_mfma_f32_16x16x32_bf16 v[24:27], a[0:3], v[96:99], 0
    ds_read_b128 a[16:19], v5 offset:8192
    v_cvt_pk_bf16_f32 v170, v244, v245
    v_cvt_pk_bf16_f32 v171, v246, v247
    v_mfma_f32_16x16x32_bf16 v[32:35], a[0:3], v[100:103], 0
    v_cvt_pk_bf16_f32 v172, v248, v249
    v_cvt_pk_bf16_f32 v173, v250, v251
    v_mfma_f32_16x16x32_bf16 v[40:43], a[0:3], v[104:107], 0
    v_cvt_pk_bf16_f32 v174, v252, v253
    v_cvt_pk_bf16_f32 v175, v254, v255
    v_mfma_f32_16x16x32_bf16 v[48:51], a[0:3], v[108:111], 0
    v_accvgpr_read_b32 v12, a64
    v_accvgpr_read_b32 v13, a65
    v_cvt_pk_bf16_f32 v176, v12, v13
    s_waitcnt lgkmcnt(3)
    v_mfma_f32_16x16x32_bf16 v[24:27], a[4:7], v[112:115], v[24:27]
    ds_read_b128 a[20:23], v6 offset:8192
    v_accvgpr_read_b32 v14, a66
    v_accvgpr_read_b32 v15, a67
    v_cvt_pk_bf16_f32 v177, v14, v15
    v_mfma_f32_16x16x32_bf16 v[32:35], a[4:7], v[116:119], v[32:35]
    v_accvgpr_read_b32 v12, a68
    v_accvgpr_read_b32 v13, a69
    v_cvt_pk_bf16_f32 v178, v12, v13
    v_mfma_f32_16x16x32_bf16 v[40:43], a[4:7], v[120:123], v[40:43]
    v_accvgpr_read_b32 v14, a70
    v_accvgpr_read_b32 v15, a71
    v_cvt_pk_bf16_f32 v179, v14, v15
    v_mfma_f32_16x16x32_bf16 v[48:51], a[4:7], v[124:127], v[48:51]
    v_accvgpr_read_b32 v12, a72
    v_accvgpr_read_b32 v13, a73
    v_cvt_pk_bf16_f32 v180, v12, v13
    s_waitcnt lgkmcnt(3)
    v_mfma_f32_16x16x32_bf16 v[24:27], a[8:11], v[128:131], v[24:27]
    ds_read_b128 a[24:27], v5 offset:2048
    v_accvgpr_read_b32 v14, a74
    v_accvgpr_read_b32 v15, a75
    v_cvt_pk_bf16_f32 v181, v14, v15
    v_mfma_f32_16x16x32_bf16 v[32:35], a[8:11], v[132:135], v[32:35]
    v_accvgpr_read_b32 v12, a76
    v_accvgpr_read_b32 v13, a77
    v_cvt_pk_bf16_f32 v182, v12, v13
    v_mfma_f32_16x16x32_bf16 v[40:43], a[8:11], v[136:139], v[40:43]
    v_accvgpr_read_b32 v14, a78
    v_accvgpr_read_b32 v15, a79
    v_cvt_pk_bf16_f32 v183, v14, v15
    v_mfma_f32_16x16x32_bf16 v[48:51], a[8:11], v[140:143], v[48:51]
    v_accvgpr_read_b32 v12, a80
    v_accvgpr_read_b32 v13, a81
    v_cvt_pk_bf16_f32 v184, v12, v13
    s_waitcnt lgkmcnt(3)
    v_mfma_f32_16x16x32_bf16 v[24:27], a[12:15], v[144:147], v[24:27]
    ds_read_b128 a[28:31], v6 offset:2048
    v_accvgpr_read_b32 v14, a82
    v_accvgpr_read_b32 v15, a83
    v_cvt_pk_bf16_f32 v185, v14, v15
    v_mfma_f32_16x16x32_bf16 v[32:35], a[12:15], v[148:151], v[32:35]
    v_accvgpr_read_b32 v12, a84
    v_accvgpr_read_b32 v13, a85
    v_cvt_pk_bf16_f32 v186, v12, v13
    v_mfma_f32_16x16x32_bf16 v[40:43], a[12:15], v[152:155], v[40:43]
    v_accvgpr_read_b32 v14, a86
    v_accvgpr_read_b32 v15, a87
    v_cvt_pk_bf16_f32 v187, v14, v15
    v_mfma_f32_16x16x32_bf16 v[48:51], a[12:15], v[156:159], v[48:51]
    v_accvgpr_read_b32 v12, a88
    v_accvgpr_read_b32 v13, a89
    v_cvt_pk_bf16_f32 v188, v12, v13
    s_waitcnt lgkmcnt(3)
    v_mfma_f32_16x16x32_bf16 v[24:27], a[16:19], v[160:163], v[24:27]
    ds_read_b128 a[0:3], v5 offset:6144
    v_accvgpr_read_b32 v14, a90
    v_accvgpr_read_b32 v15, a91
    v_cvt_pk_bf16_f32 v189, v14, v15
    v_mfma_f32_16x16x32_bf16 v[32:35], a[16:19], v[164:167], v[32:35]
    v_accvgpr_read_b32 v12, a92
    v_accvgpr_read_b32 v13, a93
    v_cvt_pk_bf16_f32 v190, v12, v13
    v_mfma_f32_16x16x32_bf16 v[40:43], a[16:19], v[168:171], v[40:43]
    v_accvgpr_read_b32 v14, a94
    v_accvgpr_read_b32 v15, a95
    v_cvt_pk_bf16_f32 v191, v14, v15
    v_mfma_f32_16x16x32_bf16 v[48:51], a[16:19], v[172:175], v[48:51]
    v_lshrrev_b32 v18, 4, v8
    v_lshrrev_b32 v16, 2, v18
    s_waitcnt lgkmcnt(3)
    v_mfma_f32_16x16x32_bf16 v[24:27], a[20:23], v[176:179], v[24:27]
    ds_read_b128 a[4:7], v6 offset:6144
    v_lshlrev_b32 v16, 7, v16
    v_mfma_f32_16x16x32_bf16 v[32:35], a[20:23], v[180:183], v[32:35]
    v_bfe_u32 v17, v18, 3, 2
    v_lshl_add_u32 v16, v17, 5, v16
    v_and_b32 v17, 3, v18
    v_mfma_f32_16x16x32_bf16 v[40:43], a[20:23], v[184:187], v[40:43]
    v_lshl_add_u32 v16, v17, 3, v16
    v_add_u32 v1, 49408, v16
    v_mfma_f32_16x16x32_bf16 v[48:51], a[20:23], v[188:191], v[48:51]
    v_xor_b32 v17, 32, v16
    v_add_u32 v2, 49408, v17
    s_waitcnt lgkmcnt(3)
    v_mfma_f32_16x16x32_bf16 v[28:31], a[24:27], v[96:99], 0
    ds_read_b128 a[8:11], v5 offset:10240
    v_xor_b32 v17, 64, v16
    v_mfma_f32_16x16x32_bf16 v[36:39], a[24:27], v[100:103], 0
    v_add_u32 v3, 49408, v17
    v_xor_b32 v17, 96, v16
    v_add_u32 v4, 49408, v17
    v_mfma_f32_16x16x32_bf16 v[44:47], a[24:27], v[104:107], 0
    v_lshrrev_b32 v16, 2, v18
    s_lshr_b32 s3, s74, 4
    v_mul_lo_u32 v21, v16, s3
    v_mfma_f32_16x16x32_bf16 v[52:55], a[24:27], v[108:111], 0
    v_and_b32 v17, 48, v8
    v_add_u32 v21, v21, v17
    s_waitcnt lgkmcnt(3)
    v_mfma_f32_16x16x32_bf16 v[28:31], a[28:31], v[112:115], v[28:31]
    ds_read_b128 a[12:15], v6 offset:10240
    v_max3_f32 v192, v24, v25, v26
    v_max3_f32 v196, v32, v33, v34
    v_mfma_f32_16x16x32_bf16 v[36:39], a[28:31], v[116:119], v[36:39]
    v_max3_f32 v200, v40, v41, v42
    v_max3_f32 v204, v48, v49, v50
    v_max_f32 v192, v192, v27
    v_mfma_f32_16x16x32_bf16 v[44:47], a[28:31], v[120:123], v[44:47]
    v_max_f32 v196, v196, v35
    v_max_f32 v200, v200, v43
    v_mfma_f32_16x16x32_bf16 v[52:55], a[28:31], v[124:127], v[52:55]
    v_max_f32 v204, v204, v51
    v_mov_b32 v193, v192
    v_mov_b32 v197, v196
    s_waitcnt lgkmcnt(3)
    v_mfma_f32_16x16x32_bf16 v[28:31], a[0:3], v[128:131], v[28:31]
    s_waitcnt vmcnt(13)
    s_barrier
    ds_read_b128 a[16:19], v5 offset:12288
    v_mov_b32 v201, v200
    v_mov_b32 v205, v204
    v_mfma_f32_16x16x32_bf16 v[36:39], a[0:3], v[132:135], v[36:39]
    v_permlane16_swap_b32 v192, v193
    v_permlane16_swap_b32 v196, v197
    v_permlane16_swap_b32 v200, v201
    v_mfma_f32_16x16x32_bf16 v[44:47], a[0:3], v[136:139], v[44:47]
    v_permlane16_swap_b32 v204, v205
    v_max_f32 v192, v192, v193
    v_max_f32 v196, v196, v197
    v_mfma_f32_16x16x32_bf16 v[52:55], a[0:3], v[140:143], v[52:55]
    v_max_f32 v200, v200, v201
    v_max_f32 v204, v204, v205
    s_waitcnt lgkmcnt(3)
    v_mfma_f32_16x16x32_bf16 v[28:31], a[4:7], v[144:147], v[28:31]
    ds_read_b128 a[20:23], v6 offset:12288
    v_mov_b32 v193, v192
    v_mov_b32 v197, v196
    v_mfma_f32_16x16x32_bf16 v[36:39], a[4:7], v[148:151], v[36:39]
    v_mov_b32 v201, v200
    v_mov_b32 v205, v204
    v_permlane32_swap_b32 v192, v193
    v_mfma_f32_16x16x32_bf16 v[44:47], a[4:7], v[152:155], v[44:47]
    v_permlane32_swap_b32 v196, v197
    v_permlane32_swap_b32 v200, v201
    v_permlane32_swap_b32 v204, v205
    v_mfma_f32_16x16x32_bf16 v[52:55], a[4:7], v[156:159], v[52:55]
    v_max_f32 v192, v192, v193
    v_max_f32 v196, v196, v197
    s_waitcnt lgkmcnt(3)
    v_mfma_f32_16x16x32_bf16 v[28:31], a[8:11], v[160:163], v[28:31]
    ds_read_b128 a[24:27], v5 offset:16384
    v_max_f32 v200, v200, v201
    v_max_f32 v204, v204, v205
    v_mfma_f32_16x16x32_bf16 v[36:39], a[8:11], v[164:167], v[36:39]
    v_sub_f32 v193, 0xc2800000, v192
    v_sub_f32 v194, 0xc2800000, v192
    v_sub_f32 v195, 0xc2800000, v192
    v_mfma_f32_16x16x32_bf16 v[44:47], a[8:11], v[168:171], v[44:47]
    v_sub_f32 v192, 0xc2800000, v192
    v_sub_f32 v197, 0xc2800000, v196
    v_sub_f32 v198, 0xc2800000, v196
    v_mfma_f32_16x16x32_bf16 v[52:55], a[8:11], v[172:175], v[52:55]
    v_sub_f32 v199, 0xc2800000, v196
    v_sub_f32 v196, 0xc2800000, v196
    v_sub_f32 v201, 0xc2800000, v200
    s_waitcnt lgkmcnt(3)
    v_mfma_f32_16x16x32_bf16 v[28:31], a[12:15], v[176:179], v[28:31]
    ds_read_b128 a[28:31], v6 offset:16384
    v_sub_f32 v202, 0xc2800000, v200
    v_mfma_f32_16x16x32_bf16 v[36:39], a[12:15], v[180:183], v[36:39]
    v_sub_f32 v203, 0xc2800000, v200
    v_sub_f32 v200, 0xc2800000, v200
    v_sub_f32 v205, 0xc2800000, v204
    v_mfma_f32_16x16x32_bf16 v[44:47], a[12:15], v[184:187], v[44:47]
    v_sub_f32 v206, 0xc2800000, v204
    v_sub_f32 v207, 0xc2800000, v204
    v_sub_f32 v204, 0xc2800000, v204
    v_mfma_f32_16x16x32_bf16 v[52:55], a[12:15], v[188:191], v[52:55]
    s_waitcnt lgkmcnt(3)
    v_mfma_f32_16x16x32_bf16 v[56:59], a[16:19], v[96:99], v[192:195]
    ds_read_b128 a[0:3], v5 offset:20480
    v_add_f32 v24, v24, v192
    v_add_f32 v25, v25, v192
    v_mfma_f32_16x16x32_bf16 v[64:67], a[16:19], v[100:103], v[196:199]
    v_add_f32 v26, v26, v192
    v_add_f32 v27, v27, v192
    v_add_f32 v32, v32, v196
    v_mfma_f32_16x16x32_bf16 v[72:75], a[16:19], v[104:107], v[200:203]
    v_add_f32 v33, v33, v196
    v_add_f32 v34, v34, v196
    v_add_f32 v35, v35, v196
    v_mfma_f32_16x16x32_bf16 v[80:83], a[16:19], v[108:111], v[204:207]
    v_exp_f32 v24, v24
    s_waitcnt lgkmcnt(3)
    v_mfma_f32_16x16x32_bf16 v[56:59], a[20:23], v[112:115], v[56:59]
    ds_read_b128 a[4:7], v6 offset:20480
    s_add_u32 m0, s45, 0
    v_exp_f32 v25, v25
    v_mfma_f32_16x16x32_bf16 v[64:67], a[20:23], v[116:119], v[64:67]
    buffer_load_dwordx4 v11, s[20:23], s43 offen offset:0 nt lds
    v_mfma_f32_16x16x32_bf16 v[72:75], a[20:23], v[120:123], v[72:75]
    v_exp_f32 v26, v26
    v_cvt_pk_bf16_f32 v24, v24, v25
    v_mfma_f32_16x16x32_bf16 v[80:83], a[20:23], v[124:127], v[80:83]
    v_exp_f32 v27, v27
    v_exp_f32 v32, v32
    s_waitcnt lgkmcnt(3)
    v_mfma_f32_16x16x32_bf16 v[56:59], a[24:27], v[128:131], v[56:59]
    ds_read_b128 a[8:11], v5 offset:14336
    v_cvt_pk_bf16_f32 v25, v26, v27
    v_mfma_f32_16x16x32_bf16 v[64:67], a[24:27], v[132:135], v[64:67]
    v_exp_f32 v33, v33
    v_exp_f32 v34, v34
    v_mfma_f32_16x16x32_bf16 v[72:75], a[24:27], v[136:139], v[72:75]
    v_cvt_pk_bf16_f32 v32, v32, v33
    v_exp_f32 v35, v35
    v_mfma_f32_16x16x32_bf16 v[80:83], a[24:27], v[140:143], v[80:83]
    v_add_f32 v40, v40, v200
    v_cvt_pk_bf16_f32 v33, v34, v35
    v_add_f32 v41, v41, v200
    s_waitcnt lgkmcnt(3)
    v_mfma_f32_16x16x32_bf16 v[56:59], a[28:31], v[144:147], v[56:59]
    ds_read_b128 a[12:15], v6 offset:14336
    s_add_u32 m0, s45, 3968
    v_add_f32 v42, v42, v200
    v_add_f32 v43, v43, v200
    v_mfma_f32_16x16x32_bf16 v[64:67], a[28:31], v[148:151], v[64:67]
    buffer_load_dwordx4 v11, s[20:23], s43 offen offset:128 nt lds
    v_add_f32 v48, v48, v204
    v_mfma_f32_16x16x32_bf16 v[72:75], a[28:31], v[152:155], v[72:75]
    v_add_f32 v49, v49, v204
    v_add_f32 v50, v50, v204
    v_add_f32 v51, v51, v204
    v_mfma_f32_16x16x32_bf16 v[80:83], a[28:31], v[156:159], v[80:83]
    v_exp_f32 v40, v40
    v_exp_f32 v41, v41
    s_waitcnt lgkmcnt(3)
    v_mfma_f32_16x16x32_bf16 v[56:59], a[0:3], v[160:163], v[56:59]
    ds_read_b128 a[16:19], v5 offset:18432
    v_exp_f32 v42, v42
    v_mfma_f32_16x16x32_bf16 v[64:67], a[0:3], v[164:167], v[64:67]
    v_cvt_pk_bf16_f32 v40, v40, v41
    v_exp_f32 v43, v43
    v_mfma_f32_16x16x32_bf16 v[72:75], a[0:3], v[168:171], v[72:75]
    v_exp_f32 v48, v48
    v_cvt_pk_bf16_f32 v41, v42, v43
    v_mfma_f32_16x16x32_bf16 v[80:83], a[0:3], v[172:175], v[80:83]
    v_exp_f32 v49, v49
    s_waitcnt lgkmcnt(3)
    v_mfma_f32_16x16x32_bf16 v[56:59], a[4:7], v[176:179], v[56:59]
    ds_read_b128 a[20:23], v6 offset:18432
    s_add_u32 m0, s45, 7936
    v_exp_f32 v50, v50
    v_mfma_f32_16x16x32_bf16 v[64:67], a[4:7], v[180:183], v[64:67]
    buffer_load_dwordx4 v11, s[20:23], s43 offen offset:256 nt lds
    s_add_u32 s43, s43, 12288
    v_cvt_pk_bf16_f32 v48, v48, v49
    v_mfma_f32_16x16x32_bf16 v[72:75], a[4:7], v[184:187], v[72:75]
    v_exp_f32 v51, v51
    v_add_f32 v28, v28, v192
    v_mfma_f32_16x16x32_bf16 v[80:83], a[4:7], v[188:191], v[80:83]
    v_cvt_pk_bf16_f32 v49, v50, v51
    v_add_f32 v29, v29, v192
    v_add_f32 v30, v30, v192
    v_add_f32 v31, v31, v192
    s_waitcnt lgkmcnt(3)
    v_mfma_f32_16x16x32_bf16 v[60:63], a[8:11], v[96:99], v[192:195]
    ds_read_b128 a[24:27], v5 offset:22528
    v_accvgpr_read_b32 v228, a57
    v_add_f32 v36, v36, v196
    v_mfma_f32_16x16x32_bf16 v[68:71], a[8:11], v[100:103], v[196:199]
    v_add_f32 v37, v37, v196
    v_add_f32 v38, v38, v196
    v_add_f32 v39, v39, v196
    v_mfma_f32_16x16x32_bf16 v[76:79], a[8:11], v[104:107], v[200:203]
    v_exp_f32 v28, v28
    v_exp_f32 v29, v29
    v_mfma_f32_16x16x32_bf16 v[84:87], a[8:11], v[108:111], v[204:207]
    s_mov_b32 s3, 0
    buffer_load_dwordx4 v[208:211], v228, s[96:99], s3 offen nt
    s_waitcnt lgkmcnt(3)
    v_mfma_f32_16x16x32_bf16 v[60:63], a[12:15], v[112:115], v[60:63]
    ds_read_b128 a[28:31], v6 offset:22528
    v_exp_f32 v30, v30
    v_mfma_f32_16x16x32_bf16 v[68:71], a[12:15], v[116:119], v[68:71]
    v_cvt_pk_bf16_f32 v26, v28, v29
    v_exp_f32 v31, v31
    v_mfma_f32_16x16x32_bf16 v[76:79], a[12:15], v[120:123], v[76:79]
    v_exp_f32 v36, v36
    v_cvt_pk_bf16_f32 v27, v30, v31
    v_mfma_f32_16x16x32_bf16 v[84:87], a[12:15], v[124:127], v[84:87]
    v_exp_f32 v37, v37
    v_exp_f32 v38, v38
    s_waitcnt lgkmcnt(3)
    v_mfma_f32_16x16x32_bf16 v[60:63], a[16:19], v[128:131], v[60:63]
    ds_read_b64_tr_b16 a[0:1], v1 offset:0
    v_cvt_pk_bf16_f32 v34, v36, v37
    v_mfma_f32_16x16x32_bf16 v[68:71], a[16:19], v[132:135], v[68:71]
    s_mov_b32 s3, 245760
    buffer_load_dwordx4 v[212:215], v228, s[96:99], s3 offen nt
    v_exp_f32 v39, v39
    v_mfma_f32_16x16x32_bf16 v[76:79], a[16:19], v[136:139], v[76:79]
    ds_read_b64_tr_b16 a[2:3], v1 offset:2048
    v_add_f32 v44, v44, v200
    v_cvt_pk_bf16_f32 v35, v38, v39
    v_mfma_f32_16x16x32_bf16 v[84:87], a[16:19], v[140:143], v[84:87]
    v_add_f32 v45, v45, v200
    v_add_f32 v46, v46, v200
    v_add_f32 v47, v47, v200
    s_waitcnt lgkmcnt(4)
    v_mfma_f32_16x16x32_bf16 v[60:63], a[20:23], v[144:147], v[60:63]
    ds_read_b64_tr_b16 a[4:5], v2 offset:0
    v_add_f32 v52, v52, v204
    v_add_f32 v53, v53, v204
    v_mfma_f32_16x16x32_bf16 v[68:71], a[20:23], v[148:151], v[68:71]
    v_add_f32 v54, v54, v204
    v_add_f32 v55, v55, v204
    v_exp_f32 v44, v44
    v_mfma_f32_16x16x32_bf16 v[76:79], a[20:23], v[152:155], v[76:79]
    ds_read_b64_tr_b16 a[6:7], v2 offset:2048
    v_exp_f32 v45, v45
    v_mfma_f32_16x16x32_bf16 v[84:87], a[20:23], v[156:159], v[84:87]
    s_mov_b32 s3, 491520
    buffer_load_dwordx4 v[216:219], v228, s[96:99], s3 offen nt
    s_waitcnt lgkmcnt(5)
    v_mfma_f32_16x16x32_bf16 v[60:63], a[24:27], v[160:163], v[60:63]
    ds_read_b64_tr_b16 a[8:9], v3 offset:0
    v_exp_f32 v46, v46
    v_mfma_f32_16x16x32_bf16 v[68:71], a[24:27], v[164:167], v[68:71]
    v_cvt_pk_bf16_f32 v42, v44, v45
    v_exp_f32 v47, v47
    v_mfma_f32_16x16x32_bf16 v[76:79], a[24:27], v[168:171], v[76:79]
    ds_read_b64_tr_b16 a[10:11], v3 offset:2048
    v_exp_f32 v52, v52
    v_mfma_f32_16x16x32_bf16 v[84:87], a[24:27], v[172:175], v[84:87]
    v_cvt_pk_bf16_f32 v43, v46, v47
    v_exp_f32 v53, v53
    s_waitcnt lgkmcnt(6)
    v_mfma_f32_16x16x32_bf16 v[60:63], a[28:31], v[176:179], v[60:63]
    ds_read_b64_tr_b16 a[12:13], v4 offset:0
    v_exp_f32 v54, v54
    v_mfma_f32_16x16x32_bf16 v[68:71], a[28:31], v[180:183], v[68:71]
    s_mov_b32 s3, 737280
    buffer_load_dwordx4 v[220:223], v228, s[96:99], s3 offen nt
    v_cvt_pk_bf16_f32 v50, v52, v53
    v_exp_f32 v55, v55
    s_nop 0
    v_cvt_pk_bf16_f32 v51, v54, v55
    v_mfma_f32_16x16x32_bf16 v[76:79], a[28:31], v[184:187], v[76:79]
    ds_read_b64_tr_b16 a[14:15], v4 offset:2048
    v_mfma_f32_16x16x32_bf16 v[84:87], a[28:31], v[188:191], v[84:87]
    v_exp_f32 v56, v56
    s_waitcnt lgkmcnt(6)
    v_mfma_f32_16x16x32_bf16 a[64:67], a[0:3], v[24:27], 0
    ds_read_b64_tr_b16 a[16:17], v1 offset:4096
    v_exp_f32 v57, v57
    v_mfma_f32_16x16x32_bf16 a[72:75], a[0:3], v[32:35], 0
    v_exp_f32 v58, v58
    v_mfma_f32_16x16x32_bf16 a[80:83], a[0:3], v[40:43], 0
    ds_read_b64_tr_b16 a[18:19], v1 offset:6144
    v_cvt_pk_bf16_f32 v56, v56, v57
    v_mfma_f32_16x16x32_bf16 a[88:91], a[0:3], v[48:51], 0
    s_mov_b32 s3, 983040
    buffer_load_dwordx4 v[224:227], v228, s[96:99], s3 offen nt
    s_waitcnt lgkmcnt(6)
    v_mfma_f32_16x16x32_bf16 a[68:71], a[4:7], v[24:27], 0
    ds_read_b64_tr_b16 a[20:21], v2 offset:4096
    v_exp_f32 v59, v59
    v_mfma_f32_16x16x32_bf16 a[76:79], a[4:7], v[32:35], 0
    v_exp_f32 v64, v64
    v_mfma_f32_16x16x32_bf16 a[84:87], a[4:7], v[40:43], 0
    ds_read_b64_tr_b16 a[22:23], v2 offset:6144
    v_cvt_pk_bf16_f32 v57, v58, v59
    v_mfma_f32_16x16x32_bf16 a[92:95], a[4:7], v[48:51], 0
    v_lshlrev_b32 v23, 4, v8
    v_and_b32 v23, 0xf00, v23
    v_mfma_f32_16x16x32_bf16 a[32:35], a[48:51], v[24:27], a[32:35]
    v_exp_f32 v65, v65
    s_waitcnt lgkmcnt(6)
    v_mfma_f32_16x16x32_bf16 a[96:99], a[8:11], v[24:27], 0
    ds_read_b64_tr_b16 a[24:25], v3 offset:4096
    v_exp_f32 v66, v66
    v_mfma_f32_16x16x32_bf16 a[104:107], a[8:11], v[32:35], 0
    v_cvt_pk_bf16_f32 v64, v64, v65
    v_exp_f32 v67, v67
    v_mfma_f32_16x16x32_bf16 a[112:115], a[8:11], v[40:43], 0
    ds_read_b64_tr_b16 a[26:27], v3 offset:6144
    v_or_b32 v14, s32, v8
    v_min_u32 v14, 1, v14
    v_mfma_f32_16x16x32_bf16 a[120:123], a[8:11], v[48:51], 0
    s_waitcnt lgkmcnt(6)
    v_mfma_f32_16x16x32_bf16 a[100:103], a[12:15], v[24:27], 0
    ds_read_b64_tr_b16 a[28:29], v4 offset:4096
    v_exp_f32 v72, v72
    v_mfma_f32_16x16x32_bf16 a[108:111], a[12:15], v[32:35], 0
    v_cvt_pk_bf16_f32 v65, v66, v67
    v_exp_f32 v73, v73
    v_mfma_f32_16x16x32_bf16 a[116:119], a[12:15], v[40:43], 0
    ds_read_b64_tr_b16 a[30:31], v4 offset:6144
    v_lshlrev_b32 v14, 30, v14
    v_mov_b32 v15, 0
    v_mfma_f32_16x16x32_bf16 a[124:127], a[12:15], v[48:51], 0
    s_waitcnt lgkmcnt(6)
    v_mfma_f32_16x16x32_bf16 a[128:131], a[16:19], v[24:27], 0
    ds_read_b64_tr_b16 a[0:1], v1 offset:8192
    buffer_store_dword v15, v14, s[76:79], s0 offen offset:64 sc1
    v_mfma_f32_16x16x32_bf16 a[136:139], a[16:19], v[32:35], 0
    v_exp_f32 v74, v74
    v_mfma_f32_16x16x32_bf16 a[144:147], a[16:19], v[40:43], 0
    ds_read_b64_tr_b16 a[2:3], v1 offset:10240
    s_and_b32 s3, s2, 7
    s_bfe_u32 s38, s2, 0x20003
    s_mul_i32 s35, s3, 245760
    s_mul_i32 s36, s38, 1966080
    s_add_u32 s35, s35, s36
    s_mul_i32 s37, s32, 5120
    s_add_u32 s35, s35, s37
    s_add_u32 s35, s35, 75497472
    s_add_u32 s12, s10, s35
    s_addc_u32 s13, s11, 0
    s_mov_b32 s14, 0
    s_mov_b32 s15, 0x00020000
    s_sub_u32 s14, 245760, s37
    s_lshr_b32 s40, s2, 5
    s_lshl_b32 s40, s40, 2
    s_add_u32 s40, s40, s32
    s_mul_i32 s40, s40, 98304
    s_mul_i32 s3, s3, 3145728
    s_add_u32 s3, s3, s40
    s_add_u32 s3, s3, 4194304
    s_add_u32 s24, s10, s3
    s_addc_u32 s25, s11, 0
    s_mov_b32 s26, 98304
    s_mov_b32 s27, 0x00020000
    s_mul_i32 s36, s38, 61440
    s_mov_b32 s35, s36
    s_lshl_b32 s38, s37, 1
    s_add_u32 s38, s38, 98816
    s_add_u32 s37, s37, 98816
    v_cvt_pk_bf16_f32 v72, v72, v73
    v_mfma_f32_16x16x32_bf16 a[152:155], a[16:19], v[48:51], 0
    v_exp_f32 v75, v75
    v_mfma_f32_16x16x32_bf16 a[36:39], a[48:51], v[32:35], a[36:39]
    v_mov_b32 v15, 1
    v_exp_f32 v80, v80
    s_waitcnt lgkmcnt(6)
    v_mfma_f32_16x16x32_bf16 a[132:135], a[20:23], v[24:27], 0
    ds_read_b64_tr_b16 a[4:5], v2 offset:8192
    v_cvt_pk_bf16_f32 v73, v74, v75
    v_mfma_f32_16x16x32_bf16 a[140:143], a[20:23], v[32:35], 0
    s_lshr_b32 s3, s2, 5
    s_lshl_b32 s3, s3, 3
    s_and_b32 s46, s2, 7
    s_add_u32 s3, s3, s46
    s_lshl_b32 s3, s3, 2
    s_bfe_u32 s46, s2, 0x20003
    s_add_u32 s3, s3, s46
    s_lshl_b32 s3, s3, 2
    s_add_u32 s3, s3, s32
    s_mulk_i32 s3, 2560
    v_lshlrev_b32 v254, 3, v8
    v_min_u32 v254, 2432, v254
    v_mfma_f32_16x16x32_bf16 a[148:151], a[20:23], v[40:43], 0
    ds_read_b64_tr_b16 a[6:7], v2 offset:10240
    v_exp_f32 v81, v81
    v_mfma_f32_16x16x32_bf16 a[156:159], a[20:23], v[48:51], 0
    v_add_u32 v254, s3, v254
    global_load_dword v255, v254, s[100:101]
    s_waitcnt lgkmcnt(6)
    v_mfma_f32_16x16x32_bf16 a[160:163], a[24:27], v[24:27], 0
    ds_read_b64_tr_b16 a[8:9], v3 offset:8192
    v_mfma_f32_16x16x32_bf16 a[168:171], a[24:27], v[32:35], 0
    v_exp_f32 v82, v82
    v_mfma_f32_16x16x32_bf16 a[176:179], a[24:27], v[40:43], 0
    ds_read_b64_tr_b16 a[10:11], v3 offset:10240
    v_cvt_pk_bf16_f32 v80, v80, v81
    v_mfma_f32_16x16x32_bf16 a[184:187], a[24:27], v[48:51], 0
    v_exp_f32 v83, v83
    s_waitcnt lgkmcnt(6)
    v_mfma_f32_16x16x32_bf16 a[164:167], a[28:31], v[24:27], 0
    ds_read_b64_tr_b16 a[12:13], v4 offset:8192
    v_exp_f32 v60, v60
    v_mfma_f32_16x16x32_bf16 a[172:175], a[28:31], v[32:35], 0
    v_cvt_pk_bf16_f32 v81, v82, v83
    v_exp_f32 v61, v61
    v_mfma_f32_16x16x32_bf16 a[180:183], a[28:31], v[40:43], 0
    ds_read_b64_tr_b16 a[14:15], v4 offset:10240
    v_mfma_f32_16x16x32_bf16 a[188:191], a[28:31], v[48:51], 0
    v_exp_f32 v62, v62
    v_cvt_pk_bf16_f32 v58, v60, v61
    v_mfma_f32_16x16x32_bf16 a[40:43], a[48:51], v[40:43], a[40:43]
    v_exp_f32 v63, v63
K2_aloop:
    s_waitcnt lgkmcnt(6)
    v_mfma_f32_16x16x32_bf16 a[192:195], a[0:3], v[24:27], a[192:195]
    s_waitcnt vmcnt(11)
    s_barrier
    v_add_u32 v5, s53, v5
    v_add_u32 v6, s53, v6
    ds_read_b128 a[16:19], v5 offset:0
    v_mfma_f32_16x16x32_bf16 a[200:203], a[0:3], v[32:35], a[200:203]
    v_mfma_f32_16x16x32_bf16 a[208:211], a[0:3], v[40:43], a[208:211]
    s_add_u32 m0, s44, 0
    v_exp_f32 v68, v68
    v_mfma_f32_16x16x32_bf16 a[216:219], a[0:3], v[48:51], a[216:219]
    buffer_load_dwordx4 v10, s[16:19], s42 offen offset:0 nt lds
    s_waitcnt lgkmcnt(5)
    v_mfma_f32_16x16x32_bf16 a[196:199], a[4:7], v[24:27], a[196:199]
    ds_read_b128 a[20:23], v6 offset:0
    v_mfma_f32_16x16x32_bf16 a[204:207], a[4:7], v[32:35], a[204:207]
    v_cvt_pk_bf16_f32 v59, v62, v63
    v_mfma_f32_16x16x32_bf16 a[212:215], a[4:7], v[40:43], a[212:215]
    v_exp_f32 v69, v69
    v_mfma_f32_16x16x32_bf16 a[220:223], a[4:7], v[48:51], a[220:223]
    s_waitcnt lgkmcnt(4)
    v_mfma_f32_16x16x32_bf16 a[224:227], a[8:11], v[24:27], a[224:227]
    ds_read_b128 a[24:27], v5 offset:4096
    v_mfma_f32_16x16x32_bf16 a[232:235], a[8:11], v[32:35], a[232:235]
    s_add_u32 m0, s44, 3968
    v_exp_f32 v70, v70
    v_mfma_f32_16x16x32_bf16 a[240:243], a[8:11], v[40:43], a[240:243]
    buffer_load_dwordx4 v10, s[16:19], s42 offen offset:128 nt lds
    v_mfma_f32_16x16x32_bf16 a[248:251], a[8:11], v[48:51], a[248:251]
    v_cvt_pk_bf16_f32 v66, v68, v69
    v_mfma_f32_16x16x32_bf16 a[44:47], a[48:51], v[48:51], a[44:47]
    v_exp_f32 v71, v71
    s_waitcnt lgkmcnt(3)
    v_mfma_f32_16x16x32_bf16 a[228:231], a[12:15], v[24:27], a[228:231]
    ds_read_b128 a[28:31], v6 offset:4096
    v_mfma_f32_16x16x32_bf16 a[236:239], a[12:15], v[32:35], a[236:239]
    v_exp_f32 v76, v76
    v_mfma_f32_16x16x32_bf16 a[244:247], a[12:15], v[40:43], a[244:247]
    s_add_u32 m0, s44, 7936
    v_cvt_pk_bf16_f32 v67, v70, v71
    v_mfma_f32_16x16x32_bf16 a[252:255], a[12:15], v[48:51], a[252:255]
    buffer_load_dwordx4 v10, s[16:19], s42 offen offset:256 nt lds
    s_add_u32 s42, s42, 12288
    s_waitcnt lgkmcnt(3)
    v_mfma_f32_16x16x32_bf16 v[24:27], a[16:19], v[96:99], v[192:195]
    ds_read_b128 a[0:3], v5 offset:8192
    v_mfma_f32_16x16x32_bf16 v[32:35], a[16:19], v[100:103], v[196:199]
    s_waitcnt vmcnt(10)
    ds_read_b64_tr_b16 v[88:89], v7 offset:0
    v_mfma_f32_16x16x32_bf16 v[40:43], a[16:19], v[104:107], v[200:203]
    v_exp_f32 v77, v77
    v_mfma_f32_16x16x32_bf16 v[48:51], a[16:19], v[108:111], v[204:207]
    ds_read_b64_tr_b16 v[90:91], v7 offset:1024
    s_waitcnt lgkmcnt(5)
    v_mfma_f32_16x16x32_bf16 v[24:27], a[20:23], v[112:115], v[24:27]
    ds_read_b128 a[4:7], v6 offset:8192
    s_add_u32 m0, s45, 12288
    v_mfma_f32_16x16x32_bf16 v[32:35], a[20:23], v[116:119], v[32:35]
    buffer_load_dwordx4 v11, s[20:23], s43 offen offset:0 nt lds
    ds_read_b64_tr_b16 v[92:93], v7 offset:32
    v_mfma_f32_16x16x32_bf16 v[40:43], a[20:23], v[120:123], v[40:43]
    v_mfma_f32_16x16x32_bf16 v[48:51], a[20:23], v[124:127], v[48:51]
    ds_read_b64_tr_b16 v[94:95], v7 offset:1056
    s_waitcnt lgkmcnt(7)
    v_mfma_f32_16x16x32_bf16 v[24:27], a[24:27], v[128:131], v[24:27]
    ds_read_b128 a[8:11], v5 offset:2048
    v_mfma_f32_16x16x32_bf16 v[32:35], a[24:27], v[132:135], v[32:35]
    v_exp_f32 v78, v78
    v_mfma_f32_16x16x32_bf16 v[40:43], a[24:27], v[136:139], v[40:43]
    v_cvt_pk_bf16_f32 v74, v76, v77
    v_mfma_f32_16x16x32_bf16 v[48:51], a[24:27], v[140:143], v[48:51]
    v_exp_f32 v79, v79
    s_waitcnt lgkmcnt(7)
    v_mfma_f32_16x16x32_bf16 v[24:27], a[28:31], v[144:147], v[24:27]
    ds_read_b128 a[12:15], v6 offset:2048
    s_add_u32 m0, s45, 16256
    v_mfma_f32_16x16x32_bf16 v[32:35], a[28:31], v[148:151], v[32:35]
    buffer_load_dwordx4 v11, s[20:23], s43 offen offset:128 nt lds
    v_mfma_f32_16x16x32_bf16 v[40:43], a[28:31], v[152:155], v[40:43]
    v_exp_f32 v84, v84
    v_mfma_f32_16x16x32_bf16 v[48:51], a[28:31], v[156:159], v[48:51]
    v_cvt_pk_bf16_f32 v75, v78, v79
    s_waitcnt lgkmcnt(7)
    v_mfma_f32_16x16x32_bf16 v[24:27], a[0:3], v[160:163], v[24:27]
    ds_read_b128 a[16:19], v5 offset:6144
    v_mfma_f32_16x16x32_bf16 v[32:35], a[0:3], v[164:167], v[32:35]
    v_exp_f32 v85, v85
    v_mfma_f32_16x16x32_bf16 v[40:43], a[0:3], v[168:171], v[40:43]
    v_mfma_f32_16x16x32_bf16 v[48:51], a[0:3], v[172:175], v[48:51]
    v_exp_f32 v86, v86
    s_waitcnt lgkmcnt(5)
    v_mfma_f32_16x16x32_bf16 v[24:27], a[4:7], v[176:179], v[24:27]
    ds_read_b128 a[20:23], v6 offset:6144
    s_add_u32 m0, s45, 20224
    v_cvt_pk_bf16_f32 v82, v84, v85
    v_mfma_f32_16x16x32_bf16 v[32:35], a[4:7], v[180:183], v[32:35]
    buffer_load_dwordx4 v11, s[20:23], s43 offen offset:256 nt lds
    s_add_u32 s43, s43, 12288
    s_lshl_b32 s3, s32, 11
    s_add_u32 s3, s3, 123392
    s_sub_u32 s45, s3, s45
    v_mfma_f32_16x16x32_bf16 v[40:43], a[4:7], v[184:187], v[40:43]
    v_mfma_f32_16x16x32_bf16 v[48:51], a[4:7], v[188:191], v[48:51]
    v_exp_f32 v87, v87
    s_nop 0
    s_waitcnt lgkmcnt(3)
    v_mfma_f32_16x16x32_bf16 v[28:31], a[8:11], v[96:99], v[192:195]
    ds_read_b128 a[24:27], v5 offset:10240
    v_mfma_f32_16x16x32_bf16 v[36:39], a[8:11], v[100:103], v[196:199]
    buffer_store_dwordx4 v[88:91], v8, s[88:91], s58 offen sc1
    v_mfma_f32_16x16x32_bf16 v[44:47], a[8:11], v[104:107], v[200:203]
    v_cvt_pk_bf16_f32 v83, v86, v87
    v_mfma_f32_16x16x32_bf16 v[52:55], a[8:11], v[108:111], v[204:207]
    v_exp_f32 v24, v24
    s_waitcnt lgkmcnt(3)
    v_mfma_f32_16x16x32_bf16 v[28:31], a[12:15], v[112:115], v[28:31]
    ds_read_b128 a[28:31], v6 offset:10240
    v_mfma_f32_16x16x32_bf16 v[36:39], a[12:15], v[116:119], v[36:39]
    buffer_store_dwordx4 v[92:95], v8, s[92:95], s58 offen sc1
    s_add_u32 s58, s58, s55
    s_cmp_ge_u32 s41, 3
    s_waitcnt vmcnt(10)
    s_cbranch_scc1 K2_sw
K2_swr:
    v_mfma_f32_16x16x32_bf16 v[44:47], a[12:15], v[120:123], v[44:47]
    v_mfma_f32_16x16x32_bf16 v[52:55], a[12:15], v[124:127], v[52:55]
    v_exp_f32 v25, v25
    s_waitcnt lgkmcnt(3)
    v_mfma_f32_16x16x32_bf16 v[28:31], a[16:19], v[128:131], v[28:31]
    ds_read_b64_tr_b16 a[0:1], v1 offset:12288
    s_mov_b32 m0, s59
    v_mfma_f32_16x16x32_bf16 v[36:39], a[16:19], v[132:135], v[36:39]
    buffer_load_dwordx4 v0, s[84:87], s57 offen nt lds
    s_add_u32 s60, s57, s56
    s_add_u32 s57, s57, s54
    v_mfma_f32_16x16x32_bf16 v[44:47], a[16:19], v[136:139], v[44:47]
    ds_read_b64_tr_b16 a[2:3], v1 offset:14336
    v_mfma_f32_16x16x32_bf16 v[52:55], a[16:19], v[140:143], v[52:55]
    v_exp_f32 v26, v26
    s_waitcnt lgkmcnt(4)
    v_mfma_f32_16x16x32_bf16 v[28:31], a[20:23], v[144:147], v[28:31]
    ds_read_b64_tr_b16 a[4:5], v2 offset:12288
    s_add_u32 m0, s59, 1024
    v_mfma_f32_16x16x32_bf16 v[36:39], a[20:23], v[148:151], v[36:39]
    buffer_load_dwordx4 v0, s[84:87], s60 offen nt lds
    v_mfma_f32_16x16x32_bf16 v[44:47], a[20:23], v[152:155], v[44:47]
    ds_read_b64_tr_b16 a[6:7], v2 offset:14336
    v_mfma_f32_16x16x32_bf16 v[52:55], a[20:23], v[156:159], v[52:55]
    v_cvt_pk_bf16_f32 v24, v24, v25
    s_waitcnt lgkmcnt(5)
    v_mfma_f32_16x16x32_bf16 v[28:31], a[24:27], v[160:163], v[28:31]
    ds_read_b64_tr_b16 a[8:9], v3 offset:12288
    v_mfma_f32_16x16x32_bf16 v[36:39], a[24:27], v[164:167], v[36:39]
    v_exp_f32 v27, v27
    v_mfma_f32_16x16x32_bf16 v[44:47], a[24:27], v[168:171], v[44:47]
    ds_read_b64_tr_b16 a[10:11], v3 offset:14336
    v_mfma_f32_16x16x32_bf16 v[52:55], a[24:27], v[172:175], v[52:55]
    v_exp_f32 v32, v32
    s_waitcnt lgkmcnt(6)
    v_mfma_f32_16x16x32_bf16 v[28:31], a[28:31], v[176:179], v[28:31]
    ds_read_b64_tr_b16 a[12:13], v4 offset:12288
    v_mfma_f32_16x16x32_bf16 v[36:39], a[28:31], v[180:183], v[36:39]
    v_cvt_pk_bf16_f32 v25, v26, v27
    v_mfma_f32_16x16x32_bf16 v[44:47], a[28:31], v[184:187], v[44:47]
    ds_read_b64_tr_b16 a[14:15], v4 offset:14336
    v_mfma_f32_16x16x32_bf16 v[52:55], a[28:31], v[188:191], v[52:55]
    v_exp_f32 v33, v33
    s_waitcnt lgkmcnt(6)
    v_mfma_f32_16x16x32_bf16 a[64:67], a[0:3], v[56:59], a[64:67]
    ds_read_b64_tr_b16 a[16:17], v1 offset:16384
    v_mfma_f32_16x16x32_bf16 a[72:75], a[0:3], v[64:67], a[72:75]
    v_exp_f32 v34, v34
    v_mfma_f32_16x16x32_bf16 a[80:83], a[0:3], v[72:75], a[80:83]
    ds_read_b64_tr_b16 a[18:19], v1 offset:18432
    v_mfma_f32_16x16x32_bf16 a[88:91], a[0:3], v[80:83], a[88:91]
    v_cvt_pk_bf16_f32 v32, v32, v33
    s_waitcnt lgkmcnt(6)
    v_mfma_f32_16x16x32_bf16 a[68:71], a[4:7], v[56:59], a[68:71]
    ds_read_b64_tr_b16 a[20:21], v2 offset:16384
    v_mfma_f32_16x16x32_bf16 a[76:79], a[4:7], v[64:67], a[76:79]
    v_exp_f32 v35, v35
    v_mfma_f32_16x16x32_bf16 a[84:87], a[4:7], v[72:75], a[84:87]
    ds_read_b64_tr_b16 a[22:23], v2 offset:18432
    v_mfma_f32_16x16x32_bf16 a[92:95], a[4:7], v[80:83], a[92:95]
    v_exp_f32 v40, v40
    v_mfma_f32_16x16x32_bf16 a[32:35], a[48:51], v[56:59], a[32:35]
    v_cvt_pk_bf16_f32 v33, v34, v35
    s_waitcnt lgkmcnt(6)
    v_mfma_f32_16x16x32_bf16 a[96:99], a[8:11], v[56:59], a[96:99]
    ds_read_b64_tr_b16 a[24:25], v3 offset:16384
    v_mfma_f32_16x16x32_bf16 a[104:107], a[8:11], v[64:67], a[104:107]
    v_exp_f32 v41, v41
    v_mfma_f32_16x16x32_bf16 a[112:115], a[8:11], v[72:75], a[112:115]
    ds_read_b64_tr_b16 a[26:27], v3 offset:18432
    v_mfma_f32_16x16x32_bf16 a[120:123], a[8:11], v[80:83], a[120:123]
    v_exp_f32 v42, v42
    s_waitcnt lgkmcnt(6)
    v_mfma_f32_16x16x32_bf16 a[100:103], a[12:15], v[56:59], a[100:103]
    ds_read_b64_tr_b16 a[28:29], v4 offset:16384
    v_mfma_f32_16x16x32_bf16 a[108:111], a[12:15], v[64:67], a[108:111]
    v_cvt_pk_bf16_f32 v40, v40, v41
    v_mfma_f32_16x16x32_bf16 a[116:119], a[12:15], v[72:75], a[116:119]
    ds_read_b64_tr_b16 a[30:31], v4 offset:18432
    v_mfma_f32_16x16x32_bf16 a[124:127], a[12:15], v[80:83], a[124:127]
    v_exp_f32 v43, v43
    s_waitcnt lgkmcnt(6)
    v_mfma_f32_16x16x32_bf16 a[128:131], a[16:19], v[56:59], a[128:131]
    ds_read_b64_tr_b16 a[0:1], v1 offset:20480
    v_mfma_f32_16x16x32_bf16 a[136:139], a[16:19], v[64:67], a[136:139]
    v_exp_f32 v48, v48
    v_mfma_f32_16x16x32_bf16 a[144:147], a[16:19], v[72:75], a[144:147]
    ds_read_b64_tr_b16 a[2:3], v1 offset:22528
    v_mfma_f32_16x16x32_bf16 a[152:155], a[16:19], v[80:83], a[152:155]
    v_cvt_pk_bf16_f32 v41, v42, v43
    v_mfma_f32_16x16x32_bf16 a[36:39], a[48:51], v[64:67], a[36:39]
    v_exp_f32 v49, v49
    s_waitcnt lgkmcnt(6)
    v_mfma_f32_16x16x32_bf16 a[132:135], a[20:23], v[56:59], a[132:135]
    ds_read_b64_tr_b16 a[4:5], v2 offset:20480
    v_mfma_f32_16x16x32_bf16 a[140:143], a[20:23], v[64:67], a[140:143]
    v_exp_f32 v50, v50
    v_mfma_f32_16x16x32_bf16 a[148:151], a[20:23], v[72:75], a[148:151]
    ds_read_b64_tr_b16 a[6:7], v2 offset:22528
    v_mfma_f32_16x16x32_bf16 a[156:159], a[20:23], v[80:83], a[156:159]
    v_cvt_pk_bf16_f32 v48, v48, v49
    s_waitcnt lgkmcnt(6)
    v_mfma_f32_16x16x32_bf16 a[160:163], a[24:27], v[56:59], a[160:163]
    ds_read_b64_tr_b16 a[8:9], v3 offset:20480
    v_mfma_f32_16x16x32_bf16 a[168:171], a[24:27], v[64:67], a[168:171]
    v_exp_f32 v51, v51
    v_mfma_f32_16x16x32_bf16 a[176:179], a[24:27], v[72:75], a[176:179]
    ds_read_b64_tr_b16 a[10:11], v3 offset:22528
    v_mfma_f32_16x16x32_bf16 a[184:187], a[24:27], v[80:83], a[184:187]
    v_exp_f32 v28, v28
    s_waitcnt lgkmcnt(6)
    v_mfma_f32_16x16x32_bf16 a[164:167], a[28:31], v[56:59], a[164:167]
    ds_read_b64_tr_b16 a[12:13], v4 offset:20480
    v_mfma_f32_16x16x32_bf16 a[172:175], a[28:31], v[64:67], a[172:175]
    v_cvt_pk_bf16_f32 v49, v50, v51
    v_mfma_f32_16x16x32_bf16 a[180:183], a[28:31], v[72:75], a[180:183]
    ds_read_b64_tr_b16 a[14:15], v4 offset:22528
    v_mfma_f32_16x16x32_bf16 a[188:191], a[28:31], v[80:83], a[188:191]
    v_exp_f32 v29, v29
    v_mfma_f32_16x16x32_bf16 a[40:43], a[48:51], v[72:75], a[40:43]
    v_exp_f32 v30, v30
    s_waitcnt lgkmcnt(6)
    v_mfma_f32_16x16x32_bf16 a[192:195], a[0:3], v[56:59], a[192:195]
    s_waitcnt vmcnt(10)
    s_barrier
    ds_read_b128 a[16:19], v5 offset:12288
    v_mfma_f32_16x16x32_bf16 a[200:203], a[0:3], v[64:67], a[200:203]
    v_cvt_pk_bf16_f32 v26, v28, v29
    v_mfma_f32_16x16x32_bf16 a[208:211], a[0:3], v[72:75], a[208:211]
    s_add_u32 m0, s44, 12288
    v_exp_f32 v31, v31
    v_mfma_f32_16x16x32_bf16 a[216:219], a[0:3], v[80:83], a[216:219]
    buffer_load_dwordx4 v10, s[16:19], s42 offen offset:0 nt lds
    s_waitcnt lgkmcnt(5)
    v_mfma_f32_16x16x32_bf16 a[196:199], a[4:7], v[56:59], a[196:199]
    ds_read_b128 a[20:23], v6 offset:12288
    v_mfma_f32_16x16x32_bf16 a[204:207], a[4:7], v[64:67], a[204:207]
    v_mfma_f32_16x16x32_bf16 a[212:215], a[4:7], v[72:75], a[212:215]
    v_exp_f32 v36, v36
    v_mfma_f32_16x16x32_bf16 a[220:223], a[4:7], v[80:83], a[220:223]
    v_cvt_pk_bf16_f32 v27, v30, v31
    s_waitcnt lgkmcnt(4)
    v_mfma_f32_16x16x32_bf16 a[224:227], a[8:11], v[56:59], a[224:227]
    ds_read_b128 a[24:27], v5 offset:16384
    v_mfma_f32_16x16x32_bf16 a[232:235], a[8:11], v[64:67], a[232:235]
    s_add_u32 m0, s44, 16256
    v_exp_f32 v37, v37
    v_mfma_f32_16x16x32_bf16 a[240:243], a[8:11], v[72:75], a[240:243]
    buffer_load_dwordx4 v10, s[16:19], s42 offen offset:128 nt lds
    v_mfma_f32_16x16x32_bf16 a[248:251], a[8:11], v[80:83], a[248:251]
    v_mfma_f32_16x16x32_bf16 a[44:47], a[48:51], v[80:83], a[44:47]
    v_exp_f32 v38, v38
    s_waitcnt lgkmcnt(3)
    v_mfma_f32_16x16x32_bf16 a[228:231], a[12:15], v[56:59], a[228:231]
    ds_read_b128 a[28:31], v6 offset:16384
    v_mfma_f32_16x16x32_bf16 a[236:239], a[12:15], v[64:67], a[236:239]
    v_cvt_pk_bf16_f32 v34, v36, v37
    v_mfma_f32_16x16x32_bf16 a[244:247], a[12:15], v[72:75], a[244:247]
    s_add_u32 m0, s44, 20224
    v_exp_f32 v39, v39
    v_mfma_f32_16x16x32_bf16 a[252:255], a[12:15], v[80:83], a[252:255]
    buffer_load_dwordx4 v10, s[16:19], s42 offen offset:256 nt lds
    s_add_u32 s42, s42, 12288
    s_lshl_b32 s3, s32, 11
    s_add_u32 s3, s3, 222208
    s_sub_u32 s44, s3, s44
    s_waitcnt lgkmcnt(3)
    v_mfma_f32_16x16x32_bf16 v[56:59], a[16:19], v[96:99], v[192:195]
    ds_read_b128 a[0:3], v5 offset:20480
    v_mfma_f32_16x16x32_bf16 v[64:67], a[16:19], v[100:103], v[196:199]
    s_cmp_eq_u32 s41, 2
    s_cselect_b32 s61, s75, 0x40000000
    buffer_atomic_add v15, v14, s[76:79], s61 offen sc1
    v_mfma_f32_16x16x32_bf16 v[72:75], a[16:19], v[104:107], v[200:203]
    v_mfma_f32_16x16x32_bf16 v[80:83], a[16:19], v[108:111], v[204:207]
    v_exp_f32 v44, v44
    s_waitcnt lgkmcnt(3)
    v_mfma_f32_16x16x32_bf16 v[56:59], a[20:23], v[112:115], v[56:59]
    ds_read_b128 a[4:7], v6 offset:20480
    s_add_u32 m0, s45, 0
    v_mfma_f32_16x16x32_bf16 v[64:67], a[20:23], v[116:119], v[64:67]
    buffer_load_dwordx4 v11, s[20:23], s43 offen offset:0 nt lds
    v_mfma_f32_16x16x32_bf16 v[72:75], a[20:23], v[120:123], v[72:75]
    v_cvt_pk_bf16_f32 v35, v38, v39
    v_mfma_f32_16x16x32_bf16 v[80:83], a[20:23], v[124:127], v[80:83]
    v_exp_f32 v45, v45
    s_waitcnt lgkmcnt(3)
    v_mfma_f32_16x16x32_bf16 v[56:59], a[24:27], v[128:131], v[56:59]
    ds_read_b128 a[8:11], v5 offset:14336
    v_mfma_f32_16x16x32_bf16 v[64:67], a[24:27], v[132:135], v[64:67]
    v_mfma_f32_16x16x32_bf16 v[72:75], a[24:27], v[136:139], v[72:75]
    v_exp_f32 v46, v46
    v_mfma_f32_16x16x32_bf16 v[80:83], a[24:27], v[140:143], v[80:83]
    v_cvt_pk_bf16_f32 v42, v44, v45
    s_waitcnt lgkmcnt(3)
    v_mfma_f32_16x16x32_bf16 v[56:59], a[28:31], v[144:147], v[56:59]
    ds_read_b128 a[12:15], v6 offset:14336
    s_add_u32 m0, s45, 3968
    v_mfma_f32_16x16x32_bf16 v[64:67], a[28:31], v[148:151], v[64:67]
    buffer_load_dwordx4 v11, s[20:23], s43 offen offset:128 nt lds
    v_mfma_f32_16x16x32_bf16 v[72:75], a[28:31], v[152:155], v[72:75]
    v_exp_f32 v47, v47
    v_mfma_f32_16x16x32_bf16 v[80:83], a[28:31], v[156:159], v[80:83]
    v_exp_f32 v52, v52
    s_waitcnt lgkmcnt(3)
    v_mfma_f32_16x16x32_bf16 v[56:59], a[0:3], v[160:163], v[56:59]
    ds_read_b128 a[16:19], v5 offset:18432
    v_mfma_f32_16x16x32_bf16 v[64:67], a[0:3], v[164:167], v[64:67]
    v_cvt_pk_bf16_f32 v43, v46, v47
    v_mfma_f32_16x16x32_bf16 v[72:75], a[0:3], v[168:171], v[72:75]
    v_exp_f32 v53, v53
    v_mfma_f32_16x16x32_bf16 v[80:83], a[0:3], v[172:175], v[80:83]
    s_waitcnt lgkmcnt(3)
    v_mfma_f32_16x16x32_bf16 v[56:59], a[4:7], v[176:179], v[56:59]
    ds_read_b128 a[20:23], v6 offset:18432
    s_add_u32 m0, s45, 7936
    v_mfma_f32_16x16x32_bf16 v[64:67], a[4:7], v[180:183], v[64:67]
    buffer_load_dwordx4 v11, s[20:23], s43 offen offset:256 nt lds
    s_add_u32 s43, s43, 12288
    v_mfma_f32_16x16x32_bf16 v[72:75], a[4:7], v[184:187], v[72:75]
    v_exp_f32 v54, v54
    v_mfma_f32_16x16x32_bf16 v[80:83], a[4:7], v[188:191], v[80:83]
    v_cvt_pk_bf16_f32 v50, v52, v53
    s_waitcnt lgkmcnt(3)
    v_mfma_f32_16x16x32_bf16 v[60:63], a[8:11], v[96:99], v[192:195]
    ds_read_b128 a[24:27], v5 offset:22528
    v_mfma_f32_16x16x32_bf16 v[68:71], a[8:11], v[100:103], v[196:199]
    v_exp_f32 v55, v55
    s_nop 0
    v_mfma_f32_16x16x32_bf16 v[76:79], a[8:11], v[104:107], v[200:203]
    v_cvt_pk_bf16_f32 v51, v54, v55
    v_mfma_f32_16x16x32_bf16 v[84:87], a[8:11], v[108:111], v[204:207]
    v_exp_f32 v56, v56
    s_waitcnt lgkmcnt(3)
    v_mfma_f32_16x16x32_bf16 v[60:63], a[12:15], v[112:115], v[60:63]
    ds_read_b128 a[28:31], v6 offset:22528
    v_mfma_f32_16x16x32_bf16 v[68:71], a[12:15], v[116:119], v[68:71]
    v_exp_f32 v57, v57
    v_mfma_f32_16x16x32_bf16 v[76:79], a[12:15], v[120:123], v[76:79]
    v_mfma_f32_16x16x32_bf16 v[84:87], a[12:15], v[124:127], v[84:87]
    v_exp_f32 v58, v58
    s_waitcnt lgkmcnt(3)
    v_mfma_f32_16x16x32_bf16 v[60:63], a[16:19], v[128:131], v[60:63]
    v_add_u32 v1, s53, v1
    v_add_u32 v2, s53, v2
    v_add_u32 v3, s53, v3
    v_add_u32 v4, s53, v4
    s_sub_u32 s53, 0, s53
    ds_read_b64_tr_b16 a[0:1], v1 offset:0
    v_mfma_f32_16x16x32_bf16 v[68:71], a[16:19], v[132:135], v[68:71]
    v_mfma_f32_16x16x32_bf16 v[76:79], a[16:19], v[136:139], v[76:79]
    ds_read_b64_tr_b16 a[2:3], v1 offset:2048
    v_mfma_f32_16x16x32_bf16 v[84:87], a[16:19], v[140:143], v[84:87]
    s_waitcnt lgkmcnt(4)
    v_mfma_f32_16x16x32_bf16 v[60:63], a[20:23], v[144:147], v[60:63]
    ds_read_b64_tr_b16 a[4:5], v2 offset:0
    v_mfma_f32_16x16x32_bf16 v[68:71], a[20:23], v[148:151], v[68:71]
    v_cvt_pk_bf16_f32 v56, v56, v57
    v_mfma_f32_16x16x32_bf16 v[76:79], a[20:23], v[152:155], v[76:79]
    ds_read_b64_tr_b16 a[6:7], v2 offset:2048
    v_mfma_f32_16x16x32_bf16 v[84:87], a[20:23], v[156:159], v[84:87]
    v_exp_f32 v59, v59
    s_waitcnt lgkmcnt(5)
    v_mfma_f32_16x16x32_bf16 v[60:63], a[24:27], v[160:163], v[60:63]
    ds_read_b64_tr_b16 a[8:9], v3 offset:0
    v_mfma_f32_16x16x32_bf16 v[68:71], a[24:27], v[164:167], v[68:71]
    v_exp_f32 v64, v64
    v_mfma_f32_16x16x32_bf16 v[76:79], a[24:27], v[168:171], v[76:79]
    ds_read_b64_tr_b16 a[10:11], v3 offset:2048
    v_mfma_f32_16x16x32_bf16 v[84:87], a[24:27], v[172:175], v[84:87]
    v_cvt_pk_bf16_f32 v57, v58, v59
    s_waitcnt lgkmcnt(6)
    v_mfma_f32_16x16x32_bf16 v[60:63], a[28:31], v[176:179], v[60:63]
    ds_read_b64_tr_b16 a[12:13], v4 offset:0
    v_mfma_f32_16x16x32_bf16 v[68:71], a[28:31], v[180:183], v[68:71]
    v_exp_f32 v65, v65
    v_mfma_f32_16x16x32_bf16 v[76:79], a[28:31], v[184:187], v[76:79]
    ds_read_b64_tr_b16 a[14:15], v4 offset:2048
    v_mfma_f32_16x16x32_bf16 v[84:87], a[28:31], v[188:191], v[84:87]
    v_exp_f32 v66, v66
    s_waitcnt lgkmcnt(6)
    v_mfma_f32_16x16x32_bf16 a[64:67], a[0:3], v[24:27], a[64:67]
    ds_read_b64_tr_b16 a[16:17], v1 offset:4096
    v_cvt_pk_bf16_f32 v64, v64, v65
    v_mfma_f32_16x16x32_bf16 a[72:75], a[0:3], v[32:35], a[72:75]
    v_exp_f32 v67, v67
    v_mfma_f32_16x16x32_bf16 a[80:83], a[0:3], v[40:43], a[80:83]
    ds_read_b64_tr_b16 a[18:19], v1 offset:6144
    v_mfma_f32_16x16x32_bf16 a[88:91], a[0:3], v[48:51], a[88:91]
    v_exp_f32 v72, v72
    s_waitcnt lgkmcnt(6)
    v_mfma_f32_16x16x32_bf16 a[68:71], a[4:7], v[24:27], a[68:71]
    ds_read_b64_tr_b16 a[20:21], v2 offset:4096
    v_mfma_f32_16x16x32_bf16 a[76:79], a[4:7], v[32:35], a[76:79]
    v_cvt_pk_bf16_f32 v65, v66, v67
    v_mfma_f32_16x16x32_bf16 a[84:87], a[4:7], v[40:43], a[84:87]
    ds_read_b64_tr_b16 a[22:23], v2 offset:6144
    v_mfma_f32_16x16x32_bf16 a[92:95], a[4:7], v[48:51], a[92:95]
    v_exp_f32 v73, v73
    v_mfma_f32_16x16x32_bf16 a[32:35], a[48:51], v[24:27], a[32:35]
    v_exp_f32 v74, v74
    s_waitcnt lgkmcnt(6)
    v_mfma_f32_16x16x32_bf16 a[96:99], a[8:11], v[24:27], a[96:99]
    ds_read_b64_tr_b16 a[24:25], v3 offset:4096
    v_mfma_f32_16x16x32_bf16 a[104:107], a[8:11], v[32:35], a[104:107]
    v_cvt_pk_bf16_f32 v72, v72, v73
    v_mfma_f32_16x16x32_bf16 a[112:115], a[8:11], v[40:43], a[112:115]
    ds_read_b64_tr_b16 a[26:27], v3 offset:6144
    v_mfma_f32_16x16x32_bf16 a[120:123], a[8:11], v[48:51], a[120:123]
    v_exp_f32 v75, v75
    s_waitcnt lgkmcnt(6)
    v_mfma_f32_16x16x32_bf16 a[100:103], a[12:15], v[24:27], a[100:103]
    ds_read_b64_tr_b16 a[28:29], v4 offset:4096
    v_mfma_f32_16x16x32_bf16 a[108:111], a[12:15], v[32:35], a[108:111]
    v_exp_f32 v80, v80
    v_mfma_f32_16x16x32_bf16 a[116:119], a[12:15], v[40:43], a[116:119]
    ds_read_b64_tr_b16 a[30:31], v4 offset:6144
    v_mfma_f32_16x16x32_bf16 a[124:127], a[12:15], v[48:51], a[124:127]
    v_cvt_pk_bf16_f32 v73, v74, v75
    s_waitcnt lgkmcnt(6)
    v_mfma_f32_16x16x32_bf16 a[128:131], a[16:19], v[24:27], a[128:131]
    ds_read_b64_tr_b16 a[0:1], v1 offset:8192
    v_mfma_f32_16x16x32_bf16 a[136:139], a[16:19], v[32:35], a[136:139]
    v_exp_f32 v81, v81
    v_mfma_f32_16x16x32_bf16 a[144:147], a[16:19], v[40:43], a[144:147]
    ds_read_b64_tr_b16 a[2:3], v1 offset:10240
    v_mfma_f32_16x16x32_bf16 a[152:155], a[16:19], v[48:51], a[152:155]
    v_exp_f32 v82, v82
    v_mfma_f32_16x16x32_bf16 a[36:39], a[48:51], v[32:35], a[36:39]
    v_cvt_pk_bf16_f32 v80, v80, v81
    s_waitcnt lgkmcnt(6)
    v_mfma_f32_16x16x32_bf16 a[132:135], a[20:23], v[24:27], a[132:135]
    ds_read_b64_tr_b16 a[4:5], v2 offset:8192
    v_mfma_f32_16x16x32_bf16 a[140:143], a[20:23], v[32:35], a[140:143]
    v_exp_f32 v83, v83
    v_mfma_f32_16x16x32_bf16 a[148:151], a[20:23], v[40:43], a[148:151]
    ds_read_b64_tr_b16 a[6:7], v2 offset:10240
    v_mfma_f32_16x16x32_bf16 a[156:159], a[20:23], v[48:51], a[156:159]
    v_exp_f32 v60, v60
    s_waitcnt lgkmcnt(6)
    v_mfma_f32_16x16x32_bf16 a[160:163], a[24:27], v[24:27], a[160:163]
    ds_read_b64_tr_b16 a[8:9], v3 offset:8192
    v_mfma_f32_16x16x32_bf16 a[168:171], a[24:27], v[32:35], a[168:171]
    v_cvt_pk_bf16_f32 v81, v82, v83
    v_mfma_f32_16x16x32_bf16 a[176:179], a[24:27], v[40:43], a[176:179]
    ds_read_b64_tr_b16 a[10:11], v3 offset:10240
    v_mfma_f32_16x16x32_bf16 a[184:187], a[24:27], v[48:51], a[184:187]
    v_exp_f32 v61, v61
    s_waitcnt lgkmcnt(6)
    v_mfma_f32_16x16x32_bf16 a[164:167], a[28:31], v[24:27], a[164:167]
    ds_read_b64_tr_b16 a[12:13], v4 offset:8192
    v_mfma_f32_16x16x32_bf16 a[172:175], a[28:31], v[32:35], a[172:175]
    v_exp_f32 v62, v62
    v_mfma_f32_16x16x32_bf16 a[180:183], a[28:31], v[40:43], a[180:183]
    ds_read_b64_tr_b16 a[14:15], v4 offset:10240
    v_cvt_pk_bf16_f32 v58, v60, v61
    v_mfma_f32_16x16x32_bf16 a[188:191], a[28:31], v[48:51], a[188:191]
    v_exp_f32 v63, v63
    v_mfma_f32_16x16x32_bf16 a[40:43], a[48:51], v[40:43], a[40:43]
    s_sub_u32 s41, s41, 1
    s_cmp_lg_u32 s41, 0
    s_cbranch_scc1 K2_aloop
    s_waitcnt lgkmcnt(6)
    v_mfma_f32_16x16x32_bf16 a[192:195], a[0:3], v[24:27], a[192:195]
    s_waitcnt vmcnt(11)
    s_barrier
    v_add_u32 v5, s53, v5
    v_add_u32 v6, s53, v6
    ds_read_b128 a[16:19], v5 offset:0
    v_mfma_f32_16x16x32_bf16 a[200:203], a[0:3], v[32:35], a[200:203]
    v_mfma_f32_16x16x32_bf16 a[208:211], a[0:3], v[40:43], a[208:211]
    s_add_u32 m0, s44, 0
    v_exp_f32 v68, v68
    v_mfma_f32_16x16x32_bf16 a[216:219], a[0:3], v[48:51], a[216:219]
    buffer_load_dwordx4 v10, s[16:19], s42 offen offset:0 nt lds
    s_waitcnt lgkmcnt(5)
    v_mfma_f32_16x16x32_bf16 a[196:199], a[4:7], v[24:27], a[196:199]
    ds_read_b128 a[20:23], v6 offset:0
    v_mfma_f32_16x16x32_bf16 a[204:207], a[4:7], v[32:35], a[204:207]
    v_mfma_f32_16x16x32_bf16 a[212:215], a[4:7], v[40:43], a[212:215]
    v_cvt_pk_bf16_f32 v59, v62, v63
    v_mfma_f32_16x16x32_bf16 a[220:223], a[4:7], v[48:51], a[220:223]
    v_exp_f32 v69, v69
    s_waitcnt lgkmcnt(4)
    v_mfma_f32_16x16x32_bf16 a[224:227], a[8:11], v[24:27], a[224:227]
    ds_read_b128 a[24:27], v5 offset:4096
    v_mfma_f32_16x16x32_bf16 a[232:235], a[8:11], v[32:35], a[232:235]
    s_add_u32 m0, s44, 3968
    v_exp_f32 v70, v70
    v_mfma_f32_16x16x32_bf16 a[240:243], a[8:11], v[40:43], a[240:243]
    buffer_load_dwordx4 v10, s[16:19], s42 offen offset:128 nt lds
    v_mfma_f32_16x16x32_bf16 a[248:251], a[8:11], v[48:51], a[248:251]
    v_cvt_pk_bf16_f32 v66, v68, v69
    v_mfma_f32_16x16x32_bf16 a[44:47], a[48:51], v[48:51], a[44:47]
    v_exp_f32 v71, v71
    s_waitcnt lgkmcnt(3)
    v_mfma_f32_16x16x32_bf16 a[228:231], a[12:15], v[24:27], a[228:231]
    ds_read_b128 a[28:31], v6 offset:4096
    v_mfma_f32_16x16x32_bf16 a[236:239], a[12:15], v[32:35], a[236:239]
    v_exp_f32 v76, v76
    v_mfma_f32_16x16x32_bf16 a[244:247], a[12:15], v[40:43], a[244:247]
    s_add_u32 m0, s44, 7936
    v_cvt_pk_bf16_f32 v67, v70, v71
    v_mfma_f32_16x16x32_bf16 a[252:255], a[12:15], v[48:51], a[252:255]
    buffer_load_dwordx4 v10, s[16:19], s42 offen offset:256 nt lds
    s_add_u32 s42, s42, 12288
    s_waitcnt lgkmcnt(3)
    v_mfma_f32_16x16x32_bf16 v[24:27], a[16:19], v[96:99], v[192:195]
    ds_read_b128 a[0:3], v5 offset:8192
    v_mfma_f32_16x16x32_bf16 v[32:35], a[16:19], v[100:103], v[196:199]
    s_waitcnt vmcnt(10)
    ds_read_b64_tr_b16 v[88:89], v7 offset:0
    v_mfma_f32_16x16x32_bf16 v[40:43], a[16:19], v[104:107], v[200:203]
    v_exp_f32 v77, v77
    v_mfma_f32_16x16x32_bf16 v[48:51], a[16:19], v[108:111], v[204:207]
    ds_read_b64_tr_b16 v[90:91], v7 offset:1024
    s_waitcnt lgkmcnt(5)
    v_mfma_f32_16x16x32_bf16 v[24:27], a[20:23], v[112:115], v[24:27]
    ds_read_b128 a[4:7], v6 offset:8192
    v_mfma_f32_16x16x32_bf16 v[32:35], a[20:23], v[116:119], v[32:35]
    ds_read_b64_tr_b16 v[92:93], v7 offset:32
    v_mfma_f32_16x16x32_bf16 v[40:43], a[20:23], v[120:123], v[40:43]
    v_exp_f32 v78, v78
    v_mfma_f32_16x16x32_bf16 v[48:51], a[20:23], v[124:127], v[48:51]
    ds_read_b64_tr_b16 v[94:95], v7 offset:1056
    s_waitcnt lgkmcnt(7)
    v_mfma_f32_16x16x32_bf16 v[24:27], a[24:27], v[128:131], v[24:27]
    ds_read_b128 a[8:11], v5 offset:2048
    s_add_u32 m0, s45, 12288
    v_cvt_pk_bf16_f32 v74, v76, v77
    v_mfma_f32_16x16x32_bf16 v[32:35], a[24:27], v[132:135], v[32:35]
    buffer_load_dwordx4 v11, s[20:23], s43 offen offset:0 nt lds
    v_mfma_f32_16x16x32_bf16 v[40:43], a[24:27], v[136:139], v[40:43]
    v_mfma_f32_16x16x32_bf16 v[48:51], a[24:27], v[140:143], v[48:51]
    v_exp_f32 v79, v79
    s_waitcnt lgkmcnt(7)
    v_mfma_f32_16x16x32_bf16 v[24:27], a[28:31], v[144:147], v[24:27]
    ds_read_b128 a[12:15], v6 offset:2048
    v_mfma_f32_16x16x32_bf16 v[32:35], a[28:31], v[148:151], v[32:35]
    v_exp_f32 v84, v84
    v_mfma_f32_16x16x32_bf16 v[40:43], a[28:31], v[152:155], v[40:43]
    s_add_u32 m0, s45, 16256
    v_cvt_pk_bf16_f32 v75, v78, v79
    v_mfma_f32_16x16x32_bf16 v[48:51], a[28:31], v[156:159], v[48:51]
    buffer_load_dwordx4 v11, s[20:23], s43 offen offset:128 nt lds
    s_waitcnt lgkmcnt(7)
    v_mfma_f32_16x16x32_bf16 v[24:27], a[0:3], v[160:163], v[24:27]
    ds_read_b128 a[16:19], v5 offset:6144
    v_mfma_f32_16x16x32_bf16 v[32:35], a[0:3], v[164:167], v[32:35]
    v_exp_f32 v85, v85
    v_mfma_f32_16x16x32_bf16 v[40:43], a[0:3], v[168:171], v[40:43]
    v_mfma_f32_16x16x32_bf16 v[48:51], a[0:3], v[172:175], v[48:51]
    v_exp_f32 v86, v86
    s_waitcnt lgkmcnt(5)
    v_mfma_f32_16x16x32_bf16 v[24:27], a[4:7], v[176:179], v[24:27]
    ds_read_b128 a[20:23], v6 offset:6144
    s_add_u32 m0, s45, 20224
    v_cvt_pk_bf16_f32 v82, v84, v85
    v_mfma_f32_16x16x32_bf16 v[32:35], a[4:7], v[180:183], v[32:35]
    buffer_load_dwordx4 v11, s[20:23], s43 offen offset:256 nt lds
    s_add_u32 s43, s43, 12288
    s_lshl_b32 s3, s32, 11
    s_add_u32 s3, s3, 123392
    s_sub_u32 s45, s3, s45
    v_mfma_f32_16x16x32_bf16 v[40:43], a[4:7], v[184:187], v[40:43]
    v_mfma_f32_16x16x32_bf16 v[48:51], a[4:7], v[188:191], v[48:51]
    v_exp_f32 v87, v87
    s_nop 0
    s_waitcnt lgkmcnt(3)
    v_mfma_f32_16x16x32_bf16 v[28:31], a[8:11], v[96:99], v[192:195]
    ds_read_b128 a[24:27], v5 offset:10240
    v_mfma_f32_16x16x32_bf16 v[36:39], a[8:11], v[100:103], v[196:199]
    buffer_store_dwordx4 v[88:91], v8, s[88:91], s58 offen sc1
    v_mfma_f32_16x16x32_bf16 v[44:47], a[8:11], v[104:107], v[200:203]
    v_cvt_pk_bf16_f32 v83, v86, v87
    v_mfma_f32_16x16x32_bf16 v[52:55], a[8:11], v[108:111], v[204:207]
    v_exp_f32 v24, v24
    s_waitcnt lgkmcnt(3)
    v_mfma_f32_16x16x32_bf16 v[28:31], a[12:15], v[112:115], v[28:31]
    ds_read_b128 a[28:31], v6 offset:10240
    v_exp_f32 v25, v25
    v_mfma_f32_16x16x32_bf16 v[36:39], a[12:15], v[116:119], v[36:39]
    buffer_store_dwordx4 v[92:95], v8, s[92:95], s58 offen sc1
    s_add_u32 s58, s58, s55
    v_mfma_f32_16x16x32_bf16 v[44:47], a[12:15], v[120:123], v[44:47]
    v_exp_f32 v26, v26
    v_mfma_f32_16x16x32_bf16 v[52:55], a[12:15], v[124:127], v[52:55]
    v_cvt_pk_bf16_f32 v24, v24, v25
    v_exp_f32 v27, v27
    s_waitcnt lgkmcnt(3)
    v_mfma_f32_16x16x32_bf16 v[28:31], a[16:19], v[128:131], v[28:31]
    s_waitcnt vmcnt(12)
    s_barrier
    ds_read_b128 a[0:3], v5 offset:12288
    v_exp_f32 v32, v32
    v_mfma_f32_16x16x32_bf16 v[36:39], a[16:19], v[132:135], v[36:39]
    buffer_load_dword v22, v23, s[76:79], 0 offen sc1
    v_mfma_f32_16x16x32_bf16 v[44:47], a[16:19], v[136:139], v[44:47]
    s_add_u32 m0, s44, 12288
    v_cvt_pk_bf16_f32 v25, v26, v27
    v_mfma_f32_16x16x32_bf16 v[52:55], a[16:19], v[140:143], v[52:55]
    buffer_load_dwordx4 v10, s[16:19], s42 offen offset:0 nt lds
    s_waitcnt lgkmcnt(3)
    v_mfma_f32_16x16x32_bf16 v[28:31], a[20:23], v[144:147], v[28:31]
    ds_read_b128 a[4:7], v6 offset:12288
    v_exp_f32 v33, v33
    v_mfma_f32_16x16x32_bf16 v[36:39], a[20:23], v[148:151], v[36:39]
    v_exp_f32 v34, v34
    v_cvt_pk_bf16_f32 v32, v32, v33
    v_mfma_f32_16x16x32_bf16 v[44:47], a[20:23], v[152:155], v[44:47]
    v_exp_f32 v35, v35
    v_mfma_f32_16x16x32_bf16 v[52:55], a[20:23], v[156:159], v[52:55]
    v_exp_f32 v40, v40
    s_waitcnt lgkmcnt(3)
    v_mfma_f32_16x16x32_bf16 v[28:31], a[24:27], v[160:163], v[28:31]
    ds_read_b128 a[8:11], v5 offset:16384
    s_add_u32 m0, s44, 16256
    v_cvt_pk_bf16_f32 v33, v34, v35
    v_mfma_f32_16x16x32_bf16 v[36:39], a[24:27], v[164:167], v[36:39]
    buffer_load_dwordx4 v10, s[16:19], s42 offen offset:128 nt lds
    v_mfma_f32_16x16x32_bf16 v[44:47], a[24:27], v[168:171], v[44:47]
    v_exp_f32 v41, v41
    v_mfma_f32_16x16x32_bf16 v[52:55], a[24:27], v[172:175], v[52:55]
    v_exp_f32 v42, v42
    v_cvt_pk_bf16_f32 v40, v40, v41
    s_waitcnt lgkmcnt(3)
    v_mfma_f32_16x16x32_bf16 v[28:31], a[28:31], v[176:179], v[28:31]
    ds_read_b128 a[12:15], v6 offset:16384
    v_exp_f32 v43, v43
    v_mfma_f32_16x16x32_bf16 v[36:39], a[28:31], v[180:183], v[36:39]
    v_exp_f32 v48, v48
    v_mfma_f32_16x16x32_bf16 v[44:47], a[28:31], v[184:187], v[44:47]
    s_add_u32 m0, s44, 20224
    v_cvt_pk_bf16_f32 v41, v42, v43
    v_exp_f32 v49, v49
    v_mfma_f32_16x16x32_bf16 v[52:55], a[28:31], v[188:191], v[52:55]
    buffer_load_dwordx4 v10, s[16:19], s42 offen offset:256 nt lds
    s_add_u32 s42, s42, 12288
    s_waitcnt lgkmcnt(3)
    v_mfma_f32_16x16x32_bf16 v[208:211], a[0:3], v[96:99], v[192:195]
    ds_read_b128 a[16:19], v5 offset:20480
    v_exp_f32 v50, v50
    v_mfma_f32_16x16x32_bf16 v[212:215], a[0:3], v[100:103], v[196:199]
    v_cvt_pk_bf16_f32 v48, v48, v49
    v_mfma_f32_16x16x32_bf16 v[216:219], a[0:3], v[104:107], v[200:203]
    v_exp_f32 v51, v51
    s_nop 0
    v_cvt_pk_bf16_f32 v49, v50, v51
    v_mfma_f32_16x16x32_bf16 v[220:223], a[0:3], v[108:111], v[204:207]
    v_exp_f32 v28, v28
    s_waitcnt lgkmcnt(3)
    v_mfma_f32_16x16x32_bf16 v[208:211], a[4:7], v[112:115], v[208:211]
    ds_read_b128 a[20:23], v6 offset:20480
    s_add_u32 m0, s45, 0
    v_exp_f32 v29, v29
    v_mfma_f32_16x16x32_bf16 v[212:215], a[4:7], v[116:119], v[212:215]
    buffer_load_dwordx4 v11, s[20:23], s43 offen offset:0 nt lds
    v_mfma_f32_16x16x32_bf16 v[216:219], a[4:7], v[120:123], v[216:219]
    v_exp_f32 v30, v30
    v_mfma_f32_16x16x32_bf16 v[220:223], a[4:7], v[124:127], v[220:223]
    v_cvt_pk_bf16_f32 v26, v28, v29
    v_exp_f32 v31, v31
    s_waitcnt lgkmcnt(3)
    v_mfma_f32_16x16x32_bf16 v[208:211], a[8:11], v[128:131], v[208:211]
    ds_read_b128 a[24:27], v5 offset:14336
    v_mfma_f32_16x16x32_bf16 v[212:215], a[8:11], v[132:135], v[212:215]
    v_exp_f32 v36, v36
    v_cvt_pk_bf16_f32 v27, v30, v31
    v_mfma_f32_16x16x32_bf16 v[216:219], a[8:11], v[136:139], v[216:219]
    s_add_u32 m0, s45, 3968
    v_exp_f32 v37, v37
    v_mfma_f32_16x16x32_bf16 v[220:223], a[8:11], v[140:143], v[220:223]
    buffer_load_dwordx4 v11, s[20:23], s43 offen offset:128 nt lds
    s_waitcnt lgkmcnt(3)
    v_mfma_f32_16x16x32_bf16 v[208:211], a[12:15], v[144:147], v[208:211]
    ds_read_b128 a[28:31], v6 offset:14336
    v_exp_f32 v38, v38
    v_mfma_f32_16x16x32_bf16 v[212:215], a[12:15], v[148:151], v[212:215]
    v_cvt_pk_bf16_f32 v34, v36, v37
    v_mfma_f32_16x16x32_bf16 v[216:219], a[12:15], v[152:155], v[216:219]
    v_exp_f32 v39, v39
    v_mfma_f32_16x16x32_bf16 v[220:223], a[12:15], v[156:159], v[220:223]
    v_exp_f32 v44, v44
    v_cvt_pk_bf16_f32 v35, v38, v39
    s_waitcnt lgkmcnt(3)
    v_mfma_f32_16x16x32_bf16 v[208:211], a[16:19], v[160:163], v[208:211]
    ds_read_b128 a[0:3], v5 offset:18432
    s_add_u32 m0, s45, 7936
    v_exp_f32 v45, v45
    v_mfma_f32_16x16x32_bf16 v[212:215], a[16:19], v[164:167], v[212:215]
    buffer_load_dwordx4 v11, s[20:23], s43 offen offset:256 nt lds
    s_add_u32 s43, s43, 12288
    v_mfma_f32_16x16x32_bf16 v[216:219], a[16:19], v[168:171], v[216:219]
    v_exp_f32 v46, v46
    v_mfma_f32_16x16x32_bf16 v[220:223], a[16:19], v[172:175], v[220:223]
    v_cvt_pk_bf16_f32 v42, v44, v45
    v_exp_f32 v47, v47
    s_waitcnt lgkmcnt(3)
    v_mfma_f32_16x16x32_bf16 v[208:211], a[20:23], v[176:179], v[208:211]
    ds_read_b128 a[4:7], v6 offset:18432
    v_mfma_f32_16x16x32_bf16 v[212:215], a[20:23], v[180:183], v[212:215]
    v_exp_f32 v52, v52
    v_cvt_pk_bf16_f32 v43, v46, v47
    v_mfma_f32_16x16x32_bf16 v[216:219], a[20:23], v[184:187], v[216:219]
    s_sub_u32 m0, s45, 36864
    v_exp_f32 v53, v53
    v_mfma_f32_16x16x32_bf16 v[220:223], a[20:23], v[188:191], v[220:223]
    buffer_load_dwordx4 v11, s[20:23], s43 offen offset:0 nt lds
    s_waitcnt lgkmcnt(3)
    v_mfma_f32_16x16x32_bf16 v[224:227], a[24:27], v[96:99], v[192:195]
    ds_read_b128 a[8:11], v5 offset:22528
    v_exp_f32 v54, v54
    v_mfma_f32_16x16x32_bf16 v[228:231], a[24:27], v[100:103], v[196:199]
    v_cvt_pk_bf16_f32 v50, v52, v53
    v_mfma_f32_16x16x32_bf16 v[232:235], a[24:27], v[104:107], v[200:203]
    v_exp_f32 v55, v55
    s_nop 0
    v_cvt_pk_bf16_f32 v51, v54, v55
    v_mfma_f32_16x16x32_bf16 v[236:239], a[24:27], v[108:111], v[204:207]
    v_exp_f32 v208, v208
    s_waitcnt lgkmcnt(3)
    v_mfma_f32_16x16x32_bf16 v[224:227], a[28:31], v[112:115], v[224:227]
    ds_read_b128 a[12:15], v6 offset:22528
    s_sub_u32 m0, s45, 32896
    v_exp_f32 v209, v209
    v_mfma_f32_16x16x32_bf16 v[228:231], a[28:31], v[116:119], v[228:231]
    buffer_load_dwordx4 v11, s[20:23], s43 offen offset:128 nt lds
    v_mfma_f32_16x16x32_bf16 v[232:235], a[28:31], v[120:123], v[232:235]
    v_exp_f32 v210, v210
    v_cvt_pk_bf16_f32 v208, v208, v209
    v_mfma_f32_16x16x32_bf16 v[236:239], a[28:31], v[124:127], v[236:239]
    v_exp_f32 v211, v211
    s_waitcnt lgkmcnt(3)
    v_mfma_f32_16x16x32_bf16 v[224:227], a[0:3], v[128:131], v[224:227]
    s_waitcnt vmcnt(14)
    s_barrier
    ds_read_b128 a[16:19], v5 offset:24576
    v_exp_f32 v212, v212
    v_mfma_f32_16x16x32_bf16 v[228:231], a[0:3], v[132:135], v[228:231]
    v_cvt_pk_bf16_f32 v209, v210, v211
    v_mfma_f32_16x16x32_bf16 v[232:235], a[0:3], v[136:139], v[232:235]
    s_sub_u32 m0, s45, 28928
    v_exp_f32 v213, v213
    v_mfma_f32_16x16x32_bf16 v[236:239], a[0:3], v[140:143], v[236:239]
    buffer_load_dwordx4 v11, s[20:23], s43 offen offset:256 nt lds
    s_add_u32 s43, s43, 12288
    s_waitcnt lgkmcnt(3)
    v_mfma_f32_16x16x32_bf16 v[224:227], a[4:7], v[144:147], v[224:227]
    ds_read_b128 a[20:23], v6 offset:24576
    v_exp_f32 v214, v214
    v_mfma_f32_16x16x32_bf16 v[228:231], a[4:7], v[148:151], v[228:231]
    v_cvt_pk_bf16_f32 v212, v212, v213
    v_exp_f32 v215, v215
    v_mfma_f32_16x16x32_bf16 v[232:235], a[4:7], v[152:155], v[232:235]
    v_exp_f32 v216, v216
    v_cvt_pk_bf16_f32 v213, v214, v215
    v_mfma_f32_16x16x32_bf16 v[236:239], a[4:7], v[156:159], v[236:239]
    v_exp_f32 v217, v217
    s_waitcnt lgkmcnt(3)
    v_mfma_f32_16x16x32_bf16 v[224:227], a[8:11], v[160:163], v[224:227]
    ds_read_b128 a[24:27], v5 offset:28672
    v_exp_f32 v218, v218
    v_mfma_f32_16x16x32_bf16 v[228:231], a[8:11], v[164:167], v[228:231]
    v_lshrrev_b32 v92, 2, v8
    v_lshl_add_u32 v92, s32, 8, v92
    v_mfma_f32_16x16x32_bf16 v[232:235], a[8:11], v[168:171], v[232:235]
    v_cvt_pk_bf16_f32 v216, v216, v217
    v_exp_f32 v219, v219
    v_mfma_f32_16x16x32_bf16 v[236:239], a[8:11], v[172:175], v[236:239]
    s_mul_i32 s3, s2, 40
    s_add_u32 s3, s3, 267264
    s_add_u32 s96, s10, s3
    s_addc_u32 s97, s11, 0
    s_mov_b32 s98, 46120
    s_mov_b32 s99, 0x00020000
    v_cmp_lt_u32 vcc, 39, v92
    v_mov_b32 v16, 0x40000000
    s_waitcnt lgkmcnt(3)
    v_mfma_f32_16x16x32_bf16 v[224:227], a[12:15], v[176:179], v[224:227]
    ds_read_b128 a[28:31], v6 offset:28672
    v_exp_f32 v220, v220
    v_mfma_f32_16x16x32_bf16 v[228:231], a[12:15], v[180:183], v[228:231]
    v_cndmask_b32 v92, v92, v16, vcc
    v_add_u32 v9, 4096, v8
    v_mfma_f32_16x16x32_bf16 v[232:235], a[12:15], v[184:187], v[232:235]
    v_cvt_pk_bf16_f32 v217, v218, v219
    v_exp_f32 v221, v221
    v_mfma_f32_16x16x32_bf16 v[236:239], a[12:15], v[188:191], v[236:239]
    v_exp_f32 v222, v222
    v_mfma_f32_16x16x32_bf16 a[32:35], a[48:51], v[56:59], a[32:35]
    v_cvt_pk_bf16_f32 v220, v220, v221
    v_exp_f32 v223, v223
    s_nop 0
    v_mfma_f32_16x16x32_bf16 a[36:39], a[48:51], v[64:67], a[36:39]
    s_waitcnt vmcnt(9)
    v_cmp_ne_u32 vcc, 16, v22
    s_cbranch_vccnz K2_r1spin
K2_r1ok:
    v_cvt_pk_bf16_f32 v221, v222, v223
    v_mfma_f32_16x16x32_bf16 a[40:43], a[48:51], v[72:75], a[40:43]
    buffer_load_dword v88, v92, s[96:99], 0 offen sc1
    v_mfma_f32_16x16x32_bf16 a[44:47], a[48:51], v[80:83], a[44:47]
    v_exp_f32 v224, v224
    s_waitcnt lgkmcnt(3)
    v_mfma_f32_16x16x32_bf16 v[240:243], a[16:19], v[96:99], v[192:195]
    ds_read_b128 a[0:3], v5 offset:32768
    buffer_load_dword v89, v92, s[96:99], s4 offen sc1
    v_mfma_f32_16x16x32_bf16 v[244:247], a[16:19], v[100:103], v[196:199]
    v_exp_f32 v225, v225
    v_mfma_f32_16x16x32_bf16 v[248:251], a[16:19], v[104:107], v[200:203]
    buffer_load_dword v90, v92, s[96:99], s5 offen sc1
    v_mfma_f32_16x16x32_bf16 v[252:255], a[16:19], v[108:111], v[204:207]
    v_exp_f32 v226, v226
    s_waitcnt lgkmcnt(3)
    v_mfma_f32_16x16x32_bf16 v[240:243], a[20:23], v[112:115], v[240:243]
    ds_read_b128 a[4:7], v6 offset:32768
    buffer_load_dword v91, v92, s[96:99], s6 offen sc1
    v_mfma_f32_16x16x32_bf16 v[244:247], a[20:23], v[116:119], v[244:247]
    v_mfma_f32_16x16x32_bf16 v[248:251], a[20:23], v[120:123], v[248:251]
    v_cvt_pk_bf16_f32 v210, v224, v225
    v_exp_f32 v227, v227
    v_mfma_f32_16x16x32_bf16 v[252:255], a[20:23], v[124:127], v[252:255]
    v_lshlrev_b32 v23, 3, v8
    s_lshr_b32 s3, s2, 5
    s_mul_i32 s3, s3, 20480
    s_add_u32 s3, s3, s36
    s_add_u32 s3, s3, 61440
    s_cmp_ge_u32 s3, 245760
    s_cselect_b32 s50, 245760, 0
    s_sub_u32 s50, s3, s50
    v_min_u32 v23, 4992, v23
    s_waitcnt lgkmcnt(3)
    v_mfma_f32_16x16x32_bf16 v[240:243], a[24:27], v[128:131], v[240:243]
    ds_read_b128 a[8:11], v5 offset:26624
    v_mfma_f32_16x16x32_bf16 v[244:247], a[24:27], v[132:135], v[244:247]
    v_exp_f32 v228, v228
    v_mfma_f32_16x16x32_bf16 v[248:251], a[24:27], v[136:139], v[248:251]
    v_cvt_pk_bf16_f32 v211, v226, v227
    v_exp_f32 v229, v229
    v_mfma_f32_16x16x32_bf16 v[252:255], a[24:27], v[140:143], v[252:255]
    v_exp_f32 v230, v230
    s_waitcnt lgkmcnt(3)
    v_mfma_f32_16x16x32_bf16 v[240:243], a[28:31], v[144:147], v[240:243]
    ds_read_b128 a[12:15], v6 offset:26624
    v_cvt_pk_bf16_f32 v214, v228, v229
    v_mfma_f32_16x16x32_bf16 v[244:247], a[28:31], v[148:151], v[244:247]
    v_exp_f32 v231, v231
    v_mfma_f32_16x16x32_bf16 v[248:251], a[28:31], v[152:155], v[248:251]
    v_exp_f32 v232, v232
    v_mfma_f32_16x16x32_bf16 v[252:255], a[28:31], v[156:159], v[252:255]
    buffer_load_dword v22, v23, s[12:15], s50 offen sc1
    s_waitcnt lgkmcnt(3)
    v_mfma_f32_16x16x32_bf16 v[240:243], a[0:3], v[160:163], v[240:243]
    ds_read_b128 a[16:19], v5 offset:30720
    v_cvt_pk_bf16_f32 v215, v230, v231
    v_mfma_f32_16x16x32_bf16 v[244:247], a[0:3], v[164:167], v[244:247]
    v_exp_f32 v233, v233
    v_mfma_f32_16x16x32_bf16 v[248:251], a[0:3], v[168:171], v[248:251]
    v_exp_f32 v234, v234
    v_mfma_f32_16x16x32_bf16 v[252:255], a[0:3], v[172:175], v[252:255]
    v_cvt_pk_bf16_f32 v218, v232, v233
    s_waitcnt lgkmcnt(3)
    v_mfma_f32_16x16x32_bf16 v[240:243], a[4:7], v[176:179], v[240:243]
    ds_read_b128 a[20:23], v6 offset:30720
    v_exp_f32 v235, v235
    v_mfma_f32_16x16x32_bf16 v[244:247], a[4:7], v[180:183], v[244:247]
    v_exp_f32 v236, v236
    v_mfma_f32_16x16x32_bf16 v[248:251], a[4:7], v[184:187], v[248:251]
    v_cvt_pk_bf16_f32 v219, v234, v235
    v_mfma_f32_16x16x32_bf16 v[252:255], a[4:7], v[188:191], v[252:255]
    v_exp_f32 v237, v237
    s_waitcnt lgkmcnt(3)
    v_mfma_f32_16x16x32_bf16 v[60:63], a[8:11], v[96:99], v[192:195]
    ds_read_b128 a[24:27], v5 offset:34816
    v_exp_f32 v238, v238
    v_mfma_f32_16x16x32_bf16 v[68:71], a[8:11], v[100:103], v[196:199]
    v_cvt_pk_bf16_f32 v222, v236, v237
    v_mfma_f32_16x16x32_bf16 v[76:79], a[8:11], v[104:107], v[200:203]
    v_exp_f32 v239, v239
    s_nop 0
    v_cvt_pk_bf16_f32 v223, v238, v239
    v_mfma_f32_16x16x32_bf16 v[84:87], a[8:11], v[108:111], v[204:207]
    v_exp_f32 v240, v240
    s_waitcnt lgkmcnt(3)
    v_mfma_f32_16x16x32_bf16 v[60:63], a[12:15], v[112:115], v[60:63]
    ds_read_b128 a[28:31], v6 offset:34816
    v_mfma_f32_16x16x32_bf16 v[68:71], a[12:15], v[116:119], v[68:71]
    v_exp_f32 v241, v241
    v_mfma_f32_16x16x32_bf16 v[76:79], a[12:15], v[120:123], v[76:79]
    v_exp_f32 v242, v242
    v_cvt_pk_bf16_f32 v240, v240, v241
    v_mfma_f32_16x16x32_bf16 v[84:87], a[12:15], v[124:127], v[84:87]
    v_exp_f32 v243, v243
    s_waitcnt lgkmcnt(3)
    v_mfma_f32_16x16x32_bf16 v[60:63], a[16:19], v[128:131], v[60:63]
    s_waitcnt vmcnt(11)
    s_barrier
    ds_read_b128 a[0:3], v5 offset:36864
    v_mfma_f32_16x16x32_bf16 v[68:71], a[16:19], v[132:135], v[68:71]
    v_exp_f32 v244, v244
    v_mfma_f32_16x16x32_bf16 v[76:79], a[16:19], v[136:139], v[76:79]
    v_cvt_pk_bf16_f32 v241, v242, v243
    v_exp_f32 v245, v245
    v_mfma_f32_16x16x32_bf16 v[84:87], a[16:19], v[140:143], v[84:87]
    s_waitcnt lgkmcnt(3)
    v_mfma_f32_16x16x32_bf16 v[60:63], a[20:23], v[144:147], v[60:63]
    ds_read_b128 a[4:7], v6 offset:36864
    v_exp_f32 v246, v246
    v_mfma_f32_16x16x32_bf16 v[68:71], a[20:23], v[148:151], v[68:71]
    v_cvt_pk_bf16_f32 v244, v244, v245
    v_mfma_f32_16x16x32_bf16 v[76:79], a[20:23], v[152:155], v[76:79]
    v_exp_f32 v247, v247
    v_mfma_f32_16x16x32_bf16 v[84:87], a[20:23], v[156:159], v[84:87]
    v_exp_f32 v248, v248
    s_waitcnt lgkmcnt(3)
    v_mfma_f32_16x16x32_bf16 v[60:63], a[24:27], v[160:163], v[60:63]
    ds_read_b128 a[8:11], v5 offset:40960
    v_cvt_pk_bf16_f32 v245, v246, v247
    v_mfma_f32_16x16x32_bf16 v[68:71], a[24:27], v[164:167], v[68:71]
    v_exp_f32 v249, v249
    v_mfma_f32_16x16x32_bf16 v[76:79], a[24:27], v[168:171], v[76:79]
    v_exp_f32 v250, v250
    v_mfma_f32_16x16x32_bf16 v[84:87], a[24:27], v[172:175], v[84:87]
    v_cvt_pk_bf16_f32 v248, v248, v249
    s_waitcnt lgkmcnt(3)
    v_mfma_f32_16x16x32_bf16 v[60:63], a[28:31], v[176:179], v[60:63]
    ds_read_b128 a[12:15], v6 offset:40960
    v_exp_f32 v251, v251
    v_mfma_f32_16x16x32_bf16 v[68:71], a[28:31], v[180:183], v[68:71]
    v_exp_f32 v252, v252
    v_mfma_f32_16x16x32_bf16 v[76:79], a[28:31], v[184:187], v[76:79]
    v_cvt_pk_bf16_f32 v249, v250, v251
    v_mfma_f32_16x16x32_bf16 v[84:87], a[28:31], v[188:191], v[84:87]
    v_exp_f32 v253, v253
    v_mfma_f32_16x16x32_bf16 a[32:35], a[48:51], v[24:27], a[32:35]
    v_exp_f32 v254, v254
    v_mfma_f32_16x16x32_bf16 a[36:39], a[48:51], v[32:35], a[36:39]
    v_cvt_pk_bf16_f32 v252, v252, v253
    v_exp_f32 v255, v255
    s_nop 0
    v_mfma_f32_16x16x32_bf16 a[40:43], a[48:51], v[40:43], a[40:43]
    v_cvt_pk_bf16_f32 v253, v254, v255
    v_mfma_f32_16x16x32_bf16 a[44:47], a[48:51], v[48:51], a[44:47]
    v_exp_f32 v60, v60
    s_waitcnt lgkmcnt(3)
    v_mfma_f32_16x16x32_bf16 v[28:31], a[0:3], v[96:99], v[192:195]
    ds_read_b128 a[16:19], v5 offset:45056
    v_mfma_f32_16x16x32_bf16 v[36:39], a[0:3], v[100:103], v[196:199]
    v_exp_f32 v61, v61
    v_mfma_f32_16x16x32_bf16 v[44:47], a[0:3], v[104:107], v[200:203]
    v_exp_f32 v62, v62
    v_mfma_f32_16x16x32_bf16 v[52:55], a[0:3], v[108:111], v[204:207]
    v_cvt_pk_bf16_f32 v242, v60, v61
    s_waitcnt lgkmcnt(3)
    v_mfma_f32_16x16x32_bf16 v[28:31], a[4:7], v[112:115], v[28:31]
    ds_read_b128 a[20:23], v6 offset:45056
    v_exp_f32 v63, v63
    v_mfma_f32_16x16x32_bf16 v[36:39], a[4:7], v[116:119], v[36:39]
    v_mfma_f32_16x16x32_bf16 v[44:47], a[4:7], v[120:123], v[44:47]
    v_exp_f32 v68, v68
    v_mfma_f32_16x16x32_bf16 v[52:55], a[4:7], v[124:127], v[52:55]
    v_cvt_pk_bf16_f32 v243, v62, v63
    v_exp_f32 v69, v69
    s_waitcnt lgkmcnt(3)
    v_mfma_f32_16x16x32_bf16 v[28:31], a[8:11], v[128:131], v[28:31]
    ds_read_b128 a[24:27], v5 offset:38912
    v_mfma_f32_16x16x32_bf16 v[36:39], a[8:11], v[132:135], v[36:39]
    v_exp_f32 v70, v70
    v_mfma_f32_16x16x32_bf16 v[44:47], a[8:11], v[136:139], v[44:47]
    v_cvt_pk_bf16_f32 v246, v68, v69
    v_mfma_f32_16x16x32_bf16 v[52:55], a[8:11], v[140:143], v[52:55]
    v_exp_f32 v71, v71
    s_waitcnt lgkmcnt(3)
    v_mfma_f32_16x16x32_bf16 v[28:31], a[12:15], v[144:147], v[28:31]
    ds_read_b128 a[28:31], v6 offset:38912
    v_mfma_f32_16x16x32_bf16 v[36:39], a[12:15], v[148:151], v[36:39]
    v_exp_f32 v76, v76
    v_mfma_f32_16x16x32_bf16 v[44:47], a[12:15], v[152:155], v[44:47]
    v_cvt_pk_bf16_f32 v247, v70, v71
    v_mfma_f32_16x16x32_bf16 v[52:55], a[12:15], v[156:159], v[52:55]
    v_exp_f32 v77, v77
    s_waitcnt lgkmcnt(3)
    v_mfma_f32_16x16x32_bf16 v[28:31], a[16:19], v[160:163], v[28:31]
    ds_read_b128 a[0:3], v5 offset:43008
    v_exp_f32 v78, v78
    v_mfma_f32_16x16x32_bf16 v[36:39], a[16:19], v[164:167], v[36:39]
    v_cvt_pk_bf16_f32 v250, v76, v77
    v_mfma_f32_16x16x32_bf16 v[44:47], a[16:19], v[168:171], v[44:47]
    v_exp_f32 v79, v79
    v_mfma_f32_16x16x32_bf16 v[52:55], a[16:19], v[172:175], v[52:55]
    v_exp_f32 v84, v84
    s_waitcnt lgkmcnt(3)
    v_mfma_f32_16x16x32_bf16 v[28:31], a[20:23], v[176:179], v[28:31]
    ds_read_b128 a[4:7], v6 offset:43008
    v_mfma_f32_16x16x32_bf16 v[36:39], a[20:23], v[180:183], v[36:39]
    v_cvt_pk_bf16_f32 v251, v78, v79
    v_mfma_f32_16x16x32_bf16 v[44:47], a[20:23], v[184:187], v[44:47]
    v_exp_f32 v85, v85
    v_mfma_f32_16x16x32_bf16 v[52:55], a[20:23], v[188:191], v[52:55]
    v_exp_f32 v86, v86
    s_waitcnt lgkmcnt(3)
    v_mfma_f32_16x16x32_bf16 v[224:227], a[24:27], v[96:99], v[192:195]
    ds_read_b128 a[8:11], v5 offset:47104
    v_cvt_pk_bf16_f32 v254, v84, v85
    v_mfma_f32_16x16x32_bf16 v[228:231], a[24:27], v[100:103], v[196:199]
    v_exp_f32 v87, v87
    s_nop 0
    v_mfma_f32_16x16x32_bf16 v[232:235], a[24:27], v[104:107], v[200:203]
    v_cvt_pk_bf16_f32 v255, v86, v87
    v_mfma_f32_16x16x32_bf16 v[236:239], a[24:27], v[108:111], v[204:207]
    v_exp_f32 v28, v28
    s_waitcnt lgkmcnt(3)
    v_mfma_f32_16x16x32_bf16 v[224:227], a[28:31], v[112:115], v[224:227]
    ds_read_b128 a[12:15], v6 offset:47104
    v_exp_f32 v29, v29
    v_mfma_f32_16x16x32_bf16 v[228:231], a[28:31], v[116:119], v[228:231]
    v_exp_f32 v30, v30
    v_mfma_f32_16x16x32_bf16 v[232:235], a[28:31], v[120:123], v[232:235]
    v_cvt_pk_bf16_f32 v28, v28, v29
    v_exp_f32 v31, v31
    v_mfma_f32_16x16x32_bf16 v[236:239], a[28:31], v[124:127], v[236:239]
    v_exp_f32 v36, v36
    s_waitcnt lgkmcnt(3)
    v_mfma_f32_16x16x32_bf16 v[224:227], a[0:3], v[128:131], v[224:227]
    v_subrev_u32 v1, 36864, v1
    v_subrev_u32 v2, 36864, v2
    v_subrev_u32 v3, 36864, v3
    v_subrev_u32 v4, 36864, v4
    ds_read_b64_tr_b16 a[16:17], v1 offset:49152
    v_mfma_f32_16x16x32_bf16 v[228:231], a[0:3], v[132:135], v[228:231]
    v_mfma_f32_16x16x32_bf16 v[232:235], a[0:3], v[136:139], v[232:235]
    ds_read_b64_tr_b16 a[18:19], v1 offset:51200
    v_cvt_pk_bf16_f32 v29, v30, v31
    v_mfma_f32_16x16x32_bf16 v[236:239], a[0:3], v[140:143], v[236:239]
    v_exp_f32 v37, v37
    s_waitcnt lgkmcnt(4)
    v_mfma_f32_16x16x32_bf16 v[224:227], a[4:7], v[144:147], v[224:227]
    ds_read_b64_tr_b16 a[20:21], v2 offset:49152
    v_exp_f32 v38, v38
    v_mfma_f32_16x16x32_bf16 v[228:231], a[4:7], v[148:151], v[228:231]
    v_cvt_pk_bf16_f32 v36, v36, v37
    v_exp_f32 v39, v39
    v_mfma_f32_16x16x32_bf16 v[232:235], a[4:7], v[152:155], v[232:235]
    ds_read_b64_tr_b16 a[22:23], v2 offset:51200
    s_waitcnt vmcnt(1)
    v_exp_f32 v44, v44
    v_mfma_f32_16x16x32_bf16 v[236:239], a[4:7], v[156:159], v[236:239]
    v_cvt_pk_bf16_f32 v37, v38, v39
    s_waitcnt lgkmcnt(5)
    v_mfma_f32_16x16x32_bf16 v[224:227], a[8:11], v[160:163], v[224:227]
    ds_read_b64_tr_b16 a[24:25], v1 offset:12288
    v_add_f32 v88, v88, v89
    v_mfma_f32_16x16x32_bf16 v[228:231], a[8:11], v[164:167], v[228:231]
    v_exp_f32 v45, v45
    v_mfma_f32_16x16x32_bf16 v[232:235], a[8:11], v[168:171], v[232:235]
    ds_read_b64_tr_b16 a[26:27], v1 offset:14336
    v_add_f32 v90, v90, v91
    v_mfma_f32_16x16x32_bf16 v[236:239], a[8:11], v[172:175], v[236:239]
    v_exp_f32 v46, v46
    v_cvt_pk_bf16_f32 v44, v44, v45
    s_waitcnt lgkmcnt(6)
    v_mfma_f32_16x16x32_bf16 v[224:227], a[12:15], v[176:179], v[224:227]
    ds_read_b64_tr_b16 a[28:29], v2 offset:12288
    v_add_f32 v88, v88, v90
    v_mfma_f32_16x16x32_bf16 v[228:231], a[12:15], v[180:183], v[228:231]
    v_exp_f32 v47, v47
    v_mfma_f32_16x16x32_bf16 v[232:235], a[12:15], v[184:187], v[232:235]
    ds_read_b64_tr_b16 a[30:31], v2 offset:14336
    v_cvt_pk_bf16_f32 v88, 0, v88
    v_exp_f32 v52, v52
    v_mfma_f32_16x16x32_bf16 v[236:239], a[12:15], v[188:191], v[236:239]
    v_cvt_pk_bf16_f32 v45, v46, v47
    v_exp_f32 v53, v53
    v_mfma_f32_16x16x32_bf16 a[32:35], a[48:51], v[208:211], a[32:35]
    s_sub_u32 s96, s96, 262144
    s_subb_u32 s97, s97, 0
    buffer_store_dword v88, v92, s[96:99], 0 offen sc1
    v_mfma_f32_16x16x32_bf16 a[36:39], a[48:51], v[212:215], a[36:39]
    v_exp_f32 v54, v54
    v_cvt_pk_bf16_f32 v52, v52, v53
    v_mfma_f32_16x16x32_bf16 a[40:43], a[48:51], v[216:219], a[40:43]
    v_exp_f32 v55, v55
    s_nop 0
    v_cvt_pk_bf16_f32 v53, v54, v55
    v_mfma_f32_16x16x32_bf16 a[44:47], a[48:51], v[220:223], a[44:47]
    v_exp_f32 v224, v224
    s_waitcnt lgkmcnt(6)
    v_mfma_f32_16x16x32_bf16 a[64:67], a[16:19], v[56:59], a[64:67]
    s_barrier
    ds_read_b64_tr_b16 a[0:1], v1 offset:24576
    v_exp_f32 v225, v225
    v_mfma_f32_16x16x32_bf16 a[72:75], a[16:19], v[64:67], a[72:75]
    v_exp_f32 v226, v226
    v_mfma_f32_16x16x32_bf16 a[80:83], a[16:19], v[72:75], a[80:83]
    ds_read_b64_tr_b16 a[2:3], v1 offset:26624
    v_mfma_f32_16x16x32_bf16 a[88:91], a[16:19], v[80:83], a[88:91]
    v_cvt_pk_bf16_f32 v30, v224, v225
    v_exp_f32 v227, v227
    s_waitcnt lgkmcnt(6)
    v_mfma_f32_16x16x32_bf16 a[68:71], a[20:23], v[56:59], a[68:71]
    ds_read_b64_tr_b16 a[4:5], v2 offset:24576
    v_mfma_f32_16x16x32_bf16 a[76:79], a[20:23], v[64:67], a[76:79]
    s_add_u32 m0, s37, 0
    s_nop 0
    buffer_load_dwordx4 v8, s[12:15], s35 offen offset:0 sc1 lds
    v_mfma_f32_16x16x32_bf16 a[84:87], a[20:23], v[72:75], a[84:87]
    ds_read_b64_tr_b16 a[6:7], v2 offset:26624
    v_exp_f32 v228, v228
    v_mfma_f32_16x16x32_bf16 a[92:95], a[20:23], v[80:83], a[92:95]
    v_cvt_pk_bf16_f32 v31, v226, v227
    s_waitcnt lgkmcnt(6)
    v_mfma_f32_16x16x32_bf16 a[32:35], a[48:51], v[240:243], a[32:35]
    ds_read_b64_tr_b16 a[8:9], v1 offset:36864
    v_exp_f32 v229, v229
    v_mfma_f32_16x16x32_bf16 a[36:39], a[48:51], v[244:247], a[36:39]
    buffer_load_dwordx4 v8, s[12:15], s35 offen offset:1024 sc1 lds
    v_mfma_f32_16x16x32_bf16 a[40:43], a[48:51], v[248:251], a[40:43]
    ds_read_b64_tr_b16 a[10:11], v1 offset:38912
    v_mfma_f32_16x16x32_bf16 a[44:47], a[48:51], v[252:255], a[44:47]
    v_exp_f32 v230, v230
    v_mfma_f32_16x16x32_bf16 a[64:67], a[24:27], v[24:27], a[64:67]
    v_cvt_pk_bf16_f32 v38, v228, v229
    v_exp_f32 v231, v231
    v_mfma_f32_16x16x32_bf16 a[72:75], a[24:27], v[32:35], a[72:75]
    buffer_load_dwordx4 v8, s[12:15], s35 offen offset:2048 sc1 lds
    v_mfma_f32_16x16x32_bf16 a[80:83], a[24:27], v[40:43], a[80:83]
    v_exp_f32 v232, v232
    v_mfma_f32_16x16x32_bf16 a[88:91], a[24:27], v[48:51], a[88:91]
    v_cvt_pk_bf16_f32 v39, v230, v231
    s_waitcnt lgkmcnt(6)
    v_mfma_f32_16x16x32_bf16 a[68:71], a[28:31], v[24:27], a[68:71]
    ds_read_b64_tr_b16 a[12:13], v2 offset:36864
    v_exp_f32 v233, v233
    v_mfma_f32_16x16x32_bf16 a[76:79], a[28:31], v[32:35], a[76:79]
    buffer_load_dwordx4 v8, s[12:15], s35 offen offset:3072 sc1 lds
    v_mfma_f32_16x16x32_bf16 a[84:87], a[28:31], v[40:43], a[84:87]
    ds_read_b64_tr_b16 a[14:15], v2 offset:38912
    v_mfma_f32_16x16x32_bf16 a[92:95], a[28:31], v[48:51], a[92:95]
    v_exp_f32 v234, v234
    v_cvt_pk_bf16_f32 v46, v232, v233
    s_waitcnt lgkmcnt(6)
    v_mfma_f32_16x16x32_bf16 a[64:67], a[0:3], v[208:211], a[64:67]
    ds_read_b64_tr_b16 a[16:17], v1 offset:0
    v_mfma_f32_16x16x32_bf16 a[72:75], a[0:3], v[212:215], a[72:75]
    s_add_u32 m0, s37, 4096
    s_nop 0
    buffer_load_dwordx4 v9, s[12:15], s35 offen offset:0 sc1 lds
    s_add_u32 s35, s35, 20480
    v_mfma_f32_16x16x32_bf16 a[80:83], a[0:3], v[216:219], a[80:83]
    ds_read_b64_tr_b16 a[18:19], v1 offset:2048
    v_exp_f32 v235, v235
    v_mfma_f32_16x16x32_bf16 a[88:91], a[0:3], v[220:223], a[88:91]
    v_exp_f32 v236, v236
    s_waitcnt lgkmcnt(6)
    v_mfma_f32_16x16x32_bf16 a[68:71], a[4:7], v[208:211], a[68:71]
    ds_read_b64_tr_b16 a[20:21], v2 offset:0
    v_cvt_pk_bf16_f32 v47, v234, v235
    v_mfma_f32_16x16x32_bf16 a[76:79], a[4:7], v[212:215], a[76:79]
    s_add_u32 m0, s37, 20480
    s_nop 0
    buffer_load_dwordx4 v8, s[12:15], s35 offen offset:0 sc1 lds
    v_mfma_f32_16x16x32_bf16 a[84:87], a[4:7], v[216:219], a[84:87]
    ds_read_b64_tr_b16 a[22:23], v2 offset:2048
    v_mfma_f32_16x16x32_bf16 a[92:95], a[4:7], v[220:223], a[92:95]
    v_exp_f32 v237, v237
    s_waitcnt lgkmcnt(6)
    v_mfma_f32_16x16x32_bf16 a[64:67], a[8:11], v[240:243], a[64:67]
    ds_read_b64_tr_b16 a[24:25], v3 offset:49152
    v_exp_f32 v238, v238
    v_mfma_f32_16x16x32_bf16 a[72:75], a[8:11], v[244:247], a[72:75]
    buffer_load_dwordx4 v8, s[12:15], s35 offen offset:1024 sc1 lds
    v_mfma_f32_16x16x32_bf16 a[80:83], a[8:11], v[248:251], a[80:83]
    ds_read_b64_tr_b16 a[26:27], v3 offset:51200
    v_cvt_pk_bf16_f32 v54, v236, v237
    v_mfma_f32_16x16x32_bf16 a[88:91], a[8:11], v[252:255], a[88:91]
    v_exp_f32 v239, v239
    s_nop 0
    s_waitcnt lgkmcnt(6)
    v_mfma_f32_16x16x32_bf16 a[68:71], a[12:15], v[240:243], a[68:71]
    ds_read_b64_tr_b16 a[28:29], v4 offset:49152
    v_cvt_pk_bf16_f32 v55, v238, v239
    v_mfma_f32_16x16x32_bf16 a[76:79], a[12:15], v[244:247], a[76:79]
    buffer_load_dwordx4 v8, s[12:15], s35 offen offset:2048 sc1 lds
    v_mfma_f32_16x16x32_bf16 a[84:87], a[12:15], v[248:251], a[84:87]
    ds_read_b64_tr_b16 a[30:31], v4 offset:51200
    v_mfma_f32_16x16x32_bf16 a[92:95], a[12:15], v[252:255], a[92:95]
    s_waitcnt lgkmcnt(6)
    v_mfma_f32_16x16x32_bf16 a[32:35], a[48:51], v[28:31], a[32:35]
    ds_read_b64_tr_b16 a[0:1], v3 offset:12288
    v_mfma_f32_16x16x32_bf16 a[36:39], a[48:51], v[36:39], a[36:39]
    buffer_load_dwordx4 v8, s[12:15], s35 offen offset:3072 sc1 lds
    v_mfma_f32_16x16x32_bf16 a[40:43], a[48:51], v[44:47], a[40:43]
    ds_read_b64_tr_b16 a[2:3], v3 offset:14336
    v_mfma_f32_16x16x32_bf16 a[44:47], a[48:51], v[52:55], a[44:47]
    v_mfma_f32_16x16x32_bf16 a[64:67], a[16:19], v[28:31], a[64:67]
    v_mfma_f32_16x16x32_bf16 a[72:75], a[16:19], v[36:39], a[72:75]
    s_add_u32 m0, s37, 24576
    s_nop 0
    buffer_load_dwordx4 v9, s[12:15], s35 offen offset:0 sc1 lds
    s_add_u32 s35, s35, 20480
    v_mfma_f32_16x16x32_bf16 a[80:83], a[16:19], v[44:47], a[80:83]
    v_mfma_f32_16x16x32_bf16 a[88:91], a[16:19], v[52:55], a[88:91]
    v_accvgpr_read_b32 v192, a32
    v_accvgpr_read_b32 v194, a36
    v_accvgpr_read_b32 v196, a40
    s_waitcnt lgkmcnt(6)
    v_mfma_f32_16x16x32_bf16 a[68:71], a[20:23], v[28:31], a[68:71]
    ds_read_b64_tr_b16 a[4:5], v4 offset:12288
    v_accvgpr_read_b32 v198, a44
    v_add_f32 v12, v192, v194
    v_mfma_f32_16x16x32_bf16 a[76:79], a[20:23], v[36:39], a[76:79]
    s_add_u32 m0, s37, 40960
    s_nop 0
    buffer_load_dwordx4 v8, s[12:15], s35 offen offset:0 sc1 lds
    v_add_f32 v13, v196, v198
    v_mfma_f32_16x16x32_bf16 a[84:87], a[20:23], v[44:47], a[84:87]
    ds_read_b64_tr_b16 a[6:7], v4 offset:14336
    v_add_f32 v12, v12, v13
    v_cmp_nge_f32 vcc, 0x71800000, v12
    s_mov_b32 s4, 24576
    s_mov_b32 s5, 49152
    s_mov_b32 s6, 73728
    s_cbranch_vccnz K2_slow
K2_back:
    v_mfma_f32_16x16x32_bf16 a[92:95], a[20:23], v[52:55], a[92:95]
    v_rcp_f32 v84, v192
    v_rcp_f32 v85, v194
    s_waitcnt lgkmcnt(6)
    v_mfma_f32_16x16x32_bf16 a[96:99], a[24:27], v[56:59], a[96:99]
    ds_read_b64_tr_b16 a[8:9], v3 offset:24576
    v_rcp_f32 v86, v196
    v_rcp_f32 v87, v198
    v_mfma_f32_16x16x32_bf16 a[104:107], a[24:27], v[64:67], a[104:107]
    buffer_load_dwordx4 v8, s[12:15], s35 offen offset:1024 sc1 lds
    v_mfma_f32_16x16x32_bf16 a[112:115], a[24:27], v[72:75], a[112:115]
    ds_read_b64_tr_b16 a[10:11], v3 offset:26624
    v_accvgpr_read_b32 v88, a64
    v_accvgpr_read_b32 v89, a65
    v_mfma_f32_16x16x32_bf16 a[120:123], a[24:27], v[80:83], a[120:123]
    v_accvgpr_read_b32 v90, a66
    v_accvgpr_read_b32 v91, a67
    s_waitcnt lgkmcnt(6)
    v_mfma_f32_16x16x32_bf16 a[100:103], a[28:31], v[56:59], a[100:103]
    ds_read_b64_tr_b16 a[12:13], v4 offset:24576
    v_accvgpr_read_b32 v92, a68
    v_mfma_f32_16x16x32_bf16 a[108:111], a[28:31], v[64:67], a[108:111]
    buffer_load_dwordx4 v8, s[12:15], s35 offen offset:2048 sc1 lds
    v_accvgpr_read_b32 v93, a69
    v_mfma_f32_16x16x32_bf16 a[116:119], a[28:31], v[72:75], a[116:119]
    ds_read_b64_tr_b16 a[14:15], v4 offset:26624
    v_accvgpr_read_b32 v94, a70
    v_mfma_f32_16x16x32_bf16 a[124:127], a[28:31], v[80:83], a[124:127]
    v_accvgpr_read_b32 v95, a71
    v_mul_f32 v88, v88, v84
    v_mul_f32 v89, v89, v84
    s_waitcnt lgkmcnt(6)
    v_mfma_f32_16x16x32_bf16 a[96:99], a[0:3], v[24:27], a[96:99]
    ds_read_b64_tr_b16 a[16:17], v3 offset:36864
    v_mul_f32 v90, v90, v84
    v_mfma_f32_16x16x32_bf16 a[104:107], a[0:3], v[32:35], a[104:107]
    buffer_load_dwordx4 v8, s[12:15], s35 offen offset:3072 sc1 lds
    v_mfma_f32_16x16x32_bf16 a[112:115], a[0:3], v[40:43], a[112:115]
    ds_read_b64_tr_b16 a[18:19], v3 offset:38912
    v_mul_f32 v91, v91, v84
    v_mul_f32 v92, v92, v84
    v_mfma_f32_16x16x32_bf16 a[120:123], a[0:3], v[48:51], a[120:123]
    v_mul_f32 v93, v93, v84
    v_mul_f32 v94, v94, v84
    s_waitcnt lgkmcnt(6)
    v_mfma_f32_16x16x32_bf16 a[100:103], a[4:7], v[24:27], a[100:103]
    ds_read_b64_tr_b16 a[20:21], v4 offset:36864
    v_mul_f32 v95, v95, v84
    v_mfma_f32_16x16x32_bf16 a[108:111], a[4:7], v[32:35], a[108:111]
    s_add_u32 m0, s37, 45056
    s_nop 0
    buffer_load_dwordx4 v9, s[12:15], s35 offen offset:0 sc1 lds
    s_sub_u32 s37, s38, s37
    v_cvt_pk_bf16_f32 v96, v88, v89
    v_mfma_f32_16x16x32_bf16 a[116:119], a[4:7], v[40:43], a[116:119]
    ds_read_b64_tr_b16 a[22:23], v4 offset:38912
    v_cvt_pk_bf16_f32 v97, v90, v91
    v_mfma_f32_16x16x32_bf16 a[124:127], a[4:7], v[48:51], a[124:127]
    v_cvt_pk_bf16_f32 v98, v92, v93
    v_cvt_pk_bf16_f32 v99, v94, v95
    s_waitcnt lgkmcnt(6)
    v_mfma_f32_16x16x32_bf16 a[96:99], a[8:11], v[208:211], a[96:99]
    ds_read_b64_tr_b16 a[24:25], v3 offset:0
    buffer_store_dwordx4 v[96:99], v8, s[28:31], 0 offen offset:0 sc1
    v_mfma_f32_16x16x32_bf16 a[104:107], a[8:11], v[212:215], a[104:107]
    v_accvgpr_read_b32 v88, a72
    v_accvgpr_read_b32 v89, a73
    v_mfma_f32_16x16x32_bf16 a[112:115], a[8:11], v[216:219], a[112:115]
    ds_read_b64_tr_b16 a[26:27], v3 offset:2048
    v_accvgpr_read_b32 v90, a74
    v_mfma_f32_16x16x32_bf16 a[120:123], a[8:11], v[220:223], a[120:123]
    v_accvgpr_read_b32 v91, a75
    v_accvgpr_read_b32 v92, a76
    v_accvgpr_read_b32 v93, a77
    s_waitcnt lgkmcnt(6)
    v_mfma_f32_16x16x32_bf16 a[100:103], a[12:15], v[208:211], a[100:103]
    ds_read_b64_tr_b16 a[28:29], v4 offset:0
    v_accvgpr_read_b32 v94, a78
    v_mfma_f32_16x16x32_bf16 a[108:111], a[12:15], v[212:215], a[108:111]
    v_accvgpr_read_b32 v95, a79
    v_mul_f32 v88, v88, v85
    v_mul_f32 v89, v89, v85
    v_mfma_f32_16x16x32_bf16 a[116:119], a[12:15], v[216:219], a[116:119]
    ds_read_b64_tr_b16 a[30:31], v4 offset:2048
    v_mul_f32 v90, v90, v85
    v_mfma_f32_16x16x32_bf16 a[124:127], a[12:15], v[220:223], a[124:127]
    v_mul_f32 v91, v91, v85
    v_mul_f32 v92, v92, v85
    s_waitcnt lgkmcnt(6)
    v_mfma_f32_16x16x32_bf16 a[96:99], a[16:19], v[240:243], a[96:99]
    ds_read_b64_tr_b16 a[0:1], v1 offset:53248
    v_mul_f32 v93, v93, v85
    v_mul_f32 v94, v94, v85
    v_mfma_f32_16x16x32_bf16 a[104:107], a[16:19], v[244:247], a[104:107]
    v_mul_f32 v95, v95, v85
    v_cvt_pk_bf16_f32 v100, v88, v89
    v_mfma_f32_16x16x32_bf16 a[112:115], a[16:19], v[248:251], a[112:115]
    ds_read_b64_tr_b16 a[2:3], v1 offset:55296
    v_cvt_pk_bf16_f32 v101, v90, v91
    v_mfma_f32_16x16x32_bf16 a[120:123], a[16:19], v[252:255], a[120:123]
    v_cvt_pk_bf16_f32 v102, v92, v93
    v_cvt_pk_bf16_f32 v103, v94, v95
    s_waitcnt lgkmcnt(6)
    v_mfma_f32_16x16x32_bf16 a[100:103], a[20:23], v[240:243], a[100:103]
    ds_read_b64_tr_b16 a[4:5], v2 offset:53248
    buffer_store_dwordx4 v[100:103], v8, s[28:31], s4 offen offset:0 sc1
    v_mfma_f32_16x16x32_bf16 a[108:111], a[20:23], v[244:247], a[108:111]
    v_accvgpr_read_b32 v88, a80
    v_accvgpr_read_b32 v89, a81
    v_mfma_f32_16x16x32_bf16 a[116:119], a[20:23], v[248:251], a[116:119]
    ds_read_b64_tr_b16 a[6:7], v2 offset:55296
    v_accvgpr_read_b32 v90, a82
    v_mfma_f32_16x16x32_bf16 a[124:127], a[20:23], v[252:255], a[124:127]
    v_accvgpr_read_b32 v91, a83
    v_accvgpr_read_b32 v92, a84
    s_waitcnt lgkmcnt(6)
    v_mfma_f32_16x16x32_bf16 a[96:99], a[24:27], v[28:31], a[96:99]
    ds_read_b64_tr_b16 a[8:9], v1 offset:16384
    v_accvgpr_read_b32 v93, a85
    v_mfma_f32_16x16x32_bf16 a[104:107], a[24:27], v[36:39], a[104:107]
    v_accvgpr_read_b32 v94, a86
    v_accvgpr_read_b32 v95, a87
    v_mfma_f32_16x16x32_bf16 a[112:115], a[24:27], v[44:47], a[112:115]
    ds_read_b64_tr_b16 a[10:11], v1 offset:18432
    v_mul_f32 v88, v88, v86
    v_mfma_f32_16x16x32_bf16 a[120:123], a[24:27], v[52:55], a[120:123]
    v_mul_f32 v89, v89, v86
    v_mul_f32 v90, v90, v86
    v_mul_f32 v91, v91, v86
    s_waitcnt lgkmcnt(6)
    v_mfma_f32_16x16x32_bf16 a[100:103], a[28:31], v[28:31], a[100:103]
    ds_read_b64_tr_b16 a[12:13], v2 offset:16384
    v_mul_f32 v92, v92, v86
    v_mfma_f32_16x16x32_bf16 a[108:111], a[28:31], v[36:39], a[108:111]
    v_mul_f32 v93, v93, v86
    v_mul_f32 v94, v94, v86
    v_mfma_f32_16x16x32_bf16 a[116:119], a[28:31], v[44:47], a[116:119]
    ds_read_b64_tr_b16 a[14:15], v2 offset:18432
    v_mul_f32 v95, v95, v86
    v_mfma_f32_16x16x32_bf16 a[124:127], a[28:31], v[52:55], a[124:127]
    v_cvt_pk_bf16_f32 v104, v88, v89
    v_cvt_pk_bf16_f32 v105, v90, v91
    s_waitcnt lgkmcnt(6)
    v_mfma_f32_16x16x32_bf16 a[128:131], a[0:3], v[56:59], a[128:131]
    ds_read_b64_tr_b16 a[16:17], v1 offset:28672
    v_cvt_pk_bf16_f32 v106, v92, v93
    v_mfma_f32_16x16x32_bf16 a[136:139], a[0:3], v[64:67], a[136:139]
    v_cvt_pk_bf16_f32 v107, v94, v95
    v_mfma_f32_16x16x32_bf16 a[144:147], a[0:3], v[72:75], a[144:147]
    ds_read_b64_tr_b16 a[18:19], v1 offset:30720
    buffer_store_dwordx4 v[104:107], v8, s[28:31], s5 offen offset:0 sc1
    v_mfma_f32_16x16x32_bf16 a[152:155], a[0:3], v[80:83], a[152:155]
    v_accvgpr_read_b32 v88, a88
    v_accvgpr_read_b32 v89, a89
    s_waitcnt lgkmcnt(6)
    v_mfma_f32_16x16x32_bf16 a[132:135], a[4:7], v[56:59], a[132:135]
    ds_read_b64_tr_b16 a[20:21], v2 offset:28672
    v_accvgpr_read_b32 v90, a90
    v_mfma_f32_16x16x32_bf16 a[140:143], a[4:7], v[64:67], a[140:143]
    v_accvgpr_read_b32 v91, a91
    v_accvgpr_read_b32 v92, a92
    v_mfma_f32_16x16x32_bf16 a[148:151], a[4:7], v[72:75], a[148:151]
    ds_read_b64_tr_b16 a[22:23], v2 offset:30720
    v_accvgpr_read_b32 v93, a93
    v_mfma_f32_16x16x32_bf16 a[156:159], a[4:7], v[80:83], a[156:159]
    v_accvgpr_read_b32 v94, a94
    v_accvgpr_read_b32 v95, a95
    s_waitcnt lgkmcnt(6)
    v_mfma_f32_16x16x32_bf16 a[128:131], a[8:11], v[24:27], a[128:131]
    ds_read_b64_tr_b16 a[24:25], v1 offset:40960
    v_mul_f32 v88, v88, v87
    v_mfma_f32_16x16x32_bf16 a[136:139], a[8:11], v[32:35], a[136:139]
    v_mul_f32 v89, v89, v87
    v_mul_f32 v90, v90, v87
    v_mul_f32 v91, v91, v87
    v_mfma_f32_16x16x32_bf16 a[144:147], a[8:11], v[40:43], a[144:147]
    ds_read_b64_tr_b16 a[26:27], v1 offset:43008
    v_mul_f32 v92, v92, v87
    v_mfma_f32_16x16x32_bf16 a[152:155], a[8:11], v[48:51], a[152:155]
    v_mul_f32 v93, v93, v87
    v_mul_f32 v94, v94, v87
    s_waitcnt lgkmcnt(6)
    v_mfma_f32_16x16x32_bf16 a[132:135], a[12:15], v[24:27], a[132:135]
    ds_read_b64_tr_b16 a[28:29], v2 offset:40960
    v_mul_f32 v95, v95, v87
    v_mfma_f32_16x16x32_bf16 a[140:143], a[12:15], v[32:35], a[140:143]
    v_cvt_pk_bf16_f32 v108, v88, v89
    v_cvt_pk_bf16_f32 v109, v90, v91
    v_mfma_f32_16x16x32_bf16 a[148:151], a[12:15], v[40:43], a[148:151]
    ds_read_b64_tr_b16 a[30:31], v2 offset:43008
    v_cvt_pk_bf16_f32 v110, v92, v93
    v_mfma_f32_16x16x32_bf16 a[156:159], a[12:15], v[48:51], a[156:159]
    v_cvt_pk_bf16_f32 v111, v94, v95
    s_waitcnt lgkmcnt(6)
    v_mfma_f32_16x16x32_bf16 a[128:131], a[16:19], v[208:211], a[128:131]
    ds_read_b64_tr_b16 a[0:1], v1 offset:4096
    buffer_store_dwordx4 v[108:111], v8, s[28:31], s6 offen offset:0 sc1
    v_mfma_f32_16x16x32_bf16 a[136:139], a[16:19], v[212:215], a[136:139]
    v_accvgpr_read_b32 v88, a96
    v_accvgpr_read_b32 v89, a97
    v_mfma_f32_16x16x32_bf16 a[144:147], a[16:19], v[216:219], a[144:147]
    ds_read_b64_tr_b16 a[2:3], v1 offset:6144
    v_accvgpr_read_b32 v90, a98
    v_mfma_f32_16x16x32_bf16 a[152:155], a[16:19], v[220:223], a[152:155]
    v_accvgpr_read_b32 v91, a99
    v_accvgpr_read_b32 v92, a100
    s_waitcnt lgkmcnt(6)
    v_mfma_f32_16x16x32_bf16 a[132:135], a[20:23], v[208:211], a[132:135]
    ds_read_b64_tr_b16 a[4:5], v2 offset:4096
    v_accvgpr_read_b32 v93, a101
    v_mfma_f32_16x16x32_bf16 a[140:143], a[20:23], v[212:215], a[140:143]
    v_accvgpr_read_b32 v94, a102
    v_accvgpr_read_b32 v95, a103
    v_mfma_f32_16x16x32_bf16 a[148:151], a[20:23], v[216:219], a[148:151]
    ds_read_b64_tr_b16 a[6:7], v2 offset:6144
    v_mul_f32 v88, v88, v84
    v_mfma_f32_16x16x32_bf16 a[156:159], a[20:23], v[220:223], a[156:159]
    v_mul_f32 v89, v89, v84
    v_mul_f32 v90, v90, v84
    s_waitcnt lgkmcnt(6)
    v_mfma_f32_16x16x32_bf16 a[128:131], a[24:27], v[240:243], a[128:131]
    ds_read_b64_tr_b16 a[8:9], v3 offset:53248
    v_mul_f32 v91, v91, v84
    v_mfma_f32_16x16x32_bf16 a[136:139], a[24:27], v[244:247], a[136:139]
    v_mul_f32 v92, v92, v84
    v_mul_f32 v93, v93, v84
    v_mfma_f32_16x16x32_bf16 a[144:147], a[24:27], v[248:251], a[144:147]
    ds_read_b64_tr_b16 a[10:11], v3 offset:55296
    v_mul_f32 v94, v94, v84
    v_mfma_f32_16x16x32_bf16 a[152:155], a[24:27], v[252:255], a[152:155]
    v_mul_f32 v95, v95, v84
    v_cvt_pk_bf16_f32 v112, v88, v89
    s_waitcnt lgkmcnt(6)
    v_mfma_f32_16x16x32_bf16 a[132:135], a[28:31], v[240:243], a[132:135]
    ds_read_b64_tr_b16 a[12:13], v4 offset:53248
    v_cvt_pk_bf16_f32 v113, v90, v91
    v_mfma_f32_16x16x32_bf16 a[140:143], a[28:31], v[244:247], a[140:143]
    v_cvt_pk_bf16_f32 v114, v92, v93
    v_cvt_pk_bf16_f32 v115, v94, v95
    v_mfma_f32_16x16x32_bf16 a[148:151], a[28:31], v[248:251], a[148:151]
    ds_read_b64_tr_b16 a[14:15], v4 offset:55296
    buffer_store_dwordx4 v[112:115], v8, s[28:31], 0 offen offset:1024 sc1
    v_mfma_f32_16x16x32_bf16 a[156:159], a[28:31], v[252:255], a[156:159]
    v_accvgpr_read_b32 v88, a104
    s_waitcnt lgkmcnt(6)
    v_mfma_f32_16x16x32_bf16 a[128:131], a[0:3], v[28:31], a[128:131]
    ds_read_b64_tr_b16 a[16:17], v3 offset:16384
    v_accvgpr_read_b32 v89, a105
    v_mfma_f32_16x16x32_bf16 a[136:139], a[0:3], v[36:39], a[136:139]
    v_accvgpr_read_b32 v90, a106
    v_accvgpr_read_b32 v91, a107
    v_mfma_f32_16x16x32_bf16 a[144:147], a[0:3], v[44:47], a[144:147]
    ds_read_b64_tr_b16 a[18:19], v3 offset:18432
    v_accvgpr_read_b32 v92, a108
    v_mfma_f32_16x16x32_bf16 a[152:155], a[0:3], v[52:55], a[152:155]
    v_accvgpr_read_b32 v93, a109
    v_accvgpr_read_b32 v94, a110
    s_waitcnt lgkmcnt(6)
    v_mfma_f32_16x16x32_bf16 a[132:135], a[4:7], v[28:31], a[132:135]
    ds_read_b64_tr_b16 a[20:21], v4 offset:16384
    v_accvgpr_read_b32 v95, a111
    v_mfma_f32_16x16x32_bf16 a[140:143], a[4:7], v[36:39], a[140:143]
    v_mul_f32 v88, v88, v85
    v_mul_f32 v89, v89, v85
    v_mfma_f32_16x16x32_bf16 a[148:151], a[4:7], v[44:47], a[148:151]
    ds_read_b64_tr_b16 a[22:23], v4 offset:18432
    v_mul_f32 v90, v90, v85
    v_mfma_f32_16x16x32_bf16 a[156:159], a[4:7], v[52:55], a[156:159]
    v_mul_f32 v91, v91, v85
    v_mul_f32 v92, v92, v85
    s_waitcnt lgkmcnt(6)
    v_mfma_f32_16x16x32_bf16 a[160:163], a[8:11], v[56:59], a[160:163]
    ds_read_b64_tr_b16 a[24:25], v3 offset:28672
    v_mul_f32 v93, v93, v85
    v_mfma_f32_16x16x32_bf16 a[168:171], a[8:11], v[64:67], a[168:171]
    v_mul_f32 v94, v94, v85
    v_mul_f32 v95, v95, v85
    v_mfma_f32_16x16x32_bf16 a[176:179], a[8:11], v[72:75], a[176:179]
    ds_read_b64_tr_b16 a[26:27], v3 offset:30720
    v_cvt_pk_bf16_f32 v116, v88, v89
    v_mfma_f32_16x16x32_bf16 a[184:187], a[8:11], v[80:83], a[184:187]
    v_cvt_pk_bf16_f32 v117, v90, v91
    v_cvt_pk_bf16_f32 v118, v92, v93
    s_waitcnt lgkmcnt(6)
    v_mfma_f32_16x16x32_bf16 a[164:167], a[12:15], v[56:59], a[164:167]
    ds_read_b64_tr_b16 a[28:29], v4 offset:28672
    v_cvt_pk_bf16_f32 v119, v94, v95
    v_mfma_f32_16x16x32_bf16 a[172:175], a[12:15], v[64:67], a[172:175]
    buffer_store_dwordx4 v[116:119], v8, s[28:31], s4 offen offset:1024 sc1
    v_mfma_f32_16x16x32_bf16 a[180:183], a[12:15], v[72:75], a[180:183]
    ds_read_b64_tr_b16 a[30:31], v4 offset:30720
    v_accvgpr_read_b32 v88, a112
    v_mfma_f32_16x16x32_bf16 a[188:191], a[12:15], v[80:83], a[188:191]
    v_accvgpr_read_b32 v89, a113
    v_accvgpr_read_b32 v90, a114
    s_waitcnt lgkmcnt(6)
    v_mfma_f32_16x16x32_bf16 a[160:163], a[16:19], v[24:27], a[160:163]
    ds_read_b64_tr_b16 a[0:1], v3 offset:40960
    v_accvgpr_read_b32 v91, a115
    v_mfma_f32_16x16x32_bf16 a[168:171], a[16:19], v[32:35], a[168:171]
    v_accvgpr_read_b32 v92, a116
    v_accvgpr_read_b32 v93, a117
    v_mfma_f32_16x16x32_bf16 a[176:179], a[16:19], v[40:43], a[176:179]
    ds_read_b64_tr_b16 a[2:3], v3 offset:43008
    v_accvgpr_read_b32 v94, a118
    v_mfma_f32_16x16x32_bf16 a[184:187], a[16:19], v[48:51], a[184:187]
    v_accvgpr_read_b32 v95, a119
    v_mul_f32 v88, v88, v86
    s_waitcnt lgkmcnt(6)
    v_mfma_f32_16x16x32_bf16 a[164:167], a[20:23], v[24:27], a[164:167]
    ds_read_b64_tr_b16 a[4:5], v4 offset:40960
    v_mul_f32 v89, v89, v86
    v_mul_f32 v90, v90, v86
    v_mfma_f32_16x16x32_bf16 a[172:175], a[20:23], v[32:35], a[172:175]
    v_mul_f32 v91, v91, v86
    v_mul_f32 v92, v92, v86
    v_mfma_f32_16x16x32_bf16 a[180:183], a[20:23], v[40:43], a[180:183]
    ds_read_b64_tr_b16 a[6:7], v4 offset:43008
    v_mul_f32 v93, v93, v86
    v_mfma_f32_16x16x32_bf16 a[188:191], a[20:23], v[48:51], a[188:191]
    v_mul_f32 v94, v94, v86
    v_mul_f32 v95, v95, v86
    s_waitcnt lgkmcnt(6)
    v_mfma_f32_16x16x32_bf16 a[160:163], a[24:27], v[208:211], a[160:163]
    ds_read_b64_tr_b16 a[8:9], v3 offset:4096
    v_cvt_pk_bf16_f32 v120, v88, v89
    v_mfma_f32_16x16x32_bf16 a[168:171], a[24:27], v[212:215], a[168:171]
    v_cvt_pk_bf16_f32 v121, v90, v91
    v_cvt_pk_bf16_f32 v122, v92, v93
    v_mfma_f32_16x16x32_bf16 a[176:179], a[24:27], v[216:219], a[176:179]
    ds_read_b64_tr_b16 a[10:11], v3 offset:6144
    v_cvt_pk_bf16_f32 v123, v94, v95
    v_mfma_f32_16x16x32_bf16 a[184:187], a[24:27], v[220:223], a[184:187]
    buffer_store_dwordx4 v[120:123], v8, s[28:31], s5 offen offset:1024 sc1
    s_waitcnt lgkmcnt(6)
    v_mfma_f32_16x16x32_bf16 a[164:167], a[28:31], v[208:211], a[164:167]
    ds_read_b64_tr_b16 a[12:13], v4 offset:4096
    v_accvgpr_read_b32 v88, a120
    v_mfma_f32_16x16x32_bf16 a[172:175], a[28:31], v[212:215], a[172:175]
    v_accvgpr_read_b32 v89, a121
    v_accvgpr_read_b32 v90, a122
    v_mfma_f32_16x16x32_bf16 a[180:183], a[28:31], v[216:219], a[180:183]
    ds_read_b64_tr_b16 a[14:15], v4 offset:6144
    v_accvgpr_read_b32 v91, a123
    v_mfma_f32_16x16x32_bf16 a[188:191], a[28:31], v[220:223], a[188:191]
    v_accvgpr_read_b32 v92, a124
    v_accvgpr_read_b32 v93, a125
    s_waitcnt lgkmcnt(6)
    v_mfma_f32_16x16x32_bf16 a[160:163], a[0:3], v[240:243], a[160:163]
    ds_read_b64_tr_b16 a[16:17], v1 offset:57344
    v_accvgpr_read_b32 v94, a126
    v_mfma_f32_16x16x32_bf16 a[168:171], a[0:3], v[244:247], a[168:171]
    v_accvgpr_read_b32 v95, a127
    v_mul_f32 v88, v88, v87
    v_mfma_f32_16x16x32_bf16 a[176:179], a[0:3], v[248:251], a[176:179]
    ds_read_b64_tr_b16 a[18:19], v1 offset:59392
    v_mul_f32 v89, v89, v87
    v_mul_f32 v90, v90, v87
    v_mfma_f32_16x16x32_bf16 a[184:187], a[0:3], v[252:255], a[184:187]
    v_mul_f32 v91, v91, v87
    v_mul_f32 v92, v92, v87
    s_waitcnt lgkmcnt(6)
    v_mfma_f32_16x16x32_bf16 a[164:167], a[4:7], v[240:243], a[164:167]
    ds_read_b64_tr_b16 a[20:21], v2 offset:57344
    v_mul_f32 v93, v93, v87
    v_mfma_f32_16x16x32_bf16 a[172:175], a[4:7], v[244:247], a[172:175]
    v_mul_f32 v94, v94, v87
    v_mul_f32 v95, v95, v87
    v_mfma_f32_16x16x32_bf16 a[180:183], a[4:7], v[248:251], a[180:183]
    ds_read_b64_tr_b16 a[22:23], v2 offset:59392
    v_cvt_pk_bf16_f32 v124, v88, v89
    v_mfma_f32_16x16x32_bf16 a[188:191], a[4:7], v[252:255], a[188:191]
    v_cvt_pk_bf16_f32 v125, v90, v91
    v_cvt_pk_bf16_f32 v126, v92, v93
    s_waitcnt lgkmcnt(6)
    v_mfma_f32_16x16x32_bf16 a[160:163], a[8:11], v[28:31], a[160:163]
    ds_read_b64_tr_b16 a[24:25], v1 offset:20480
    v_cvt_pk_bf16_f32 v127, v94, v95
    v_mfma_f32_16x16x32_bf16 a[168:171], a[8:11], v[36:39], a[168:171]
    buffer_store_dwordx4 v[124:127], v8, s[28:31], s6 offen offset:1024 sc1
    v_mfma_f32_16x16x32_bf16 a[176:179], a[8:11], v[44:47], a[176:179]
    ds_read_b64_tr_b16 a[26:27], v1 offset:22528
    v_accvgpr_read_b32 v88, a128
    v_mfma_f32_16x16x32_bf16 a[184:187], a[8:11], v[52:55], a[184:187]
    v_accvgpr_read_b32 v89, a129
    v_accvgpr_read_b32 v90, a130
    s_waitcnt lgkmcnt(6)
    v_mfma_f32_16x16x32_bf16 a[164:167], a[12:15], v[28:31], a[164:167]
    ds_read_b64_tr_b16 a[28:29], v2 offset:20480
    v_accvgpr_read_b32 v91, a131
    v_mfma_f32_16x16x32_bf16 a[172:175], a[12:15], v[36:39], a[172:175]
    v_accvgpr_read_b32 v92, a132
    v_accvgpr_read_b32 v93, a133
    v_mfma_f32_16x16x32_bf16 a[180:183], a[12:15], v[44:47], a[180:183]
    ds_read_b64_tr_b16 a[30:31], v2 offset:22528
    v_accvgpr_read_b32 v94, a134
    v_mfma_f32_16x16x32_bf16 a[188:191], a[12:15], v[52:55], a[188:191]
    v_accvgpr_read_b32 v95, a135
    v_mul_f32 v88, v88, v84
    s_waitcnt lgkmcnt(6)
    v_mfma_f32_16x16x32_bf16 a[192:195], a[16:19], v[56:59], a[192:195]
    ds_read_b64_tr_b16 a[0:1], v1 offset:32768
    v_mul_f32 v89, v89, v84
    v_mfma_f32_16x16x32_bf16 a[200:203], a[16:19], v[64:67], a[200:203]
    v_mul_f32 v90, v90, v84
    v_mul_f32 v91, v91, v84
    v_mfma_f32_16x16x32_bf16 a[208:211], a[16:19], v[72:75], a[208:211]
    ds_read_b64_tr_b16 a[2:3], v1 offset:34816
    v_mul_f32 v92, v92, v84
    v_mfma_f32_16x16x32_bf16 a[216:219], a[16:19], v[80:83], a[216:219]
    v_mul_f32 v93, v93, v84
    v_mul_f32 v94, v94, v84
    s_waitcnt lgkmcnt(6)
    v_mfma_f32_16x16x32_bf16 a[196:199], a[20:23], v[56:59], a[196:199]
    ds_read_b64_tr_b16 a[4:5], v2 offset:32768
    v_mul_f32 v95, v95, v84
    v_mfma_f32_16x16x32_bf16 a[204:207], a[20:23], v[64:67], a[204:207]
    v_cvt_pk_bf16_f32 v128, v88, v89
    v_cvt_pk_bf16_f32 v129, v90, v91
    v_mfma_f32_16x16x32_bf16 a[212:215], a[20:23], v[72:75], a[212:215]
    ds_read_b64_tr_b16 a[6:7], v2 offset:34816
    v_cvt_pk_bf16_f32 v130, v92, v93
    v_mfma_f32_16x16x32_bf16 a[220:223], a[20:23], v[80:83], a[220:223]
    v_cvt_pk_bf16_f32 v131, v94, v95
    buffer_store_dwordx4 v[128:131], v8, s[28:31], 0 offen offset:2048 sc1
    s_waitcnt lgkmcnt(6)
    v_mfma_f32_16x16x32_bf16 a[192:195], a[24:27], v[24:27], a[192:195]
    ds_read_b64_tr_b16 a[8:9], v1 offset:45056
    v_accvgpr_read_b32 v88, a136
    v_mfma_f32_16x16x32_bf16 a[200:203], a[24:27], v[32:35], a[200:203]
    v_accvgpr_read_b32 v89, a137
    v_accvgpr_read_b32 v90, a138
    v_mfma_f32_16x16x32_bf16 a[208:211], a[24:27], v[40:43], a[208:211]
    ds_read_b64_tr_b16 a[10:11], v1 offset:47104
    v_accvgpr_read_b32 v91, a139
    v_mfma_f32_16x16x32_bf16 a[216:219], a[24:27], v[48:51], a[216:219]
    v_accvgpr_read_b32 v92, a140
    v_accvgpr_read_b32 v93, a141
    s_waitcnt lgkmcnt(6)
    v_mfma_f32_16x16x32_bf16 a[196:199], a[28:31], v[24:27], a[196:199]
    ds_read_b64_tr_b16 a[12:13], v2 offset:45056
    v_accvgpr_read_b32 v94, a142
    v_mfma_f32_16x16x32_bf16 a[204:207], a[28:31], v[32:35], a[204:207]
    v_accvgpr_read_b32 v95, a143
    v_mul_f32 v88, v88, v85
    v_mfma_f32_16x16x32_bf16 a[212:215], a[28:31], v[40:43], a[212:215]
    ds_read_b64_tr_b16 a[14:15], v2 offset:47104
    v_mul_f32 v89, v89, v85
    v_mfma_f32_16x16x32_bf16 a[220:223], a[28:31], v[48:51], a[220:223]
    v_mul_f32 v90, v90, v85
    v_mul_f32 v91, v91, v85
    s_waitcnt lgkmcnt(6)
    v_mfma_f32_16x16x32_bf16 a[192:195], a[0:3], v[208:211], a[192:195]
    ds_read_b64_tr_b16 a[16:17], v1 offset:8192
    v_mul_f32 v92, v92, v85
    v_mfma_f32_16x16x32_bf16 a[200:203], a[0:3], v[212:215], a[200:203]
    v_mul_f32 v93, v93, v85
    v_mul_f32 v94, v94, v85
    v_mfma_f32_16x16x32_bf16 a[208:211], a[0:3], v[216:219], a[208:211]
    ds_read_b64_tr_b16 a[18:19], v1 offset:10240
    v_mul_f32 v95, v95, v85
    v_mfma_f32_16x16x32_bf16 a[216:219], a[0:3], v[220:223], a[216:219]
    v_cvt_pk_bf16_f32 v132, v88, v89
    v_cvt_pk_bf16_f32 v133, v90, v91
    s_waitcnt lgkmcnt(6)
    v_mfma_f32_16x16x32_bf16 a[196:199], a[4:7], v[208:211], a[196:199]
    ds_read_b64_tr_b16 a[20:21], v2 offset:8192
    v_cvt_pk_bf16_f32 v134, v92, v93
    v_mfma_f32_16x16x32_bf16 a[204:207], a[4:7], v[212:215], a[204:207]
    v_cvt_pk_bf16_f32 v135, v94, v95
    v_mfma_f32_16x16x32_bf16 a[212:215], a[4:7], v[216:219], a[212:215]
    ds_read_b64_tr_b16 a[22:23], v2 offset:10240
    buffer_store_dwordx4 v[132:135], v8, s[28:31], s4 offen offset:2048 sc1
    v_mfma_f32_16x16x32_bf16 a[220:223], a[4:7], v[220:223], a[220:223]
    v_accvgpr_read_b32 v88, a144
    v_accvgpr_read_b32 v89, a145
    s_waitcnt lgkmcnt(6)
    v_mfma_f32_16x16x32_bf16 a[192:195], a[8:11], v[240:243], a[192:195]
    ds_read_b64_tr_b16 a[24:25], v3 offset:57344
    v_accvgpr_read_b32 v90, a146
    v_mfma_f32_16x16x32_bf16 a[200:203], a[8:11], v[244:247], a[200:203]
    v_accvgpr_read_b32 v91, a147
    v_accvgpr_read_b32 v92, a148
    v_mfma_f32_16x16x32_bf16 a[208:211], a[8:11], v[248:251], a[208:211]
    ds_read_b64_tr_b16 a[26:27], v3 offset:59392
    v_accvgpr_read_b32 v93, a149
    v_mfma_f32_16x16x32_bf16 a[216:219], a[8:11], v[252:255], a[216:219]
    v_accvgpr_read_b32 v94, a150
    v_accvgpr_read_b32 v95, a151
    s_waitcnt lgkmcnt(6)
    v_mfma_f32_16x16x32_bf16 a[196:199], a[12:15], v[240:243], a[196:199]
    ds_read_b64_tr_b16 a[28:29], v4 offset:57344
    v_mul_f32 v88, v88, v86
    v_mfma_f32_16x16x32_bf16 a[204:207], a[12:15], v[244:247], a[204:207]
    v_mul_f32 v89, v89, v86
    v_mul_f32 v90, v90, v86
    v_mul_f32 v91, v91, v86
    v_mfma_f32_16x16x32_bf16 a[212:215], a[12:15], v[248:251], a[212:215]
    ds_read_b64_tr_b16 a[30:31], v4 offset:59392
    v_mul_f32 v92, v92, v86
    v_mfma_f32_16x16x32_bf16 a[220:223], a[12:15], v[252:255], a[220:223]
    v_mul_f32 v93, v93, v86
    v_mul_f32 v94, v94, v86
    s_waitcnt lgkmcnt(6)
    v_mfma_f32_16x16x32_bf16 a[192:195], a[16:19], v[28:31], a[192:195]
    ds_read_b64_tr_b16 a[0:1], v3 offset:20480
    v_mul_f32 v95, v95, v86
    v_mfma_f32_16x16x32_bf16 a[200:203], a[16:19], v[36:39], a[200:203]
    v_cvt_pk_bf16_f32 v136, v88, v89
    v_cvt_pk_bf16_f32 v137, v90, v91
    v_mfma_f32_16x16x32_bf16 a[208:211], a[16:19], v[44:47], a[208:211]
    ds_read_b64_tr_b16 a[2:3], v3 offset:22528
    v_cvt_pk_bf16_f32 v138, v92, v93
    v_mfma_f32_16x16x32_bf16 a[216:219], a[16:19], v[52:55], a[216:219]
    v_cvt_pk_bf16_f32 v139, v94, v95
    s_waitcnt lgkmcnt(6)
    v_mfma_f32_16x16x32_bf16 a[196:199], a[20:23], v[28:31], a[196:199]
    ds_read_b64_tr_b16 a[4:5], v4 offset:20480
    buffer_store_dwordx4 v[136:139], v8, s[28:31], s5 offen offset:2048 sc1
    v_mfma_f32_16x16x32_bf16 a[204:207], a[20:23], v[36:39], a[204:207]
    v_accvgpr_read_b32 v88, a152
    v_accvgpr_read_b32 v89, a153
    v_mfma_f32_16x16x32_bf16 a[212:215], a[20:23], v[44:47], a[212:215]
    ds_read_b64_tr_b16 a[6:7], v4 offset:22528
    v_accvgpr_read_b32 v90, a154
    v_mfma_f32_16x16x32_bf16 a[220:223], a[20:23], v[52:55], a[220:223]
    v_accvgpr_read_b32 v91, a155
    v_accvgpr_read_b32 v92, a156
    s_waitcnt lgkmcnt(6)
    v_mfma_f32_16x16x32_bf16 a[224:227], a[24:27], v[56:59], a[224:227]
    ds_read_b64_tr_b16 a[8:9], v3 offset:32768
    v_accvgpr_read_b32 v93, a157
    v_mfma_f32_16x16x32_bf16 a[232:235], a[24:27], v[64:67], a[232:235]
    v_accvgpr_read_b32 v94, a158
    v_accvgpr_read_b32 v95, a159
    v_mfma_f32_16x16x32_bf16 a[240:243], a[24:27], v[72:75], a[240:243]
    ds_read_b64_tr_b16 a[10:11], v3 offset:34816
    v_mul_f32 v88, v88, v87
    v_mfma_f32_16x16x32_bf16 a[248:251], a[24:27], v[80:83], a[248:251]
    v_mul_f32 v89, v89, v87
    v_mul_f32 v90, v90, v87
    v_mul_f32 v91, v91, v87
    s_waitcnt lgkmcnt(6)
    v_mfma_f32_16x16x32_bf16 a[228:231], a[28:31], v[56:59], a[228:231]
    ds_read_b64_tr_b16 a[12:13], v4 offset:32768
    v_mul_f32 v92, v92, v87
    v_mfma_f32_16x16x32_bf16 a[236:239], a[28:31], v[64:67], a[236:239]
    v_mul_f32 v93, v93, v87
    v_mul_f32 v94, v94, v87
    v_mfma_f32_16x16x32_bf16 a[244:247], a[28:31], v[72:75], a[244:247]
    ds_read_b64_tr_b16 a[14:15], v4 offset:34816
    v_mul_f32 v95, v95, v87
    v_mfma_f32_16x16x32_bf16 a[252:255], a[28:31], v[80:83], a[252:255]
    v_cvt_pk_bf16_f32 v140, v88, v89
    v_cvt_pk_bf16_f32 v141, v90, v91
    s_waitcnt lgkmcnt(6)
    v_mfma_f32_16x16x32_bf16 a[224:227], a[0:3], v[24:27], a[224:227]
    ds_read_b64_tr_b16 a[16:17], v3 offset:45056
    v_cvt_pk_bf16_f32 v142, v92, v93
    v_mfma_f32_16x16x32_bf16 a[232:235], a[0:3], v[32:35], a[232:235]
    v_cvt_pk_bf16_f32 v143, v94, v95
    v_mfma_f32_16x16x32_bf16 a[240:243], a[0:3], v[40:43], a[240:243]
    ds_read_b64_tr_b16 a[18:19], v3 offset:47104
    buffer_store_dwordx4 v[140:143], v8, s[28:31], s6 offen offset:2048 sc1
    v_mfma_f32_16x16x32_bf16 a[248:251], a[0:3], v[48:51], a[248:251]
    v_accvgpr_read_b32 v88, a160
    v_accvgpr_read_b32 v89, a161
    s_waitcnt lgkmcnt(6)
    v_mfma_f32_16x16x32_bf16 a[228:231], a[4:7], v[24:27], a[228:231]
    ds_read_b64_tr_b16 a[20:21], v4 offset:45056
    v_accvgpr_read_b32 v90, a162
    v_mfma_f32_16x16x32_bf16 a[236:239], a[4:7], v[32:35], a[236:239]
    v_accvgpr_read_b32 v91, a163
    v_accvgpr_read_b32 v92, a164
    v_mfma_f32_16x16x32_bf16 a[244:247], a[4:7], v[40:43], a[244:247]
    ds_read_b64_tr_b16 a[22:23], v4 offset:47104
    s_and_b32 s51, s2, 0xe7
    s_lshl_b32 s51, s51, 8
    s_add_u32 s51, s51, 8192
    v_and_b32 v0, 0x180, v8
    v_mfma_f32_16x16x32_bf16 a[252:255], a[4:7], v[48:51], a[252:255]
    v_accvgpr_read_b32 v93, a165
    s_waitcnt lgkmcnt(6)
    v_mfma_f32_16x16x32_bf16 a[224:227], a[8:11], v[208:211], a[224:227]
    ds_read_b64_tr_b16 a[24:25], v3 offset:8192
    v_lshlrev_b32 v0, 4, v0
    v_mfma_f32_16x16x32_bf16 a[232:235], a[8:11], v[212:215], a[232:235]
    v_accvgpr_read_b32 v94, a166
    v_accvgpr_read_b32 v95, a167
    v_mfma_f32_16x16x32_bf16 a[240:243], a[8:11], v[216:219], a[240:243]
    ds_read_b64_tr_b16 a[26:27], v3 offset:10240
    v_mov_b32 v12, 3
    v_mfma_f32_16x16x32_bf16 a[248:251], a[8:11], v[220:223], a[248:251]
    v_mul_f32 v88, v88, v84
    v_mul_f32 v89, v89, v84
    s_waitcnt lgkmcnt(6)
    v_mfma_f32_16x16x32_bf16 a[228:231], a[12:15], v[208:211], a[228:231]
    ds_read_b64_tr_b16 a[28:29], v4 offset:8192
    s_waitcnt vmcnt(4)
    s_barrier
    buffer_store_dword v12, v14, s[76:79], s0 offen sc1
    v_mfma_f32_16x16x32_bf16 a[236:239], a[12:15], v[212:215], a[236:239]
    v_mul_f32 v90, v90, v84
    v_mfma_f32_16x16x32_bf16 a[244:247], a[12:15], v[216:219], a[244:247]
    ds_read_b64_tr_b16 a[30:31], v4 offset:10240
    v_mul_f32 v91, v91, v84
    v_mfma_f32_16x16x32_bf16 a[252:255], a[12:15], v[220:223], a[252:255]
    v_mul_f32 v92, v92, v84
    v_mul_f32 v93, v93, v84
    s_waitcnt lgkmcnt(6)
    v_mfma_f32_16x16x32_bf16 a[224:227], a[16:19], v[240:243], a[224:227]
    v_mul_f32 v94, v94, v84
    v_mul_f32 v95, v95, v84
    v_mfma_f32_16x16x32_bf16 a[232:235], a[16:19], v[244:247], a[232:235]
    v_cvt_pk_bf16_f32 v144, v88, v89
    v_mfma_f32_16x16x32_bf16 a[240:243], a[16:19], v[248:251], a[240:243]
    v_cvt_pk_bf16_f32 v145, v90, v91
    v_cvt_pk_bf16_f32 v146, v92, v93
    v_mfma_f32_16x16x32_bf16 a[248:251], a[16:19], v[252:255], a[248:251]
    v_cvt_pk_bf16_f32 v147, v94, v95
    buffer_store_dwordx4 v[144:147], v8, s[28:31], 0 offen offset:3072 sc1
    s_waitcnt lgkmcnt(4)
    v_mfma_f32_16x16x32_bf16 a[228:231], a[20:23], v[240:243], a[228:231]
    v_accvgpr_read_b32 v88, a168
    v_mfma_f32_16x16x32_bf16 a[236:239], a[20:23], v[244:247], a[236:239]
    v_accvgpr_read_b32 v89, a169
    v_accvgpr_read_b32 v90, a170
    v_mfma_f32_16x16x32_bf16 a[244:247], a[20:23], v[248:251], a[244:247]
    v_accvgpr_read_b32 v91, a171
    v_accvgpr_read_b32 v92, a172
    v_mfma_f32_16x16x32_bf16 a[252:255], a[20:23], v[252:255], a[252:255]
    v_accvgpr_read_b32 v93, a173
    v_accvgpr_read_b32 v94, a174
    s_waitcnt lgkmcnt(2)
    v_mfma_f32_16x16x32_bf16 a[224:227], a[24:27], v[28:31], a[224:227]
    v_accvgpr_read_b32 v95, a175
    v_mul_f32 v88, v88, v85
    v_mfma_f32_16x16x32_bf16 a[232:235], a[24:27], v[36:39], a[232:235]
    v_mul_f32 v89, v89, v85
    v_mul_f32 v90, v90, v85
    v_mfma_f32_16x16x32_bf16 a[240:243], a[24:27], v[44:47], a[240:243]
    v_mul_f32 v91, v91, v85
    v_mul_f32 v92, v92, v85
    v_mfma_f32_16x16x32_bf16 a[248:251], a[24:27], v[52:55], a[248:251]
    v_mul_f32 v93, v93, v85
    s_waitcnt lgkmcnt(0)
    v_mfma_f32_16x16x32_bf16 a[228:231], a[28:31], v[28:31], a[228:231]
    v_mul_f32 v94, v94, v85
    v_mul_f32 v95, v95, v85
    v_mfma_f32_16x16x32_bf16 a[236:239], a[28:31], v[36:39], a[236:239]
    v_cvt_pk_bf16_f32 v148, v88, v89
    v_cvt_pk_bf16_f32 v149, v90, v91
    v_mfma_f32_16x16x32_bf16 a[244:247], a[28:31], v[44:47], a[244:247]
    v_cvt_pk_bf16_f32 v150, v92, v93
    v_cvt_pk_bf16_f32 v151, v94, v95
    v_mfma_f32_16x16x32_bf16 a[252:255], a[28:31], v[52:55], a[252:255]
    buffer_store_dwordx4 v[148:151], v8, s[28:31], s4 offen offset:3072 sc1
    v_add_u32 v1, 98816, v8
    v_add_u32 v2, 4096, v8
    s_barrier
    ds_read_b128 a[0:3], v1 offset:0
    ds_read_b128 a[4:7], v1 offset:1024
    ds_read_b128 a[8:11], v1 offset:2048
    ds_read_b128 a[12:15], v1 offset:3072
    ds_read_b128 a[16:19], v1 offset:4096
    ds_read_b128 a[20:23], v1 offset:5120
    ds_read_b128 a[24:27], v1 offset:6144
    s_waitcnt lgkmcnt(3)
    v_mfma_f32_16x16x32_bf16 a[64:67], a[0:3], v[96:99], 0
    ds_read_b128 a[28:31], v1 offset:7168
    s_lshr_b32 s3, s2, 5
    s_mul_i32 s49, s3, 245760
    s_mul_i32 s3, s32, 61440
    s_add_u32 s49, s49, s3
    v_accvgpr_read_b32 v88, a176
    v_accvgpr_read_b32 v89, a177
    v_mfma_f32_16x16x32_bf16 a[72:75], a[0:3], v[100:103], 0
    s_add_u32 s49, s49, 88080384
    s_add_u32 s56, s10, s49
    s_addc_u32 s57, s11, 0
    s_mov_b32 s58, 61440
    v_accvgpr_read_b32 v90, a178
    v_mfma_f32_16x16x32_bf16 a[80:83], a[0:3], v[104:107], 0
    s_mov_b32 s59, 0x00020000
    s_and_b32 s3, s2, 1
    s_lshr_b32 s42, s2, 5
    s_lshl_b32 s44, s42, 3
    v_accvgpr_read_b32 v91, a179
    v_accvgpr_read_b32 v92, a180
    v_mfma_f32_16x16x32_bf16 a[88:91], a[0:3], v[108:111], 0
    s_add_u32 s44, s44, s3
    s_and_b32 s42, s2, 0xe1
    s_lshl_b32 s42, s42, 8
    s_add_u32 s42, s42, 8192
    v_accvgpr_read_b32 v93, a181
    v_mfma_f32_16x16x32_bf16 a[68:71], a[4:7], v[96:99], 0
    ds_read_b128 a[0:3], v1 offset:8192
    s_bfe_u32 s3, s2, 0x20001
    s_add_u32 s75, s75, 4096
    s_bfe_u32 s43, s2, 0x20003
    s_lshl_b32 s46, s3, 1
    v_accvgpr_read_b32 v94, a182
    v_mfma_f32_16x16x32_bf16 a[76:79], a[4:7], v[100:103], 0
    s_add_u32 s46, s46, s44
    s_lshl_b32 s46, s46, 2
    s_add_u32 s46, s46, s43
    s_mul_i32 s47, s46, 10240
    v_accvgpr_read_b32 v95, a183
    v_mul_f32 v88, v88, v86
    v_mfma_f32_16x16x32_bf16 a[84:87], a[4:7], v[104:107], 0
    s_add_u32 s84, s100, s47
    s_addc_u32 s85, s101, 0
    s_mov_b32 s86, 10240
    s_mov_b32 s87, 0x00020000
    v_mul_f32 v89, v89, v86
    v_mfma_f32_16x16x32_bf16 a[92:95], a[4:7], v[108:111], 0
    s_mov_b32 s88, s10
    s_mov_b32 s89, s11
    s_mov_b32 s90, 15360
    s_mov_b32 s91, 0x00020000
    v_mul_f32 v90, v90, v86
    v_mul_f32 v91, v91, v86
    v_mfma_f32_16x16x32_bf16 v[192:195], a[8:11], v[96:99], 0
    ds_read_b128 a[4:7], v1 offset:9216
    s_lshr_b32 s47, s46, 1
    s_mul_i32 s45, s47, 20480
    s_and_b32 s46, s46, 1
    s_lshl_b32 s46, s46, 7
    v_mul_f32 v92, v92, v86
    v_mfma_f32_16x16x32_bf16 v[200:203], a[8:11], v[100:103], 0
    s_add_u32 s45, s45, s46
    s_lshl_b32 s46, s32, 1
    s_add_u32 s44, s44, s46
    s_and_b32 s46, s2, 7
    v_mul_f32 v93, v93, v86
    v_mfma_f32_16x16x32_bf16 v[208:211], a[8:11], v[104:107], 0
    s_mul_i32 s46, s46, 2621440
    s_lshr_b32 s47, s44, 1
    s_mul_i32 s47, s47, 81920
    s_add_u32 s46, s46, s47
    v_mul_f32 v94, v94, v86
    v_mul_f32 v95, v95, v86
    v_mfma_f32_16x16x32_bf16 v[216:219], a[8:11], v[108:111], 0
    s_mul_i32 s47, s43, 5120
    s_add_u32 s46, s46, s47
    s_add_u32 s46, s46, 33554432
    s_add_u32 s16, s10, s46
    s_addc_u32 s17, s11, 0
    v_cvt_pk_bf16_f32 v152, v88, v89
    v_mfma_f32_16x16x32_bf16 v[196:199], a[12:15], v[96:99], 0
    ds_read_b128 a[8:11], v1 offset:10240
    s_mov_b32 s18, 66560
    s_mov_b32 s19, 0x00020000
    s_add_u32 s96, s43, 1
    s_and_b32 s96, s96, 3
    v_cvt_pk_bf16_f32 v153, v90, v91
    v_cvt_pk_bf16_f32 v154, v92, v93
    v_mfma_f32_16x16x32_bf16 v[204:207], a[12:15], v[100:103], 0
    s_xor_b32 s97, s43, 2
    s_xor_b32 s98, s96, 2
    s_mulk_i32 s96, 6144
    s_mulk_i32 s97, 6144
    v_cvt_pk_bf16_f32 v155, v94, v95
    v_mfma_f32_16x16x32_bf16 v[212:215], a[12:15], v[104:107], 0
    s_mulk_i32 s98, 6144
    v_add_u32 v80, s96, v8
    v_add_u32 v81, s97, v8
    v_add_u32 v82, s98, v8
    buffer_store_dwordx4 v[152:155], v8, s[28:31], s5 offen offset:3072 sc1
    v_mfma_f32_16x16x32_bf16 v[220:223], a[12:15], v[108:111], 0
    s_mulk_i32 s96, 10
    s_mulk_i32 s97, 10
    s_mulk_i32 s98, 10
    s_movk_i32 s72, 20480
    v_accvgpr_read_b32 v88, a184
    v_accvgpr_read_b32 v89, a185
    s_waitcnt lgkmcnt(3)
    v_mfma_f32_16x16x32_bf16 v[224:227], a[16:19], v[96:99], 0
    ds_read_b128 a[12:15], v1 offset:11264
    s_mov_b32 s73, 40960
    s_mov_b32 s74, 61440
    s_lshl_b32 s3, s3, 2
    s_add_u32 s43, s43, s3
    v_accvgpr_read_b32 v90, a186
    v_mfma_f32_16x16x32_bf16 v[232:235], a[16:19], v[100:103], 0
    s_mul_i32 s46, s32, 3072
    s_add_u32 s46, s46, 5120
    s_mul_i32 s49, s32, 160
    v_accvgpr_read_b32 v91, a187
    v_accvgpr_read_b32 v92, a188
    v_mfma_f32_16x16x32_bf16 v[240:243], a[16:19], v[104:107], 0
    v_accvgpr_read_b32 v93, a189
    v_mfma_f32_16x16x32_bf16 v[248:251], a[16:19], v[108:111], 0
    v_accvgpr_read_b32 v94, a190
    v_mfma_f32_16x16x32_bf16 v[228:231], a[20:23], v[96:99], 0
    ds_read_b128 a[16:19], v1 offset:12288
    s_add_u32 m0, s37, 0
    v_accvgpr_read_b32 v95, a191
    v_mul_f32 v88, v88, v87
    v_mfma_f32_16x16x32_bf16 v[236:239], a[20:23], v[100:103], 0
    s_add_u32 s35, s96, 0
    buffer_load_dwordx4 v8, s[12:15], s35 offen offset:0 sc1 lds
    v_mul_f32 v89, v89, v87
    v_mfma_f32_16x16x32_bf16 v[244:247], a[20:23], v[104:107], 0
    v_mul_f32 v90, v90, v87
    v_mul_f32 v91, v91, v87
    v_mfma_f32_16x16x32_bf16 v[252:255], a[20:23], v[108:111], 0
    v_mul_f32 v92, v92, v87
    v_mfma_f32_16x16x32_bf16 v[48:51], a[24:27], v[96:99], 0
    ds_read_b128 a[20:23], v1 offset:13312
    v_mul_f32 v93, v93, v87
    v_mfma_f32_16x16x32_bf16 v[56:59], a[24:27], v[100:103], 0
    v_mul_f32 v94, v94, v87
    v_mul_f32 v95, v95, v87
    v_mfma_f32_16x16x32_bf16 v[64:67], a[24:27], v[104:107], 0
    v_cvt_pk_bf16_f32 v156, v88, v89
    v_mfma_f32_16x16x32_bf16 v[72:75], a[24:27], v[108:111], 0
    v_cvt_pk_bf16_f32 v157, v90, v91
    v_cvt_pk_bf16_f32 v158, v92, v93
    v_mfma_f32_16x16x32_bf16 v[52:55], a[28:31], v[96:99], 0
    ds_read_b128 a[24:27], v1 offset:14336
    v_cvt_pk_bf16_f32 v159, v94, v95
    v_mfma_f32_16x16x32_bf16 v[60:63], a[28:31], v[100:103], 0
    buffer_load_dwordx4 v8, s[12:15], s35 offen offset:1024 sc1 lds
    buffer_store_dwordx4 v[156:159], v8, s[28:31], s6 offen offset:3072 sc1
    v_mfma_f32_16x16x32_bf16 v[68:71], a[28:31], v[104:107], 0
    v_accvgpr_read_b32 v88, a192
    v_accvgpr_read_b32 v89, a193
    v_mfma_f32_16x16x32_bf16 v[76:79], a[28:31], v[108:111], 0
    v_accvgpr_read_b32 v90, a194
    s_waitcnt lgkmcnt(3)
    v_mfma_f32_16x16x32_bf16 v[16:19], a[0:3], v[96:99], 0
    ds_read_b128 a[28:31], v1 offset:15360
    v_accvgpr_read_b32 v91, a195
    v_accvgpr_read_b32 v92, a196
    v_mfma_f32_16x16x32_bf16 v[24:27], a[0:3], v[100:103], 0
    v_accvgpr_read_b32 v93, a197
    v_mfma_f32_16x16x32_bf16 v[32:35], a[0:3], v[104:107], 0
    v_accvgpr_read_b32 v94, a198
    v_mfma_f32_16x16x32_bf16 v[40:43], a[0:3], v[108:111], 0
    v_accvgpr_read_b32 v95, a199
    v_mul_f32 v88, v88, v84
    v_mfma_f32_16x16x32_bf16 v[20:23], a[4:7], v[96:99], 0
    ds_read_b128 a[0:3], v1 offset:16384
    v_mul_f32 v89, v89, v84
    v_mfma_f32_16x16x32_bf16 v[28:31], a[4:7], v[100:103], 0
    buffer_load_dwordx4 v8, s[12:15], s35 offen offset:2048 sc1 lds
    v_mul_f32 v90, v90, v84
    v_mul_f32 v91, v91, v84
    v_mfma_f32_16x16x32_bf16 v[36:39], a[4:7], v[104:107], 0
    v_mul_f32 v92, v92, v84
    v_mfma_f32_16x16x32_bf16 v[44:47], a[4:7], v[108:111], 0
    v_mul_f32 v93, v93, v84
    v_mfma_f32_16x16x32_bf16 a[64:67], a[8:11], v[112:115], a[64:67]
    ds_read_b128 a[4:7], v1 offset:17408
    v_mul_f32 v94, v94, v84
    v_mul_f32 v95, v95, v84
    v_mfma_f32_16x16x32_bf16 a[72:75], a[8:11], v[116:119], a[72:75]
    v_cvt_pk_bf16_f32 v160, v88, v89
    v_mfma_f32_16x16x32_bf16 a[80:83], a[8:11], v[120:123], a[80:83]
    v_cvt_pk_bf16_f32 v161, v90, v91
    v_cvt_pk_bf16_f32 v162, v92, v93
    v_mfma_f32_16x16x32_bf16 a[88:91], a[8:11], v[124:127], a[88:91]
    v_cvt_pk_bf16_f32 v163, v94, v95
    v_mfma_f32_16x16x32_bf16 a[68:71], a[12:15], v[112:115], a[68:71]
    ds_read_b128 a[8:11], v1 offset:18432
    buffer_store_dwordx4 v[160:163], v9, s[28:31], 0 offen offset:0 sc1
    v_mfma_f32_16x16x32_bf16 a[76:79], a[12:15], v[116:119], a[76:79]
    buffer_load_dwordx4 v8, s[12:15], s35 offen offset:3072 sc1 lds
    v_accvgpr_read_b32 v88, a200
    v_accvgpr_read_b32 v89, a201
    v_mfma_f32_16x16x32_bf16 a[84:87], a[12:15], v[120:123], a[84:87]
    v_accvgpr_read_b32 v90, a202
    v_mfma_f32_16x16x32_bf16 a[92:95], a[12:15], v[124:127], a[92:95]
    v_accvgpr_read_b32 v91, a203
    v_accvgpr_read_b32 v92, a204
    s_waitcnt lgkmcnt(3)
    v_mfma_f32_16x16x32_bf16 v[192:195], a[16:19], v[112:115], v[192:195]
    ds_read_b128 a[12:15], v1 offset:19456
    v_accvgpr_read_b32 v93, a205
    v_mfma_f32_16x16x32_bf16 v[200:203], a[16:19], v[116:119], v[200:203]
    v_accvgpr_read_b32 v94, a206
    v_mfma_f32_16x16x32_bf16 v[208:211], a[16:19], v[120:123], v[208:211]
    buffer_load_dword v11, v0, s[76:79], s51 offen sc1
    v_accvgpr_read_b32 v95, a207
    v_mul_f32 v88, v88, v85
    v_mfma_f32_16x16x32_bf16 v[216:219], a[16:19], v[124:127], v[216:219]
    v_mul_f32 v89, v89, v85
    v_mfma_f32_16x16x32_bf16 v[196:199], a[20:23], v[112:115], v[196:199]
    ds_read_b128 a[16:19], v1 offset:20480
    s_add_u32 m0, s37, 4096
    v_mul_f32 v90, v90, v85
    v_mul_f32 v91, v91, v85
    v_mfma_f32_16x16x32_bf16 v[204:207], a[20:23], v[116:119], v[204:207]
    buffer_load_dwordx4 v2, s[12:15], s35 offen offset:0 sc1 lds
    v_mul_f32 v92, v92, v85
    v_mfma_f32_16x16x32_bf16 v[212:215], a[20:23], v[120:123], v[212:215]
    v_mul_f32 v93, v93, v85
    v_mfma_f32_16x16x32_bf16 v[220:223], a[20:23], v[124:127], v[220:223]
    v_mul_f32 v94, v94, v85
    v_mul_f32 v95, v95, v85
    v_mfma_f32_16x16x32_bf16 v[224:227], a[24:27], v[112:115], v[224:227]
    ds_read_b128 a[20:23], v1 offset:21504
    v_cvt_pk_bf16_f32 v164, v88, v89
    v_mfma_f32_16x16x32_bf16 v[232:235], a[24:27], v[116:119], v[232:235]
    v_cvt_pk_bf16_f32 v165, v90, v91
    v_cvt_pk_bf16_f32 v166, v92, v93
    v_mfma_f32_16x16x32_bf16 v[240:243], a[24:27], v[120:123], v[240:243]
    v_cvt_pk_bf16_f32 v167, v94, v95
    v_mfma_f32_16x16x32_bf16 v[248:251], a[24:27], v[124:127], v[248:251]
    buffer_store_dwordx4 v[164:167], v9, s[28:31], s4 offen offset:0 sc1
    v_mfma_f32_16x16x32_bf16 v[228:231], a[28:31], v[112:115], v[228:231]
    ds_read_b128 a[24:27], v1 offset:22528
    s_add_u32 m0, s37, 20480
    v_accvgpr_read_b32 v88, a208
    v_accvgpr_read_b32 v89, a209
    v_mfma_f32_16x16x32_bf16 v[236:239], a[28:31], v[116:119], v[236:239]
    s_add_u32 s35, s97, 0
    buffer_load_dwordx4 v8, s[12:15], s35 offen offset:0 sc1 lds
    v_accvgpr_read_b32 v90, a210
    v_mfma_f32_16x16x32_bf16 v[244:247], a[28:31], v[120:123], v[244:247]
    v_accvgpr_read_b32 v91, a211
    v_accvgpr_read_b32 v92, a212
    v_mfma_f32_16x16x32_bf16 v[252:255], a[28:31], v[124:127], v[252:255]
    v_accvgpr_read_b32 v93, a213
    s_waitcnt lgkmcnt(3)
    v_mfma_f32_16x16x32_bf16 v[48:51], a[0:3], v[112:115], v[48:51]
    ds_read_b128 a[28:31], v1 offset:23552
    v_accvgpr_read_b32 v94, a214
    v_mfma_f32_16x16x32_bf16 v[56:59], a[0:3], v[116:119], v[56:59]
    v_accvgpr_read_b32 v95, a215
    v_mul_f32 v88, v88, v86
    v_mfma_f32_16x16x32_bf16 v[64:67], a[0:3], v[120:123], v[64:67]
    v_mul_f32 v89, v89, v86
    v_mfma_f32_16x16x32_bf16 v[72:75], a[0:3], v[124:127], v[72:75]
    v_mul_f32 v90, v90, v86
    v_mul_f32 v91, v91, v86
    v_mfma_f32_16x16x32_bf16 v[52:55], a[4:7], v[112:115], v[52:55]
    ds_read_b128 a[0:3], v1 offset:24576
    v_mul_f32 v92, v92, v86
    v_mfma_f32_16x16x32_bf16 v[60:63], a[4:7], v[116:119], v[60:63]
    buffer_load_dwordx4 v8, s[12:15], s35 offen offset:1024 sc1 lds
    v_mul_f32 v93, v93, v86
    v_mfma_f32_16x16x32_bf16 v[68:71], a[4:7], v[120:123], v[68:71]
    v_mul_f32 v94, v94, v86
    v_mul_f32 v95, v95, v86
    v_mfma_f32_16x16x32_bf16 v[76:79], a[4:7], v[124:127], v[76:79]
    v_cvt_pk_bf16_f32 v168, v88, v89
    v_mfma_f32_16x16x32_bf16 v[16:19], a[8:11], v[112:115], v[16:19]
    ds_read_b128 a[4:7], v1 offset:25600
    v_cvt_pk_bf16_f32 v169, v90, v91
    v_cvt_pk_bf16_f32 v170, v92, v93
    v_mfma_f32_16x16x32_bf16 v[24:27], a[8:11], v[116:119], v[24:27]
    v_cvt_pk_bf16_f32 v171, v94, v95
    v_mfma_f32_16x16x32_bf16 v[32:35], a[8:11], v[120:123], v[32:35]
    buffer_store_dwordx4 v[168:171], v9, s[28:31], s5 offen offset:0 sc1
    v_mfma_f32_16x16x32_bf16 v[40:43], a[8:11], v[124:127], v[40:43]
    v_accvgpr_read_b32 v88, a216
    v_accvgpr_read_b32 v89, a217
    v_mfma_f32_16x16x32_bf16 v[20:23], a[12:15], v[112:115], v[20:23]
    ds_read_b128 a[8:11], v1 offset:26624
    v_accvgpr_read_b32 v90, a218
    v_mfma_f32_16x16x32_bf16 v[28:31], a[12:15], v[116:119], v[28:31]
    buffer_load_dwordx4 v8, s[12:15], s35 offen offset:2048 sc1 lds
    v_accvgpr_read_b32 v91, a219
    v_accvgpr_read_b32 v92, a220
    v_mfma_f32_16x16x32_bf16 v[36:39], a[12:15], v[120:123], v[36:39]
    v_accvgpr_read_b32 v93, a221
    v_mfma_f32_16x16x32_bf16 v[44:47], a[12:15], v[124:127], v[44:47]
    v_accvgpr_read_b32 v94, a222
    s_waitcnt lgkmcnt(3)
    v_mfma_f32_16x16x32_bf16 a[64:67], a[16:19], v[128:131], a[64:67]
    ds_read_b128 a[12:15], v1 offset:27648
    v_accvgpr_read_b32 v95, a223
    v_mul_f32 v88, v88, v87
    v_mfma_f32_16x16x32_bf16 a[72:75], a[16:19], v[132:135], a[72:75]
    v_mul_f32 v89, v89, v87
    v_mfma_f32_16x16x32_bf16 a[80:83], a[16:19], v[136:139], a[80:83]
    v_mul_f32 v90, v90, v87
    v_mul_f32 v91, v91, v87
    v_mfma_f32_16x16x32_bf16 a[88:91], a[16:19], v[140:143], a[88:91]
    v_mul_f32 v92, v92, v87
    v_mfma_f32_16x16x32_bf16 a[68:71], a[20:23], v[128:131], a[68:71]
    ds_read_b128 a[16:19], v1 offset:28672
    v_mul_f32 v93, v93, v87
    v_mfma_f32_16x16x32_bf16 a[76:79], a[20:23], v[132:135], a[76:79]
    buffer_load_dwordx4 v8, s[12:15], s35 offen offset:3072 sc1 lds
    v_mul_f32 v94, v94, v87
    v_mul_f32 v95, v95, v87
    v_mfma_f32_16x16x32_bf16 a[84:87], a[20:23], v[136:139], a[84:87]
    v_cvt_pk_bf16_f32 v172, v88, v89
    v_mfma_f32_16x16x32_bf16 a[92:95], a[20:23], v[140:143], a[92:95]
    v_cvt_pk_bf16_f32 v173, v90, v91
    v_cvt_pk_bf16_f32 v174, v92, v93
    v_mfma_f32_16x16x32_bf16 v[192:195], a[24:27], v[128:131], v[192:195]
    ds_read_b128 a[20:23], v1 offset:29696
    v_cvt_pk_bf16_f32 v175, v94, v95
    v_mfma_f32_16x16x32_bf16 v[200:203], a[24:27], v[132:135], v[200:203]
    buffer_store_dwordx4 v[172:175], v9, s[28:31], s6 offen offset:0 sc1
    v_mfma_f32_16x16x32_bf16 v[208:211], a[24:27], v[136:139], v[208:211]
    v_accvgpr_read_b32 v88, a224
    v_accvgpr_read_b32 v89, a225
    v_mfma_f32_16x16x32_bf16 v[216:219], a[24:27], v[140:143], v[216:219]
    v_accvgpr_read_b32 v90, a226
    v_mfma_f32_16x16x32_bf16 v[196:199], a[28:31], v[128:131], v[196:199]
    ds_read_b128 a[24:27], v1 offset:30720
    s_add_u32 m0, s37, 24576
    v_accvgpr_read_b32 v91, a227
    v_accvgpr_read_b32 v92, a228
    v_mfma_f32_16x16x32_bf16 v[204:207], a[28:31], v[132:135], v[204:207]
    buffer_load_dwordx4 v2, s[12:15], s35 offen offset:0 sc1 lds
    v_accvgpr_read_b32 v93, a229
    v_mfma_f32_16x16x32_bf16 v[212:215], a[28:31], v[136:139], v[212:215]
    v_accvgpr_read_b32 v94, a230
    v_mfma_f32_16x16x32_bf16 v[220:223], a[28:31], v[140:143], v[220:223]
    v_accvgpr_read_b32 v95, a231
    v_mul_f32 v88, v88, v84
    s_waitcnt lgkmcnt(3)
    v_mfma_f32_16x16x32_bf16 v[224:227], a[0:3], v[128:131], v[224:227]
    ds_read_b128 a[28:31], v1 offset:31744
    v_mul_f32 v89, v89, v84
    v_mfma_f32_16x16x32_bf16 v[232:235], a[0:3], v[132:135], v[232:235]
    v_mul_f32 v90, v90, v84
    v_mul_f32 v91, v91, v84
    v_mfma_f32_16x16x32_bf16 v[240:243], a[0:3], v[136:139], v[240:243]
    v_mul_f32 v92, v92, v84
    v_mfma_f32_16x16x32_bf16 v[248:251], a[0:3], v[140:143], v[248:251]
    v_mul_f32 v93, v93, v84
    v_mfma_f32_16x16x32_bf16 v[228:231], a[4:7], v[128:131], v[228:231]
    ds_read_b128 a[0:3], v1 offset:32768
    v_mul_f32 v94, v94, v84
    v_mul_f32 v95, v95, v84
    v_mfma_f32_16x16x32_bf16 v[236:239], a[4:7], v[132:135], v[236:239]
    v_cvt_pk_bf16_f32 v176, v88, v89
    v_mfma_f32_16x16x32_bf16 v[244:247], a[4:7], v[136:139], v[244:247]
    v_cvt_pk_bf16_f32 v177, v90, v91
    v_cvt_pk_bf16_f32 v178, v92, v93
    v_mfma_f32_16x16x32_bf16 v[252:255], a[4:7], v[140:143], v[252:255]
    v_cvt_pk_bf16_f32 v179, v94, v95
    v_mfma_f32_16x16x32_bf16 v[48:51], a[8:11], v[128:131], v[48:51]
    ds_read_b128 a[4:7], v1 offset:33792
    buffer_store_dwordx4 v[176:179], v9, s[28:31], 0 offen offset:1024 sc1
    v_mfma_f32_16x16x32_bf16 v[56:59], a[8:11], v[132:135], v[56:59]
    v_accvgpr_read_b32 v88, a232
    v_accvgpr_read_b32 v89, a233
    v_mfma_f32_16x16x32_bf16 v[64:67], a[8:11], v[136:139], v[64:67]
    v_accvgpr_read_b32 v90, a234
    v_mfma_f32_16x16x32_bf16 v[72:75], a[8:11], v[140:143], v[72:75]
    v_accvgpr_read_b32 v91, a235
    v_accvgpr_read_b32 v92, a236
    v_mfma_f32_16x16x32_bf16 v[52:55], a[12:15], v[128:131], v[52:55]
    ds_read_b128 a[8:11], v1 offset:34816
    v_accvgpr_read_b32 v93, a237
    v_mfma_f32_16x16x32_bf16 v[60:63], a[12:15], v[132:135], v[60:63]
    v_accvgpr_read_b32 v94, a238
    s_waitcnt vmcnt(10)
    v_cmp_gt_u32 vcc, 3, v11
    s_cbranch_vccnz MO1_spin
MO1_ok:
    v_mfma_f32_16x16x32_bf16 v[68:71], a[12:15], v[136:139], v[68:71]
    v_accvgpr_read_b32 v95, a239
    v_mul_f32 v88, v88, v85
    v_mfma_f32_16x16x32_bf16 v[76:79], a[12:15], v[140:143], v[76:79]
    buffer_load_dwordx4 a[96:99], v80, s[24:27], 0 offen offset:0 sc1
    v_mul_f32 v89, v89, v85
    s_waitcnt lgkmcnt(3)
    v_mfma_f32_16x16x32_bf16 v[16:19], a[16:19], v[128:131], v[16:19]
    ds_read_b128 a[12:15], v1 offset:35840
    v_mul_f32 v90, v90, v85
    v_mul_f32 v91, v91, v85
    v_mfma_f32_16x16x32_bf16 v[24:27], a[16:19], v[132:135], v[24:27]
    v_mul_f32 v92, v92, v85
    v_mfma_f32_16x16x32_bf16 v[32:35], a[16:19], v[136:139], v[32:35]
    v_mul_f32 v93, v93, v85
    v_mfma_f32_16x16x32_bf16 v[40:43], a[16:19], v[140:143], v[40:43]
    v_mul_f32 v94, v94, v85
    v_mul_f32 v95, v95, v85
    v_mfma_f32_16x16x32_bf16 v[20:23], a[20:23], v[128:131], v[20:23]
    ds_read_b128 a[16:19], v1 offset:36864
    v_cvt_pk_bf16_f32 v180, v88, v89
    v_mfma_f32_16x16x32_bf16 v[28:31], a[20:23], v[132:135], v[28:31]
    v_cvt_pk_bf16_f32 v181, v90, v91
    v_cvt_pk_bf16_f32 v182, v92, v93
    v_mfma_f32_16x16x32_bf16 v[36:39], a[20:23], v[136:139], v[36:39]
    v_cvt_pk_bf16_f32 v183, v94, v95
    v_mfma_f32_16x16x32_bf16 v[44:47], a[20:23], v[140:143], v[44:47]
    buffer_load_dwordx4 a[100:103], v80, s[24:27], s4 offen offset:0 sc1
    buffer_store_dwordx4 v[180:183], v9, s[28:31], s4 offen offset:1024 sc1
    v_mfma_f32_16x16x32_bf16 a[64:67], a[24:27], v[144:147], a[64:67]
    ds_read_b128 a[20:23], v1 offset:37888
    v_accvgpr_read_b32 v88, a240
    v_accvgpr_read_b32 v89, a241
    v_mfma_f32_16x16x32_bf16 a[72:75], a[24:27], v[148:151], a[72:75]
    v_accvgpr_read_b32 v90, a242
    v_mfma_f32_16x16x32_bf16 a[80:83], a[24:27], v[152:155], a[80:83]
    v_accvgpr_read_b32 v91, a243
    v_accvgpr_read_b32 v92, a244
    v_mfma_f32_16x16x32_bf16 a[88:91], a[24:27], v[156:159], a[88:91]
    v_accvgpr_read_b32 v93, a245
    v_mfma_f32_16x16x32_bf16 a[68:71], a[28:31], v[144:147], a[68:71]
    ds_read_b128 a[24:27], v1 offset:38912
    v_accvgpr_read_b32 v94, a246
    v_mfma_f32_16x16x32_bf16 a[76:79], a[28:31], v[148:151], a[76:79]
    v_accvgpr_read_b32 v95, a247
    v_mul_f32 v88, v88, v86
    v_mfma_f32_16x16x32_bf16 a[84:87], a[28:31], v[152:155], a[84:87]
    v_mul_f32 v89, v89, v86
    v_mfma_f32_16x16x32_bf16 a[92:95], a[28:31], v[156:159], a[92:95]
    buffer_load_dwordx4 a[104:107], v80, s[24:27], s5 offen offset:0 sc1
    v_mul_f32 v90, v90, v86
    v_mul_f32 v91, v91, v86
    s_waitcnt lgkmcnt(3)
    v_mfma_f32_16x16x32_bf16 v[192:195], a[0:3], v[144:147], v[192:195]
    ds_read_b128 a[28:31], v1 offset:39936
    v_mul_f32 v92, v92, v86
    v_mfma_f32_16x16x32_bf16 v[200:203], a[0:3], v[148:151], v[200:203]
    v_mul_f32 v93, v93, v86
    v_mfma_f32_16x16x32_bf16 v[208:211], a[0:3], v[152:155], v[208:211]
    v_mul_f32 v94, v94, v86
    v_mul_f32 v95, v95, v86
    v_mfma_f32_16x16x32_bf16 v[216:219], a[0:3], v[156:159], v[216:219]
    v_cvt_pk_bf16_f32 v184, v88, v89
    v_mfma_f32_16x16x32_bf16 v[196:199], a[4:7], v[144:147], v[196:199]
    ds_read_b128 a[0:3], v1 offset:40960
    v_cvt_pk_bf16_f32 v185, v90, v91
    v_cvt_pk_bf16_f32 v186, v92, v93
    v_mfma_f32_16x16x32_bf16 v[204:207], a[4:7], v[148:151], v[204:207]
    v_cvt_pk_bf16_f32 v187, v94, v95
    v_mfma_f32_16x16x32_bf16 v[212:215], a[4:7], v[152:155], v[212:215]
    buffer_store_dwordx4 v[184:187], v9, s[28:31], s5 offen offset:1024 sc1
    v_mfma_f32_16x16x32_bf16 v[220:223], a[4:7], v[156:159], v[220:223]
    buffer_load_dwordx4 a[108:111], v80, s[24:27], s6 offen offset:0 sc1
    v_accvgpr_read_b32 v88, a248
    v_accvgpr_read_b32 v89, a249
    v_mfma_f32_16x16x32_bf16 v[224:227], a[8:11], v[144:147], v[224:227]
    ds_read_b128 a[4:7], v1 offset:41984
    v_accvgpr_read_b32 v90, a250
    v_mfma_f32_16x16x32_bf16 v[232:235], a[8:11], v[148:151], v[232:235]
    v_accvgpr_read_b32 v91, a251
    v_accvgpr_read_b32 v92, a252
    v_mfma_f32_16x16x32_bf16 v[240:243], a[8:11], v[152:155], v[240:243]
    v_accvgpr_read_b32 v93, a253
    v_mfma_f32_16x16x32_bf16 v[248:251], a[8:11], v[156:159], v[248:251]
    v_accvgpr_read_b32 v94, a254
    v_mfma_f32_16x16x32_bf16 v[228:231], a[12:15], v[144:147], v[228:231]
    ds_read_b128 a[8:11], v1 offset:43008
    v_accvgpr_read_b32 v95, a255
    v_mul_f32 v88, v88, v87
    v_mfma_f32_16x16x32_bf16 v[236:239], a[12:15], v[148:151], v[236:239]
    v_mul_f32 v89, v89, v87
    v_mfma_f32_16x16x32_bf16 v[244:247], a[12:15], v[152:155], v[244:247]
    v_mul_f32 v90, v90, v87
    v_mul_f32 v91, v91, v87
    v_mfma_f32_16x16x32_bf16 v[252:255], a[12:15], v[156:159], v[252:255]
    buffer_load_dwordx4 a[112:115], v80, s[24:27], 0 offen offset:1024 sc1
    v_mul_f32 v92, v92, v87
    s_waitcnt lgkmcnt(3)
    v_mfma_f32_16x16x32_bf16 v[48:51], a[16:19], v[144:147], v[48:51]
    ds_read_b128 a[12:15], v1 offset:44032
    v_mul_f32 v93, v93, v87
    v_mfma_f32_16x16x32_bf16 v[56:59], a[16:19], v[148:151], v[56:59]
    v_mul_f32 v94, v94, v87
    v_mul_f32 v95, v95, v87
    v_mfma_f32_16x16x32_bf16 v[64:67], a[16:19], v[152:155], v[64:67]
    v_cvt_pk_bf16_f32 v188, v88, v89
    v_mfma_f32_16x16x32_bf16 v[72:75], a[16:19], v[156:159], v[72:75]
    v_cvt_pk_bf16_f32 v189, v90, v91
    v_cvt_pk_bf16_f32 v190, v92, v93
    v_mfma_f32_16x16x32_bf16 v[52:55], a[20:23], v[144:147], v[52:55]
    ds_read_b128 a[16:19], v1 offset:45056
    v_cvt_pk_bf16_f32 v191, v94, v95
    v_mfma_f32_16x16x32_bf16 v[60:63], a[20:23], v[148:151], v[60:63]
    buffer_store_dwordx4 v[188:191], v9, s[28:31], s6 offen offset:1024 sc1
    v_mfma_f32_16x16x32_bf16 v[68:71], a[20:23], v[152:155], v[68:71]
    v_mfma_f32_16x16x32_bf16 v[76:79], a[20:23], v[156:159], v[76:79]
    buffer_load_dwordx4 a[116:119], v80, s[24:27], s4 offen offset:1024 sc1
    v_bfe_u32 v9, v8, 7, 2
    v_mfma_f32_16x16x32_bf16 v[16:19], a[24:27], v[144:147], v[16:19]
    ds_read_b128 a[20:23], v1 offset:46080
    v_lshrrev_b32 v10, 9, v8
    v_mfma_f32_16x16x32_bf16 v[24:27], a[24:27], v[148:151], v[24:27]
    v_lshlrev_b32 v9, 2, v9
    v_mfma_f32_16x16x32_bf16 v[32:35], a[24:27], v[152:155], v[32:35]
    v_lshl_add_u32 v9, v10, 5, v9
    v_mfma_f32_16x16x32_bf16 v[40:43], a[24:27], v[156:159], v[40:43]
    v_add_u32 v9, s49, v9
    v_mfma_f32_16x16x32_bf16 v[20:23], a[28:31], v[144:147], v[20:23]
    ds_read_b128 a[24:27], v1 offset:47104
    v_bfe_u32 v6, v8, 4, 3
    v_mfma_f32_16x16x32_bf16 v[28:31], a[28:31], v[148:151], v[28:31]
    v_mul_u32_u24 v6, 1280, v6
    v_mfma_f32_16x16x32_bf16 v[36:39], a[28:31], v[152:155], v[36:39]
    v_lshl_add_u32 v6, v9, 1, v6
    v_mfma_f32_16x16x32_bf16 v[44:47], a[28:31], v[156:159], v[44:47]
    v_lshlrev_b32 v9, 2, v9
    s_waitcnt lgkmcnt(3)
    v_mfma_f32_16x16x32_bf16 a[64:67], a[0:3], v[160:163], a[64:67]
    ds_read_b128 a[28:31], v1 offset:48128
    v_lshlrev_b32 v5, 30, v10
    v_mfma_f32_16x16x32_bf16 a[72:75], a[0:3], v[164:167], a[72:75]
    buffer_load_dwordx4 a[120:123], v80, s[24:27], s5 offen offset:1024 sc1
    v_add_u32 v7, v6, v5
    v_mfma_f32_16x16x32_bf16 a[80:83], a[0:3], v[168:171], a[80:83]
    v_add_u32 v9, 147456, v9
    v_mfma_f32_16x16x32_bf16 a[88:91], a[0:3], v[172:175], a[88:91]
    v_mov_b32 v12, 4
    v_mfma_f32_16x16x32_bf16 a[68:71], a[4:7], v[160:163], a[68:71]
    ds_read_b128 a[0:3], v1 offset:49152
    v_mfma_f32_16x16x32_bf16 a[76:79], a[4:7], v[164:167], a[76:79]
    v_mfma_f32_16x16x32_bf16 a[84:87], a[4:7], v[168:171], a[84:87]
    v_mfma_f32_16x16x32_bf16 a[92:95], a[4:7], v[172:175], a[92:95]
    v_mfma_f32_16x16x32_bf16 v[192:195], a[8:11], v[160:163], v[192:195]
    ds_read_b128 a[4:7], v1 offset:50176
    v_mfma_f32_16x16x32_bf16 v[200:203], a[8:11], v[164:167], v[200:203]
    buffer_load_dwordx4 a[124:127], v80, s[24:27], s6 offen offset:1024 sc1
    v_mfma_f32_16x16x32_bf16 v[208:211], a[8:11], v[168:171], v[208:211]
    v_mfma_f32_16x16x32_bf16 v[216:219], a[8:11], v[172:175], v[216:219]
    v_mfma_f32_16x16x32_bf16 v[196:199], a[12:15], v[160:163], v[196:199]
    ds_read_b128 a[8:11], v1 offset:51200
    v_mfma_f32_16x16x32_bf16 v[204:207], a[12:15], v[164:167], v[204:207]
    v_mfma_f32_16x16x32_bf16 v[212:215], a[12:15], v[168:171], v[212:215]
    v_mfma_f32_16x16x32_bf16 v[220:223], a[12:15], v[172:175], v[220:223]
    s_waitcnt lgkmcnt(3)
    v_mfma_f32_16x16x32_bf16 v[224:227], a[16:19], v[160:163], v[224:227]
    ds_read_b128 a[12:15], v1 offset:52224
    v_mfma_f32_16x16x32_bf16 v[232:235], a[16:19], v[164:167], v[232:235]
    buffer_load_dwordx4 a[128:131], v81, s[24:27], 0 offen offset:0 sc1
    v_mfma_f32_16x16x32_bf16 v[240:243], a[16:19], v[168:171], v[240:243]
    v_mfma_f32_16x16x32_bf16 v[248:251], a[16:19], v[172:175], v[248:251]
    v_mfma_f32_16x16x32_bf16 v[228:231], a[20:23], v[160:163], v[228:231]
    ds_read_b128 a[16:19], v1 offset:53248
    v_mfma_f32_16x16x32_bf16 v[236:239], a[20:23], v[164:167], v[236:239]
    v_mfma_f32_16x16x32_bf16 v[244:247], a[20:23], v[168:171], v[244:247]
    v_mfma_f32_16x16x32_bf16 v[252:255], a[20:23], v[172:175], v[252:255]
    v_mfma_f32_16x16x32_bf16 v[48:51], a[24:27], v[160:163], v[48:51]
    ds_read_b128 a[20:23], v1 offset:54272
    v_mfma_f32_16x16x32_bf16 v[56:59], a[24:27], v[164:167], v[56:59]
    buffer_load_dwordx4 a[132:135], v81, s[24:27], s4 offen offset:0 sc1
    v_mfma_f32_16x16x32_bf16 v[64:67], a[24:27], v[168:171], v[64:67]
    v_mfma_f32_16x16x32_bf16 v[72:75], a[24:27], v[172:175], v[72:75]
    v_mfma_f32_16x16x32_bf16 v[52:55], a[28:31], v[160:163], v[52:55]
    ds_read_b128 a[24:27], v1 offset:55296
    v_mfma_f32_16x16x32_bf16 v[60:63], a[28:31], v[164:167], v[60:63]
    v_mfma_f32_16x16x32_bf16 v[68:71], a[28:31], v[168:171], v[68:71]
    v_mfma_f32_16x16x32_bf16 v[76:79], a[28:31], v[172:175], v[76:79]
    s_waitcnt lgkmcnt(3)
    v_mfma_f32_16x16x32_bf16 v[16:19], a[0:3], v[160:163], v[16:19]
    ds_read_b128 a[28:31], v1 offset:56320
    v_mfma_f32_16x16x32_bf16 v[24:27], a[0:3], v[164:167], v[24:27]
    buffer_load_dwordx4 a[136:139], v81, s[24:27], s5 offen offset:0 sc1
    v_mfma_f32_16x16x32_bf16 v[32:35], a[0:3], v[168:171], v[32:35]
    v_mfma_f32_16x16x32_bf16 v[40:43], a[0:3], v[172:175], v[40:43]
    v_mfma_f32_16x16x32_bf16 v[20:23], a[4:7], v[160:163], v[20:23]
    ds_read_b128 a[0:3], v1 offset:57344
    v_mfma_f32_16x16x32_bf16 v[28:31], a[4:7], v[164:167], v[28:31]
    v_mfma_f32_16x16x32_bf16 v[36:39], a[4:7], v[168:171], v[36:39]
    v_mfma_f32_16x16x32_bf16 v[44:47], a[4:7], v[172:175], v[44:47]
    v_mfma_f32_16x16x32_bf16 a[64:67], a[8:11], v[176:179], a[64:67]
    ds_read_b128 a[4:7], v1 offset:58368
    v_mfma_f32_16x16x32_bf16 a[72:75], a[8:11], v[180:183], a[72:75]
    buffer_load_dwordx4 a[140:143], v81, s[24:27], s6 offen offset:0 sc1
    v_mfma_f32_16x16x32_bf16 a[80:83], a[8:11], v[184:187], a[80:83]
    v_mfma_f32_16x16x32_bf16 a[88:91], a[8:11], v[188:191], a[88:91]
    v_mfma_f32_16x16x32_bf16 a[68:71], a[12:15], v[176:179], a[68:71]
    ds_read_b128 a[8:11], v1 offset:59392
    v_mfma_f32_16x16x32_bf16 a[76:79], a[12:15], v[180:183], a[76:79]
    v_mfma_f32_16x16x32_bf16 a[84:87], a[12:15], v[184:187], a[84:87]
    v_mfma_f32_16x16x32_bf16 a[92:95], a[12:15], v[188:191], a[92:95]
    s_waitcnt lgkmcnt(3)
    v_mfma_f32_16x16x32_bf16 v[192:195], a[16:19], v[176:179], v[192:195]
    ds_read_b128 a[12:15], v1 offset:60416
    v_mfma_f32_16x16x32_bf16 v[200:203], a[16:19], v[180:183], v[200:203]
    v_mfma_f32_16x16x32_bf16 v[208:211], a[16:19], v[184:187], v[208:211]
    v_mfma_f32_16x16x32_bf16 v[216:219], a[16:19], v[188:191], v[216:219]
    buffer_load_dwordx4 a[144:147], v81, s[24:27], 0 offen offset:1024 sc1
    v_mfma_f32_16x16x32_bf16 v[196:199], a[20:23], v[176:179], v[196:199]
    s_waitcnt vmcnt(25)
    s_barrier
    ds_read_b128 a[16:19], v8 offset:0
    v_mfma_f32_16x16x32_bf16 v[204:207], a[20:23], v[180:183], v[204:207]
    v_mfma_f32_16x16x32_bf16 v[212:215], a[20:23], v[184:187], v[212:215]
    v_mfma_f32_16x16x32_bf16 v[220:223], a[20:23], v[188:191], v[220:223]
    v_mfma_f32_16x16x32_bf16 v[224:227], a[24:27], v[176:179], v[224:227]
    ds_read_b128 a[20:23], v8 offset:1024
    v_mfma_f32_16x16x32_bf16 v[232:235], a[24:27], v[180:183], v[232:235]
    v_mfma_f32_16x16x32_bf16 v[240:243], a[24:27], v[184:187], v[240:243]
    v_mfma_f32_16x16x32_bf16 v[248:251], a[24:27], v[188:191], v[248:251]
    buffer_load_dwordx4 a[148:151], v81, s[24:27], s4 offen offset:1024 sc1
    v_mfma_f32_16x16x32_bf16 v[228:231], a[28:31], v[176:179], v[228:231]
    ds_read_b128 a[24:27], v8 offset:2048
    s_add_u32 m0, s37, 40960
    s_waitcnt vmcnt(9)
    s_barrier
    buffer_store_dword v12, v14, s[76:79], s0 offen sc1
    buffer_atomic_add v15, v14, s[76:79], s75 offen sc1
    v_mfma_f32_16x16x32_bf16 v[236:239], a[28:31], v[180:183], v[236:239]
    s_add_u32 s35, s98, 0
    buffer_load_dwordx4 v8, s[12:15], s35 offen offset:0 sc1 lds
    v_mfma_f32_16x16x32_bf16 v[244:247], a[28:31], v[184:187], v[244:247]
    v_lshlrev_b32 v12, 4, v8
    v_mfma_f32_16x16x32_bf16 v[252:255], a[28:31], v[188:191], v[252:255]
    s_waitcnt lgkmcnt(3)
    v_mfma_f32_16x16x32_bf16 v[48:51], a[0:3], v[176:179], v[48:51]
    ds_read_b128 a[28:31], v8 offset:3072
    v_mfma_f32_16x16x32_bf16 v[56:59], a[0:3], v[180:183], v[56:59]
    v_mfma_f32_16x16x32_bf16 v[64:67], a[0:3], v[184:187], v[64:67]
    v_and_b32 v12, 0xf00, v12
    v_mfma_f32_16x16x32_bf16 v[72:75], a[0:3], v[188:191], v[72:75]
    buffer_load_dwordx4 a[152:155], v81, s[24:27], s5 offen offset:1024 sc1
    v_mfma_f32_16x16x32_bf16 v[52:55], a[4:7], v[176:179], v[52:55]
    ds_read_b128 a[0:3], v8 offset:4096
    v_mfma_f32_16x16x32_bf16 v[60:63], a[4:7], v[180:183], v[60:63]
    buffer_load_dwordx2 v[160:161], v6, s[84:87], 0 offen offset:0
    v_mfma_f32_16x16x32_bf16 v[68:71], a[4:7], v[184:187], v[68:71]
    v_add_u32 v12, 4096, v12
    v_mfma_f32_16x16x32_bf16 v[76:79], a[4:7], v[188:191], v[76:79]
    v_mfma_f32_16x16x32_bf16 v[16:19], a[8:11], v[176:179], v[16:19]
    ds_read_b128 a[4:7], v8 offset:5120
    v_mfma_f32_16x16x32_bf16 v[24:27], a[8:11], v[180:183], v[24:27]
    v_mfma_f32_16x16x32_bf16 v[32:35], a[8:11], v[184:187], v[32:35]
    v_mfma_f32_16x16x32_bf16 v[40:43], a[8:11], v[188:191], v[40:43]
    buffer_load_dwordx4 a[156:159], v81, s[24:27], s6 offen offset:1024 sc1
    v_mfma_f32_16x16x32_bf16 v[20:23], a[12:15], v[176:179], v[20:23]
    ds_read_b128 a[8:11], v8 offset:6144
    v_mfma_f32_16x16x32_bf16 v[28:31], a[12:15], v[180:183], v[28:31]
    buffer_load_dwordx4 v8, s[12:15], s35 offen offset:1024 sc1 lds
    v_mfma_f32_16x16x32_bf16 v[36:39], a[12:15], v[184:187], v[36:39]
    v_mfma_f32_16x16x32_bf16 v[44:47], a[12:15], v[188:191], v[44:47]
    s_waitcnt lgkmcnt(3)
    v_mfma_f32_16x16x32_bf16 a[64:67], a[16:19], a[96:99], a[64:67]
    ds_read_b128 a[12:15], v8 offset:7168
    v_mfma_f32_16x16x32_bf16 a[72:75], a[16:19], a[100:103], a[72:75]
    buffer_load_dwordx2 v[162:163], v6, s[84:87], 0 offen offset:32
    v_mfma_f32_16x16x32_bf16 a[80:83], a[16:19], a[104:107], a[80:83]
    v_mfma_f32_16x16x32_bf16 a[88:91], a[16:19], a[108:111], a[88:91]
    buffer_load_dwordx4 v[96:99], v82, s[24:27], 0 offen offset:0 sc1
    v_mfma_f32_16x16x32_bf16 a[68:71], a[20:23], a[96:99], a[68:71]
    ds_read_b128 a[16:19], v8 offset:8192
    v_mfma_f32_16x16x32_bf16 a[76:79], a[20:23], a[100:103], a[76:79]
    v_mfma_f32_16x16x32_bf16 a[84:87], a[20:23], a[104:107], a[84:87]
    v_mfma_f32_16x16x32_bf16 a[92:95], a[20:23], a[108:111], a[92:95]
    v_mfma_f32_16x16x32_bf16 v[192:195], a[24:27], a[96:99], v[192:195]
    ds_read_b128 a[20:23], v8 offset:9216
    v_mfma_f32_16x16x32_bf16 v[200:203], a[24:27], a[100:103], v[200:203]
    buffer_load_dwordx4 v8, s[12:15], s35 offen offset:2048 sc1 lds
    v_mfma_f32_16x16x32_bf16 v[208:211], a[24:27], a[104:107], v[208:211]
    v_mfma_f32_16x16x32_bf16 v[216:219], a[24:27], a[108:111], v[216:219]
    buffer_load_dwordx4 v[100:103], v82, s[24:27], s4 offen offset:0 sc1
    v_mfma_f32_16x16x32_bf16 v[196:199], a[28:31], a[96:99], v[196:199]
    ds_read_b128 a[24:27], v8 offset:10240
    v_mfma_f32_16x16x32_bf16 v[204:207], a[28:31], a[100:103], v[204:207]
    v_mfma_f32_16x16x32_bf16 v[212:215], a[28:31], a[104:107], v[212:215]
    v_mfma_f32_16x16x32_bf16 v[220:223], a[28:31], a[108:111], v[220:223]
    buffer_load_dwordx2 v[164:165], v6, s[84:87], 0 offen offset:128
    s_waitcnt lgkmcnt(3)
    v_mfma_f32_16x16x32_bf16 v[224:227], a[0:3], a[96:99], v[224:227]
    ds_read_b128 a[28:31], v8 offset:11264
    v_mfma_f32_16x16x32_bf16 v[232:235], a[0:3], a[100:103], v[232:235]
    v_mfma_f32_16x16x32_bf16 v[240:243], a[0:3], a[104:107], v[240:243]
    v_mfma_f32_16x16x32_bf16 v[248:251], a[0:3], a[108:111], v[248:251]
    v_mfma_f32_16x16x32_bf16 v[228:231], a[4:7], a[96:99], v[228:231]
    ds_read_b128 a[0:3], v8 offset:12288
    v_mfma_f32_16x16x32_bf16 v[236:239], a[4:7], a[100:103], v[236:239]
    buffer_load_dwordx4 v[104:107], v82, s[24:27], s5 offen offset:0 sc1
    v_mfma_f32_16x16x32_bf16 v[244:247], a[4:7], a[104:107], v[244:247]
    v_mfma_f32_16x16x32_bf16 v[252:255], a[4:7], a[108:111], v[252:255]
    buffer_load_dwordx4 v8, s[12:15], s35 offen offset:3072 sc1 lds
    v_mfma_f32_16x16x32_bf16 v[48:51], a[8:11], a[96:99], v[48:51]
    ds_read_b128 a[4:7], v8 offset:13312
    v_mfma_f32_16x16x32_bf16 v[56:59], a[8:11], a[100:103], v[56:59]
    v_mfma_f32_16x16x32_bf16 v[64:67], a[8:11], a[104:107], v[64:67]
    v_mfma_f32_16x16x32_bf16 v[72:75], a[8:11], a[108:111], v[72:75]
    v_mfma_f32_16x16x32_bf16 v[52:55], a[12:15], a[96:99], v[52:55]
    ds_read_b128 a[8:11], v8 offset:14336
    v_mfma_f32_16x16x32_bf16 v[60:63], a[12:15], a[100:103], v[60:63]
    buffer_load_dwordx4 v[108:111], v82, s[24:27], s6 offen offset:0 sc1
    v_mfma_f32_16x16x32_bf16 v[68:71], a[12:15], a[104:107], v[68:71]
    buffer_load_dword v11, v0, s[76:79], s51 offen sc1
    v_mfma_f32_16x16x32_bf16 v[76:79], a[12:15], a[108:111], v[76:79]
    buffer_load_dwordx2 v[166:167], v6, s[84:87], 0 offen offset:160
    s_waitcnt lgkmcnt(3)
    v_mfma_f32_16x16x32_bf16 v[16:19], a[16:19], a[96:99], v[16:19]
    ds_read_b128 a[12:15], v8 offset:15360
    v_mfma_f32_16x16x32_bf16 v[24:27], a[16:19], a[100:103], v[24:27]
    v_mfma_f32_16x16x32_bf16 v[32:35], a[16:19], a[104:107], v[32:35]
    v_mfma_f32_16x16x32_bf16 v[40:43], a[16:19], a[108:111], v[40:43]
    v_mfma_f32_16x16x32_bf16 v[20:23], a[20:23], a[96:99], v[20:23]
    ds_read_b128 a[16:19], v8 offset:16384
    v_mfma_f32_16x16x32_bf16 v[28:31], a[20:23], a[100:103], v[28:31]
    buffer_load_dwordx4 v[112:115], v82, s[24:27], 0 offen offset:1024 sc1
    v_mfma_f32_16x16x32_bf16 v[36:39], a[20:23], a[104:107], v[36:39]
    s_add_u32 m0, s37, 45056
    v_mfma_f32_16x16x32_bf16 v[44:47], a[20:23], a[108:111], v[44:47]
    buffer_load_dwordx4 v2, s[12:15], s35 offen offset:0 sc1 lds
    s_sub_u32 s37, s38, s37
    s_waitcnt vmcnt(25)
    v_mfma_f32_16x16x32_bf16 a[64:67], a[24:27], a[112:115], a[64:67]
    ds_read_b128 a[20:23], v8 offset:17408
    v_mfma_f32_16x16x32_bf16 a[72:75], a[24:27], a[116:119], a[72:75]
    v_mfma_f32_16x16x32_bf16 a[80:83], a[24:27], a[120:123], a[80:83]
    v_mfma_f32_16x16x32_bf16 a[88:91], a[24:27], a[124:127], a[88:91]
    buffer_load_dwordx2 v[168:169], v7, s[84:87], 0 offen offset:256
    v_mfma_f32_16x16x32_bf16 a[68:71], a[28:31], a[112:115], a[68:71]
    ds_read_b128 a[24:27], v8 offset:18432
    v_mfma_f32_16x16x32_bf16 a[76:79], a[28:31], a[116:119], a[76:79]
    buffer_load_dwordx4 v[116:119], v82, s[24:27], s4 offen offset:1024 sc1
    v_mfma_f32_16x16x32_bf16 a[84:87], a[28:31], a[120:123], a[84:87]
    v_mfma_f32_16x16x32_bf16 a[92:95], a[28:31], a[124:127], a[92:95]
    s_waitcnt lgkmcnt(3)
    v_mfma_f32_16x16x32_bf16 v[192:195], a[0:3], a[112:115], v[192:195]
    ds_read_b128 a[28:31], v8 offset:19456
    v_mfma_f32_16x16x32_bf16 v[200:203], a[0:3], a[116:119], v[200:203]
    v_mfma_f32_16x16x32_bf16 v[208:211], a[0:3], a[120:123], v[208:211]
    s_add_u32 m0, s37, 0
    v_mfma_f32_16x16x32_bf16 v[216:219], a[0:3], a[124:127], v[216:219]
    s_add_u32 s35, s96, 20480
    buffer_load_dwordx4 v8, s[12:15], s35 offen offset:0 sc1 lds
    v_mfma_f32_16x16x32_bf16 v[196:199], a[4:7], a[112:115], v[196:199]
    s_barrier
    ds_read_b128 a[0:3], v8 offset:20480
    v_mfma_f32_16x16x32_bf16 v[204:207], a[4:7], a[116:119], v[204:207]
    buffer_load_dwordx4 v[120:123], v82, s[24:27], s5 offen offset:1024 sc1
    v_mfma_f32_16x16x32_bf16 v[212:215], a[4:7], a[120:123], v[212:215]
    v_mfma_f32_16x16x32_bf16 v[220:223], a[4:7], a[124:127], v[220:223]
    v_mfma_f32_16x16x32_bf16 v[224:227], a[8:11], a[112:115], v[224:227]
    ds_read_b128 a[4:7], v8 offset:21504
    v_mfma_f32_16x16x32_bf16 v[232:235], a[8:11], a[116:119], v[232:235]
    buffer_load_dwordx2 v[170:171], v7, s[84:87], 0 offen offset:288
    v_mfma_f32_16x16x32_bf16 v[240:243], a[8:11], a[120:123], v[240:243]
    v_mfma_f32_16x16x32_bf16 v[248:251], a[8:11], a[124:127], v[248:251]
    v_mfma_f32_16x16x32_bf16 v[228:231], a[12:15], a[112:115], v[228:231]
    ds_read_b128 a[8:11], v8 offset:22528
    v_mfma_f32_16x16x32_bf16 v[236:239], a[12:15], a[116:119], v[236:239]
    buffer_load_dwordx4 v[124:127], v82, s[24:27], s6 offen offset:1024 sc1
    v_mfma_f32_16x16x32_bf16 v[244:247], a[12:15], a[120:123], v[244:247]
    v_mfma_f32_16x16x32_bf16 v[252:255], a[12:15], a[124:127], v[252:255]
    s_waitcnt lgkmcnt(3)
    v_mfma_f32_16x16x32_bf16 v[48:51], a[16:19], a[112:115], v[48:51]
    ds_read_b128 a[12:15], v8 offset:23552
    v_mfma_f32_16x16x32_bf16 v[56:59], a[16:19], a[116:119], v[56:59]
    buffer_load_dwordx4 v8, s[12:15], s35 offen offset:1024 sc1 lds
    v_mfma_f32_16x16x32_bf16 v[64:67], a[16:19], a[120:123], v[64:67]
    v_mfma_f32_16x16x32_bf16 v[72:75], a[16:19], a[124:127], v[72:75]
    v_mfma_f32_16x16x32_bf16 v[52:55], a[20:23], a[112:115], v[52:55]
    ds_read_b128 a[16:19], v8 offset:24576
    v_mfma_f32_16x16x32_bf16 v[60:63], a[20:23], a[116:119], v[60:63]
    s_waitcnt vmcnt(10)
    v_cmp_gt_u32 vcc, 4, v11
    s_cbranch_vccnz MO_spin
MO_ok:
    v_mfma_f32_16x16x32_bf16 v[68:71], a[20:23], a[120:123], v[68:71]
    v_mfma_f32_16x16x32_bf16 v[76:79], a[20:23], a[124:127], v[76:79]
    buffer_load_dwordx4 v[128:131], v80, s[24:27], 0 offen offset:2048 sc1
    v_lshrrev_b32 v4, 7, v8
    v_mfma_f32_16x16x32_bf16 v[16:19], a[24:27], a[112:115], v[16:19]
    ds_read_b128 a[20:23], v8 offset:25600
    v_mfma_f32_16x16x32_bf16 v[24:27], a[24:27], a[116:119], v[24:27]
    v_lshlrev_b32 v4, 8, v4
    v_mfma_f32_16x16x32_bf16 v[32:35], a[24:27], a[120:123], v[32:35]
    v_mfma_f32_16x16x32_bf16 v[40:43], a[24:27], a[124:127], v[40:43]
    buffer_load_dwordx4 v[132:135], v80, s[24:27], s4 offen offset:2048 sc1
    v_and_b32 v6, 0x70, v8
    v_mfma_f32_16x16x32_bf16 v[20:23], a[28:31], a[112:115], v[20:23]
    ds_read_b128 a[24:27], v8 offset:26624
    v_mfma_f32_16x16x32_bf16 v[28:31], a[28:31], a[116:119], v[28:31]
    s_mul_i32 s49, s32, 5120
    v_mfma_f32_16x16x32_bf16 v[36:39], a[28:31], a[120:123], v[36:39]
    v_mfma_f32_16x16x32_bf16 v[44:47], a[28:31], a[124:127], v[44:47]
    buffer_load_dwordx4 v8, s[12:15], s35 offen offset:2048 sc1 lds
    v_add3_u32 v4, v4, v6, s49
    s_waitcnt lgkmcnt(3)
    v_mfma_f32_16x16x32_bf16 a[64:67], a[0:3], a[128:131], a[64:67]
    ds_read_b128 a[28:31], v8 offset:27648
    v_mfma_f32_16x16x32_bf16 a[72:75], a[0:3], a[132:135], a[72:75]
    buffer_load_dwordx4 v[136:139], v80, s[24:27], s5 offen offset:2048 sc1
    v_add_u32 v5, 4096, v5
    v_mfma_f32_16x16x32_bf16 a[80:83], a[0:3], a[136:139], a[80:83]
    v_mfma_f32_16x16x32_bf16 a[88:91], a[0:3], a[140:143], a[88:91]
    v_add_u32 v5, v4, v5
    v_mfma_f32_16x16x32_bf16 a[68:71], a[4:7], a[128:131], a[68:71]
    ds_read_b128 a[0:3], v8 offset:28672
    v_mfma_f32_16x16x32_bf16 a[76:79], a[4:7], a[132:135], a[76:79]
    buffer_load_dwordx4 v[140:143], v80, s[24:27], s6 offen offset:2048 sc1
    v_lshlrev_b32 v0, 4, v6
    v_mfma_f32_16x16x32_bf16 a[84:87], a[4:7], a[136:139], a[84:87]
    v_mfma_f32_16x16x32_bf16 a[92:95], a[4:7], a[140:143], a[92:95]
    s_andn2_b32 s51, s42, 0x100
    v_mfma_f32_16x16x32_bf16 v[192:195], a[8:11], a[128:131], v[192:195]
    ds_read_b128 a[4:7], v8 offset:29696
    v_mfma_f32_16x16x32_bf16 v[200:203], a[8:11], a[132:135], v[200:203]
    s_lshl_b32 s49, s32, 11
    v_mfma_f32_16x16x32_bf16 v[208:211], a[8:11], a[136:139], v[208:211]
    v_mfma_f32_16x16x32_bf16 v[216:219], a[8:11], a[140:143], v[216:219]
    buffer_load_dwordx4 v[144:147], v80, s[24:27], 0 offen offset:3072 sc1
    s_add_u32 s51, s51, s49
    v_mfma_f32_16x16x32_bf16 v[196:199], a[12:15], a[128:131], v[196:199]
    ds_read_b128 a[8:11], v8 offset:30720
    v_mfma_f32_16x16x32_bf16 v[204:207], a[12:15], a[132:135], v[204:207]
    buffer_load_dwordx4 v8, s[12:15], s35 offen offset:3072 sc1 lds
    v_mov_b32 v15, 6
    v_mfma_f32_16x16x32_bf16 v[212:215], a[12:15], a[136:139], v[212:215]
    v_mfma_f32_16x16x32_bf16 v[220:223], a[12:15], a[140:143], v[220:223]
    buffer_load_dwordx4 v[148:151], v80, s[24:27], s4 offen offset:3072 sc1
    s_waitcnt lgkmcnt(3)
    v_mfma_f32_16x16x32_bf16 v[224:227], a[16:19], a[128:131], v[224:227]
    ds_read_b128 a[12:15], v8 offset:31744
    v_mfma_f32_16x16x32_bf16 v[232:235], a[16:19], a[132:135], v[232:235]
    v_mfma_f32_16x16x32_bf16 v[240:243], a[16:19], a[136:139], v[240:243]
    v_mfma_f32_16x16x32_bf16 v[248:251], a[16:19], a[140:143], v[248:251]
    v_mfma_f32_16x16x32_bf16 v[228:231], a[20:23], a[128:131], v[228:231]
    ds_read_b128 a[16:19], v8 offset:32768
    v_mfma_f32_16x16x32_bf16 v[236:239], a[20:23], a[132:135], v[236:239]
    buffer_load_dwordx4 v[152:155], v80, s[24:27], s5 offen offset:3072 sc1
    v_mfma_f32_16x16x32_bf16 v[244:247], a[20:23], a[136:139], v[244:247]
    v_mfma_f32_16x16x32_bf16 v[252:255], a[20:23], a[140:143], v[252:255]
    v_mfma_f32_16x16x32_bf16 v[48:51], a[24:27], a[128:131], v[48:51]
    ds_read_b128 a[20:23], v8 offset:33792
    v_mfma_f32_16x16x32_bf16 v[56:59], a[24:27], a[132:135], v[56:59]
    buffer_load_dwordx4 v[156:159], v80, s[24:27], s6 offen offset:3072 sc1
    v_mfma_f32_16x16x32_bf16 v[64:67], a[24:27], a[136:139], v[64:67]
    s_add_u32 m0, s37, 4096
    v_mfma_f32_16x16x32_bf16 v[72:75], a[24:27], a[140:143], v[72:75]
    buffer_load_dwordx4 v2, s[12:15], s35 offen offset:0 sc1 lds
    s_and_b32 s3, s32, 1
    s_lshl_b32 s3, s3, 12
    s_sub_u32 s12, s12, s3
    s_subb_u32 s13, s13, 0
    s_add_u32 s14, s14, s3
    s_lshl_b32 s37, s32, 10
    s_add_u32 s37, s37, 98816
    v_mfma_f32_16x16x32_bf16 v[52:55], a[28:31], a[128:131], v[52:55]
    ds_read_b128 a[24:27], v8 offset:34816
    v_mfma_f32_16x16x32_bf16 v[60:63], a[28:31], a[132:135], v[60:63]
    v_mfma_f32_16x16x32_bf16 v[68:71], a[28:31], a[136:139], v[68:71]
    v_mfma_f32_16x16x32_bf16 v[76:79], a[28:31], a[140:143], v[76:79]
    buffer_load_dwordx4 a[160:163], v81, s[24:27], 0 offen offset:2048 sc1
    s_waitcnt lgkmcnt(3)
    v_mfma_f32_16x16x32_bf16 v[16:19], a[0:3], a[128:131], v[16:19]
    ds_read_b128 a[28:31], v8 offset:35840
    v_mfma_f32_16x16x32_bf16 v[24:27], a[0:3], a[132:135], v[24:27]
    v_mfma_f32_16x16x32_bf16 v[32:35], a[0:3], a[136:139], v[32:35]
    v_mfma_f32_16x16x32_bf16 v[40:43], a[0:3], a[140:143], v[40:43]
    buffer_load_dwordx4 a[164:167], v81, s[24:27], s4 offen offset:2048 sc1
    v_mfma_f32_16x16x32_bf16 v[20:23], a[4:7], a[128:131], v[20:23]
    ds_read_b128 a[0:3], v8 offset:36864
    v_mfma_f32_16x16x32_bf16 v[28:31], a[4:7], a[132:135], v[28:31]
    v_mfma_f32_16x16x32_bf16 v[36:39], a[4:7], a[136:139], v[36:39]
    v_mfma_f32_16x16x32_bf16 v[44:47], a[4:7], a[140:143], v[44:47]
    v_mfma_f32_16x16x32_bf16 a[64:67], a[8:11], a[144:147], a[64:67]
    ds_read_b128 a[4:7], v8 offset:37888
    v_mfma_f32_16x16x32_bf16 a[72:75], a[8:11], a[148:151], a[72:75]
    buffer_load_dwordx4 a[168:171], v81, s[24:27], s5 offen offset:2048 sc1
    v_mfma_f32_16x16x32_bf16 a[80:83], a[8:11], a[152:155], a[80:83]
    s_add_u32 m0, s37, 20480
    v_mfma_f32_16x16x32_bf16 a[88:91], a[8:11], a[156:159], a[88:91]
    s_add_u32 s35, s97, 20480
    buffer_load_dwordx4 v8, s[12:15], s35 offen sc1 lds
    v_mfma_f32_16x16x32_bf16 a[68:71], a[12:15], a[144:147], a[68:71]
    ds_read_b128 a[8:11], v8 offset:38912
    v_mfma_f32_16x16x32_bf16 a[76:79], a[12:15], a[148:151], a[76:79]
    buffer_load_dwordx4 a[172:175], v81, s[24:27], s6 offen offset:2048 sc1
    v_mfma_f32_16x16x32_bf16 a[84:87], a[12:15], a[152:155], a[84:87]
    v_mfma_f32_16x16x32_bf16 a[92:95], a[12:15], a[156:159], a[92:95]
    s_waitcnt lgkmcnt(3)
    v_mfma_f32_16x16x32_bf16 v[192:195], a[16:19], a[144:147], v[192:195]
    ds_read_b128 a[12:15], v8 offset:39936
    v_mfma_f32_16x16x32_bf16 v[200:203], a[16:19], a[148:151], v[200:203]
    v_mfma_f32_16x16x32_bf16 v[208:211], a[16:19], a[152:155], v[208:211]
    v_mfma_f32_16x16x32_bf16 v[216:219], a[16:19], a[156:159], v[216:219]
    buffer_load_dwordx4 a[176:179], v81, s[24:27], 0 offen offset:3072 sc1
    v_mfma_f32_16x16x32_bf16 v[196:199], a[20:23], a[144:147], v[196:199]
    s_waitcnt vmcnt(24)
    s_barrier
    ds_read_b128 a[16:19], v8 offset:40960
    v_mfma_f32_16x16x32_bf16 v[204:207], a[20:23], a[148:151], v[204:207]
    v_mfma_f32_16x16x32_bf16 v[212:215], a[20:23], a[152:155], v[212:215]
    v_mfma_f32_16x16x32_bf16 v[220:223], a[20:23], a[156:159], v[220:223]
    buffer_load_dwordx4 a[180:183], v81, s[24:27], s4 offen offset:3072 sc1
    v_mfma_f32_16x16x32_bf16 v[224:227], a[24:27], a[144:147], v[224:227]
    ds_read_b128 a[20:23], v8 offset:41984
    s_add_u32 m0, s37, 24576
    v_mfma_f32_16x16x32_bf16 v[232:235], a[24:27], a[148:151], v[232:235]
    s_add_u32 s35, s98, 20480
    buffer_load_dwordx4 v8, s[12:15], s35 offen sc1 lds
    v_mfma_f32_16x16x32_bf16 v[240:243], a[24:27], a[152:155], v[240:243]
    v_mfma_f32_16x16x32_bf16 v[248:251], a[24:27], a[156:159], v[248:251]
    v_mfma_f32_16x16x32_bf16 v[228:231], a[28:31], a[144:147], v[228:231]
    ds_read_b128 a[24:27], v8 offset:43008
    v_mfma_f32_16x16x32_bf16 v[236:239], a[28:31], a[148:151], v[236:239]
    buffer_load_dwordx4 a[184:187], v81, s[24:27], s5 offen offset:3072 sc1
    v_mfma_f32_16x16x32_bf16 v[244:247], a[28:31], a[152:155], v[244:247]
    v_mfma_f32_16x16x32_bf16 v[252:255], a[28:31], a[156:159], v[252:255]
    s_waitcnt lgkmcnt(3)
    v_mfma_f32_16x16x32_bf16 v[48:51], a[0:3], a[144:147], v[48:51]
    ds_read_b128 a[28:31], v8 offset:44032
    v_mfma_f32_16x16x32_bf16 v[56:59], a[0:3], a[148:151], v[56:59]
    buffer_load_dwordx4 a[188:191], v81, s[24:27], s6 offen offset:3072 sc1
    v_mfma_f32_16x16x32_bf16 v[64:67], a[0:3], a[152:155], v[64:67]
    v_mfma_f32_16x16x32_bf16 v[72:75], a[0:3], a[156:159], v[72:75]
    v_mfma_f32_16x16x32_bf16 v[52:55], a[4:7], a[144:147], v[52:55]
    ds_read_b128 a[0:3], v8 offset:45056
    s_add_u32 m0, s37, 28672
    v_mfma_f32_16x16x32_bf16 v[60:63], a[4:7], a[148:151], v[60:63]
    s_add_u32 s35, s96, 40960
    buffer_load_dwordx4 v8, s[12:15], s35 offen sc1 lds
    v_mfma_f32_16x16x32_bf16 v[68:71], a[4:7], a[152:155], v[68:71]
    v_mfma_f32_16x16x32_bf16 v[76:79], a[4:7], a[156:159], v[76:79]
    buffer_load_dwordx4 a[192:195], v82, s[24:27], 0 offen offset:2048 sc1
    v_mfma_f32_16x16x32_bf16 v[16:19], a[8:11], a[144:147], v[16:19]
    ds_read_b128 a[4:7], v8 offset:46080
    v_mfma_f32_16x16x32_bf16 v[24:27], a[8:11], a[148:151], v[24:27]
    v_mfma_f32_16x16x32_bf16 v[32:35], a[8:11], a[152:155], v[32:35]
    v_mfma_f32_16x16x32_bf16 v[40:43], a[8:11], a[156:159], v[40:43]
    buffer_load_dwordx4 a[196:199], v82, s[24:27], s4 offen offset:2048 sc1
    v_mfma_f32_16x16x32_bf16 v[20:23], a[12:15], a[144:147], v[20:23]
    ds_read_b128 a[8:11], v8 offset:47104
    v_mfma_f32_16x16x32_bf16 v[28:31], a[12:15], a[148:151], v[28:31]
    v_mfma_f32_16x16x32_bf16 v[36:39], a[12:15], a[152:155], v[36:39]
    v_mfma_f32_16x16x32_bf16 v[44:47], a[12:15], a[156:159], v[44:47]
    s_waitcnt lgkmcnt(3)
    v_mfma_f32_16x16x32_bf16 a[64:67], a[16:19], v[96:99], a[64:67]
    ds_read_b128 a[12:15], v8 offset:48128
    v_mfma_f32_16x16x32_bf16 a[72:75], a[16:19], v[100:103], a[72:75]
    buffer_load_dwordx4 a[200:203], v82, s[24:27], s5 offen offset:2048 sc1
    v_mfma_f32_16x16x32_bf16 a[80:83], a[16:19], v[104:107], a[80:83]
    s_add_u32 m0, s37, 32768
    v_mfma_f32_16x16x32_bf16 a[88:91], a[16:19], v[108:111], a[88:91]
    s_add_u32 s35, s97, 40960
    buffer_load_dwordx4 v8, s[12:15], s35 offen sc1 lds
    v_mfma_f32_16x16x32_bf16 a[68:71], a[20:23], v[96:99], a[68:71]
    ds_read_b128 a[16:19], v8 offset:49152
    v_mfma_f32_16x16x32_bf16 a[76:79], a[20:23], v[100:103], a[76:79]
    buffer_load_dwordx4 a[204:207], v82, s[24:27], s6 offen offset:2048 sc1
    v_mfma_f32_16x16x32_bf16 a[84:87], a[20:23], v[104:107], a[84:87]
    v_mfma_f32_16x16x32_bf16 a[92:95], a[20:23], v[108:111], a[92:95]
    v_mfma_f32_16x16x32_bf16 v[192:195], a[24:27], v[96:99], v[192:195]
    ds_read_b128 a[20:23], v8 offset:50176
    v_mfma_f32_16x16x32_bf16 v[200:203], a[24:27], v[100:103], v[200:203]
    v_mfma_f32_16x16x32_bf16 v[208:211], a[24:27], v[104:107], v[208:211]
    v_mfma_f32_16x16x32_bf16 v[216:219], a[24:27], v[108:111], v[216:219]
    buffer_load_dwordx4 a[208:211], v82, s[24:27], 0 offen offset:3072 sc1
    v_mfma_f32_16x16x32_bf16 v[196:199], a[28:31], v[96:99], v[196:199]
    ds_read_b128 a[24:27], v8 offset:51200
    v_mfma_f32_16x16x32_bf16 v[204:207], a[28:31], v[100:103], v[204:207]
    v_mfma_f32_16x16x32_bf16 v[212:215], a[28:31], v[104:107], v[212:215]
    v_mfma_f32_16x16x32_bf16 v[220:223], a[28:31], v[108:111], v[220:223]
    buffer_load_dwordx4 a[212:215], v82, s[24:27], s4 offen offset:3072 sc1
    s_waitcnt lgkmcnt(3)
    v_mfma_f32_16x16x32_bf16 v[224:227], a[0:3], v[96:99], v[224:227]
    ds_read_b128 a[28:31], v8 offset:52224
    s_add_u32 m0, s37, 36864
    v_mfma_f32_16x16x32_bf16 v[232:235], a[0:3], v[100:103], v[232:235]
    s_add_u32 s35, s98, 40960
    buffer_load_dwordx4 v8, s[12:15], s35 offen sc1 lds
    v_mfma_f32_16x16x32_bf16 v[240:243], a[0:3], v[104:107], v[240:243]
    v_mfma_f32_16x16x32_bf16 v[248:251], a[0:3], v[108:111], v[248:251]
    v_mfma_f32_16x16x32_bf16 v[228:231], a[4:7], v[96:99], v[228:231]
    ds_read_b128 a[0:3], v8 offset:53248
    v_mfma_f32_16x16x32_bf16 v[236:239], a[4:7], v[100:103], v[236:239]
    buffer_load_dwordx4 a[216:219], v82, s[24:27], s5 offen offset:3072 sc1
    v_mfma_f32_16x16x32_bf16 v[244:247], a[4:7], v[104:107], v[244:247]
    v_mfma_f32_16x16x32_bf16 v[252:255], a[4:7], v[108:111], v[252:255]
    v_mfma_f32_16x16x32_bf16 v[48:51], a[8:11], v[96:99], v[48:51]
    ds_read_b128 a[4:7], v8 offset:54272
    v_mfma_f32_16x16x32_bf16 v[56:59], a[8:11], v[100:103], v[56:59]
    buffer_load_dwordx4 a[220:223], v82, s[24:27], s6 offen offset:3072 sc1
    v_mfma_f32_16x16x32_bf16 v[64:67], a[8:11], v[104:107], v[64:67]
    v_mfma_f32_16x16x32_bf16 v[72:75], a[8:11], v[108:111], v[72:75]
    v_mfma_f32_16x16x32_bf16 v[52:55], a[12:15], v[96:99], v[52:55]
    ds_read_b128 a[8:11], v8 offset:55296
    v_mfma_f32_16x16x32_bf16 v[60:63], a[12:15], v[100:103], v[60:63]
    v_mfma_f32_16x16x32_bf16 v[68:71], a[12:15], v[104:107], v[68:71]
    v_add_u32 v80, 4096, v80
    v_mfma_f32_16x16x32_bf16 v[76:79], a[12:15], v[108:111], v[76:79]
    buffer_load_dwordx4 a[224:227], v80, s[24:27], 0 offen offset:0 sc1
    s_waitcnt lgkmcnt(3)
    v_mfma_f32_16x16x32_bf16 v[16:19], a[16:19], v[96:99], v[16:19]
    ds_read_b128 a[12:15], v8 offset:56320
    s_add_u32 m0, s37, 40960
    v_mfma_f32_16x16x32_bf16 v[24:27], a[16:19], v[100:103], v[24:27]
    s_add_u32 s35, s97, 22528
    buffer_load_dwordx4 v8, s[12:15], s35 offen sc1 lds
    v_mfma_f32_16x16x32_bf16 v[32:35], a[16:19], v[104:107], v[32:35]
    v_mfma_f32_16x16x32_bf16 v[40:43], a[16:19], v[108:111], v[40:43]
    buffer_load_dwordx4 a[228:231], v80, s[24:27], s4 offen offset:0 sc1
    v_mfma_f32_16x16x32_bf16 v[20:23], a[20:23], v[96:99], v[20:23]
    ds_read_b128 a[16:19], v8 offset:57344
    v_mfma_f32_16x16x32_bf16 v[28:31], a[20:23], v[100:103], v[28:31]
    v_mfma_f32_16x16x32_bf16 v[36:39], a[20:23], v[104:107], v[36:39]
    v_mfma_f32_16x16x32_bf16 v[44:47], a[20:23], v[108:111], v[44:47]
    s_waitcnt vmcnt(36)
    v_mfma_f32_16x16x32_bf16 a[64:67], a[24:27], v[112:115], a[64:67]
    ds_read_b128 a[20:23], v8 offset:58368
    v_mfma_f32_16x16x32_bf16 a[72:75], a[24:27], v[116:119], a[72:75]
    buffer_load_dwordx4 a[232:235], v80, s[24:27], s5 offen offset:0 sc1
    v_mfma_f32_16x16x32_bf16 a[80:83], a[24:27], v[120:123], a[80:83]
    s_add_u32 m0, s37, 45056
    v_mfma_f32_16x16x32_bf16 a[88:91], a[24:27], v[124:127], a[88:91]
    s_add_u32 s35, s98, 22528
    buffer_load_dwordx4 v8, s[12:15], s35 offen sc1 lds
    v_mfma_f32_16x16x32_bf16 a[68:71], a[28:31], v[112:115], a[68:71]
    ds_read_b128 a[24:27], v8 offset:59392
    v_mfma_f32_16x16x32_bf16 a[76:79], a[28:31], v[116:119], a[76:79]
    buffer_load_dwordx4 a[236:239], v80, s[24:27], s6 offen offset:0 sc1
    v_mfma_f32_16x16x32_bf16 a[84:87], a[28:31], v[120:123], a[84:87]
    v_mfma_f32_16x16x32_bf16 a[92:95], a[28:31], v[124:127], a[92:95]
    s_waitcnt lgkmcnt(3)
    v_mfma_f32_16x16x32_bf16 v[192:195], a[0:3], v[112:115], v[192:195]
    ds_read_b128 a[28:31], v8 offset:60416
    v_mfma_f32_16x16x32_bf16 v[200:203], a[0:3], v[116:119], v[200:203]
    v_mfma_f32_16x16x32_bf16 v[208:211], a[0:3], v[120:123], v[208:211]
    v_mfma_f32_16x16x32_bf16 v[216:219], a[0:3], v[124:127], v[216:219]
    buffer_load_dwordx4 a[240:243], v80, s[24:27], 0 offen offset:1024 sc1
    v_mfma_f32_16x16x32_bf16 v[196:199], a[4:7], v[112:115], v[196:199]
    s_waitcnt vmcnt(28)
    s_barrier
    ds_read_b128 a[0:3], v1 offset:0
    v_mfma_f32_16x16x32_bf16 v[204:207], a[4:7], v[116:119], v[204:207]
    v_mfma_f32_16x16x32_bf16 v[212:215], a[4:7], v[120:123], v[212:215]
    v_mfma_f32_16x16x32_bf16 v[220:223], a[4:7], v[124:127], v[220:223]
    buffer_load_dwordx4 a[244:247], v80, s[24:27], s4 offen offset:1024 sc1
    v_mfma_f32_16x16x32_bf16 v[224:227], a[8:11], v[112:115], v[224:227]
    ds_read_b128 a[4:7], v1 offset:1024
    s_add_u32 m0, s37, 49152
    v_mfma_f32_16x16x32_bf16 v[232:235], a[8:11], v[116:119], v[232:235]
    s_add_u32 s35, s96, 43008
    buffer_load_dwordx4 v8, s[12:15], s35 offen sc1 lds
    v_mfma_f32_16x16x32_bf16 v[240:243], a[8:11], v[120:123], v[240:243]
    buffer_load_dword v11, v12, s[76:79], 0 offen sc1
    v_mfma_f32_16x16x32_bf16 v[248:251], a[8:11], v[124:127], v[248:251]
    v_mfma_f32_16x16x32_bf16 v[228:231], a[12:15], v[112:115], v[228:231]
    ds_read_b128 a[8:11], v1 offset:2048
    v_mfma_f32_16x16x32_bf16 v[236:239], a[12:15], v[116:119], v[236:239]
    buffer_load_dwordx4 a[248:251], v80, s[24:27], s5 offen offset:1024 sc1
    v_mfma_f32_16x16x32_bf16 v[244:247], a[12:15], v[120:123], v[244:247]
    v_mfma_f32_16x16x32_bf16 v[252:255], a[12:15], v[124:127], v[252:255]
    s_waitcnt lgkmcnt(3)
    v_mfma_f32_16x16x32_bf16 v[48:51], a[16:19], v[112:115], v[48:51]
    ds_read_b128 a[12:15], v1 offset:3072
    v_mfma_f32_16x16x32_bf16 v[56:59], a[16:19], v[116:119], v[56:59]
    buffer_load_dwordx4 a[252:255], v80, s[24:27], s6 offen offset:1024 sc1
    v_mfma_f32_16x16x32_bf16 v[64:67], a[16:19], v[120:123], v[64:67]
    s_add_u32 m0, s37, 53248
    v_mfma_f32_16x16x32_bf16 v[72:75], a[16:19], v[124:127], v[72:75]
    s_add_u32 s35, s97, 43008
    buffer_load_dwordx4 v8, s[12:15], s35 offen sc1 lds
    v_mfma_f32_16x16x32_bf16 v[52:55], a[20:23], v[112:115], v[52:55]
    ds_read_b128 a[16:19], v1 offset:4096
    v_mfma_f32_16x16x32_bf16 v[60:63], a[20:23], v[116:119], v[60:63]
    v_mfma_f32_16x16x32_bf16 v[68:71], a[20:23], v[120:123], v[68:71]
    v_add_u32 v81, 4096, v81
    v_mfma_f32_16x16x32_bf16 v[76:79], a[20:23], v[124:127], v[76:79]
    buffer_load_dwordx4 a[96:99], v81, s[24:27], 0 offen offset:0 sc1
    v_mfma_f32_16x16x32_bf16 v[16:19], a[24:27], v[112:115], v[16:19]
    ds_read_b128 a[20:23], v1 offset:5120
    v_mfma_f32_16x16x32_bf16 v[24:27], a[24:27], v[116:119], v[24:27]
    v_mfma_f32_16x16x32_bf16 v[32:35], a[24:27], v[120:123], v[32:35]
    v_mfma_f32_16x16x32_bf16 v[40:43], a[24:27], v[124:127], v[40:43]
    buffer_load_dwordx4 a[100:103], v81, s[24:27], s4 offen offset:0 sc1
    v_mfma_f32_16x16x32_bf16 v[20:23], a[28:31], v[112:115], v[20:23]
    ds_read_b128 a[24:27], v1 offset:6144
    v_mfma_f32_16x16x32_bf16 v[28:31], a[28:31], v[116:119], v[28:31]
    v_mfma_f32_16x16x32_bf16 v[36:39], a[28:31], v[120:123], v[36:39]
    s_add_u32 m0, s37, 57344
    v_mfma_f32_16x16x32_bf16 v[44:47], a[28:31], v[124:127], v[44:47]
    s_add_u32 s35, s98, 43008
    buffer_load_dwordx4 v8, s[12:15], s35 offen sc1 lds
    s_lshl_b32 s37, s32, 10
    s_waitcnt lgkmcnt(3)
    v_mfma_f32_16x16x32_bf16 a[64:67], a[0:3], v[128:131], a[64:67]
    ds_read_b128 a[28:31], v1 offset:7168
    v_mfma_f32_16x16x32_bf16 a[72:75], a[0:3], v[132:135], a[72:75]
    buffer_load_dwordx4 a[104:107], v81, s[24:27], s5 offen offset:0 sc1
    v_mfma_f32_16x16x32_bf16 a[80:83], a[0:3], v[136:139], a[80:83]
    v_mfma_f32_16x16x32_bf16 a[88:91], a[0:3], v[140:143], a[88:91]
    v_mfma_f32_16x16x32_bf16 a[68:71], a[4:7], v[128:131], a[68:71]
    ds_read_b128 a[0:3], v1 offset:8192
    v_mfma_f32_16x16x32_bf16 a[76:79], a[4:7], v[132:135], a[76:79]
    buffer_load_dwordx4 a[108:111], v81, s[24:27], s6 offen offset:0 sc1
    v_mfma_f32_16x16x32_bf16 a[84:87], a[4:7], v[136:139], a[84:87]
    s_add_u32 m0, s37, 0
    v_mfma_f32_16x16x32_bf16 a[92:95], a[4:7], v[140:143], a[92:95]
    s_add_u32 s35, s97, 24576
    buffer_load_dwordx4 v8, s[12:15], s35 offen sc1 lds
    v_mfma_f32_16x16x32_bf16 v[192:195], a[8:11], v[128:131], v[192:195]
    ds_read_b128 a[4:7], v1 offset:9216
    v_mfma_f32_16x16x32_bf16 v[200:203], a[8:11], v[132:135], v[200:203]
    v_mfma_f32_16x16x32_bf16 v[208:211], a[8:11], v[136:139], v[208:211]
    v_mfma_f32_16x16x32_bf16 v[216:219], a[8:11], v[140:143], v[216:219]
    buffer_load_dwordx4 a[112:115], v81, s[24:27], 0 offen offset:1024 sc1
    v_mfma_f32_16x16x32_bf16 v[196:199], a[12:15], v[128:131], v[196:199]
    ds_read_b128 a[8:11], v1 offset:10240
    s_add_u32 m0, s37, 4096
    v_mfma_f32_16x16x32_bf16 v[204:207], a[12:15], v[132:135], v[204:207]
    s_add_u32 s35, s98, 24576
    buffer_load_dwordx4 v8, s[12:15], s35 offen sc1 lds
    v_mfma_f32_16x16x32_bf16 v[212:215], a[12:15], v[136:139], v[212:215]
    v_mfma_f32_16x16x32_bf16 v[220:223], a[12:15], v[140:143], v[220:223]
    buffer_load_dwordx4 a[116:119], v81, s[24:27], s4 offen offset:1024 sc1
    s_waitcnt lgkmcnt(3)
    v_mfma_f32_16x16x32_bf16 v[224:227], a[16:19], v[128:131], v[224:227]
    ds_read_b128 a[12:15], v1 offset:11264
    v_mfma_f32_16x16x32_bf16 v[232:235], a[16:19], v[132:135], v[232:235]
    v_mfma_f32_16x16x32_bf16 v[240:243], a[16:19], v[136:139], v[240:243]
    v_mfma_f32_16x16x32_bf16 v[248:251], a[16:19], v[140:143], v[248:251]
    v_mfma_f32_16x16x32_bf16 v[228:231], a[20:23], v[128:131], v[228:231]
    ds_read_b128 a[16:19], v1 offset:12288
    v_mfma_f32_16x16x32_bf16 v[236:239], a[20:23], v[132:135], v[236:239]
    buffer_load_dwordx4 a[120:123], v81, s[24:27], s5 offen offset:1024 sc1
    v_mfma_f32_16x16x32_bf16 v[244:247], a[20:23], v[136:139], v[244:247]
    s_add_u32 m0, s37, 8192
    v_mfma_f32_16x16x32_bf16 v[252:255], a[20:23], v[140:143], v[252:255]
    s_add_u32 s35, s96, 45056
    buffer_load_dwordx4 v8, s[12:15], s35 offen sc1 lds
    v_mfma_f32_16x16x32_bf16 v[48:51], a[24:27], v[128:131], v[48:51]
    ds_read_b128 a[20:23], v1 offset:13312
    v_mfma_f32_16x16x32_bf16 v[56:59], a[24:27], v[132:135], v[56:59]
    buffer_load_dwordx4 a[124:127], v81, s[24:27], s6 offen offset:1024 sc1
    v_mfma_f32_16x16x32_bf16 v[64:67], a[24:27], v[136:139], v[64:67]
    v_mfma_f32_16x16x32_bf16 v[72:75], a[24:27], v[140:143], v[72:75]
    v_mfma_f32_16x16x32_bf16 v[52:55], a[28:31], v[128:131], v[52:55]
    ds_read_b128 a[24:27], v1 offset:14336
    s_add_u32 m0, s37, 12288
    v_mfma_f32_16x16x32_bf16 v[60:63], a[28:31], v[132:135], v[60:63]
    s_add_u32 s35, s97, 45056
    buffer_load_dwordx4 v8, s[12:15], s35 offen sc1 lds
    v_mfma_f32_16x16x32_bf16 v[68:71], a[28:31], v[136:139], v[68:71]
    v_add_u32 v82, 4096, v82
    v_mfma_f32_16x16x32_bf16 v[76:79], a[28:31], v[140:143], v[76:79]
    buffer_load_dwordx4 a[128:131], v82, s[24:27], 0 offen offset:0 sc1
    s_waitcnt lgkmcnt(3)
    v_mfma_f32_16x16x32_bf16 v[16:19], a[0:3], v[128:131], v[16:19]
    ds_read_b128 a[28:31], v1 offset:15360
    v_mfma_f32_16x16x32_bf16 v[24:27], a[0:3], v[132:135], v[24:27]
    v_mfma_f32_16x16x32_bf16 v[32:35], a[0:3], v[136:139], v[32:35]
    v_mfma_f32_16x16x32_bf16 v[40:43], a[0:3], v[140:143], v[40:43]
    buffer_load_dwordx4 a[132:135], v82, s[24:27], s4 offen offset:0 sc1
    v_mfma_f32_16x16x32_bf16 v[20:23], a[4:7], v[128:131], v[20:23]
    ds_read_b128 a[0:3], v1 offset:16384
    s_add_u32 m0, s37, 16384
    v_mfma_f32_16x16x32_bf16 v[28:31], a[4:7], v[132:135], v[28:31]
    s_add_u32 s35, s98, 45056
    buffer_load_dwordx4 v8, s[12:15], s35 offen sc1 lds
    v_mfma_f32_16x16x32_bf16 v[36:39], a[4:7], v[136:139], v[36:39]
    v_mfma_f32_16x16x32_bf16 v[44:47], a[4:7], v[140:143], v[44:47]
    v_mfma_f32_16x16x32_bf16 a[64:67], a[8:11], v[144:147], a[64:67]
    ds_read_b128 a[4:7], v1 offset:17408
    s_mul_i32 s3, s43, 245760
    s_add_u32 s3, s3, 83886080
    s_add_u32 s68, s10, s3
    s_addc_u32 s69, s11, 0
    s_mov_b32 s70, 245760
    s_mov_b32 s71, 0x00020000
    s_mul_i32 s41, s32, 3072
    s_mov_b32 s50, s41
    s_waitcnt vmcnt(19)
    v_cmp_ne_u32 vcc, 16, v11
    s_cbranch_vccnz MR_spin
MR_ok:
    v_mfma_f32_16x16x32_bf16 a[72:75], a[8:11], v[148:151], a[72:75]
    buffer_load_dwordx4 a[136:139], v82, s[24:27], s5 offen offset:0 sc1
    v_mfma_f32_16x16x32_bf16 a[80:83], a[8:11], v[152:155], a[80:83]
    v_mfma_f32_16x16x32_bf16 a[88:91], a[8:11], v[156:159], a[88:91]
    v_mfma_f32_16x16x32_bf16 a[68:71], a[12:15], v[144:147], a[68:71]
    ds_read_b128 a[8:11], v1 offset:18432
    v_mfma_f32_16x16x32_bf16 a[76:79], a[12:15], v[148:151], a[76:79]
    buffer_load_dwordx4 a[140:143], v82, s[24:27], s6 offen offset:0 sc1
    v_mfma_f32_16x16x32_bf16 a[84:87], a[12:15], v[152:155], a[84:87]
    s_add_u32 m0, s50, 73728
    v_mfma_f32_16x16x32_bf16 a[92:95], a[12:15], v[156:159], a[92:95]
    buffer_load_dwordx4 v8, s[68:71], s41 offen offset:0 sc1 lds
    s_waitcnt lgkmcnt(3)
    v_mfma_f32_16x16x32_bf16 v[192:195], a[16:19], v[144:147], v[192:195]
    ds_read_b128 a[12:15], v1 offset:19456
    v_mfma_f32_16x16x32_bf16 v[200:203], a[16:19], v[148:151], v[200:203]
    buffer_load_dwordx4 v8, s[68:71], s41 offen offset:1024 sc1 lds
    v_mfma_f32_16x16x32_bf16 v[208:211], a[16:19], v[152:155], v[208:211]
    v_mfma_f32_16x16x32_bf16 v[216:219], a[16:19], v[156:159], v[216:219]
    buffer_load_dwordx4 a[144:147], v82, s[24:27], 0 offen offset:1024 sc1
    v_mfma_f32_16x16x32_bf16 v[196:199], a[20:23], v[144:147], v[196:199]
    s_barrier
    ds_read_b128 a[16:19], v1 offset:20480
    v_mfma_f32_16x16x32_bf16 v[204:207], a[20:23], v[148:151], v[204:207]
    buffer_load_dwordx4 v8, s[68:71], s41 offen offset:2048 sc1 lds
    s_add_u32 s41, s41, 12288
    v_mfma_f32_16x16x32_bf16 v[212:215], a[20:23], v[152:155], v[212:215]
    v_mfma_f32_16x16x32_bf16 v[220:223], a[20:23], v[156:159], v[220:223]
    buffer_load_dwordx4 a[148:151], v82, s[24:27], s4 offen offset:1024 sc1
    v_mfma_f32_16x16x32_bf16 v[224:227], a[24:27], v[144:147], v[224:227]
    ds_read_b128 a[20:23], v1 offset:21504
    s_add_u32 m0, s50, 86016
    v_mfma_f32_16x16x32_bf16 v[232:235], a[24:27], v[148:151], v[232:235]
    buffer_load_dwordx4 v8, s[68:71], s41 offen offset:0 sc1 lds
    v_mfma_f32_16x16x32_bf16 v[240:243], a[24:27], v[152:155], v[240:243]
    v_mfma_f32_16x16x32_bf16 v[248:251], a[24:27], v[156:159], v[248:251]
    buffer_load_dwordx4 v8, s[68:71], s41 offen offset:1024 sc1 lds
    v_mfma_f32_16x16x32_bf16 v[228:231], a[28:31], v[144:147], v[228:231]
    ds_read_b128 a[24:27], v1 offset:22528
    v_mfma_f32_16x16x32_bf16 v[236:239], a[28:31], v[148:151], v[236:239]
    buffer_load_dwordx4 a[152:155], v82, s[24:27], s5 offen offset:1024 sc1
    v_mfma_f32_16x16x32_bf16 v[244:247], a[28:31], v[152:155], v[244:247]
    v_mfma_f32_16x16x32_bf16 v[252:255], a[28:31], v[156:159], v[252:255]
    buffer_load_dwordx4 v8, s[68:71], s41 offen offset:2048 sc1 lds
    s_add_u32 s41, s41, 12288
    s_waitcnt lgkmcnt(3)
    v_mfma_f32_16x16x32_bf16 v[48:51], a[0:3], v[144:147], v[48:51]
    ds_read_b128 a[28:31], v1 offset:23552
    v_mfma_f32_16x16x32_bf16 v[56:59], a[0:3], v[148:151], v[56:59]
    buffer_load_dwordx4 a[156:159], v82, s[24:27], s6 offen offset:1024 sc1
    v_mfma_f32_16x16x32_bf16 v[64:67], a[0:3], v[152:155], v[64:67]
    v_mfma_f32_16x16x32_bf16 v[72:75], a[0:3], v[156:159], v[72:75]
    v_mfma_f32_16x16x32_bf16 v[52:55], a[4:7], v[144:147], v[52:55]
    ds_read_b128 a[0:3], v1 offset:24576
    v_mfma_f32_16x16x32_bf16 v[60:63], a[4:7], v[148:151], v[60:63]
    v_mfma_f32_16x16x32_bf16 v[68:71], a[4:7], v[152:155], v[68:71]
    v_mfma_f32_16x16x32_bf16 v[76:79], a[4:7], v[156:159], v[76:79]
    v_mfma_f32_16x16x32_bf16 v[16:19], a[8:11], v[144:147], v[16:19]
    ds_read_b128 a[4:7], v1 offset:25600
    v_mfma_f32_16x16x32_bf16 v[24:27], a[8:11], v[148:151], v[24:27]
    v_mfma_f32_16x16x32_bf16 v[32:35], a[8:11], v[152:155], v[32:35]
    v_mfma_f32_16x16x32_bf16 v[40:43], a[8:11], v[156:159], v[40:43]
    v_mfma_f32_16x16x32_bf16 v[20:23], a[12:15], v[144:147], v[20:23]
    ds_read_b128 a[8:11], v1 offset:26624
    v_mfma_f32_16x16x32_bf16 v[28:31], a[12:15], v[148:151], v[28:31]
    v_mfma_f32_16x16x32_bf16 v[36:39], a[12:15], v[152:155], v[36:39]
    v_mfma_f32_16x16x32_bf16 v[44:47], a[12:15], v[156:159], v[44:47]
    s_waitcnt lgkmcnt(3)
    v_mfma_f32_16x16x32_bf16 a[64:67], a[16:19], a[160:163], a[64:67]
    ds_read_b128 a[12:15], v1 offset:27648
    v_mfma_f32_16x16x32_bf16 a[72:75], a[16:19], a[164:167], a[72:75]
    v_mfma_f32_16x16x32_bf16 a[68:71], a[20:23], a[160:163], a[68:71]
    ds_read_b128 a[16:19], v1 offset:28672
    v_mfma_f32_16x16x32_bf16 a[76:79], a[20:23], a[164:167], a[76:79]
    v_mfma_f32_16x16x32_bf16 a[64:67], a[24:27], a[176:179], a[64:67]
    ds_read_b128 a[20:23], v1 offset:29696
    v_mfma_f32_16x16x32_bf16 a[72:75], a[24:27], a[180:183], a[72:75]
    v_mfma_f32_16x16x32_bf16 a[68:71], a[28:31], a[176:179], a[68:71]
    ds_read_b128 a[24:27], v1 offset:30720
    v_mfma_f32_16x16x32_bf16 a[76:79], a[28:31], a[180:183], a[76:79]
    s_waitcnt lgkmcnt(3)
    v_mfma_f32_16x16x32_bf16 a[64:67], a[0:3], a[192:195], a[64:67]
    ds_read_b128 a[28:31], v1 offset:31744
    v_mfma_f32_16x16x32_bf16 a[72:75], a[0:3], a[196:199], a[72:75]
    v_mfma_f32_16x16x32_bf16 a[68:71], a[4:7], a[192:195], a[68:71]
    ds_read_b128 a[0:3], v1 offset:32768
    v_mfma_f32_16x16x32_bf16 a[76:79], a[4:7], a[196:199], a[76:79]
    v_mfma_f32_16x16x32_bf16 a[64:67], a[8:11], a[208:211], a[64:67]
    ds_read_b128 a[4:7], v1 offset:33792
    v_mfma_f32_16x16x32_bf16 a[72:75], a[8:11], a[212:215], a[72:75]
    v_mfma_f32_16x16x32_bf16 a[68:71], a[12:15], a[208:211], a[68:71]
    ds_read_b128 a[8:11], v1 offset:34816
    s_add_u32 m0, s37, 20480
    v_mfma_f32_16x16x32_bf16 a[76:79], a[12:15], a[212:215], a[76:79]
    s_add_u32 s35, s97, 26624
    buffer_load_dwordx4 v8, s[12:15], s35 offen sc1 lds
    s_waitcnt lgkmcnt(3)
    v_mfma_f32_16x16x32_bf16 a[64:67], a[16:19], a[224:227], a[64:67]
    ds_read_b128 a[12:15], v1 offset:35840
    v_mfma_f32_16x16x32_bf16 a[72:75], a[16:19], a[228:231], a[72:75]
    v_mfma_f32_16x16x32_bf16 a[68:71], a[20:23], a[224:227], a[68:71]
    ds_read_b128 a[16:19], v1 offset:36864
    v_mfma_f32_16x16x32_bf16 a[76:79], a[20:23], a[228:231], a[76:79]
    s_waitcnt vmcnt(30)
    v_mfma_f32_16x16x32_bf16 a[64:67], a[24:27], a[240:243], a[64:67]
    ds_read_b128 a[20:23], v1 offset:37888
    s_add_u32 m0, s37, 24576
    v_mfma_f32_16x16x32_bf16 a[72:75], a[24:27], a[244:247], a[72:75]
    s_add_u32 s35, s98, 26624
    buffer_load_dwordx4 v8, s[12:15], s35 offen sc1 lds
    v_mfma_f32_16x16x32_bf16 a[68:71], a[28:31], a[240:243], a[68:71]
    ds_read_b128 a[24:27], v1 offset:38912
    v_mfma_f32_16x16x32_bf16 a[76:79], a[28:31], a[244:247], a[76:79]
    s_waitcnt vmcnt(25) lgkmcnt(3)
    v_mfma_f32_16x16x32_bf16 a[64:67], a[0:3], a[96:99], a[64:67]
    ds_read_b128 a[28:31], v1 offset:39936
    v_mfma_f32_16x16x32_bf16 a[72:75], a[0:3], a[100:103], a[72:75]
    v_mfma_f32_16x16x32_bf16 a[68:71], a[4:7], a[96:99], a[68:71]
    ds_read_b128 a[0:3], v1 offset:20480
    s_add_u32 m0, s37, 28672
    v_mfma_f32_16x16x32_bf16 a[76:79], a[4:7], a[100:103], a[76:79]
    s_add_u32 s35, s96, 47104
    buffer_load_dwordx4 v8, s[12:15], s35 offen sc1 lds
    s_waitcnt vmcnt(19)
    v_mfma_f32_16x16x32_bf16 a[64:67], a[8:11], a[112:115], a[64:67]
    ds_read_b128 a[4:7], v1 offset:21504
    v_mfma_f32_16x16x32_bf16 a[72:75], a[8:11], a[116:119], a[72:75]
    v_mfma_f32_16x16x32_bf16 a[68:71], a[12:15], a[112:115], a[68:71]
    ds_read_b128 a[8:11], v1 offset:22528
    v_mfma_f32_16x16x32_bf16 a[76:79], a[12:15], a[116:119], a[76:79]
    s_waitcnt vmcnt(13) lgkmcnt(3)
    v_mfma_f32_16x16x32_bf16 a[64:67], a[16:19], a[128:131], a[64:67]
    ds_read_b128 a[12:15], v1 offset:23552
    s_add_u32 m0, s37, 32768
    v_mfma_f32_16x16x32_bf16 a[72:75], a[16:19], a[132:135], a[72:75]
    s_add_u32 s35, s97, 47104
    buffer_load_dwordx4 v8, s[12:15], s35 offen sc1 lds
    v_mfma_f32_16x16x32_bf16 a[68:71], a[20:23], a[128:131], a[68:71]
    ds_read_b128 a[16:19], v1 offset:24576
    v_mfma_f32_16x16x32_bf16 a[76:79], a[20:23], a[132:135], a[76:79]
    s_waitcnt vmcnt(4)
    v_mfma_f32_16x16x32_bf16 a[64:67], a[24:27], a[144:147], a[64:67]
    ds_read_b128 a[20:23], v1 offset:25600
    v_mfma_f32_16x16x32_bf16 a[72:75], a[24:27], a[148:151], a[72:75]
    v_mfma_f32_16x16x32_bf16 a[68:71], a[28:31], a[144:147], a[68:71]
    ds_read_b128 a[24:27], v1 offset:26624
    s_add_u32 m0, s37, 36864
    v_mfma_f32_16x16x32_bf16 a[76:79], a[28:31], a[148:151], a[76:79]
    s_add_u32 s35, s98, 47104
    buffer_load_dwordx4 v8, s[12:15], s35 offen sc1 lds
    s_waitcnt lgkmcnt(3)
    v_mfma_f32_16x16x32_bf16 a[80:83], a[0:3], a[168:171], a[80:83]
    ds_read_b128 a[28:31], v1 offset:27648
    v_mfma_f32_16x16x32_bf16 a[88:91], a[0:3], a[172:175], a[88:91]
    v_mfma_f32_16x16x32_bf16 a[84:87], a[4:7], a[168:171], a[84:87]
    ds_read_b128 a[0:3], v1 offset:28672
    v_mfma_f32_16x16x32_bf16 a[92:95], a[4:7], a[172:175], a[92:95]
    v_accvgpr_read_b32 v176, a64
    v_mfma_f32_16x16x32_bf16 a[80:83], a[8:11], a[184:187], a[80:83]
    ds_read_b128 a[4:7], v1 offset:29696
    v_accvgpr_read_b32 v177, a65
    v_mfma_f32_16x16x32_bf16 a[88:91], a[8:11], a[188:191], a[88:91]
    v_accvgpr_read_b32 v178, a66
    v_mfma_f32_16x16x32_bf16 a[84:87], a[12:15], a[184:187], a[84:87]
    ds_read_b128 a[8:11], v1 offset:30720
    v_accvgpr_read_b32 v179, a67
    v_mfma_f32_16x16x32_bf16 a[92:95], a[12:15], a[188:191], a[92:95]
    v_accvgpr_read_b32 v180, a68
    s_waitcnt lgkmcnt(3)
    v_mfma_f32_16x16x32_bf16 a[80:83], a[16:19], a[200:203], a[80:83]
    ds_read_b128 a[12:15], v1 offset:31744
    v_accvgpr_read_b32 v181, a69
    v_mfma_f32_16x16x32_bf16 a[88:91], a[16:19], a[204:207], a[88:91]
    v_accvgpr_read_b32 v182, a70
    v_mfma_f32_16x16x32_bf16 a[84:87], a[20:23], a[200:203], a[84:87]
    ds_read_b128 a[16:19], v1 offset:32768
    v_accvgpr_read_b32 v183, a71
    v_mfma_f32_16x16x32_bf16 a[92:95], a[20:23], a[204:207], a[92:95]
    v_cvt_pk_bf16_f32 v176, v176, v177
    v_mfma_f32_16x16x32_bf16 a[80:83], a[24:27], a[216:219], a[80:83]
    ds_read_b128 a[20:23], v1 offset:33792
    v_cvt_pk_bf16_f32 v177, v178, v179
    v_mfma_f32_16x16x32_bf16 a[88:91], a[24:27], a[220:223], a[88:91]
    v_cvt_pk_bf16_f32 v178, v180, v181
    v_mfma_f32_16x16x32_bf16 a[84:87], a[28:31], a[216:219], a[84:87]
    ds_read_b128 a[24:27], v1 offset:34816
    v_cvt_pk_bf16_f32 v179, v182, v183
    v_mfma_f32_16x16x32_bf16 a[92:95], a[28:31], a[220:223], a[92:95]
    buffer_store_dwordx4 v[176:179], v8, s[16:19], 0 offen offset:0 sc1
    s_waitcnt lgkmcnt(3)
    v_mfma_f32_16x16x32_bf16 a[80:83], a[0:3], a[232:235], a[80:83]
    ds_read_b128 a[28:31], v1 offset:35840
    v_accvgpr_read_b32 v184, a72
    v_mfma_f32_16x16x32_bf16 a[88:91], a[0:3], a[236:239], a[88:91]
    v_accvgpr_read_b32 v185, a73
    v_mfma_f32_16x16x32_bf16 a[84:87], a[4:7], a[232:235], a[84:87]
    ds_read_b128 a[0:3], v1 offset:36864
    v_accvgpr_read_b32 v186, a74
    v_mfma_f32_16x16x32_bf16 a[92:95], a[4:7], a[236:239], a[92:95]
    v_accvgpr_read_b32 v187, a75
    v_mfma_f32_16x16x32_bf16 a[80:83], a[8:11], a[248:251], a[80:83]
    ds_read_b128 a[4:7], v1 offset:37888
    v_accvgpr_read_b32 v188, a76
    v_mfma_f32_16x16x32_bf16 a[88:91], a[8:11], a[252:255], a[88:91]
    v_accvgpr_read_b32 v189, a77
    v_mfma_f32_16x16x32_bf16 a[84:87], a[12:15], a[248:251], a[84:87]
    ds_read_b128 a[8:11], v1 offset:38912
    v_accvgpr_read_b32 v190, a78
    v_mfma_f32_16x16x32_bf16 a[92:95], a[12:15], a[252:255], a[92:95]
    v_accvgpr_read_b32 v191, a79
    s_waitcnt lgkmcnt(3)
    v_mfma_f32_16x16x32_bf16 a[80:83], a[16:19], a[104:107], a[80:83]
    ds_read_b128 a[12:15], v1 offset:39936
    v_cvt_pk_bf16_f32 v184, v184, v185
    v_mfma_f32_16x16x32_bf16 a[88:91], a[16:19], a[108:111], a[88:91]
    v_cvt_pk_bf16_f32 v185, v186, v187
    v_mfma_f32_16x16x32_bf16 a[84:87], a[20:23], a[104:107], a[84:87]
    s_barrier
    ds_read_b128 a[16:19], v1 offset:40960
    v_cvt_pk_bf16_f32 v186, v188, v189
    v_mfma_f32_16x16x32_bf16 a[92:95], a[20:23], a[108:111], a[92:95]
    v_cvt_pk_bf16_f32 v187, v190, v191
    v_mfma_f32_16x16x32_bf16 a[80:83], a[24:27], a[120:123], a[80:83]
    ds_read_b128 a[20:23], v1 offset:41984
    buffer_store_dwordx4 v[184:187], v8, s[16:19], s72 offen offset:0 sc1
    v_mfma_f32_16x16x32_bf16 a[88:91], a[24:27], a[124:127], a[88:91]
    v_mfma_f32_16x16x32_bf16 a[84:87], a[28:31], a[120:123], a[84:87]
    ds_read_b128 a[24:27], v1 offset:43008
    v_mfma_f32_16x16x32_bf16 a[92:95], a[28:31], a[124:127], a[92:95]
    s_waitcnt lgkmcnt(3)
    v_mfma_f32_16x16x32_bf16 a[80:83], a[0:3], a[136:139], a[80:83]
    ds_read_b128 a[28:31], v1 offset:44032
    v_mfma_f32_16x16x32_bf16 a[88:91], a[0:3], a[140:143], a[88:91]
    v_mfma_f32_16x16x32_bf16 a[84:87], a[4:7], a[136:139], a[84:87]
    ds_read_b128 a[0:3], v1 offset:45056
    v_mfma_f32_16x16x32_bf16 a[92:95], a[4:7], a[140:143], a[92:95]
    v_mfma_f32_16x16x32_bf16 a[80:83], a[8:11], a[152:155], a[80:83]
    ds_read_b128 a[4:7], v1 offset:46080
    v_mfma_f32_16x16x32_bf16 a[88:91], a[8:11], a[156:159], a[88:91]
    v_mfma_f32_16x16x32_bf16 a[84:87], a[12:15], a[152:155], a[84:87]
    ds_read_b128 a[8:11], v1 offset:47104
    v_mfma_f32_16x16x32_bf16 a[92:95], a[12:15], a[156:159], a[92:95]
    s_waitcnt lgkmcnt(3)
    v_mfma_f32_16x16x32_bf16 v[192:195], a[16:19], a[160:163], v[192:195]
    ds_read_b128 a[12:15], v1 offset:48128
    v_mfma_f32_16x16x32_bf16 v[200:203], a[16:19], a[164:167], v[200:203]
    v_mfma_f32_16x16x32_bf16 v[196:199], a[20:23], a[160:163], v[196:199]
    ds_read_b128 a[16:19], v1 offset:49152
    v_mfma_f32_16x16x32_bf16 v[204:207], a[20:23], a[164:167], v[204:207]
    v_accvgpr_read_b32 v176, a80
    v_mfma_f32_16x16x32_bf16 v[192:195], a[24:27], a[176:179], v[192:195]
    ds_read_b128 a[20:23], v1 offset:50176
    v_accvgpr_read_b32 v177, a81
    v_mfma_f32_16x16x32_bf16 v[200:203], a[24:27], a[180:183], v[200:203]
    v_accvgpr_read_b32 v178, a82
    v_mfma_f32_16x16x32_bf16 v[196:199], a[28:31], a[176:179], v[196:199]
    ds_read_b128 a[24:27], v1 offset:51200
    v_accvgpr_read_b32 v179, a83
    v_mfma_f32_16x16x32_bf16 v[204:207], a[28:31], a[180:183], v[204:207]
    v_accvgpr_read_b32 v180, a84
    s_waitcnt lgkmcnt(3)
    v_mfma_f32_16x16x32_bf16 v[192:195], a[0:3], a[192:195], v[192:195]
    ds_read_b128 a[28:31], v1 offset:52224
    v_accvgpr_read_b32 v181, a85
    v_mfma_f32_16x16x32_bf16 v[200:203], a[0:3], a[196:199], v[200:203]
    v_accvgpr_read_b32 v182, a86
    v_mfma_f32_16x16x32_bf16 v[196:199], a[4:7], a[192:195], v[196:199]
    ds_read_b128 a[0:3], v1 offset:53248
    v_accvgpr_read_b32 v183, a87
    v_mfma_f32_16x16x32_bf16 v[204:207], a[4:7], a[196:199], v[204:207]
    v_cvt_pk_bf16_f32 v176, v176, v177
    v_mfma_f32_16x16x32_bf16 v[192:195], a[8:11], a[208:211], v[192:195]
    ds_read_b128 a[4:7], v1 offset:54272
    v_cvt_pk_bf16_f32 v177, v178, v179
    v_mfma_f32_16x16x32_bf16 v[200:203], a[8:11], a[212:215], v[200:203]
    v_cvt_pk_bf16_f32 v178, v180, v181
    v_mfma_f32_16x16x32_bf16 v[196:199], a[12:15], a[208:211], v[196:199]
    ds_read_b128 a[8:11], v1 offset:55296
    v_cvt_pk_bf16_f32 v179, v182, v183
    v_mfma_f32_16x16x32_bf16 v[204:207], a[12:15], a[212:215], v[204:207]
    buffer_store_dwordx4 v[176:179], v8, s[16:19], s73 offen offset:0 sc1
    s_waitcnt lgkmcnt(3)
    v_mfma_f32_16x16x32_bf16 v[192:195], a[16:19], a[224:227], v[192:195]
    ds_read_b128 a[12:15], v1 offset:56320
    v_accvgpr_read_b32 v184, a88
    v_mfma_f32_16x16x32_bf16 v[200:203], a[16:19], a[228:231], v[200:203]
    v_accvgpr_read_b32 v185, a89
    v_mfma_f32_16x16x32_bf16 v[196:199], a[20:23], a[224:227], v[196:199]
    ds_read_b128 a[16:19], v1 offset:57344
    v_accvgpr_read_b32 v186, a90
    v_mfma_f32_16x16x32_bf16 v[204:207], a[20:23], a[228:231], v[204:207]
    v_accvgpr_read_b32 v187, a91
    v_mfma_f32_16x16x32_bf16 v[192:195], a[24:27], a[240:243], v[192:195]
    ds_read_b128 a[20:23], v1 offset:58368
    s_add_u32 m0, s37, 40960
    v_accvgpr_read_b32 v188, a92
    v_mfma_f32_16x16x32_bf16 v[200:203], a[24:27], a[244:247], v[200:203]
    s_add_u32 s35, s97, 28672
    buffer_load_dwordx4 v8, s[12:15], s35 offen sc1 lds
    v_accvgpr_read_b32 v189, a93
    v_mfma_f32_16x16x32_bf16 v[196:199], a[28:31], a[240:243], v[196:199]
    ds_read_b128 a[24:27], v1 offset:59392
    v_accvgpr_read_b32 v190, a94
    v_mfma_f32_16x16x32_bf16 v[204:207], a[28:31], a[244:247], v[204:207]
    v_accvgpr_read_b32 v191, a95
    s_waitcnt lgkmcnt(3)
    v_mfma_f32_16x16x32_bf16 v[192:195], a[0:3], a[96:99], v[192:195]
    ds_read_b128 a[28:31], v1 offset:60416
    v_cvt_pk_bf16_f32 v184, v184, v185
    v_mfma_f32_16x16x32_bf16 v[200:203], a[0:3], a[100:103], v[200:203]
    v_cvt_pk_bf16_f32 v185, v186, v187
    v_mfma_f32_16x16x32_bf16 v[196:199], a[4:7], a[96:99], v[196:199]
    ds_read_b128 a[0:3], v1 offset:40960
    v_cvt_pk_bf16_f32 v186, v188, v189
    v_mfma_f32_16x16x32_bf16 v[204:207], a[4:7], a[100:103], v[204:207]
    v_cvt_pk_bf16_f32 v187, v190, v191
    v_mfma_f32_16x16x32_bf16 v[192:195], a[8:11], a[112:115], v[192:195]
    ds_read_b128 a[4:7], v1 offset:41984
    s_add_u32 m0, s37, 45056
    buffer_store_dwordx4 v[184:187], v8, s[16:19], s74 offen offset:0 sc1
    v_mfma_f32_16x16x32_bf16 v[200:203], a[8:11], a[116:119], v[200:203]
    s_add_u32 s35, s98, 28672
    buffer_load_dwordx4 v8, s[12:15], s35 offen sc1 lds
    v_mfma_f32_16x16x32_bf16 v[196:199], a[12:15], a[112:115], v[196:199]
    ds_read_b128 a[8:11], v1 offset:43008
    v_mfma_f32_16x16x32_bf16 v[204:207], a[12:15], a[116:119], v[204:207]
    s_waitcnt lgkmcnt(3)
    v_mfma_f32_16x16x32_bf16 v[192:195], a[16:19], a[128:131], v[192:195]
    ds_read_b128 a[12:15], v1 offset:44032
    v_mfma_f32_16x16x32_bf16 v[200:203], a[16:19], a[132:135], v[200:203]
    v_mfma_f32_16x16x32_bf16 v[196:199], a[20:23], a[128:131], v[196:199]
    ds_read_b128 a[16:19], v1 offset:45056
    v_mfma_f32_16x16x32_bf16 v[204:207], a[20:23], a[132:135], v[204:207]
    v_mfma_f32_16x16x32_bf16 v[192:195], a[24:27], a[144:147], v[192:195]
    ds_read_b128 a[20:23], v1 offset:46080
    s_add_u32 m0, s37, 49152
    v_mfma_f32_16x16x32_bf16 v[200:203], a[24:27], a[148:151], v[200:203]
    s_add_u32 s35, s96, 49152
    buffer_load_dwordx4 v8, s[12:15], s35 offen sc1 lds
    v_mfma_f32_16x16x32_bf16 v[196:199], a[28:31], a[144:147], v[196:199]
    ds_read_b128 a[24:27], v1 offset:47104
    v_mfma_f32_16x16x32_bf16 v[204:207], a[28:31], a[148:151], v[204:207]
    s_waitcnt lgkmcnt(3)
    v_mfma_f32_16x16x32_bf16 v[208:211], a[0:3], a[168:171], v[208:211]
    ds_read_b128 a[28:31], v1 offset:48128
    v_mfma_f32_16x16x32_bf16 v[216:219], a[0:3], a[172:175], v[216:219]
    v_mfma_f32_16x16x32_bf16 v[212:215], a[4:7], a[168:171], v[212:215]
    ds_read_b128 a[0:3], v1 offset:49152
    v_mfma_f32_16x16x32_bf16 v[220:223], a[4:7], a[172:175], v[220:223]
    v_cvt_pk_bf16_f32 v192, v192, v193
    v_mfma_f32_16x16x32_bf16 v[208:211], a[8:11], a[184:187], v[208:211]
    ds_read_b128 a[4:7], v1 offset:50176
    s_add_u32 m0, s37, 53248
    v_mfma_f32_16x16x32_bf16 v[216:219], a[8:11], a[188:191], v[216:219]
    s_add_u32 s35, s97, 49152
    buffer_load_dwordx4 v8, s[12:15], s35 offen sc1 lds
    v_cvt_pk_bf16_f32 v193, v194, v195
    v_mfma_f32_16x16x32_bf16 v[212:215], a[12:15], a[184:187], v[212:215]
    ds_read_b128 a[8:11], v1 offset:51200
    v_mfma_f32_16x16x32_bf16 v[220:223], a[12:15], a[188:191], v[220:223]
    s_waitcnt lgkmcnt(3)
    v_mfma_f32_16x16x32_bf16 v[208:211], a[16:19], a[200:203], v[208:211]
    ds_read_b128 a[12:15], v1 offset:52224
    v_cvt_pk_bf16_f32 v194, v196, v197
    v_mfma_f32_16x16x32_bf16 v[216:219], a[16:19], a[204:207], v[216:219]
    v_mfma_f32_16x16x32_bf16 v[212:215], a[20:23], a[200:203], v[212:215]
    ds_read_b128 a[16:19], v1 offset:53248
    v_cvt_pk_bf16_f32 v195, v198, v199
    v_mfma_f32_16x16x32_bf16 v[220:223], a[20:23], a[204:207], v[220:223]
    v_mfma_f32_16x16x32_bf16 v[208:211], a[24:27], a[216:219], v[208:211]
    ds_read_b128 a[20:23], v1 offset:54272
    s_add_u32 m0, s37, 57344
    v_mfma_f32_16x16x32_bf16 v[216:219], a[24:27], a[220:223], v[216:219]
    s_add_u32 s35, s98, 49152
    buffer_load_dwordx4 v8, s[12:15], s35 offen sc1 lds
    buffer_store_dwordx4 v[192:195], v8, s[16:19], 0 offen offset:1024 sc1
    v_mfma_f32_16x16x32_bf16 v[212:215], a[28:31], a[216:219], v[212:215]
    ds_read_b128 a[24:27], v1 offset:55296
    v_mfma_f32_16x16x32_bf16 v[220:223], a[28:31], a[220:223], v[220:223]
    s_waitcnt lgkmcnt(3)
    v_mfma_f32_16x16x32_bf16 v[208:211], a[0:3], a[232:235], v[208:211]
    ds_read_b128 a[28:31], v1 offset:56320
    v_cvt_pk_bf16_f32 v200, v200, v201
    v_mfma_f32_16x16x32_bf16 v[216:219], a[0:3], a[236:239], v[216:219]
    v_mfma_f32_16x16x32_bf16 v[212:215], a[4:7], a[232:235], v[212:215]
    ds_read_b128 a[0:3], v1 offset:57344
    v_cvt_pk_bf16_f32 v201, v202, v203
    v_mfma_f32_16x16x32_bf16 v[220:223], a[4:7], a[236:239], v[220:223]
    v_mfma_f32_16x16x32_bf16 v[208:211], a[8:11], a[248:251], v[208:211]
    ds_read_b128 a[4:7], v1 offset:58368
    v_mfma_f32_16x16x32_bf16 v[216:219], a[8:11], a[252:255], v[216:219]
    v_cvt_pk_bf16_f32 v202, v204, v205
    v_mfma_f32_16x16x32_bf16 v[212:215], a[12:15], a[248:251], v[212:215]
    ds_read_b128 a[8:11], v1 offset:59392
    v_mfma_f32_16x16x32_bf16 v[220:223], a[12:15], a[252:255], v[220:223]
    v_cvt_pk_bf16_f32 v203, v206, v207
    s_waitcnt lgkmcnt(3)
    v_mfma_f32_16x16x32_bf16 v[208:211], a[16:19], a[104:107], v[208:211]
    ds_read_b128 a[12:15], v1 offset:60416
    v_mfma_f32_16x16x32_bf16 v[216:219], a[16:19], a[108:111], v[216:219]
    v_mfma_f32_16x16x32_bf16 v[212:215], a[20:23], a[104:107], v[212:215]
    s_barrier
    ds_read_b128 a[16:19], v8 offset:0
    buffer_store_dwordx4 v[200:203], v8, s[16:19], s72 offen offset:1024 sc1
    v_mfma_f32_16x16x32_bf16 v[220:223], a[20:23], a[108:111], v[220:223]
    v_mfma_f32_16x16x32_bf16 v[208:211], a[24:27], a[120:123], v[208:211]
    ds_read_b128 a[20:23], v8 offset:1024
    v_mfma_f32_16x16x32_bf16 v[216:219], a[24:27], a[124:127], v[216:219]
    v_mfma_f32_16x16x32_bf16 v[212:215], a[28:31], a[120:123], v[212:215]
    ds_read_b128 a[24:27], v8 offset:2048
    v_mfma_f32_16x16x32_bf16 v[220:223], a[28:31], a[124:127], v[220:223]
    s_waitcnt lgkmcnt(3)
    v_mfma_f32_16x16x32_bf16 v[208:211], a[0:3], a[136:139], v[208:211]
    ds_read_b128 a[28:31], v8 offset:3072
    v_mfma_f32_16x16x32_bf16 v[216:219], a[0:3], a[140:143], v[216:219]
    v_mfma_f32_16x16x32_bf16 v[212:215], a[4:7], a[136:139], v[212:215]
    ds_read_b128 a[0:3], v8 offset:4096
    v_mfma_f32_16x16x32_bf16 v[220:223], a[4:7], a[140:143], v[220:223]
    v_mfma_f32_16x16x32_bf16 v[208:211], a[8:11], a[152:155], v[208:211]
    ds_read_b128 a[4:7], v8 offset:5120
    s_add_u32 m0, s50, 98304
    v_mfma_f32_16x16x32_bf16 v[216:219], a[8:11], a[156:159], v[216:219]
    buffer_load_dwordx4 v8, s[68:71], s41 offen offset:0 sc1 lds
    v_mfma_f32_16x16x32_bf16 v[212:215], a[12:15], a[152:155], v[212:215]
    ds_read_b128 a[8:11], v8 offset:6144
    v_mfma_f32_16x16x32_bf16 v[220:223], a[12:15], a[156:159], v[220:223]
    s_waitcnt lgkmcnt(3)
    v_mfma_f32_16x16x32_bf16 v[224:227], a[16:19], a[160:163], v[224:227]
    ds_read_b128 a[12:15], v8 offset:7168
    v_mfma_f32_16x16x32_bf16 v[232:235], a[16:19], a[164:167], v[232:235]
    v_mfma_f32_16x16x32_bf16 v[228:231], a[20:23], a[160:163], v[228:231]
    ds_read_b128 a[16:19], v8 offset:8192
    v_mfma_f32_16x16x32_bf16 v[236:239], a[20:23], a[164:167], v[236:239]
    v_cvt_pk_bf16_f32 v208, v208, v209
    v_mfma_f32_16x16x32_bf16 v[224:227], a[24:27], a[176:179], v[224:227]
    ds_read_b128 a[20:23], v8 offset:9216
    v_mfma_f32_16x16x32_bf16 v[232:235], a[24:27], a[180:183], v[232:235]
    v_cvt_pk_bf16_f32 v209, v210, v211
    v_mfma_f32_16x16x32_bf16 v[228:231], a[28:31], a[176:179], v[228:231]
    ds_read_b128 a[24:27], v8 offset:10240
    v_mfma_f32_16x16x32_bf16 v[236:239], a[28:31], a[180:183], v[236:239]
    s_waitcnt lgkmcnt(3)
    v_mfma_f32_16x16x32_bf16 v[224:227], a[0:3], a[192:195], v[224:227]
    ds_read_b128 a[28:31], v8 offset:11264
    v_cvt_pk_bf16_f32 v210, v212, v213
    v_mfma_f32_16x16x32_bf16 v[232:235], a[0:3], a[196:199], v[232:235]
    buffer_load_dwordx4 v8, s[68:71], s41 offen offset:1024 sc1 lds
    v_mfma_f32_16x16x32_bf16 v[228:231], a[4:7], a[192:195], v[228:231]
    ds_read_b128 a[0:3], v8 offset:12288
    v_cvt_pk_bf16_f32 v211, v214, v215
    v_mfma_f32_16x16x32_bf16 v[236:239], a[4:7], a[196:199], v[236:239]
    v_mfma_f32_16x16x32_bf16 v[224:227], a[8:11], a[208:211], v[224:227]
    ds_read_b128 a[4:7], v8 offset:13312
    v_mfma_f32_16x16x32_bf16 v[232:235], a[8:11], a[212:215], v[232:235]
    buffer_store_dwordx4 v[208:211], v8, s[16:19], s73 offen offset:1024 sc1
    v_mfma_f32_16x16x32_bf16 v[228:231], a[12:15], a[208:211], v[228:231]
    ds_read_b128 a[8:11], v8 offset:14336
    v_mfma_f32_16x16x32_bf16 v[236:239], a[12:15], a[212:215], v[236:239]
    s_waitcnt lgkmcnt(3)
    v_mfma_f32_16x16x32_bf16 v[224:227], a[16:19], a[224:227], v[224:227]
    ds_read_b128 a[12:15], v8 offset:15360
    v_cvt_pk_bf16_f32 v216, v216, v217
    v_mfma_f32_16x16x32_bf16 v[232:235], a[16:19], a[228:231], v[232:235]
    v_mfma_f32_16x16x32_bf16 v[228:231], a[20:23], a[224:227], v[228:231]
    ds_read_b128 a[16:19], v8 offset:16384
    v_cvt_pk_bf16_f32 v217, v218, v219
    v_mfma_f32_16x16x32_bf16 v[236:239], a[20:23], a[228:231], v[236:239]
    v_mfma_f32_16x16x32_bf16 v[224:227], a[24:27], a[240:243], v[224:227]
    ds_read_b128 a[20:23], v8 offset:17408
    v_mfma_f32_16x16x32_bf16 v[232:235], a[24:27], a[244:247], v[232:235]
    buffer_load_dwordx4 v8, s[68:71], s41 offen offset:2048 sc1 lds
    s_add_u32 s41, s41, 12288
    v_cvt_pk_bf16_f32 v218, v220, v221
    v_mfma_f32_16x16x32_bf16 v[228:231], a[28:31], a[240:243], v[228:231]
    ds_read_b128 a[24:27], v8 offset:18432
    v_mfma_f32_16x16x32_bf16 v[236:239], a[28:31], a[244:247], v[236:239]
    v_cvt_pk_bf16_f32 v219, v222, v223
    s_waitcnt lgkmcnt(3)
    v_mfma_f32_16x16x32_bf16 v[224:227], a[0:3], a[96:99], v[224:227]
    ds_read_b128 a[28:31], v8 offset:19456
    v_mfma_f32_16x16x32_bf16 v[232:235], a[0:3], a[100:103], v[232:235]
    v_mfma_f32_16x16x32_bf16 v[228:231], a[4:7], a[96:99], v[228:231]
    ds_read_b128 a[0:3], v8 offset:0
    buffer_store_dwordx4 v[216:219], v8, s[16:19], s74 offen offset:1024 sc1
    v_mfma_f32_16x16x32_bf16 v[236:239], a[4:7], a[100:103], v[236:239]
    v_mfma_f32_16x16x32_bf16 v[224:227], a[8:11], a[112:115], v[224:227]
    ds_read_b128 a[4:7], v8 offset:1024
    v_mfma_f32_16x16x32_bf16 v[232:235], a[8:11], a[116:119], v[232:235]
    v_mfma_f32_16x16x32_bf16 v[228:231], a[12:15], a[112:115], v[228:231]
    ds_read_b128 a[8:11], v8 offset:2048
    v_mfma_f32_16x16x32_bf16 v[236:239], a[12:15], a[116:119], v[236:239]
    s_waitcnt lgkmcnt(3)
    v_mfma_f32_16x16x32_bf16 v[224:227], a[16:19], a[128:131], v[224:227]
    ds_read_b128 a[12:15], v8 offset:3072
    s_add_u32 m0, s50, 110592
    v_mfma_f32_16x16x32_bf16 v[232:235], a[16:19], a[132:135], v[232:235]
    buffer_load_dwordx4 v8, s[68:71], s41 offen offset:0 sc1 lds
    v_mfma_f32_16x16x32_bf16 v[228:231], a[20:23], a[128:131], v[228:231]
    ds_read_b128 a[16:19], v8 offset:4096
    v_mfma_f32_16x16x32_bf16 v[236:239], a[20:23], a[132:135], v[236:239]
    v_mfma_f32_16x16x32_bf16 v[224:227], a[24:27], a[144:147], v[224:227]
    ds_read_b128 a[20:23], v8 offset:5120
    v_mfma_f32_16x16x32_bf16 v[232:235], a[24:27], a[148:151], v[232:235]
    v_mfma_f32_16x16x32_bf16 v[228:231], a[28:31], a[144:147], v[228:231]
    ds_read_b128 a[24:27], v8 offset:6144
    v_mfma_f32_16x16x32_bf16 v[236:239], a[28:31], a[148:151], v[236:239]
    s_waitcnt lgkmcnt(3)
    v_mfma_f32_16x16x32_bf16 v[240:243], a[0:3], a[168:171], v[240:243]
    ds_read_b128 a[28:31], v8 offset:7168
    v_mfma_f32_16x16x32_bf16 v[248:251], a[0:3], a[172:175], v[248:251]
    v_mfma_f32_16x16x32_bf16 v[244:247], a[4:7], a[168:171], v[244:247]
    ds_read_b128 a[0:3], v8 offset:8192
    v_mfma_f32_16x16x32_bf16 v[252:255], a[4:7], a[172:175], v[252:255]
    v_cvt_pk_bf16_f32 v224, v224, v225
    v_mfma_f32_16x16x32_bf16 v[240:243], a[8:11], a[184:187], v[240:243]
    ds_read_b128 a[4:7], v8 offset:9216
    v_mfma_f32_16x16x32_bf16 v[248:251], a[8:11], a[188:191], v[248:251]
    buffer_load_dwordx4 v8, s[68:71], s41 offen offset:1024 sc1 lds
    v_cvt_pk_bf16_f32 v225, v226, v227
    v_mfma_f32_16x16x32_bf16 v[244:247], a[12:15], a[184:187], v[244:247]
    ds_read_b128 a[8:11], v8 offset:10240
    v_mfma_f32_16x16x32_bf16 v[252:255], a[12:15], a[188:191], v[252:255]
    s_waitcnt lgkmcnt(3)
    v_mfma_f32_16x16x32_bf16 v[240:243], a[16:19], a[200:203], v[240:243]
    ds_read_b128 a[12:15], v8 offset:11264
    v_cvt_pk_bf16_f32 v226, v228, v229
    v_mfma_f32_16x16x32_bf16 v[248:251], a[16:19], a[204:207], v[248:251]
    v_mfma_f32_16x16x32_bf16 v[244:247], a[20:23], a[200:203], v[244:247]
    ds_read_b128 a[16:19], v8 offset:12288
    v_cvt_pk_bf16_f32 v227, v230, v231
    v_mfma_f32_16x16x32_bf16 v[252:255], a[20:23], a[204:207], v[252:255]
    v_mfma_f32_16x16x32_bf16 v[240:243], a[24:27], a[216:219], v[240:243]
    ds_read_b128 a[20:23], v8 offset:13312
    v_mfma_f32_16x16x32_bf16 v[248:251], a[24:27], a[220:223], v[248:251]
    buffer_store_dwordx4 v[224:227], v8, s[16:19], 0 offen offset:2048 sc1
    v_mfma_f32_16x16x32_bf16 v[244:247], a[28:31], a[216:219], v[244:247]
    ds_read_b128 a[24:27], v8 offset:14336
    v_mfma_f32_16x16x32_bf16 v[252:255], a[28:31], a[220:223], v[252:255]
    s_waitcnt lgkmcnt(3)
    v_mfma_f32_16x16x32_bf16 v[240:243], a[0:3], a[232:235], v[240:243]
    ds_read_b128 a[28:31], v8 offset:15360
    v_cvt_pk_bf16_f32 v232, v232, v233
    v_mfma_f32_16x16x32_bf16 v[248:251], a[0:3], a[236:239], v[248:251]
    buffer_load_dwordx4 v8, s[68:71], s41 offen offset:2048 sc1 lds
    s_add_u32 s41, s41, 12288
    v_mfma_f32_16x16x32_bf16 v[244:247], a[4:7], a[232:235], v[244:247]
    ds_read_b128 a[0:3], v8 offset:16384
    v_cvt_pk_bf16_f32 v233, v234, v235
    v_mfma_f32_16x16x32_bf16 v[252:255], a[4:7], a[236:239], v[252:255]
    v_mfma_f32_16x16x32_bf16 v[240:243], a[8:11], a[248:251], v[240:243]
    ds_read_b128 a[4:7], v8 offset:17408
    v_mfma_f32_16x16x32_bf16 v[248:251], a[8:11], a[252:255], v[248:251]
    v_cvt_pk_bf16_f32 v234, v236, v237
    v_mfma_f32_16x16x32_bf16 v[244:247], a[12:15], a[248:251], v[244:247]
    ds_read_b128 a[8:11], v8 offset:18432
    v_mfma_f32_16x16x32_bf16 v[252:255], a[12:15], a[252:255], v[252:255]
    v_cvt_pk_bf16_f32 v235, v238, v239
    s_waitcnt lgkmcnt(3)
    v_mfma_f32_16x16x32_bf16 v[240:243], a[16:19], a[104:107], v[240:243]
    ds_read_b128 a[12:15], v8 offset:19456
    v_mfma_f32_16x16x32_bf16 v[248:251], a[16:19], a[108:111], v[248:251]
    v_mfma_f32_16x16x32_bf16 v[244:247], a[20:23], a[104:107], v[244:247]
    s_waitcnt vmcnt(20)
    s_barrier
    ds_read_b128 a[16:19], v8 offset:20480
    buffer_store_dwordx4 v[232:235], v8, s[16:19], s72 offen offset:2048 sc1
    v_mfma_f32_16x16x32_bf16 v[252:255], a[20:23], a[108:111], v[252:255]
    v_mfma_f32_16x16x32_bf16 v[240:243], a[24:27], a[120:123], v[240:243]
    ds_read_b128 a[20:23], v8 offset:21504
    v_mfma_f32_16x16x32_bf16 v[248:251], a[24:27], a[124:127], v[248:251]
    v_mfma_f32_16x16x32_bf16 v[244:247], a[28:31], a[120:123], v[244:247]
    ds_read_b128 a[24:27], v8 offset:22528
    v_mfma_f32_16x16x32_bf16 v[252:255], a[28:31], a[124:127], v[252:255]
    s_waitcnt lgkmcnt(3)
    v_mfma_f32_16x16x32_bf16 v[240:243], a[0:3], a[136:139], v[240:243]
    ds_read_b128 a[28:31], v8 offset:23552
    v_mfma_f32_16x16x32_bf16 v[248:251], a[0:3], a[140:143], v[248:251]
    v_mfma_f32_16x16x32_bf16 v[244:247], a[4:7], a[136:139], v[244:247]
    ds_read_b128 a[0:3], v8 offset:24576
    v_mfma_f32_16x16x32_bf16 v[252:255], a[4:7], a[140:143], v[252:255]
    v_mfma_f32_16x16x32_bf16 v[240:243], a[8:11], a[152:155], v[240:243]
    ds_read_b128 a[4:7], v8 offset:25600
    v_mfma_f32_16x16x32_bf16 v[248:251], a[8:11], a[156:159], v[248:251]
    v_mfma_f32_16x16x32_bf16 v[244:247], a[12:15], a[152:155], v[244:247]
    ds_read_b128 a[8:11], v8 offset:26624
    v_mfma_f32_16x16x32_bf16 v[252:255], a[12:15], a[156:159], v[252:255]
    s_waitcnt lgkmcnt(3)
    v_mfma_f32_16x16x32_bf16 v[48:51], a[16:19], a[160:163], v[48:51]
    ds_read_b128 a[12:15], v8 offset:27648
    s_add_u32 m0, s50, 122880
    v_mfma_f32_16x16x32_bf16 v[56:59], a[16:19], a[164:167], v[56:59]
    buffer_load_dwordx4 v8, s[68:71], s41 offen offset:0 sc1 lds
    v_mfma_f32_16x16x32_bf16 v[52:55], a[20:23], a[160:163], v[52:55]
    ds_read_b128 a[16:19], v8 offset:28672
    v_mfma_f32_16x16x32_bf16 v[60:63], a[20:23], a[164:167], v[60:63]
    v_cvt_pk_bf16_f32 v240, v240, v241
    v_mfma_f32_16x16x32_bf16 v[48:51], a[24:27], a[176:179], v[48:51]
    ds_read_b128 a[20:23], v8 offset:29696
    v_mfma_f32_16x16x32_bf16 v[56:59], a[24:27], a[180:183], v[56:59]
    v_cvt_pk_bf16_f32 v241, v242, v243
    v_mfma_f32_16x16x32_bf16 v[52:55], a[28:31], a[176:179], v[52:55]
    ds_read_b128 a[24:27], v8 offset:30720
    v_mfma_f32_16x16x32_bf16 v[60:63], a[28:31], a[180:183], v[60:63]
    s_waitcnt lgkmcnt(3)
    v_mfma_f32_16x16x32_bf16 v[48:51], a[0:3], a[192:195], v[48:51]
    ds_read_b128 a[28:31], v8 offset:31744
    v_cvt_pk_bf16_f32 v242, v244, v245
    v_mfma_f32_16x16x32_bf16 v[56:59], a[0:3], a[196:199], v[56:59]
    v_mfma_f32_16x16x32_bf16 v[52:55], a[4:7], a[192:195], v[52:55]
    ds_read_b128 a[0:3], v8 offset:32768
    v_cvt_pk_bf16_f32 v243, v246, v247
    v_mfma_f32_16x16x32_bf16 v[60:63], a[4:7], a[196:199], v[60:63]
    buffer_load_dwordx4 v8, s[68:71], s41 offen offset:1024 sc1 lds
    v_mfma_f32_16x16x32_bf16 v[48:51], a[8:11], a[208:211], v[48:51]
    ds_read_b128 a[4:7], v8 offset:33792
    v_mfma_f32_16x16x32_bf16 v[56:59], a[8:11], a[212:215], v[56:59]
    buffer_store_dwordx4 v[240:243], v8, s[16:19], s73 offen offset:2048 sc1
    v_mfma_f32_16x16x32_bf16 v[52:55], a[12:15], a[208:211], v[52:55]
    ds_read_b128 a[8:11], v8 offset:34816
    v_mfma_f32_16x16x32_bf16 v[60:63], a[12:15], a[212:215], v[60:63]
    s_waitcnt lgkmcnt(3)
    v_mfma_f32_16x16x32_bf16 v[48:51], a[16:19], a[224:227], v[48:51]
    ds_read_b128 a[12:15], v8 offset:35840
    v_cvt_pk_bf16_f32 v248, v248, v249
    v_mfma_f32_16x16x32_bf16 v[56:59], a[16:19], a[228:231], v[56:59]
    v_mfma_f32_16x16x32_bf16 v[52:55], a[20:23], a[224:227], v[52:55]
    ds_read_b128 a[16:19], v8 offset:36864
    v_cvt_pk_bf16_f32 v249, v250, v251
    v_mfma_f32_16x16x32_bf16 v[60:63], a[20:23], a[228:231], v[60:63]
    v_mfma_f32_16x16x32_bf16 v[48:51], a[24:27], a[240:243], v[48:51]
    ds_read_b128 a[20:23], v8 offset:37888
    v_mfma_f32_16x16x32_bf16 v[56:59], a[24:27], a[244:247], v[56:59]
    buffer_load_dwordx4 v8, s[68:71], s41 offen offset:2048 sc1 lds
    s_add_u32 s41, s41, 12288
    v_cvt_pk_bf16_f32 v250, v252, v253
    v_mfma_f32_16x16x32_bf16 v[52:55], a[28:31], a[240:243], v[52:55]
    ds_read_b128 a[24:27], v8 offset:38912
    v_mfma_f32_16x16x32_bf16 v[60:63], a[28:31], a[244:247], v[60:63]
    v_cvt_pk_bf16_f32 v251, v254, v255
    s_waitcnt lgkmcnt(3)
    v_mfma_f32_16x16x32_bf16 v[48:51], a[0:3], a[96:99], v[48:51]
    ds_read_b128 a[28:31], v8 offset:39936
    v_mfma_f32_16x16x32_bf16 v[56:59], a[0:3], a[100:103], v[56:59]
    v_mfma_f32_16x16x32_bf16 v[52:55], a[4:7], a[96:99], v[52:55]
    ds_read_b128 a[0:3], v8 offset:20480
    buffer_store_dwordx4 v[248:251], v8, s[16:19], s74 offen offset:2048 sc1
    v_mfma_f32_16x16x32_bf16 v[60:63], a[4:7], a[100:103], v[60:63]
    v_mfma_f32_16x16x32_bf16 v[48:51], a[8:11], a[112:115], v[48:51]
    ds_read_b128 a[4:7], v8 offset:21504
    v_mfma_f32_16x16x32_bf16 v[56:59], a[8:11], a[116:119], v[56:59]
    v_mfma_f32_16x16x32_bf16 v[52:55], a[12:15], a[112:115], v[52:55]
    ds_read_b128 a[8:11], v8 offset:22528
    s_add_u32 m0, s50, 135168
    v_mfma_f32_16x16x32_bf16 v[60:63], a[12:15], a[116:119], v[60:63]
    buffer_load_dwordx4 v8, s[68:71], s41 offen offset:0 sc1 lds
    s_waitcnt lgkmcnt(3)
    v_mfma_f32_16x16x32_bf16 v[48:51], a[16:19], a[128:131], v[48:51]
    ds_read_b128 a[12:15], v8 offset:23552
    v_mfma_f32_16x16x32_bf16 v[56:59], a[16:19], a[132:135], v[56:59]
    v_mfma_f32_16x16x32_bf16 v[52:55], a[20:23], a[128:131], v[52:55]
    ds_read_b128 a[16:19], v8 offset:24576
    v_mfma_f32_16x16x32_bf16 v[60:63], a[20:23], a[132:135], v[60:63]
    v_mfma_f32_16x16x32_bf16 v[48:51], a[24:27], a[144:147], v[48:51]
    ds_read_b128 a[20:23], v8 offset:25600
    v_mfma_f32_16x16x32_bf16 v[56:59], a[24:27], a[148:151], v[56:59]
    v_mfma_f32_16x16x32_bf16 v[52:55], a[28:31], a[144:147], v[52:55]
    ds_read_b128 a[24:27], v8 offset:26624
    v_mfma_f32_16x16x32_bf16 v[60:63], a[28:31], a[148:151], v[60:63]
    s_waitcnt lgkmcnt(3)
    v_mfma_f32_16x16x32_bf16 v[64:67], a[0:3], a[168:171], v[64:67]
    ds_read_b128 a[28:31], v8 offset:27648
    v_mfma_f32_16x16x32_bf16 v[72:75], a[0:3], a[172:175], v[72:75]
    buffer_load_dwordx4 v8, s[68:71], s41 offen offset:1024 sc1 lds
    v_mfma_f32_16x16x32_bf16 v[68:71], a[4:7], a[168:171], v[68:71]
    ds_read_b128 a[0:3], v8 offset:28672
    v_mfma_f32_16x16x32_bf16 v[76:79], a[4:7], a[172:175], v[76:79]
    v_cvt_pk_bf16_f32 v48, v48, v49
    v_mfma_f32_16x16x32_bf16 v[64:67], a[8:11], a[184:187], v[64:67]
    ds_read_b128 a[4:7], v8 offset:29696
    v_mfma_f32_16x16x32_bf16 v[72:75], a[8:11], a[188:191], v[72:75]
    v_cvt_pk_bf16_f32 v49, v50, v51
    v_mfma_f32_16x16x32_bf16 v[68:71], a[12:15], a[184:187], v[68:71]
    ds_read_b128 a[8:11], v8 offset:30720
    v_mfma_f32_16x16x32_bf16 v[76:79], a[12:15], a[188:191], v[76:79]
    s_waitcnt lgkmcnt(3)
    v_mfma_f32_16x16x32_bf16 v[64:67], a[16:19], a[200:203], v[64:67]
    ds_read_b128 a[12:15], v8 offset:31744
    v_cvt_pk_bf16_f32 v50, v52, v53
    v_mfma_f32_16x16x32_bf16 v[72:75], a[16:19], a[204:207], v[72:75]
    v_mfma_f32_16x16x32_bf16 v[68:71], a[20:23], a[200:203], v[68:71]
    ds_read_b128 a[16:19], v8 offset:32768
    v_cvt_pk_bf16_f32 v51, v54, v55
    v_mfma_f32_16x16x32_bf16 v[76:79], a[20:23], a[204:207], v[76:79]
    buffer_load_dwordx4 v8, s[68:71], s41 offen offset:2048 sc1 lds
    s_add_u32 s41, s41, 12288
    v_mfma_f32_16x16x32_bf16 v[64:67], a[24:27], a[216:219], v[64:67]
    ds_read_b128 a[20:23], v8 offset:33792
    v_mfma_f32_16x16x32_bf16 v[72:75], a[24:27], a[220:223], v[72:75]
    buffer_store_dwordx4 v[48:51], v8, s[16:19], 0 offen offset:3072 sc1
    v_mfma_f32_16x16x32_bf16 v[68:71], a[28:31], a[216:219], v[68:71]
    ds_read_b128 a[24:27], v8 offset:34816
    v_mfma_f32_16x16x32_bf16 v[76:79], a[28:31], a[220:223], v[76:79]
    s_waitcnt lgkmcnt(3)
    v_mfma_f32_16x16x32_bf16 v[64:67], a[0:3], a[232:235], v[64:67]
    ds_read_b128 a[28:31], v8 offset:35840
    v_cvt_pk_bf16_f32 v56, v56, v57
    v_mfma_f32_16x16x32_bf16 v[72:75], a[0:3], a[236:239], v[72:75]
    v_mfma_f32_16x16x32_bf16 v[68:71], a[4:7], a[232:235], v[68:71]
    ds_read_b128 a[0:3], v8 offset:36864
    v_cvt_pk_bf16_f32 v57, v58, v59
    v_mfma_f32_16x16x32_bf16 v[76:79], a[4:7], a[236:239], v[76:79]
    v_mfma_f32_16x16x32_bf16 v[64:67], a[8:11], a[248:251], v[64:67]
    ds_read_b128 a[4:7], v8 offset:37888
    s_add_u32 m0, s50, 147456
    v_mfma_f32_16x16x32_bf16 v[72:75], a[8:11], a[252:255], v[72:75]
    buffer_load_dwordx4 v8, s[88:91], s46 offen offset:0 sc1 lds
    v_cvt_pk_bf16_f32 v58, v60, v61
    v_mfma_f32_16x16x32_bf16 v[68:71], a[12:15], a[248:251], v[68:71]
    ds_read_b128 a[8:11], v8 offset:38912
    v_mfma_f32_16x16x32_bf16 v[76:79], a[12:15], a[252:255], v[76:79]
    v_cvt_pk_bf16_f32 v59, v62, v63
    s_waitcnt lgkmcnt(3)
    v_mfma_f32_16x16x32_bf16 v[64:67], a[16:19], a[104:107], v[64:67]
    ds_read_b128 a[12:15], v8 offset:39936
    v_mfma_f32_16x16x32_bf16 v[72:75], a[16:19], a[108:111], v[72:75]
    buffer_load_dwordx4 v8, s[88:91], s46 offen offset:1024 sc1 lds
    v_mfma_f32_16x16x32_bf16 v[68:71], a[20:23], a[104:107], v[68:71]
    s_waitcnt vmcnt(23)
    s_barrier
    ds_read_b128 a[16:19], v8 offset:40960
    buffer_store_dwordx4 v[56:59], v8, s[16:19], s72 offen offset:3072 sc1
    v_mfma_f32_16x16x32_bf16 v[76:79], a[20:23], a[108:111], v[76:79]
    v_mfma_f32_16x16x32_bf16 v[64:67], a[24:27], a[120:123], v[64:67]
    ds_read_b128 a[20:23], v8 offset:41984
    v_mfma_f32_16x16x32_bf16 v[72:75], a[24:27], a[124:127], v[72:75]
    buffer_load_dwordx4 v8, s[88:91], s46 offen offset:2048 sc1 lds
    v_mfma_f32_16x16x32_bf16 v[68:71], a[28:31], a[120:123], v[68:71]
    ds_read_b128 a[24:27], v8 offset:43008
    v_mfma_f32_16x16x32_bf16 v[76:79], a[28:31], a[124:127], v[76:79]
    s_waitcnt lgkmcnt(3)
    v_mfma_f32_16x16x32_bf16 v[64:67], a[0:3], a[136:139], v[64:67]
    ds_read_b128 a[28:31], v8 offset:44032
    v_mfma_f32_16x16x32_bf16 v[72:75], a[0:3], a[140:143], v[72:75]
    v_mfma_f32_16x16x32_bf16 v[68:71], a[4:7], a[136:139], v[68:71]
    ds_read_b128 a[0:3], v8 offset:45056
    v_mfma_f32_16x16x32_bf16 v[76:79], a[4:7], a[140:143], v[76:79]
    v_mfma_f32_16x16x32_bf16 v[64:67], a[8:11], a[152:155], v[64:67]
    ds_read_b128 a[4:7], v8 offset:46080
    v_mfma_f32_16x16x32_bf16 v[72:75], a[8:11], a[156:159], v[72:75]
    v_mfma_f32_16x16x32_bf16 v[68:71], a[12:15], a[152:155], v[68:71]
    ds_read_b128 a[8:11], v8 offset:47104
    v_mfma_f32_16x16x32_bf16 v[76:79], a[12:15], a[156:159], v[76:79]
    s_waitcnt lgkmcnt(3)
    v_mfma_f32_16x16x32_bf16 v[16:19], a[16:19], a[160:163], v[16:19]
    ds_read_b128 a[12:15], v8 offset:48128
    v_mfma_f32_16x16x32_bf16 v[24:27], a[16:19], a[164:167], v[24:27]
    v_mfma_f32_16x16x32_bf16 v[20:23], a[20:23], a[160:163], v[20:23]
    ds_read_b128 a[16:19], v8 offset:49152
    s_add_u32 s46, s45, 33554432
    s_add_u32 s20, s10, s46
    s_addc_u32 s21, s11, 0
    v_lshlrev_b32 v216, 16, v160
    v_mfma_f32_16x16x32_bf16 v[28:31], a[20:23], a[164:167], v[28:31]
    v_cvt_pk_bf16_f32 v64, v64, v65
    s_mov_b32 s22, 18370432
    s_mov_b32 s23, 0x00020000
    v_mfma_f32_16x16x32_bf16 v[16:19], a[24:27], a[176:179], v[16:19]
    ds_read_b128 a[20:23], v8 offset:50176
    s_add_u32 s46, s45, 58720256
    s_add_u32 s92, s10, s46
    s_addc_u32 s93, s11, 0
    v_mfma_f32_16x16x32_bf16 v[24:27], a[24:27], a[180:183], v[24:27]
    v_cvt_pk_bf16_f32 v65, v66, v67
    s_mov_b32 s94, 20352
    s_mov_b32 s95, 0x00020000
    v_and_b32 v217, 0xffff0000, v160
    v_mfma_f32_16x16x32_bf16 v[20:23], a[28:31], a[176:179], v[20:23]
    ds_read_b128 a[24:27], v8 offset:51200
    s_add_u32 s46, s45, 62914560
    s_add_u32 s64, s10, s46
    s_addc_u32 s65, s11, 0
    v_mfma_f32_16x16x32_bf16 v[28:31], a[28:31], a[180:183], v[28:31]
    s_mov_b32 s66, 20352
    s_mov_b32 s67, 0x00020000
    s_waitcnt lgkmcnt(3)
    v_mfma_f32_16x16x32_bf16 v[16:19], a[0:3], a[192:195], v[16:19]
    ds_read_b128 a[28:31], v8 offset:52224
    v_cvt_pk_bf16_f32 v66, v68, v69
    s_mov_b32 s38, 0
    s_mov_b32 s39, 0x3f80
    v_lshlrev_b32 v218, 16, v161
    v_mfma_f32_16x16x32_bf16 v[24:27], a[0:3], a[196:199], v[24:27]
    s_mov_b32 s40, 0x3f800000
    v_mfma_f32_16x16x32_bf16 v[20:23], a[4:7], a[192:195], v[20:23]
    ds_read_b128 a[0:3], v8 offset:53248
    v_cvt_pk_bf16_f32 v67, v70, v71
    v_mfma_f32_16x16x32_bf16 v[28:31], a[4:7], a[196:199], v[28:31]
    v_and_b32 v219, 0xffff0000, v161
    v_mfma_f32_16x16x32_bf16 v[16:19], a[8:11], a[208:211], v[16:19]
    ds_read_b128 a[4:7], v8 offset:54272
    v_mfma_f32_16x16x32_bf16 v[24:27], a[8:11], a[212:215], v[24:27]
    buffer_store_dwordx4 v[64:67], v8, s[16:19], s73 offen offset:3072 sc1
    v_mfma_f32_16x16x32_bf16 v[20:23], a[12:15], a[208:211], v[20:23]
    ds_read_b128 a[8:11], v8 offset:55296
    v_lshlrev_b32 v220, 16, v162
    v_mfma_f32_16x16x32_bf16 v[28:31], a[12:15], a[212:215], v[28:31]
    s_waitcnt lgkmcnt(3)
    v_mfma_f32_16x16x32_bf16 v[16:19], a[16:19], a[224:227], v[16:19]
    ds_read_b128 a[12:15], v8 offset:56320
    v_cvt_pk_bf16_f32 v72, v72, v73
    v_mfma_f32_16x16x32_bf16 v[24:27], a[16:19], a[228:231], v[24:27]
    v_and_b32 v221, 0xffff0000, v162
    v_mfma_f32_16x16x32_bf16 v[20:23], a[20:23], a[224:227], v[20:23]
    ds_read_b128 a[16:19], v8 offset:57344
    v_cvt_pk_bf16_f32 v73, v74, v75
    v_mfma_f32_16x16x32_bf16 v[28:31], a[20:23], a[228:231], v[28:31]
    v_mfma_f32_16x16x32_bf16 v[16:19], a[24:27], a[240:243], v[16:19]
    ds_read_b128 a[20:23], v8 offset:58368
    v_mfma_f32_16x16x32_bf16 v[24:27], a[24:27], a[244:247], v[24:27]
    v_cvt_pk_bf16_f32 v74, v76, v77
    v_lshlrev_b32 v222, 16, v163
    v_mfma_f32_16x16x32_bf16 v[20:23], a[28:31], a[240:243], v[20:23]
    ds_read_b128 a[24:27], v8 offset:59392
    v_mfma_f32_16x16x32_bf16 v[28:31], a[28:31], a[244:247], v[28:31]
    v_cvt_pk_bf16_f32 v75, v78, v79
    s_waitcnt lgkmcnt(3)
    v_mfma_f32_16x16x32_bf16 v[16:19], a[0:3], a[96:99], v[16:19]
    ds_read_b128 a[28:31], v8 offset:60416
    v_and_b32 v223, 0xffff0000, v163
    v_mfma_f32_16x16x32_bf16 v[24:27], a[0:3], a[100:103], v[24:27]
    v_mfma_f32_16x16x32_bf16 v[20:23], a[4:7], a[96:99], v[20:23]
    ds_read_b128 a[0:3], v8 offset:40960
    buffer_store_dwordx4 v[72:75], v8, s[16:19], s74 offen offset:3072 sc1
    v_mfma_f32_16x16x32_bf16 v[28:31], a[4:7], a[100:103], v[28:31]
    v_lshlrev_b32 v224, 16, v164
    v_mfma_f32_16x16x32_bf16 v[16:19], a[8:11], a[112:115], v[16:19]
    ds_read_b128 a[4:7], v8 offset:41984
    v_mfma_f32_16x16x32_bf16 v[24:27], a[8:11], a[116:119], v[24:27]
    v_mfma_f32_16x16x32_bf16 v[20:23], a[12:15], a[112:115], v[20:23]
    ds_read_b128 a[8:11], v8 offset:43008
    v_and_b32 v225, 0xffff0000, v164
    v_mfma_f32_16x16x32_bf16 v[28:31], a[12:15], a[116:119], v[28:31]
    s_waitcnt lgkmcnt(3)
    v_mfma_f32_16x16x32_bf16 v[16:19], a[16:19], a[128:131], v[16:19]
    ds_read_b128 a[12:15], v8 offset:44032
    v_mfma_f32_16x16x32_bf16 v[24:27], a[16:19], a[132:135], v[24:27]
    v_lshlrev_b32 v226, 16, v165
    v_mfma_f32_16x16x32_bf16 v[20:23], a[20:23], a[128:131], v[20:23]
    ds_read_b128 a[16:19], v8 offset:45056
    v_mfma_f32_16x16x32_bf16 v[28:31], a[20:23], a[132:135], v[28:31]
    v_mfma_f32_16x16x32_bf16 v[16:19], a[24:27], a[144:147], v[16:19]
    ds_read_b128 a[20:23], v8 offset:46080
    v_and_b32 v227, 0xffff0000, v165
    v_mfma_f32_16x16x32_bf16 v[24:27], a[24:27], a[148:151], v[24:27]
    v_mfma_f32_16x16x32_bf16 v[20:23], a[28:31], a[144:147], v[20:23]
    ds_read_b128 a[24:27], v8 offset:47104
    v_mfma_f32_16x16x32_bf16 v[28:31], a[28:31], a[148:151], v[28:31]
    s_waitcnt lgkmcnt(3)
    v_mfma_f32_16x16x32_bf16 v[32:35], a[0:3], a[168:171], v[32:35]
    ds_read_b128 a[28:31], v8 offset:48128
    v_lshlrev_b32 v228, 16, v166
    v_mfma_f32_16x16x32_bf16 v[40:43], a[0:3], a[172:175], v[40:43]
    v_mfma_f32_16x16x32_bf16 v[36:39], a[4:7], a[168:171], v[36:39]
    ds_read_b128 a[0:3], v8 offset:49152
    v_mfma_f32_16x16x32_bf16 v[44:47], a[4:7], a[172:175], v[44:47]
    v_cvt_pk_bf16_f32 v16, v16, v17
    v_and_b32 v229, 0xffff0000, v166
    v_mfma_f32_16x16x32_bf16 v[32:35], a[8:11], a[184:187], v[32:35]
    ds_read_b128 a[4:7], v8 offset:50176
    v_mfma_f32_16x16x32_bf16 v[40:43], a[8:11], a[188:191], v[40:43]
    v_cvt_pk_bf16_f32 v17, v18, v19
    v_mfma_f32_16x16x32_bf16 v[36:39], a[12:15], a[184:187], v[36:39]
    ds_read_b128 a[8:11], v8 offset:51200
    v_lshlrev_b32 v230, 16, v167
    v_mfma_f32_16x16x32_bf16 v[44:47], a[12:15], a[188:191], v[44:47]
    s_waitcnt lgkmcnt(3)
    v_mfma_f32_16x16x32_bf16 v[32:35], a[16:19], a[200:203], v[32:35]
    ds_read_b128 a[12:15], v8 offset:52224
    v_cvt_pk_bf16_f32 v18, v20, v21
    v_mfma_f32_16x16x32_bf16 v[40:43], a[16:19], a[204:207], v[40:43]
    v_and_b32 v231, 0xffff0000, v167
    v_mfma_f32_16x16x32_bf16 v[36:39], a[20:23], a[200:203], v[36:39]
    ds_read_b128 a[16:19], v8 offset:53248
    v_cvt_pk_bf16_f32 v19, v22, v23
    v_mfma_f32_16x16x32_bf16 v[44:47], a[20:23], a[204:207], v[44:47]
    v_mfma_f32_16x16x32_bf16 v[32:35], a[24:27], a[216:219], v[32:35]
    ds_read_b128 a[20:23], v8 offset:54272
    v_lshlrev_b32 v232, 16, v168
    v_mfma_f32_16x16x32_bf16 v[40:43], a[24:27], a[220:223], v[40:43]
    buffer_store_dwordx4 v[16:19], v2, s[16:19], 0 offen offset:0 sc1
    v_mfma_f32_16x16x32_bf16 v[36:39], a[28:31], a[216:219], v[36:39]
    ds_read_b128 a[24:27], v8 offset:55296
    v_mfma_f32_16x16x32_bf16 v[44:47], a[28:31], a[220:223], v[44:47]
    v_and_b32 v233, 0xffff0000, v168
    s_waitcnt lgkmcnt(3)
    v_mfma_f32_16x16x32_bf16 v[32:35], a[0:3], a[232:235], v[32:35]
    ds_read_b128 a[28:31], v8 offset:56320
    v_cvt_pk_bf16_f32 v24, v24, v25
    v_mfma_f32_16x16x32_bf16 v[40:43], a[0:3], a[236:239], v[40:43]
    v_mfma_f32_16x16x32_bf16 v[36:39], a[4:7], a[232:235], v[36:39]
    ds_read_b128 a[0:3], v8 offset:57344
    v_cvt_pk_bf16_f32 v25, v26, v27
    v_mfma_f32_16x16x32_bf16 v[44:47], a[4:7], a[236:239], v[44:47]
    v_lshlrev_b32 v234, 16, v169
    v_mfma_f32_16x16x32_bf16 v[32:35], a[8:11], a[248:251], v[32:35]
    ds_read_b128 a[4:7], v8 offset:58368
    buffer_load_dword v11, v0, s[76:79], s51 offen sc1
    v_mfma_f32_16x16x32_bf16 v[40:43], a[8:11], a[252:255], v[40:43]
    v_cvt_pk_bf16_f32 v26, v28, v29
    v_mfma_f32_16x16x32_bf16 v[36:39], a[12:15], a[248:251], v[36:39]
    ds_read_b128 a[8:11], v8 offset:59392
    v_and_b32 v235, 0xffff0000, v169
    v_mfma_f32_16x16x32_bf16 v[44:47], a[12:15], a[252:255], v[44:47]
    v_cvt_pk_bf16_f32 v27, v30, v31
    s_waitcnt lgkmcnt(3)
    v_mfma_f32_16x16x32_bf16 v[32:35], a[16:19], a[104:107], v[32:35]
    ds_read_b128 a[12:15], v8 offset:60416
    v_mfma_f32_16x16x32_bf16 v[40:43], a[16:19], a[108:111], v[40:43]
    v_lshlrev_b32 v236, 16, v170
    v_mfma_f32_16x16x32_bf16 v[36:39], a[20:23], a[104:107], v[36:39]
    buffer_store_dwordx4 v[24:27], v2, s[16:19], s72 offen offset:0 sc1
    v_mfma_f32_16x16x32_bf16 v[44:47], a[20:23], a[108:111], v[44:47]
    v_mfma_f32_16x16x32_bf16 v[32:35], a[24:27], a[120:123], v[32:35]
    v_and_b32 v237, 0xffff0000, v170
    v_mfma_f32_16x16x32_bf16 v[40:43], a[24:27], a[124:127], v[40:43]
    v_mfma_f32_16x16x32_bf16 v[36:39], a[28:31], a[120:123], v[36:39]
    v_mfma_f32_16x16x32_bf16 v[44:47], a[28:31], a[124:127], v[44:47]
    v_lshlrev_b32 v238, 16, v171
    s_waitcnt lgkmcnt(0)
    v_mfma_f32_16x16x32_bf16 v[32:35], a[0:3], a[136:139], v[32:35]
    v_mfma_f32_16x16x32_bf16 v[40:43], a[0:3], a[140:143], v[40:43]
    v_mfma_f32_16x16x32_bf16 v[36:39], a[4:7], a[136:139], v[36:39]
    v_and_b32 v239, 0xffff0000, v171
    v_mfma_f32_16x16x32_bf16 v[44:47], a[4:7], a[140:143], v[44:47]
    v_mfma_f32_16x16x32_bf16 v[32:35], a[8:11], a[152:155], v[32:35]
    v_mfma_f32_16x16x32_bf16 v[40:43], a[8:11], a[156:159], v[40:43]
    v_mfma_f32_16x16x32_bf16 v[36:39], a[12:15], a[152:155], v[36:39]
    v_mfma_f32_16x16x32_bf16 v[44:47], a[12:15], a[156:159], v[44:47]
    s_nop 6
    v_cvt_pk_bf16_f32 v32, v32, v33
    v_cvt_pk_bf16_f32 v33, v34, v35
    v_cvt_pk_bf16_f32 v34, v36, v37
    v_cvt_pk_bf16_f32 v35, v38, v39
    buffer_store_dwordx4 v[32:35], v2, s[16:19], s73 offen offset:0 sc1
    v_cvt_pk_bf16_f32 v40, v40, v41
    v_cvt_pk_bf16_f32 v41, v42, v43
    v_cvt_pk_bf16_f32 v42, v44, v45
    v_cvt_pk_bf16_f32 v43, v46, v47
    buffer_store_dwordx4 v[40:43], v2, s[16:19], s74 offen offset:0 sc1
    s_waitcnt vmcnt(3)
    v_cmp_le_u32 vcc, 6, v11
    s_and_b32 s46, vcc_lo, 255
    s_mov_b32 s47, s46
    s_xor_b32 s46, s46, s47
    v_and_b32 v6, 0x70, v8
    v_lshlrev_b32 v6, 1, v6
    v_add_u32 v6, 160256, v6
    s_lshl_b32 s49, s32, 3
    v_add_u32 v7, s49, v6
    s_waitcnt vmcnt(0)
    s_barrier
    buffer_store_dword v15, v14, s[76:79], s0 offen sc1
    s_cmp_eq_u32 s47, 0
    s_cbranch_scc1 MP_y
    s_bitcmp1_b32 s47, 0
    s_cbranch_scc0 MP_r0
    s_mov_b32 s3, 0
    buffer_load_dwordx4 v[128:131], v4, s[20:23], s3 offen offset:2048 sc1
    buffer_load_dwordx4 v[160:163], v5, s[20:23], s3 offen offset:0 sc1
    buffer_load_dwordx4 v[96:99], v4, s[20:23], s3 offen offset:0 sc1
MP_r0:
    s_bitcmp1_b32 s47, 1
    s_cbranch_scc0 MP_r1
    s_mov_b32 s3, 2621440
    buffer_load_dwordx4 v[132:135], v4, s[20:23], s3 offen offset:2048 sc1
    buffer_load_dwordx4 v[164:167], v5, s[20:23], s3 offen offset:0 sc1
    buffer_load_dwordx4 v[100:103], v4, s[20:23], s3 offen offset:0 sc1
MP_r1:
    s_bitcmp1_b32 s47, 2
    s_cbranch_scc0 MP_r2
    s_mov_b32 s3, 5242880
    buffer_load_dwordx4 v[136:139], v4, s[20:23], s3 offen offset:2048 sc1
    buffer_load_dwordx4 v[168:171], v5, s[20:23], s3 offen offset:0 sc1
    buffer_load_dwordx4 v[104:107], v4, s[20:23], s3 offen offset:0 sc1
MP_r2:
    s_bitcmp1_b32 s47, 3
    s_cbranch_scc0 MP_r3
    s_mov_b32 s3, 7864320
    buffer_load_dwordx4 v[140:143], v4, s[20:23], s3 offen offset:2048 sc1
    buffer_load_dwordx4 v[172:175], v5, s[20:23], s3 offen offset:0 sc1
    buffer_load_dwordx4 v[108:111], v4, s[20:23], s3 offen offset:0 sc1
MP_r3:
    s_bitcmp1_b32 s47, 4
    s_cbranch_scc0 MP_r4
    s_mov_b32 s3, 10485760
    buffer_load_dwordx4 v[144:147], v4, s[20:23], s3 offen offset:2048 sc1
    buffer_load_dwordx4 v[176:179], v5, s[20:23], s3 offen offset:0 sc1
    buffer_load_dwordx4 v[112:115], v4, s[20:23], s3 offen offset:0 sc1
MP_r4:
    s_bitcmp1_b32 s47, 5
    s_cbranch_scc0 MP_r5
    s_mov_b32 s3, 13107200
    buffer_load_dwordx4 v[148:151], v4, s[20:23], s3 offen offset:2048 sc1
    buffer_load_dwordx4 v[180:183], v5, s[20:23], s3 offen offset:0 sc1
    buffer_load_dwordx4 v[116:119], v4, s[20:23], s3 offen offset:0 sc1
MP_r5:
    s_bitcmp1_b32 s47, 6
    s_cbranch_scc0 MP_r6
    s_mov_b32 s3, 15728640
    buffer_load_dwordx4 v[152:155], v4, s[20:23], s3 offen offset:2048 sc1
    buffer_load_dwordx4 v[184:187], v5, s[20:23], s3 offen offset:0 sc1
    buffer_load_dwordx4 v[120:123], v4, s[20:23], s3 offen offset:0 sc1
MP_r6:
    s_bitcmp1_b32 s47, 7
    s_cbranch_scc0 MP_r7
    s_mov_b32 s3, 18350080
    buffer_load_dwordx4 v[156:159], v4, s[20:23], s3 offen offset:2048 sc1
    buffer_load_dwordx4 v[188:191], v5, s[20:23], s3 offen offset:0 sc1
    buffer_load_dwordx4 v[124:127], v4, s[20:23], s3 offen offset:0 sc1
MP_r7:
    s_or_b32 s46, s46, s47
MP_y:
    buffer_load_dword v11, v0, s[76:79], s51 offen sc1
    ds_read_b128 v[192:195], v9 offset:5120
    ds_read_b128 v[196:199], v9 offset:5184
    ds_read_b128 v[200:203], v9 offset:5376
    ds_read_b128 v[204:207], v9 offset:5440
    ds_read_b128 v[208:211], v9 offset:5632
    ds_read_b128 v[212:215], v9 offset:5696
    ds_read_b128 v[48:51], v9 offset:0
    ds_read_b128 v[52:55], v9 offset:64
    ds_read_b128 v[56:59], v9 offset:256
    ds_read_b128 v[60:63], v9 offset:320
    ds_read_b128 v[64:67], v9 offset:512
    ds_read_b128 v[68:71], v9 offset:576
    ds_read_b128 v[72:75], v9 offset:2560
    ds_read_b128 v[76:79], v9 offset:2624
    ds_read_b128 v[80:83], v9 offset:2816
    ds_read_b128 v[84:87], v9 offset:2880
    ds_read_b128 v[88:91], v9 offset:3072
    ds_read_b128 v[92:95], v9 offset:3136
    s_waitcnt lgkmcnt(12)
    v_add_f32 v192, 1.0, v192
    v_add_f32 v193, 1.0, v193
    v_add_f32 v194, 1.0, v194
    v_add_f32 v195, 1.0, v195
    v_add_f32 v196, 1.0, v196
    v_add_f32 v197, 1.0, v197
    v_add_f32 v198, 1.0, v198
    v_add_f32 v199, 1.0, v199
    v_add_f32 v200, 1.0, v200
    v_add_f32 v201, 1.0, v201
    v_add_f32 v202, 1.0, v202
    v_add_f32 v203, 1.0, v203
    v_add_f32 v204, 1.0, v204
    v_add_f32 v205, 1.0, v205
    v_add_f32 v206, 1.0, v206
    v_add_f32 v207, 1.0, v207
    v_add_f32 v208, 1.0, v208
    v_add_f32 v209, 1.0, v209
    v_add_f32 v210, 1.0, v210
    v_add_f32 v211, 1.0, v211
    v_add_f32 v212, 1.0, v212
    v_add_f32 v213, 1.0, v213
    v_add_f32 v214, 1.0, v214
    v_add_f32 v215, 1.0, v215
    v_cvt_pk_bf16_f32 v192, v192, v193
    v_cvt_pk_bf16_f32 v194, v194, v195
    v_cvt_pk_bf16_f32 v196, v196, v197
    v_cvt_pk_bf16_f32 v198, v198, v199
    v_cvt_pk_bf16_f32 v200, v200, v201
    v_cvt_pk_bf16_f32 v202, v202, v203
    v_cvt_pk_bf16_f32 v204, v204, v205
    v_cvt_pk_bf16_f32 v206, v206, v207
    v_cvt_pk_bf16_f32 v208, v208, v209
    v_cvt_pk_bf16_f32 v210, v210, v211
    v_cvt_pk_bf16_f32 v212, v212, v213
    v_cvt_pk_bf16_f32 v214, v214, v215
    v_and_b32 v193, 0xffff0000, v192
    v_lshlrev_b32 v192, 16, v192
    v_and_b32 v195, 0xffff0000, v194
    v_lshlrev_b32 v194, 16, v194
    v_and_b32 v197, 0xffff0000, v196
    v_lshlrev_b32 v196, 16, v196
    v_and_b32 v199, 0xffff0000, v198
    v_lshlrev_b32 v198, 16, v198
    v_and_b32 v201, 0xffff0000, v200
    v_lshlrev_b32 v200, 16, v200
    v_and_b32 v203, 0xffff0000, v202
    v_lshlrev_b32 v202, 16, v202
    v_and_b32 v205, 0xffff0000, v204
    v_lshlrev_b32 v204, 16, v204
    v_and_b32 v207, 0xffff0000, v206
    v_lshlrev_b32 v206, 16, v206
    v_and_b32 v209, 0xffff0000, v208
    v_lshlrev_b32 v208, 16, v208
    v_and_b32 v211, 0xffff0000, v210
    v_lshlrev_b32 v210, 16, v210
    v_and_b32 v213, 0xffff0000, v212
    v_lshlrev_b32 v212, 16, v212
    v_and_b32 v215, 0xffff0000, v214
    v_lshlrev_b32 v214, 16, v214
    s_waitcnt lgkmcnt(0)
    s_mul_i32 s49, s44, 40960
    s_add_u32 s49, s49, 62914560
    s_add_u32 s28, s10, s49
    s_addc_u32 s29, s11, 0
    s_mov_b32 s30, 40960
    s_mov_b32 s31, 0x00020000
    s_mul_i32 s49, s44, 98304
    s_mul_i32 s3, s43, 3072
    s_add_u32 s49, s49, s3
    s_add_u32 s49, s49, 67108864
    s_add_u32 s52, s10, s49
    s_addc_u32 s53, s11, 0
    s_mov_b32 s54, 52224
    s_mov_b32 s55, 0x00020000
    s_mov_b32 s37, 0
    v_mov_b32 v15, 7
    s_mov_b32 s48, 0
    s_branch MP_e
MP_l:
    buffer_load_dword v11, v0, s[76:79], s51 offen sc1
MP_e:
    s_waitcnt vmcnt(0)
    v_cmp_le_u32 vcc, 6, v11
    s_add_u32 s48, s48, 1
    s_cmp_gt_u32 s48, 200000
    s_cselect_b32 s49, -1, vcc_lo
    s_andn2_b32 s47, s49, s46
    s_and_b32 s47, s47, 255
    s_cbranch_scc0 MP_n
    s_bitcmp1_b32 s47, 0
    s_cbranch_scc0 MP_s0
    s_mov_b32 s3, 0
    buffer_load_dwordx4 v[128:131], v4, s[20:23], s3 offen offset:2048 sc1
    buffer_load_dwordx4 v[160:163], v5, s[20:23], s3 offen offset:0 sc1
    buffer_load_dwordx4 v[96:99], v4, s[20:23], s3 offen offset:0 sc1
MP_s0:
    s_bitcmp1_b32 s47, 1
    s_cbranch_scc0 MP_s1
    s_mov_b32 s3, 2621440
    buffer_load_dwordx4 v[132:135], v4, s[20:23], s3 offen offset:2048 sc1
    buffer_load_dwordx4 v[164:167], v5, s[20:23], s3 offen offset:0 sc1
    buffer_load_dwordx4 v[100:103], v4, s[20:23], s3 offen offset:0 sc1
MP_s1:
    s_bitcmp1_b32 s47, 2
    s_cbranch_scc0 MP_s2
    s_mov_b32 s3, 5242880
    buffer_load_dwordx4 v[136:139], v4, s[20:23], s3 offen offset:2048 sc1
    buffer_load_dwordx4 v[168:171], v5, s[20:23], s3 offen offset:0 sc1
    buffer_load_dwordx4 v[104:107], v4, s[20:23], s3 offen offset:0 sc1
MP_s2:
    s_bitcmp1_b32 s47, 3
    s_cbranch_scc0 MP_s3
    s_mov_b32 s3, 7864320
    buffer_load_dwordx4 v[140:143], v4, s[20:23], s3 offen offset:2048 sc1
    buffer_load_dwordx4 v[172:175], v5, s[20:23], s3 offen offset:0 sc1
    buffer_load_dwordx4 v[108:111], v4, s[20:23], s3 offen offset:0 sc1
MP_s3:
    s_bitcmp1_b32 s47, 4
    s_cbranch_scc0 MP_s4
    s_mov_b32 s3, 10485760
    buffer_load_dwordx4 v[144:147], v4, s[20:23], s3 offen offset:2048 sc1
    buffer_load_dwordx4 v[176:179], v5, s[20:23], s3 offen offset:0 sc1
    buffer_load_dwordx4 v[112:115], v4, s[20:23], s3 offen offset:0 sc1
MP_s4:
    s_bitcmp1_b32 s47, 5
    s_cbranch_scc0 MP_s5
    s_mov_b32 s3, 13107200
    buffer_load_dwordx4 v[148:151], v4, s[20:23], s3 offen offset:2048 sc1
    buffer_load_dwordx4 v[180:183], v5, s[20:23], s3 offen offset:0 sc1
    buffer_load_dwordx4 v[116:119], v4, s[20:23], s3 offen offset:0 sc1
MP_s5:
    s_bitcmp1_b32 s47, 6
    s_cbranch_scc0 MP_s6
    s_mov_b32 s3, 15728640
    buffer_load_dwordx4 v[152:155], v4, s[20:23], s3 offen offset:2048 sc1
    buffer_load_dwordx4 v[184:187], v5, s[20:23], s3 offen offset:0 sc1
    buffer_load_dwordx4 v[120:123], v4, s[20:23], s3 offen offset:0 sc1
MP_s6:
    s_bitcmp1_b32 s47, 7
    s_cbranch_scc0 MP_s7
    s_mov_b32 s3, 18350080
    buffer_load_dwordx4 v[156:159], v4, s[20:23], s3 offen offset:2048 sc1
    buffer_load_dwordx4 v[188:191], v5, s[20:23], s3 offen offset:0 sc1
    buffer_load_dwordx4 v[124:127], v4, s[20:23], s3 offen offset:0 sc1
MP_s7:
    s_or_b32 s46, s46, s47
MP_n:
    s_cmpk_lg_u32 s46, 255
    s_cbranch_scc1 MP_l
    v_and_b32 v0, 0x180, v8
    s_lshl_b32 s3, s32, 9
    v_lshl_add_u32 v0, v0, 4, s3
    s_add_u32 m0, s50, 0
    s_nop 0
    buffer_load_dwordx4 v8, s[68:71], s41 offen offset:0 sc1 lds
    s_bitcmp1_b32 s47, 0
    s_cbranch_scc0 MP_w0
    s_waitcnt vmcnt(1)
MP_w0:
    v_lshlrev_b32 v16, 16, v96
    v_and_b32 v17, 0xffff0000, v96
    v_lshlrev_b32 v18, 16, v97
    v_and_b32 v19, 0xffff0000, v97
    v_lshlrev_b32 v20, 16, v98
    v_and_b32 v21, 0xffff0000, v98
    v_lshlrev_b32 v22, 16, v99
    v_and_b32 v23, 0xffff0000, v99
    v_lshlrev_b32 v24, 16, v128
    v_and_b32 v25, 0xffff0000, v128
    v_lshlrev_b32 v26, 16, v129
    v_and_b32 v27, 0xffff0000, v129
    v_lshlrev_b32 v28, 16, v130
    v_and_b32 v29, 0xffff0000, v130
    buffer_load_dwordx4 v8, s[68:71], s41 offen offset:1024 sc1 lds
    v_lshlrev_b32 v30, 16, v131
    v_and_b32 v31, 0xffff0000, v131
    v_lshlrev_b32 v32, 16, v160
    v_and_b32 v33, 0xffff0000, v160
    v_lshlrev_b32 v34, 16, v161
    v_and_b32 v35, 0xffff0000, v161
    v_lshlrev_b32 v36, 16, v162
    v_and_b32 v37, 0xffff0000, v162
    v_lshlrev_b32 v38, 16, v163
    v_and_b32 v39, 0xffff0000, v163
    s_bitcmp1_b32 s47, 1
    s_cbranch_scc0 MP_w1
    s_waitcnt vmcnt(2)
MP_w1:
    v_dot2c_f32_bf16 v16, s39, v100
    v_dot2c_f32_bf16 v17, s40, v100
    v_dot2c_f32_bf16 v18, s39, v101
    v_dot2c_f32_bf16 v19, s40, v101
    buffer_load_dwordx4 v8, s[68:71], s41 offen offset:2048 sc1 lds
    s_add_u32 s41, s41, 12288
    v_dot2c_f32_bf16 v20, s39, v102
    v_dot2c_f32_bf16 v21, s40, v102
    v_dot2c_f32_bf16 v22, s39, v103
    v_dot2c_f32_bf16 v23, s40, v103
    v_dot2c_f32_bf16 v24, s39, v132
    v_dot2c_f32_bf16 v25, s40, v132
    v_dot2c_f32_bf16 v26, s39, v133
    v_dot2c_f32_bf16 v27, s40, v133
    v_dot2c_f32_bf16 v28, s39, v134
    v_dot2c_f32_bf16 v29, s40, v134
    v_dot2c_f32_bf16 v30, s39, v135
    v_dot2c_f32_bf16 v31, s40, v135
    v_dot2c_f32_bf16 v32, s39, v164
    v_dot2c_f32_bf16 v33, s40, v164
    s_add_u32 m0, s50, 12288
    s_nop 0
    buffer_load_dwordx4 v8, s[68:71], s41 offen offset:0 sc1 lds
    v_dot2c_f32_bf16 v34, s39, v165
    v_dot2c_f32_bf16 v35, s40, v165
    v_dot2c_f32_bf16 v36, s39, v166
    v_dot2c_f32_bf16 v37, s40, v166
    v_dot2c_f32_bf16 v38, s39, v167
    v_dot2c_f32_bf16 v39, s40, v167
    s_bitcmp1_b32 s47, 2
    s_cbranch_scc0 MP_w2
    s_waitcnt vmcnt(4)
MP_w2:
    v_dot2c_f32_bf16 v16, s39, v104
    v_dot2c_f32_bf16 v17, s40, v104
    v_dot2c_f32_bf16 v18, s39, v105
    v_dot2c_f32_bf16 v19, s40, v105
    v_dot2c_f32_bf16 v20, s39, v106
    v_dot2c_f32_bf16 v21, s40, v106
    v_dot2c_f32_bf16 v22, s39, v107
    v_dot2c_f32_bf16 v23, s40, v107
    buffer_load_dwordx4 v8, s[68:71], s41 offen offset:1024 sc1 lds
    v_dot2c_f32_bf16 v24, s39, v136
    v_dot2c_f32_bf16 v25, s40, v136
    v_dot2c_f32_bf16 v26, s39, v137
    v_dot2c_f32_bf16 v27, s40, v137
    v_dot2c_f32_bf16 v28, s39, v138
    v_dot2c_f32_bf16 v29, s40, v138
    v_dot2c_f32_bf16 v30, s39, v139
    v_dot2c_f32_bf16 v31, s40, v139
    v_dot2c_f32_bf16 v32, s39, v168
    v_dot2c_f32_bf16 v33, s40, v168
    v_dot2c_f32_bf16 v34, s39, v169
    v_dot2c_f32_bf16 v35, s40, v169
    v_dot2c_f32_bf16 v36, s39, v170
    v_dot2c_f32_bf16 v37, s40, v170
    buffer_load_dwordx4 v8, s[68:71], s41 offen offset:2048 sc1 lds
    s_add_u32 s41, s41, 12288
    v_dot2c_f32_bf16 v38, s39, v171
    v_dot2c_f32_bf16 v39, s40, v171
    s_bitcmp1_b32 s47, 3
    s_cbranch_scc0 MP_w3
    s_waitcnt vmcnt(6)
MP_w3:
    v_dot2c_f32_bf16 v16, s39, v108
    v_dot2c_f32_bf16 v17, s40, v108
    v_dot2c_f32_bf16 v18, s39, v109
    v_dot2c_f32_bf16 v19, s40, v109
    v_dot2c_f32_bf16 v20, s39, v110
    v_dot2c_f32_bf16 v21, s40, v110
    v_dot2c_f32_bf16 v22, s39, v111
    v_dot2c_f32_bf16 v23, s40, v111
    v_dot2c_f32_bf16 v24, s39, v140
    v_dot2c_f32_bf16 v25, s40, v140
    v_dot2c_f32_bf16 v26, s39, v141
    v_dot2c_f32_bf16 v27, s40, v141
    s_add_u32 m0, s50, 24576
    s_nop 0
    buffer_load_dwordx4 v8, s[68:71], s41 offen offset:0 sc1 lds
    v_dot2c_f32_bf16 v28, s39, v142
    v_dot2c_f32_bf16 v29, s40, v142
    v_dot2c_f32_bf16 v30, s39, v143
    v_dot2c_f32_bf16 v31, s40, v143
    v_dot2c_f32_bf16 v32, s39, v172
    v_dot2c_f32_bf16 v33, s40, v172
    v_dot2c_f32_bf16 v34, s39, v173
    v_dot2c_f32_bf16 v35, s40, v173
    v_dot2c_f32_bf16 v36, s39, v174
    v_dot2c_f32_bf16 v37, s40, v174
    v_dot2c_f32_bf16 v38, s39, v175
    v_dot2c_f32_bf16 v39, s40, v175
    s_bitcmp1_b32 s47, 4
    s_cbranch_scc0 MP_w4
    s_waitcnt vmcnt(7)
MP_w4:
    v_dot2c_f32_bf16 v16, s39, v112
    v_dot2c_f32_bf16 v17, s40, v112
    buffer_load_dwordx4 v8, s[68:71], s41 offen offset:1024 sc1 lds
    v_dot2c_f32_bf16 v18, s39, v113
    v_dot2c_f32_bf16 v19, s40, v113
    v_dot2c_f32_bf16 v20, s39, v114
    v_dot2c_f32_bf16 v21, s40, v114
    v_dot2c_f32_bf16 v22, s39, v115
    v_dot2c_f32_bf16 v23, s40, v115
    v_dot2c_f32_bf16 v24, s39, v144
    v_dot2c_f32_bf16 v25, s40, v144
    v_dot2c_f32_bf16 v26, s39, v145
    v_dot2c_f32_bf16 v27, s40, v145
    v_dot2c_f32_bf16 v28, s39, v146
    v_dot2c_f32_bf16 v29, s40, v146
    v_dot2c_f32_bf16 v30, s39, v147
    v_dot2c_f32_bf16 v31, s40, v147
    buffer_load_dwordx4 v8, s[68:71], s41 offen offset:2048 sc1 lds
    s_add_u32 s41, s41, 12288
    v_dot2c_f32_bf16 v32, s39, v176
    v_dot2c_f32_bf16 v33, s40, v176
    v_dot2c_f32_bf16 v34, s39, v177
    v_dot2c_f32_bf16 v35, s40, v177
    v_dot2c_f32_bf16 v36, s39, v178
    v_dot2c_f32_bf16 v37, s40, v178
    v_dot2c_f32_bf16 v38, s39, v179
    v_dot2c_f32_bf16 v39, s40, v179
    s_bitcmp1_b32 s47, 5
    s_cbranch_scc0 MP_w5
    s_waitcnt vmcnt(9)
MP_w5:
    v_dot2c_f32_bf16 v16, s39, v116
    v_dot2c_f32_bf16 v17, s40, v116
    v_dot2c_f32_bf16 v18, s39, v117
    v_dot2c_f32_bf16 v19, s40, v117
    v_dot2c_f32_bf16 v20, s39, v118
    v_dot2c_f32_bf16 v21, s40, v118
    s_add_u32 m0, s50, 36864
    s_nop 0
    buffer_load_dwordx4 v8, s[68:71], s41 offen offset:0 sc1 lds
    v_dot2c_f32_bf16 v22, s39, v119
    v_dot2c_f32_bf16 v23, s40, v119
    v_dot2c_f32_bf16 v24, s39, v148
    v_dot2c_f32_bf16 v25, s40, v148
    v_dot2c_f32_bf16 v26, s39, v149
    v_dot2c_f32_bf16 v27, s40, v149
    v_dot2c_f32_bf16 v28, s39, v150
    v_dot2c_f32_bf16 v29, s40, v150
    v_dot2c_f32_bf16 v30, s39, v151
    v_dot2c_f32_bf16 v31, s40, v151
    v_dot2c_f32_bf16 v32, s39, v180
    v_dot2c_f32_bf16 v33, s40, v180
    v_dot2c_f32_bf16 v34, s39, v181
    v_dot2c_f32_bf16 v35, s40, v181
    buffer_load_dwordx4 v8, s[68:71], s41 offen offset:1024 sc1 lds
    v_dot2c_f32_bf16 v36, s39, v182
    v_dot2c_f32_bf16 v37, s40, v182
    v_dot2c_f32_bf16 v38, s39, v183
    v_dot2c_f32_bf16 v39, s40, v183
    s_bitcmp1_b32 s47, 6
    s_cbranch_scc0 MP_w6
    s_waitcnt vmcnt(11)
MP_w6:
    v_dot2c_f32_bf16 v16, s39, v120
    v_dot2c_f32_bf16 v17, s40, v120
    v_dot2c_f32_bf16 v18, s39, v121
    v_dot2c_f32_bf16 v19, s40, v121
    v_dot2c_f32_bf16 v20, s39, v122
    v_dot2c_f32_bf16 v21, s40, v122
    v_dot2c_f32_bf16 v22, s39, v123
    v_dot2c_f32_bf16 v23, s40, v123
    v_dot2c_f32_bf16 v24, s39, v152
    v_dot2c_f32_bf16 v25, s40, v152
    buffer_load_dwordx4 v8, s[68:71], s41 offen offset:2048 sc1 lds
    s_add_u32 s41, s41, 12288
    v_dot2c_f32_bf16 v26, s39, v153
    v_dot2c_f32_bf16 v27, s40, v153
    v_dot2c_f32_bf16 v28, s39, v154
    v_dot2c_f32_bf16 v29, s40, v154
    v_dot2c_f32_bf16 v30, s39, v155
    v_dot2c_f32_bf16 v31, s40, v155
    v_dot2c_f32_bf16 v32, s39, v184
    v_dot2c_f32_bf16 v33, s40, v184
    v_dot2c_f32_bf16 v34, s39, v185
    v_dot2c_f32_bf16 v35, s40, v185
    v_dot2c_f32_bf16 v36, s39, v186
    v_dot2c_f32_bf16 v37, s40, v186
    v_dot2c_f32_bf16 v38, s39, v187
    v_dot2c_f32_bf16 v39, s40, v187
    s_add_u32 m0, s50, 49152
    s_nop 0
    buffer_load_dwordx4 v8, s[68:71], s41 offen offset:0 sc1 lds
    s_bitcmp1_b32 s47, 7
    s_cbranch_scc0 MP_w7
    s_waitcnt vmcnt(13)
MP_w7:
    v_dot2c_f32_bf16 v16, s39, v124
    v_dot2c_f32_bf16 v17, s40, v124
    v_dot2c_f32_bf16 v18, s39, v125
    v_dot2c_f32_bf16 v19, s40, v125
    v_dot2c_f32_bf16 v20, s39, v126
    v_dot2c_f32_bf16 v21, s40, v126
    v_dot2c_f32_bf16 v22, s39, v127
    v_dot2c_f32_bf16 v23, s40, v127
    v_dot2c_f32_bf16 v24, s39, v156
    v_dot2c_f32_bf16 v25, s40, v156
    v_dot2c_f32_bf16 v26, s39, v157
    v_dot2c_f32_bf16 v27, s40, v157
    v_dot2c_f32_bf16 v28, s39, v158
    v_dot2c_f32_bf16 v29, s40, v158
    buffer_load_dwordx4 v8, s[68:71], s41 offen offset:1024 sc1 lds
    v_dot2c_f32_bf16 v30, s39, v159
    v_dot2c_f32_bf16 v31, s40, v159
    v_dot2c_f32_bf16 v32, s39, v188
    v_dot2c_f32_bf16 v33, s40, v188
    v_dot2c_f32_bf16 v34, s39, v189
    v_dot2c_f32_bf16 v35, s40, v189
    v_dot2c_f32_bf16 v36, s39, v190
    v_dot2c_f32_bf16 v37, s40, v190
    v_dot2c_f32_bf16 v38, s39, v191
    v_dot2c_f32_bf16 v39, s40, v191
    s_nop 1
    v_pk_fma_f32 v[216:217], v[16:17], v[48:49], v[216:217]
    v_pk_fma_f32 v[218:219], v[18:19], v[50:51], v[218:219]
    v_pk_fma_f32 v[220:221], v[20:21], v[52:53], v[220:221]
    v_pk_fma_f32 v[222:223], v[22:23], v[54:55], v[222:223]
    buffer_load_dwordx4 v8, s[68:71], s41 offen offset:2048 sc1 lds
    s_add_u32 s41, s41, 12288
    v_pk_fma_f32 v[224:225], v[24:25], v[56:57], v[224:225]
    v_pk_fma_f32 v[226:227], v[26:27], v[58:59], v[226:227]
    v_pk_fma_f32 v[228:229], v[28:29], v[60:61], v[228:229]
    v_pk_fma_f32 v[230:231], v[30:31], v[62:63], v[230:231]
    v_pk_fma_f32 v[232:233], v[32:33], v[64:65], v[232:233]
    v_pk_fma_f32 v[234:235], v[34:35], v[66:67], v[234:235]
    v_pk_fma_f32 v[236:237], v[36:37], v[68:69], v[236:237]
    v_pk_fma_f32 v[238:239], v[38:39], v[70:71], v[238:239]
    v_pk_add_f32 v[40:41], v[216:217], v[218:219]
    v_pk_mul_f32 v[42:43], v[216:217], v[216:217]
    v_pk_add_f32 v[44:45], v[220:221], v[222:223]
    v_pk_mul_f32 v[46:47], v[218:219], v[218:219]
    v_pk_fma_f32 v[42:43], v[220:221], v[220:221], v[42:43]
    v_pk_fma_f32 v[46:47], v[222:223], v[222:223], v[46:47]
    s_add_u32 m0, s50, 61440
    s_nop 0
    buffer_load_dwordx4 v8, s[68:71], s41 offen offset:0 sc1 lds
    v_pk_add_f32 v[40:41], v[40:41], v[224:225]
    v_pk_fma_f32 v[42:43], v[224:225], v[224:225], v[42:43]
    v_pk_add_f32 v[44:45], v[44:45], v[226:227]
    v_pk_fma_f32 v[46:47], v[226:227], v[226:227], v[46:47]
    v_pk_add_f32 v[40:41], v[40:41], v[228:229]
    v_pk_fma_f32 v[42:43], v[228:229], v[228:229], v[42:43]
    v_pk_add_f32 v[44:45], v[44:45], v[230:231]
    v_pk_fma_f32 v[46:47], v[230:231], v[230:231], v[46:47]
    v_pk_add_f32 v[40:41], v[40:41], v[232:233]
    v_pk_fma_f32 v[42:43], v[232:233], v[232:233], v[42:43]
    v_pk_add_f32 v[44:45], v[44:45], v[234:235]
    v_pk_fma_f32 v[46:47], v[234:235], v[234:235], v[46:47]
    v_pk_add_f32 v[40:41], v[40:41], v[236:237]
    v_pk_fma_f32 v[42:43], v[236:237], v[236:237], v[42:43]
    buffer_load_dwordx4 v8, s[68:71], s41 offen offset:1024 sc1 lds
    v_pk_add_f32 v[44:45], v[44:45], v[238:239]
    v_pk_fma_f32 v[46:47], v[238:239], v[238:239], v[46:47]
    v_pk_add_f32 v[40:41], v[40:41], v[44:45]
    v_pk_add_f32 v[42:43], v[42:43], v[46:47]
    v_add_f32 v40, v40, v41
    v_add_f32 v41, v42, v43
    v_cvt_pk_bf16_f32 v16, v216, v217
    v_cvt_pk_bf16_f32 v17, v218, v219
    v_add_f32_dpp v40, v40, v40 row_ror:8 row_mask:0xf bank_mask:0xf
    v_add_f32_dpp v41, v41, v41 row_ror:8 row_mask:0xf bank_mask:0xf
    v_mov_b32 v42, v40
    v_mov_b32 v43, v41
    v_cvt_pk_bf16_f32 v18, v220, v221
    v_permlane16_swap_b32 v40, v42
    buffer_load_dwordx4 v8, s[68:71], s41 offen offset:2048 sc1 lds
    s_add_u32 s41, s41, 12288
    v_permlane16_swap_b32 v41, v43
    v_add_f32 v40, v40, v42
    v_add_f32 v41, v41, v43
    v_mov_b32 v42, v40
    v_mov_b32 v43, v41
    v_cvt_pk_bf16_f32 v19, v222, v223
    v_permlane32_swap_b32 v40, v42
    v_permlane32_swap_b32 v41, v43
    v_add_f32 v40, v40, v42
    v_add_f32 v41, v41, v43
    ds_write_b64 v7, v[40:41]
    v_cvt_pk_bf16_f32 v20, v224, v225
    v_cvt_pk_bf16_f32 v21, v226, v227
    v_cvt_pk_bf16_f32 v22, v228, v229
    v_cvt_pk_bf16_f32 v23, v230, v231
    v_cvt_pk_bf16_f32 v24, v232, v233
    v_cvt_pk_bf16_f32 v25, v234, v235
    v_cvt_pk_bf16_f32 v26, v236, v237
    v_cvt_pk_bf16_f32 v27, v238, v239
    s_waitcnt lgkmcnt(0)
    s_barrier
    ds_read_b128 v[40:43], v6
    ds_read_b128 v[44:47], v6 offset:16
    buffer_store_dwordx4 v[16:19], v4, s[92:95], 0 offen offset:0 sc1
    buffer_store_dwordx4 v[20:23], v4, s[92:95], 0 offen offset:2048 sc1
    buffer_store_dwordx4 v[24:27], v5, s[92:95], 0 offen offset:0 sc1
    v_pk_mul_f32 v[216:217], v[216:217], v[192:193]
    v_pk_mul_f32 v[218:219], v[218:219], v[194:195]
    v_pk_mul_f32 v[220:221], v[220:221], v[196:197]
    v_pk_mul_f32 v[222:223], v[222:223], v[198:199]
    v_pk_mul_f32 v[224:225], v[224:225], v[200:201]
    v_pk_mul_f32 v[226:227], v[226:227], v[202:203]
    v_pk_mul_f32 v[228:229], v[228:229], v[204:205]
    v_pk_mul_f32 v[230:231], v[230:231], v[206:207]
    v_pk_mul_f32 v[232:233], v[232:233], v[208:209]
    v_pk_mul_f32 v[234:235], v[234:235], v[210:211]
    v_pk_mul_f32 v[236:237], v[236:237], v[212:213]
    v_pk_mul_f32 v[238:239], v[238:239], v[214:215]
    s_waitcnt lgkmcnt(0)
    v_pk_add_f32 v[40:41], v[40:41], v[42:43]
    v_pk_add_f32 v[44:45], v[44:45], v[46:47]
    v_pk_add_f32 v[40:41], v[40:41], v[44:45]
    v_mul_f32 v40, 0x3acccccd, v40
    v_mul_f32 v42, v40, v40
    v_mov_b32 v43, 0x3acccccd
    v_fma_f32 v41, v41, v43, -v42
    v_max_f32 v41, 0, v41
    v_add_f32 v41, 0x3727c5ac, v41
    v_rsq_f32 v42, v41
    s_nop 0
    v_mul_f32 v40, v40, v42
    v_pk_fma_f32 v[72:73], v[192:193], v[40:41], v[72:73] op_sel_hi:[1,0,1] neg_lo:[0,1,0] neg_hi:[0,1,0]
    v_pk_fma_f32 v[74:75], v[194:195], v[40:41], v[74:75] op_sel_hi:[1,0,1] neg_lo:[0,1,0] neg_hi:[0,1,0]
    v_pk_fma_f32 v[76:77], v[196:197], v[40:41], v[76:77] op_sel_hi:[1,0,1] neg_lo:[0,1,0] neg_hi:[0,1,0]
    v_pk_fma_f32 v[78:79], v[198:199], v[40:41], v[78:79] op_sel_hi:[1,0,1] neg_lo:[0,1,0] neg_hi:[0,1,0]
    v_pk_fma_f32 v[72:73], v[216:217], v[42:43], v[72:73] op_sel_hi:[1,0,1]
    v_pk_fma_f32 v[74:75], v[218:219], v[42:43], v[74:75] op_sel_hi:[1,0,1]
    v_pk_fma_f32 v[76:77], v[220:221], v[42:43], v[76:77] op_sel_hi:[1,0,1]
    v_pk_fma_f32 v[78:79], v[222:223], v[42:43], v[78:79] op_sel_hi:[1,0,1]
    v_cvt_pk_bf16_f32 v28, v72, v73
    v_cvt_pk_bf16_f32 v29, v74, v75
    v_cvt_pk_bf16_f32 v30, v76, v77
    v_cvt_pk_bf16_f32 v31, v78, v79
    buffer_store_dwordx4 v[28:31], v4, s[64:67], 0 offen offset:0 sc1
    v_pk_fma_f32 v[80:81], v[200:201], v[40:41], v[80:81] op_sel_hi:[1,0,1] neg_lo:[0,1,0] neg_hi:[0,1,0]
    v_pk_fma_f32 v[82:83], v[202:203], v[40:41], v[82:83] op_sel_hi:[1,0,1] neg_lo:[0,1,0] neg_hi:[0,1,0]
    v_pk_fma_f32 v[84:85], v[204:205], v[40:41], v[84:85] op_sel_hi:[1,0,1] neg_lo:[0,1,0] neg_hi:[0,1,0]
    v_pk_fma_f32 v[86:87], v[206:207], v[40:41], v[86:87] op_sel_hi:[1,0,1] neg_lo:[0,1,0] neg_hi:[0,1,0]
    v_pk_fma_f32 v[80:81], v[224:225], v[42:43], v[80:81] op_sel_hi:[1,0,1]
    v_pk_fma_f32 v[82:83], v[226:227], v[42:43], v[82:83] op_sel_hi:[1,0,1]
    v_pk_fma_f32 v[84:85], v[228:229], v[42:43], v[84:85] op_sel_hi:[1,0,1]
    v_pk_fma_f32 v[86:87], v[230:231], v[42:43], v[86:87] op_sel_hi:[1,0,1]
    v_cvt_pk_bf16_f32 v32, v80, v81
    v_cvt_pk_bf16_f32 v33, v82, v83
    v_cvt_pk_bf16_f32 v34, v84, v85
    v_cvt_pk_bf16_f32 v35, v86, v87
    buffer_store_dwordx4 v[32:35], v4, s[64:67], 0 offen offset:2048 sc1
    v_pk_fma_f32 v[88:89], v[208:209], v[40:41], v[88:89] op_sel_hi:[1,0,1] neg_lo:[0,1,0] neg_hi:[0,1,0]
    v_pk_fma_f32 v[90:91], v[210:211], v[40:41], v[90:91] op_sel_hi:[1,0,1] neg_lo:[0,1,0] neg_hi:[0,1,0]
    v_pk_fma_f32 v[92:93], v[212:213], v[40:41], v[92:93] op_sel_hi:[1,0,1] neg_lo:[0,1,0] neg_hi:[0,1,0]
    v_pk_fma_f32 v[94:95], v[214:215], v[40:41], v[94:95] op_sel_hi:[1,0,1] neg_lo:[0,1,0] neg_hi:[0,1,0]
    v_pk_fma_f32 v[88:89], v[232:233], v[42:43], v[88:89] op_sel_hi:[1,0,1]
    v_pk_fma_f32 v[90:91], v[234:235], v[42:43], v[90:91] op_sel_hi:[1,0,1]
    v_pk_fma_f32 v[92:93], v[236:237], v[42:43], v[92:93] op_sel_hi:[1,0,1]
    v_pk_fma_f32 v[94:95], v[238:239], v[42:43], v[94:95] op_sel_hi:[1,0,1]
    v_cvt_pk_bf16_f32 v36, v88, v89
    v_cvt_pk_bf16_f32 v37, v90, v91
    v_cvt_pk_bf16_f32 v38, v92, v93
    v_cvt_pk_bf16_f32 v39, v94, v95
    buffer_store_dwordx4 v[36:39], v5, s[64:67], 0 offen offset:0 sc1
    v_add_u32 v2, 49152, v8
    v_add_u32 v3, 98304, v8
    v_add_u32 v4, 20480, v8
    s_and_b32 s3, s2, 7
    s_bfe_u32 s46, s2, 0x10004
    s_lshl_b32 s39, s3, 5
    s_add_u32 s39, s39, s46
    s_lshl_b32 s39, s39, 8
    s_add_u32 s39, s39, 8192
    s_lshl_b32 s3, s3, 4
    s_lshl_b32 s46, s46, 1
    s_add_u32 s3, s3, s46
    s_and_b32 s46, s2, 8
    s_add_u32 s3, s3, s46
    s_mul_i32 s46, s3, 49152
    s_mul_i32 s47, s32, 12288
    s_add_u32 s46, s46, s47
    s_add_u32 s46, s46, 67108864
    s_add_u32 s16, s10, s46
    s_addc_u32 s17, s11, 0
    s_mov_b32 s18, 258048
    s_mov_b32 s19, 0x00020000
    s_lshr_b32 s46, s32, 1
    s_lshl_b32 s46, s46, 2
    s_and_b32 s47, s32, 1
    s_add_u32 s46, s46, s47
    s_add_u32 s3, s3, s46
    s_mul_i32 s3, s3, 20480
    s_add_u32 s46, s3, 58720256
    s_add_u32 s20, s10, s46
    s_addc_u32 s21, s11, 0
    s_mov_b32 s22, 20480
    s_mov_b32 s23, 0x00020000
    s_lshr_b32 s47, s2, 5
    s_mul_i32 s46, s47, 160
    s_add_u32 s3, s3, s46
    s_add_u32 s84, s62, s3
    s_addc_u32 s85, s63, 0
    s_mov_b32 s86, 0
    s_mov_b32 s87, 0x00020000
    s_sub_u32 s86, 20480, s46
    s_lshl_b32 s40, s46, 1
    s_add_u32 s40, s40, 155136
    s_mul_i32 s47, s47, 5
    s_add_u32 s46, s47, 0
    s_lshr_b32 s92, s46, 1
    s_lshl_b32 s92, s92, 10
    s_and_b32 s46, s46, 1
    s_lshl_b32 s46, s46, 3
    s_add_u32 s92, s92, s46
    s_add_u32 s46, s47, 1
    s_lshr_b32 s93, s46, 1
    s_lshl_b32 s93, s93, 10
    s_and_b32 s46, s46, 1
    s_lshl_b32 s46, s46, 3
    s_add_u32 s93, s93, s46
    s_add_u32 s46, s47, 2
    s_lshr_b32 s94, s46, 1
    s_lshl_b32 s94, s94, 10
    s_and_b32 s46, s46, 1
    s_lshl_b32 s46, s46, 3
    s_add_u32 s94, s94, s46
    s_add_u32 s46, s47, 3
    s_lshr_b32 s95, s46, 1
    s_lshl_b32 s95, s95, 10
    s_and_b32 s46, s46, 1
    s_waitcnt vmcnt(0)
    s_barrier
    buffer_store_dword v15, v14, s[76:79], s0 offen sc1
    buffer_load_dword v11, v0, s[76:79], s42 offen sc1
    s_lshl_b32 s46, s46, 3
    s_add_u32 s95, s95, s46
    s_add_u32 s46, s47, 4
    s_lshr_b32 s96, s46, 1
    s_lshl_b32 s96, s96, 10
    s_and_b32 s46, s46, 1
    s_lshl_b32 s46, s46, 3
    s_add_u32 s96, s96, s46
    s_add_u32 s46, s32, 0
    s_and_b32 s47, s46, 1
    s_and_b32 s46, s46, 2
    s_lshl_b32 s46, s46, 1
    s_add_u32 s46, s46, s47
    s_mul_i32 s12, s46, 49152
    s_add_u32 s13, s12, 3072
    s_add_u32 s14, s12, 6144
    s_add_u32 s15, s12, 9216
    s_add_u32 s46, s32, 1
    s_and_b32 s47, s46, 1
    s_and_b32 s46, s46, 2
    s_lshl_b32 s46, s46, 1
    s_add_u32 s46, s46, s47
    s_mul_i32 s24, s46, 49152
    s_add_u32 s25, s24, 3072
    s_add_u32 s26, s24, 6144
    s_add_u32 s27, s24, 9216
    s_add_u32 s46, s32, 2
    s_and_b32 s47, s46, 1
    s_and_b32 s46, s46, 2
    s_lshl_b32 s46, s46, 1
    s_add_u32 s46, s46, s47
    s_mul_i32 s64, s46, 49152
    s_add_u32 s65, s64, 3072
    s_add_u32 s66, s64, 6144
    s_add_u32 s67, s64, 9216
    s_add_u32 s46, s32, 3
    s_and_b32 s47, s46, 1
    s_and_b32 s46, s46, 2
    s_lshl_b32 s46, s46, 1
    s_add_u32 s46, s46, s47
    s_mul_i32 s88, s46, 49152
    s_add_u32 s89, s88, 3072
    s_add_u32 s90, s88, 6144
    s_add_u32 s91, s88, 9216
    v_mov_b32 v6, 0xc0135761
    s_mov_b32 s98, 1.0
    s_mov_b32 s97, 49152
    v_mov_b32 v7, 0xbdd2d3e8
    v_min_u32 v14, 1, v8
    s_add_u32 s46, s32, 64
    v_lshl_add_u32 v14, v14, 30, s46
    v_mov_b32 v15, 1
    s_bfe_u32 s46, s2, 0x10003
    s_lshl_b32 s46, s46, 1
    s_add_u32 s46, s46, 64
    v_bfe_u32 v5, v8, 4, 1
    ds_read_b128 v[80:83], v2 offset:24576
    ds_read_b128 v[84:87], v2 offset:25600
    ds_read_b128 v[88:91], v2 offset:26624
    ds_read_b128 v[92:95], v2 offset:27648
    ds_read_b128 a[240:243], v2 offset:28672
    ds_read_b128 a[244:247], v2 offset:29696
    ds_read_b128 a[248:251], v2 offset:30720
    s_waitcnt vmcnt(0)
    v_cmp_gt_u32 vcc, 7, v11
    s_cbranch_vccnz MH_spin
MH_ok:
    buffer_load_dwordx4 v[96:99], v8, s[28:31], s37 offen offset:0 sc1
    buffer_load_dwordx4 v[100:103], v4, s[28:31], s37 offen offset:0 sc1
    buffer_load_dwordx4 v[104:107], v8, s[28:31], s37 offen offset:1024 sc1
    buffer_load_dwordx4 v[108:111], v4, s[28:31], s37 offen offset:1024 sc1
    buffer_load_dwordx4 v[112:115], v8, s[28:31], s37 offen offset:2048 sc1
    buffer_load_dwordx4 v[116:119], v4, s[28:31], s37 offen offset:2048 sc1
    buffer_load_dwordx4 v[120:123], v8, s[28:31], s37 offen offset:3072 sc1
    buffer_load_dwordx4 v[124:127], v4, s[28:31], s37 offen offset:3072 sc1
    s_add_u32 s37, s37, 4096
    buffer_load_dwordx4 v[128:131], v8, s[28:31], s37 offen offset:0 sc1
    buffer_load_dwordx4 v[132:135], v4, s[28:31], s37 offen offset:0 sc1
    buffer_load_dwordx4 v[136:139], v8, s[28:31], s37 offen offset:1024 sc1
    buffer_load_dwordx4 v[140:143], v4, s[28:31], s37 offen offset:1024 sc1
    buffer_load_dwordx4 v[144:147], v8, s[28:31], s37 offen offset:2048 sc1
    buffer_load_dwordx4 v[148:151], v4, s[28:31], s37 offen offset:2048 sc1
    s_waitcnt vmcnt(12) lgkmcnt(3)
    v_mfma_f32_16x16x32_bf16 v[16:19], v[80:83], v[96:99], 0
    ds_read_b128 a[252:255], v2 offset:31744
    v_mfma_f32_16x16x32_bf16 v[20:23], v[80:83], v[100:103], 0
    buffer_load_dwordx4 v[152:155], v8, s[28:31], s37 offen offset:3072 sc1
    v_mfma_f32_16x16x32_bf16 v[24:27], v[84:87], v[96:99], 0
    ds_read_b128 v[80:83], v2 offset:32768
    v_mfma_f32_16x16x32_bf16 v[28:31], v[84:87], v[100:103], 0
    buffer_load_dwordx4 v[156:159], v4, s[28:31], s37 offen offset:3072 sc1
    s_add_u32 s37, s37, 4096
    v_mfma_f32_16x16x32_bf16 v[32:35], v[88:91], v[96:99], 0
    ds_read_b128 v[84:87], v2 offset:33792
    v_mfma_f32_16x16x32_bf16 v[36:39], v[88:91], v[100:103], 0
    v_mfma_f32_16x16x32_bf16 v[40:43], v[92:95], v[96:99], 0
    ds_read_b128 v[88:91], v2 offset:34816
    v_mfma_f32_16x16x32_bf16 v[44:47], v[92:95], v[100:103], 0
    buffer_load_dwordx4 v[160:163], v8, s[28:31], s37 offen offset:0 sc1
    s_waitcnt vmcnt(13) lgkmcnt(3)
    v_mfma_f32_16x16x32_bf16 v[16:19], a[240:243], v[104:107], v[16:19]
    ds_read_b128 v[92:95], v2 offset:35840
    v_mfma_f32_16x16x32_bf16 v[20:23], a[240:243], v[108:111], v[20:23]
    buffer_load_dwordx4 v[164:167], v4, s[28:31], s37 offen offset:0 sc1
    v_mfma_f32_16x16x32_bf16 v[24:27], a[244:247], v[104:107], v[24:27]
    ds_read_b128 a[240:243], v2 offset:36864
    v_mfma_f32_16x16x32_bf16 v[28:31], a[244:247], v[108:111], v[28:31]
    v_mfma_f32_16x16x32_bf16 v[32:35], a[248:251], v[104:107], v[32:35]
    ds_read_b128 a[244:247], v2 offset:37888
    v_mfma_f32_16x16x32_bf16 v[36:39], a[248:251], v[108:111], v[36:39]
    buffer_load_dwordx4 v[168:171], v8, s[28:31], s37 offen offset:1024 sc1
    v_mfma_f32_16x16x32_bf16 v[40:43], a[252:255], v[104:107], v[40:43]
    ds_read_b128 a[248:251], v2 offset:38912
    v_mfma_f32_16x16x32_bf16 v[44:47], a[252:255], v[108:111], v[44:47]
    buffer_load_dwordx4 v[172:175], v4, s[28:31], s37 offen offset:1024 sc1
    s_waitcnt vmcnt(14) lgkmcnt(3)
    v_mfma_f32_16x16x32_bf16 v[16:19], v[80:83], v[112:115], v[16:19]
    ds_read_b128 a[252:255], v2 offset:39936
    v_mfma_f32_16x16x32_bf16 v[20:23], v[80:83], v[116:119], v[20:23]
    buffer_load_dwordx4 v[176:179], v8, s[28:31], s37 offen offset:2048 sc1
    v_mfma_f32_16x16x32_bf16 v[24:27], v[84:87], v[112:115], v[24:27]
    ds_read_b128 v[80:83], v2 offset:40960
    v_mfma_f32_16x16x32_bf16 v[28:31], v[84:87], v[116:119], v[28:31]
    v_mfma_f32_16x16x32_bf16 v[32:35], v[88:91], v[112:115], v[32:35]
    ds_read_b128 v[84:87], v2 offset:41984
    v_add3_u32 v0, v0, v5, s46
    v_mfma_f32_16x16x32_bf16 v[36:39], v[88:91], v[116:119], v[36:39]
    buffer_load_dwordx4 v[180:183], v4, s[28:31], s37 offen offset:2048 sc1
    v_mfma_f32_16x16x32_bf16 v[40:43], v[92:95], v[112:115], v[40:43]
    ds_read_b128 v[88:91], v2 offset:43008
    v_mfma_f32_16x16x32_bf16 v[44:47], v[92:95], v[116:119], v[44:47]
    buffer_load_dwordx4 v[184:187], v8, s[28:31], s37 offen offset:3072 sc1
    s_waitcnt vmcnt(15) lgkmcnt(3)
    v_mfma_f32_16x16x32_bf16 v[16:19], a[240:243], v[120:123], v[16:19]
    ds_read_b128 v[92:95], v2 offset:44032
    v_mfma_f32_16x16x32_bf16 v[20:23], a[240:243], v[124:127], v[20:23]
    v_mfma_f32_16x16x32_bf16 v[24:27], a[244:247], v[120:123], v[24:27]
    ds_read_b128 a[240:243], v2 offset:45056
    v_mfma_f32_16x16x32_bf16 v[28:31], a[244:247], v[124:127], v[28:31]
    buffer_load_dwordx4 v[188:191], v4, s[28:31], s37 offen offset:3072 sc1
    s_add_u32 s37, s37, 4096
    v_mfma_f32_16x16x32_bf16 v[32:35], a[248:251], v[120:123], v[32:35]
    ds_read_b128 a[244:247], v2 offset:46080
    v_mfma_f32_16x16x32_bf16 v[36:39], a[248:251], v[124:127], v[36:39]
    buffer_load_dwordx4 v[192:195], v8, s[28:31], s37 offen offset:0 sc1
    v_mfma_f32_16x16x32_bf16 v[40:43], a[252:255], v[120:123], v[40:43]
    ds_read_b128 a[248:251], v2 offset:47104
    v_mfma_f32_16x16x32_bf16 v[44:47], a[252:255], v[124:127], v[44:47]
    buffer_load_dwordx4 v[196:199], v4, s[28:31], s37 offen offset:0 sc1
    s_waitcnt vmcnt(16) lgkmcnt(3)
    v_mfma_f32_16x16x32_bf16 v[16:19], v[80:83], v[128:131], v[16:19]
    ds_read_b128 a[252:255], v2 offset:48128
    v_mfma_f32_16x16x32_bf16 v[20:23], v[80:83], v[132:135], v[20:23]
    v_mfma_f32_16x16x32_bf16 v[24:27], v[84:87], v[128:131], v[24:27]
    ds_read_b128 v[80:83], v3 offset:0
    v_mfma_f32_16x16x32_bf16 v[28:31], v[84:87], v[132:135], v[28:31]
    buffer_load_dwordx4 v[200:203], v8, s[28:31], s37 offen offset:1024 sc1
    v_mfma_f32_16x16x32_bf16 v[32:35], v[88:91], v[128:131], v[32:35]
    ds_read_b128 v[84:87], v3 offset:1024
    v_mfma_f32_16x16x32_bf16 v[36:39], v[88:91], v[132:135], v[36:39]
    buffer_load_dwordx4 v[204:207], v4, s[28:31], s37 offen offset:1024 sc1
    v_mfma_f32_16x16x32_bf16 v[40:43], v[92:95], v[128:131], v[40:43]
    ds_read_b128 v[88:91], v3 offset:2048
    v_mfma_f32_16x16x32_bf16 v[44:47], v[92:95], v[132:135], v[44:47]
    s_waitcnt vmcnt(16) lgkmcnt(3)
    v_mfma_f32_16x16x32_bf16 v[16:19], a[240:243], v[136:139], v[16:19]
    ds_read_b128 v[92:95], v3 offset:3072
    v_mfma_f32_16x16x32_bf16 v[20:23], a[240:243], v[140:143], v[20:23]
    buffer_load_dwordx4 v[208:211], v8, s[28:31], s37 offen offset:2048 sc1
    v_mfma_f32_16x16x32_bf16 v[24:27], a[244:247], v[136:139], v[24:27]
    ds_read_b128 a[240:243], v3 offset:4096
    v_mfma_f32_16x16x32_bf16 v[28:31], a[244:247], v[140:143], v[28:31]
    buffer_load_dwordx4 v[212:215], v4, s[28:31], s37 offen offset:2048 sc1
    v_mfma_f32_16x16x32_bf16 v[32:35], a[248:251], v[136:139], v[32:35]
    ds_read_b128 a[244:247], v3 offset:5120
    v_mfma_f32_16x16x32_bf16 v[36:39], a[248:251], v[140:143], v[36:39]
    buffer_load_dwordx4 v[216:219], v8, s[28:31], s37 offen offset:3072 sc1
    v_mfma_f32_16x16x32_bf16 v[40:43], a[252:255], v[136:139], v[40:43]
    ds_read_b128 a[248:251], v3 offset:6144
    v_mfma_f32_16x16x32_bf16 v[44:47], a[252:255], v[140:143], v[44:47]
    s_waitcnt vmcnt(17) lgkmcnt(3)
    v_mfma_f32_16x16x32_bf16 v[16:19], v[80:83], v[144:147], v[16:19]
    ds_read_b128 a[252:255], v3 offset:7168
    v_mfma_f32_16x16x32_bf16 v[20:23], v[80:83], v[148:151], v[20:23]
    buffer_load_dwordx4 v[220:223], v4, s[28:31], s37 offen offset:3072 sc1
    s_add_u32 s37, s37, 4096
    v_mfma_f32_16x16x32_bf16 v[24:27], v[84:87], v[144:147], v[24:27]
    ds_read_b128 v[80:83], v3 offset:8192
    v_mfma_f32_16x16x32_bf16 v[28:31], v[84:87], v[148:151], v[28:31]
    buffer_load_dwordx4 v[224:227], v8, s[28:31], s37 offen offset:0 sc1
    v_mfma_f32_16x16x32_bf16 v[32:35], v[88:91], v[144:147], v[32:35]
    ds_read_b128 v[84:87], v3 offset:9216
    v_mfma_f32_16x16x32_bf16 v[36:39], v[88:91], v[148:151], v[36:39]
    v_mfma_f32_16x16x32_bf16 v[40:43], v[92:95], v[144:147], v[40:43]
    ds_read_b128 v[88:91], v3 offset:10240
    v_mfma_f32_16x16x32_bf16 v[44:47], v[92:95], v[148:151], v[44:47]
    buffer_load_dwordx4 v[228:231], v4, s[28:31], s37 offen offset:0 sc1
    s_waitcnt vmcnt(18) lgkmcnt(3)
    v_mfma_f32_16x16x32_bf16 v[16:19], a[240:243], v[152:155], v[16:19]
    ds_read_b128 v[92:95], v3 offset:11264
    v_mfma_f32_16x16x32_bf16 v[20:23], a[240:243], v[156:159], v[20:23]
    buffer_load_dwordx4 v[232:235], v8, s[28:31], s37 offen offset:1024 sc1
    v_mfma_f32_16x16x32_bf16 v[24:27], a[244:247], v[152:155], v[24:27]
    ds_read_b128 a[240:243], v3 offset:12288
    v_mfma_f32_16x16x32_bf16 v[28:31], a[244:247], v[156:159], v[28:31]
    buffer_load_dwordx4 v[236:239], v4, s[28:31], s37 offen offset:1024 sc1
    v_mfma_f32_16x16x32_bf16 v[32:35], a[248:251], v[152:155], v[32:35]
    ds_read_b128 a[244:247], v3 offset:13312
    v_mfma_f32_16x16x32_bf16 v[36:39], a[248:251], v[156:159], v[36:39]
    v_mfma_f32_16x16x32_bf16 v[40:43], a[252:255], v[152:155], v[40:43]
    ds_read_b128 a[248:251], v3 offset:14336
    v_mfma_f32_16x16x32_bf16 v[44:47], a[252:255], v[156:159], v[44:47]
    buffer_load_dwordx4 v[240:243], v8, s[28:31], s37 offen offset:2048 sc1
    s_waitcnt vmcnt(19) lgkmcnt(3)
    v_mfma_f32_16x16x32_bf16 v[16:19], v[80:83], v[160:163], v[16:19]
    ds_read_b128 a[252:255], v3 offset:15360
    v_mfma_f32_16x16x32_bf16 v[20:23], v[80:83], v[164:167], v[20:23]
    buffer_load_dwordx4 v[244:247], v4, s[28:31], s37 offen offset:2048 sc1
    v_mfma_f32_16x16x32_bf16 v[24:27], v[84:87], v[160:163], v[24:27]
    ds_read_b128 v[80:83], v3 offset:16384
    v_mfma_f32_16x16x32_bf16 v[28:31], v[84:87], v[164:167], v[28:31]
    v_mfma_f32_16x16x32_bf16 v[32:35], v[88:91], v[160:163], v[32:35]
    ds_read_b128 v[84:87], v3 offset:17408
    v_mfma_f32_16x16x32_bf16 v[36:39], v[88:91], v[164:167], v[36:39]
    buffer_load_dwordx4 v[248:251], v8, s[28:31], s37 offen offset:3072 sc1
    v_mfma_f32_16x16x32_bf16 v[40:43], v[92:95], v[160:163], v[40:43]
    ds_read_b128 v[88:91], v3 offset:18432
    v_mfma_f32_16x16x32_bf16 v[44:47], v[92:95], v[164:167], v[44:47]
    buffer_load_dwordx4 v[252:255], v4, s[28:31], s37 offen offset:3072 sc1
    s_add_u32 s37, s37, 4096
    s_waitcnt vmcnt(20) lgkmcnt(3)
    v_mfma_f32_16x16x32_bf16 v[16:19], a[240:243], v[168:171], v[16:19]
    ds_read_b128 v[92:95], v3 offset:19456
    v_mfma_f32_16x16x32_bf16 v[20:23], a[240:243], v[172:175], v[20:23]
    v_mfma_f32_16x16x32_bf16 v[24:27], a[244:247], v[168:171], v[24:27]
    ds_read_b128 a[240:243], v3 offset:20480
    v_mfma_f32_16x16x32_bf16 v[28:31], a[244:247], v[172:175], v[28:31]
    v_mfma_f32_16x16x32_bf16 v[32:35], a[248:251], v[168:171], v[32:35]
    ds_read_b128 a[244:247], v3 offset:21504
    v_mfma_f32_16x16x32_bf16 v[36:39], a[248:251], v[172:175], v[36:39]
    v_mfma_f32_16x16x32_bf16 v[40:43], a[252:255], v[168:171], v[40:43]
    ds_read_b128 a[248:251], v3 offset:22528
    v_mfma_f32_16x16x32_bf16 v[44:47], a[252:255], v[172:175], v[44:47]
    s_waitcnt vmcnt(18) lgkmcnt(3)
    v_mfma_f32_16x16x32_bf16 v[16:19], v[80:83], v[176:179], v[16:19]
    ds_read_b128 a[252:255], v3 offset:23552
    v_mfma_f32_16x16x32_bf16 v[20:23], v[80:83], v[180:183], v[20:23]
    v_mfma_f32_16x16x32_bf16 v[24:27], v[84:87], v[176:179], v[24:27]
    s_barrier
    ds_read_b128 v[80:83], v3 offset:24576
    v_mfma_f32_16x16x32_bf16 v[28:31], v[84:87], v[180:183], v[28:31]
    v_mfma_f32_16x16x32_bf16 v[32:35], v[88:91], v[176:179], v[32:35]
    ds_read_b128 v[84:87], v3 offset:25600
    v_mfma_f32_16x16x32_bf16 v[36:39], v[88:91], v[180:183], v[36:39]
    v_mfma_f32_16x16x32_bf16 v[40:43], v[92:95], v[176:179], v[40:43]
    ds_read_b128 v[88:91], v3 offset:26624
    s_add_u32 m0, s50, 73728
    v_mfma_f32_16x16x32_bf16 v[44:47], v[92:95], v[180:183], v[44:47]
    buffer_load_dwordx4 v8, s[68:71], s41 offen offset:0 sc1 lds
    s_waitcnt vmcnt(17) lgkmcnt(3)
    v_mfma_f32_16x16x32_bf16 v[16:19], a[240:243], v[184:187], v[16:19]
    ds_read_b128 v[92:95], v3 offset:27648
    v_mfma_f32_16x16x32_bf16 v[20:23], a[240:243], v[188:191], v[20:23]
    v_mfma_f32_16x16x32_bf16 v[24:27], a[244:247], v[184:187], v[24:27]
    ds_read_b128 a[240:243], v3 offset:28672
    v_mfma_f32_16x16x32_bf16 v[28:31], a[244:247], v[188:191], v[28:31]
    buffer_load_dwordx4 v8, s[68:71], s41 offen offset:1024 sc1 lds
    v_mfma_f32_16x16x32_bf16 v[32:35], a[248:251], v[184:187], v[32:35]
    ds_read_b128 a[244:247], v3 offset:29696
    v_mfma_f32_16x16x32_bf16 v[36:39], a[248:251], v[188:191], v[36:39]
    buffer_load_dwordx4 v8, s[68:71], s41 offen offset:2048 sc1 lds
    s_add_u32 s41, s41, 12288
    v_mfma_f32_16x16x32_bf16 v[40:43], a[252:255], v[184:187], v[40:43]
    ds_read_b128 a[248:251], v3 offset:30720
    v_mfma_f32_16x16x32_bf16 v[44:47], a[252:255], v[188:191], v[44:47]
    s_waitcnt vmcnt(17) lgkmcnt(3)
    v_mfma_f32_16x16x32_bf16 v[16:19], v[80:83], v[192:195], v[16:19]
    ds_read_b128 a[252:255], v3 offset:31744
    s_add_u32 m0, s50, 86016
    v_mfma_f32_16x16x32_bf16 v[20:23], v[80:83], v[196:199], v[20:23]
    buffer_load_dwordx4 v8, s[68:71], s41 offen offset:0 sc1 lds
    v_mfma_f32_16x16x32_bf16 v[24:27], v[84:87], v[192:195], v[24:27]
    ds_read_b128 v[80:83], v3 offset:32768
    v_mfma_f32_16x16x32_bf16 v[28:31], v[84:87], v[196:199], v[28:31]
    v_mfma_f32_16x16x32_bf16 v[32:35], v[88:91], v[192:195], v[32:35]
    ds_read_b128 v[84:87], v3 offset:33792
    v_mfma_f32_16x16x32_bf16 v[36:39], v[88:91], v[196:199], v[36:39]
    buffer_load_dwordx4 v8, s[68:71], s41 offen offset:1024 sc1 lds
    v_mfma_f32_16x16x32_bf16 v[40:43], v[92:95], v[192:195], v[40:43]
    ds_read_b128 v[88:91], v3 offset:34816
    v_mfma_f32_16x16x32_bf16 v[44:47], v[92:95], v[196:199], v[44:47]
    s_waitcnt vmcnt(17) lgkmcnt(3)
    v_mfma_f32_16x16x32_bf16 v[16:19], a[240:243], v[200:203], v[16:19]
    ds_read_b128 v[92:95], v3 offset:35840
    v_mfma_f32_16x16x32_bf16 v[20:23], a[240:243], v[204:207], v[20:23]
    buffer_load_dwordx4 v8, s[68:71], s41 offen offset:2048 sc1 lds
    s_add_u32 s41, s41, 12288
    v_mfma_f32_16x16x32_bf16 v[24:27], a[244:247], v[200:203], v[24:27]
    ds_read_b128 a[240:243], v3 offset:36864
    v_mfma_f32_16x16x32_bf16 v[28:31], a[244:247], v[204:207], v[28:31]
    v_mfma_f32_16x16x32_bf16 v[32:35], a[248:251], v[200:203], v[32:35]
    ds_read_b128 a[244:247], v3 offset:37888
    v_mfma_f32_16x16x32_bf16 v[36:39], a[248:251], v[204:207], v[36:39]
    buffer_load_dwordx4 a[0:3], v8, s[56:59], s38 offen offset:0 sc1
    v_mfma_f32_16x16x32_bf16 v[40:43], a[252:255], v[200:203], v[40:43]
    ds_read_b128 a[248:251], v3 offset:38912
    v_mfma_f32_16x16x32_bf16 v[44:47], a[252:255], v[204:207], v[44:47]
    buffer_load_dwordx4 a[4:7], v8, s[56:59], s38 offen offset:1024 sc1
    s_waitcnt vmcnt(18) lgkmcnt(3)
    v_mfma_f32_16x16x32_bf16 v[16:19], v[80:83], v[208:211], v[16:19]
    ds_read_b128 a[252:255], v3 offset:39936
    v_mfma_f32_16x16x32_bf16 v[20:23], v[80:83], v[212:215], v[20:23]
    v_mfma_f32_16x16x32_bf16 v[24:27], v[84:87], v[208:211], v[24:27]
    ds_read_b128 v[80:83], v3 offset:40960
    v_mfma_f32_16x16x32_bf16 v[28:31], v[84:87], v[212:215], v[28:31]
    buffer_load_dwordx4 a[8:11], v8, s[56:59], s38 offen offset:2048 sc1
    v_mfma_f32_16x16x32_bf16 v[32:35], v[88:91], v[208:211], v[32:35]
    ds_read_b128 v[84:87], v3 offset:41984
    v_mfma_f32_16x16x32_bf16 v[36:39], v[88:91], v[212:215], v[36:39]
    v_mfma_f32_16x16x32_bf16 v[40:43], v[92:95], v[208:211], v[40:43]
    ds_read_b128 v[88:91], v3 offset:43008
    v_mfma_f32_16x16x32_bf16 v[44:47], v[92:95], v[212:215], v[44:47]
    buffer_load_dwordx4 a[12:15], v8, s[56:59], s38 offen offset:3072 sc1
    s_mov_b32 s38, 4096
    s_waitcnt vmcnt(18) lgkmcnt(3)
    v_mfma_f32_16x16x32_bf16 v[16:19], a[240:243], v[216:219], v[16:19]
    ds_read_b128 v[92:95], v3 offset:44032
    v_mfma_f32_16x16x32_bf16 v[20:23], a[240:243], v[220:223], v[20:23]
    v_mfma_f32_16x16x32_bf16 v[24:27], a[244:247], v[216:219], v[24:27]
    ds_read_b128 a[240:243], v3 offset:45056
    v_mfma_f32_16x16x32_bf16 v[28:31], a[244:247], v[220:223], v[28:31]
    buffer_load_dwordx4 a[16:19], v8, s[56:59], s38 offen offset:0 sc1
    s_mov_b32 s38, 12288
    v_mfma_f32_16x16x32_bf16 v[32:35], a[248:251], v[216:219], v[32:35]
    ds_read_b128 a[244:247], v3 offset:46080
    v_mfma_f32_16x16x32_bf16 v[36:39], a[248:251], v[220:223], v[36:39]
    v_mfma_f32_16x16x32_bf16 v[40:43], a[252:255], v[216:219], v[40:43]
    ds_read_b128 a[248:251], v3 offset:47104
    v_mfma_f32_16x16x32_bf16 v[44:47], a[252:255], v[220:223], v[44:47]
    buffer_load_dwordx4 a[20:23], v8, s[56:59], s38 offen offset:3072 sc1
    s_mov_b32 s38, 16384
    s_waitcnt vmcnt(18) lgkmcnt(3)
    v_mfma_f32_16x16x32_bf16 v[16:19], v[80:83], v[224:227], v[16:19]
    ds_read_b128 a[252:255], v3 offset:48128
    v_mfma_f32_16x16x32_bf16 v[20:23], v[80:83], v[228:231], v[20:23]
    buffer_load_dwordx4 a[24:27], v8, s[56:59], s38 offen offset:0 sc1
    v_mfma_f32_16x16x32_bf16 v[24:27], v[84:87], v[224:227], v[24:27]
    s_barrier
    ds_read_b128 v[80:83], v8 offset:0
    v_mfma_f32_16x16x32_bf16 v[28:31], v[84:87], v[228:231], v[28:31]
    v_mfma_f32_16x16x32_bf16 v[32:35], v[88:91], v[224:227], v[32:35]
    ds_read_b128 v[84:87], v8 offset:1024
    v_mfma_f32_16x16x32_bf16 v[36:39], v[88:91], v[228:231], v[36:39]
    buffer_load_dwordx4 a[28:31], v8, s[56:59], s38 offen offset:1024 sc1
    v_mfma_f32_16x16x32_bf16 v[40:43], v[92:95], v[224:227], v[40:43]
    ds_read_b128 v[88:91], v8 offset:2048
    v_mfma_f32_16x16x32_bf16 v[44:47], v[92:95], v[228:231], v[44:47]
    s_waitcnt vmcnt(18) lgkmcnt(3)
    v_mfma_f32_16x16x32_bf16 v[16:19], a[240:243], v[232:235], v[16:19]
    ds_read_b128 v[92:95], v8 offset:3072
    s_add_u32 m0, s50, 98304
    v_mfma_f32_16x16x32_bf16 v[20:23], a[240:243], v[236:239], v[20:23]
    buffer_load_dwordx4 v8, s[68:71], s41 offen offset:0 sc1 lds
    v_mfma_f32_16x16x32_bf16 v[24:27], a[244:247], v[232:235], v[24:27]
    ds_read_b128 a[240:243], v8 offset:4096
    v_mfma_f32_16x16x32_bf16 v[28:31], a[244:247], v[236:239], v[28:31]
    v_mfma_f32_16x16x32_bf16 v[32:35], a[248:251], v[232:235], v[32:35]
    ds_read_b128 a[244:247], v8 offset:5120
    v_mfma_f32_16x16x32_bf16 v[36:39], a[248:251], v[236:239], v[36:39]
    buffer_load_dwordx4 v8, s[68:71], s41 offen offset:1024 sc1 lds
    v_mfma_f32_16x16x32_bf16 v[40:43], a[252:255], v[232:235], v[40:43]
    ds_read_b128 a[248:251], v8 offset:6144
    v_mfma_f32_16x16x32_bf16 v[44:47], a[252:255], v[236:239], v[44:47]
    s_waitcnt vmcnt(18) lgkmcnt(3)
    v_mfma_f32_16x16x32_bf16 v[16:19], v[80:83], v[240:243], v[16:19]
    ds_read_b128 a[252:255], v8 offset:7168
    v_mfma_f32_16x16x32_bf16 v[20:23], v[80:83], v[244:247], v[20:23]
    buffer_load_dwordx4 v8, s[68:71], s41 offen offset:2048 sc1 lds
    s_add_u32 s41, s41, 12288
    v_mfma_f32_16x16x32_bf16 v[24:27], v[84:87], v[240:243], v[24:27]
    ds_read_b128 v[80:83], v8 offset:8192
    s_add_u32 m0, s50, 110592
    v_mfma_f32_16x16x32_bf16 v[28:31], v[84:87], v[244:247], v[28:31]
    buffer_load_dwordx4 v8, s[68:71], s41 offen offset:0 sc1 lds
    v_mfma_f32_16x16x32_bf16 v[32:35], v[88:91], v[240:243], v[32:35]
    ds_read_b128 v[84:87], v8 offset:9216
    v_mfma_f32_16x16x32_bf16 v[36:39], v[88:91], v[244:247], v[36:39]
    v_mfma_f32_16x16x32_bf16 v[40:43], v[92:95], v[240:243], v[40:43]
    ds_read_b128 v[88:91], v8 offset:10240
    v_mfma_f32_16x16x32_bf16 v[44:47], v[92:95], v[244:247], v[44:47]
    buffer_load_dwordx4 v8, s[68:71], s41 offen offset:1024 sc1 lds
    s_waitcnt vmcnt(19) lgkmcnt(3)
    v_mfma_f32_16x16x32_bf16 v[16:19], a[240:243], v[248:251], v[16:19]
    ds_read_b128 v[92:95], v8 offset:11264
    v_mfma_f32_16x16x32_bf16 v[20:23], a[240:243], v[252:255], v[20:23]
    v_mfma_f32_16x16x32_bf16 v[24:27], a[244:247], v[248:251], v[24:27]
    ds_read_b128 a[240:243], v8 offset:12288
    v_mfma_f32_16x16x32_bf16 v[28:31], a[244:247], v[252:255], v[28:31]
    buffer_load_dwordx4 v8, s[68:71], s41 offen offset:2048 sc1 lds
    s_add_u32 s41, s41, 12288
    v_mfma_f32_16x16x32_bf16 v[32:35], a[248:251], v[248:251], v[32:35]
    ds_read_b128 a[244:247], v8 offset:13312
    v_mfma_f32_16x16x32_bf16 v[36:39], a[248:251], v[252:255], v[36:39]
    v_mfma_f32_16x16x32_bf16 v[40:43], a[252:255], v[248:251], v[40:43]
    ds_read_b128 a[248:251], v8 offset:14336
    v_mfma_f32_16x16x32_bf16 v[44:47], a[252:255], v[252:255], v[44:47]
    buffer_load_dwordx4 a[32:35], v8, s[56:59], s38 offen offset:2048 sc1
    s_waitcnt lgkmcnt(3)
    v_mfma_f32_16x16x32_bf16 v[48:51], v[80:83], v[96:99], 0
    ds_read_b128 a[252:255], v8 offset:15360
    v_mfma_f32_16x16x32_bf16 v[52:55], v[80:83], v[100:103], 0
    v_mfma_f32_16x16x32_bf16 v[56:59], v[84:87], v[96:99], 0
    ds_read_b128 v[80:83], v8 offset:16384
    v_mfma_f32_16x16x32_bf16 v[60:63], v[84:87], v[100:103], 0
    v_pk_mul_f32 v[4:5], v[16:17], v[16:17]
    v_pk_mul_f32 v[32:33], v[16:17], v[32:33]
    v_pk_fma_f32 v[4:5], v[4:5], v[6:7], v[6:7] op_sel:[0,1,0] op_sel_hi:[1,1,0]
    v_pk_mul_f32 v[16:17], v[4:5], v[16:17]
    v_exp_f32 v16, v16
    v_exp_f32 v17, v17
    buffer_load_dwordx4 a[36:39], v8, s[56:59], s38 offen offset:3072 sc1
    s_mov_b32 s38, 28672
    v_mfma_f32_16x16x32_bf16 v[64:67], v[88:91], v[96:99], 0
    ds_read_b128 v[84:87], v8 offset:17408
    v_mfma_f32_16x16x32_bf16 v[68:71], v[88:91], v[100:103], 0
    buffer_load_dwordx4 a[40:43], v8, s[56:59], s38 offen offset:2048 sc1
    v_mfma_f32_16x16x32_bf16 v[72:75], v[92:95], v[96:99], 0
    ds_read_b128 v[88:91], v8 offset:18432
    v_mfma_f32_16x16x32_bf16 v[76:79], v[92:95], v[100:103], 0
    v_pk_add_f32 v[16:17], v[16:17], s[98:99] op_sel_hi:[1,0]
    v_rcp_f32 v16, v16
    v_rcp_f32 v17, v17
    s_waitcnt lgkmcnt(3)
    v_mfma_f32_16x16x32_bf16 v[48:51], a[240:243], v[104:107], v[48:51]
    ds_read_b128 v[92:95], v8 offset:19456
    v_mfma_f32_16x16x32_bf16 v[52:55], a[240:243], v[108:111], v[52:55]
    buffer_load_dwordx4 a[44:47], v8, s[56:59], s38 offen offset:3072 sc1
    s_mov_b32 s38, 32768
    v_mfma_f32_16x16x32_bf16 v[56:59], a[244:247], v[104:107], v[56:59]
    ds_read_b128 a[240:243], v8 offset:20480
    v_mfma_f32_16x16x32_bf16 v[60:63], a[244:247], v[108:111], v[60:63]
    v_pk_mul_f32 v[4:5], v[18:19], v[18:19]
    v_pk_mul_f32 v[34:35], v[18:19], v[34:35]
    v_pk_fma_f32 v[4:5], v[4:5], v[6:7], v[6:7] op_sel:[0,1,0] op_sel_hi:[1,1,0]
    v_pk_mul_f32 v[18:19], v[4:5], v[18:19]
    v_exp_f32 v18, v18
    v_exp_f32 v19, v19
    v_mfma_f32_16x16x32_bf16 v[64:67], a[248:251], v[104:107], v[64:67]
    ds_read_b128 a[244:247], v8 offset:21504
    v_mfma_f32_16x16x32_bf16 v[68:71], a[248:251], v[108:111], v[68:71]
    buffer_load_dwordx4 a[48:51], v8, s[56:59], s38 offen offset:0 sc1
    v_mfma_f32_16x16x32_bf16 v[72:75], a[252:255], v[104:107], v[72:75]
    ds_read_b128 a[248:251], v8 offset:22528
    v_mfma_f32_16x16x32_bf16 v[76:79], a[252:255], v[108:111], v[76:79]
    v_pk_add_f32 v[18:19], v[18:19], s[98:99] op_sel_hi:[1,0]
    v_pk_mul_f32 v[16:17], v[32:33], v[16:17]
    v_rcp_f32 v18, v18
    v_rcp_f32 v19, v19
    s_waitcnt lgkmcnt(3)
    v_mfma_f32_16x16x32_bf16 v[48:51], v[80:83], v[112:115], v[48:51]
    ds_read_b128 a[252:255], v8 offset:23552
    v_mfma_f32_16x16x32_bf16 v[52:55], v[80:83], v[116:119], v[52:55]
    buffer_load_dwordx4 a[52:55], v8, s[56:59], s38 offen offset:1024 sc1
    v_mfma_f32_16x16x32_bf16 v[56:59], v[84:87], v[112:115], v[56:59]
    s_barrier
    ds_read_b128 v[80:83], v8 offset:24576
    v_mfma_f32_16x16x32_bf16 v[60:63], v[84:87], v[116:119], v[60:63]
    v_pk_mul_f32 v[4:5], v[24:25], v[24:25]
    v_pk_mul_f32 v[40:41], v[24:25], v[40:41]
    v_pk_fma_f32 v[4:5], v[4:5], v[6:7], v[6:7] op_sel:[0,1,0] op_sel_hi:[1,1,0]
    v_pk_mul_f32 v[24:25], v[4:5], v[24:25]
    v_exp_f32 v24, v24
    v_exp_f32 v25, v25
    v_mfma_f32_16x16x32_bf16 v[64:67], v[88:91], v[112:115], v[64:67]
    ds_read_b128 v[84:87], v8 offset:25600
    v_mfma_f32_16x16x32_bf16 v[68:71], v[88:91], v[116:119], v[68:71]
    buffer_load_dwordx4 a[56:59], v8, s[56:59], s38 offen offset:2048 sc1
    s_mov_b32 s38, 45056
    v_mfma_f32_16x16x32_bf16 v[72:75], v[92:95], v[112:115], v[72:75]
    ds_read_b128 v[88:91], v8 offset:26624
    s_add_u32 m0, s50, 122880
    v_mfma_f32_16x16x32_bf16 v[76:79], v[92:95], v[116:119], v[76:79]
    v_pk_add_f32 v[24:25], v[24:25], s[98:99] op_sel_hi:[1,0]
    v_pk_mul_f32 v[18:19], v[34:35], v[18:19]
    v_rcp_f32 v24, v24
    v_rcp_f32 v25, v25
    buffer_load_dwordx4 v8, s[68:71], s41 offen offset:0 sc1 lds
    s_waitcnt lgkmcnt(3)
    v_mfma_f32_16x16x32_bf16 v[48:51], a[240:243], v[120:123], v[48:51]
    ds_read_b128 v[92:95], v8 offset:27648
    v_mfma_f32_16x16x32_bf16 v[52:55], a[240:243], v[124:127], v[52:55]
    v_mfma_f32_16x16x32_bf16 v[56:59], a[244:247], v[120:123], v[56:59]
    ds_read_b128 a[240:243], v8 offset:28672
    v_mfma_f32_16x16x32_bf16 v[60:63], a[244:247], v[124:127], v[60:63]
    v_pk_mul_f32 v[4:5], v[26:27], v[26:27]
    v_pk_mul_f32 v[42:43], v[26:27], v[42:43]
    v_pk_fma_f32 v[4:5], v[4:5], v[6:7], v[6:7] op_sel:[0,1,0] op_sel_hi:[1,1,0]
    v_pk_mul_f32 v[26:27], v[4:5], v[26:27]
    v_exp_f32 v26, v26
    v_exp_f32 v27, v27
    buffer_load_dwordx4 v8, s[68:71], s41 offen offset:1024 sc1 lds
    v_mfma_f32_16x16x32_bf16 v[64:67], a[248:251], v[120:123], v[64:67]
    ds_read_b128 a[244:247], v8 offset:29696
    v_mfma_f32_16x16x32_bf16 v[68:71], a[248:251], v[124:127], v[68:71]
    v_mfma_f32_16x16x32_bf16 v[72:75], a[252:255], v[120:123], v[72:75]
    ds_read_b128 a[248:251], v8 offset:30720
    v_mfma_f32_16x16x32_bf16 v[76:79], a[252:255], v[124:127], v[76:79]
    v_pk_add_f32 v[26:27], v[26:27], s[98:99] op_sel_hi:[1,0]
    v_pk_mul_f32 v[24:25], v[40:41], v[24:25]
    v_rcp_f32 v26, v26
    v_rcp_f32 v27, v27
    buffer_load_dwordx4 v8, s[68:71], s41 offen offset:2048 sc1 lds
    s_add_u32 s41, s41, 12288
    s_waitcnt lgkmcnt(3)
    v_mfma_f32_16x16x32_bf16 v[48:51], v[80:83], v[128:131], v[48:51]
    ds_read_b128 a[252:255], v8 offset:31744
    v_mfma_f32_16x16x32_bf16 v[52:55], v[80:83], v[132:135], v[52:55]
    v_mfma_f32_16x16x32_bf16 v[56:59], v[84:87], v[128:131], v[56:59]
    ds_read_b128 v[80:83], v8 offset:32768
    s_add_u32 m0, s50, 135168
    v_mfma_f32_16x16x32_bf16 v[60:63], v[84:87], v[132:135], v[60:63]
    v_pk_mul_f32 v[26:27], v[42:43], v[26:27]
    v_cvt_pk_bf16_f32 v16, v16, v17
    v_cvt_pk_bf16_f32 v17, v18, v19
    v_cvt_pk_bf16_f32 v18, v24, v25
    v_cvt_pk_bf16_f32 v19, v26, v27
    buffer_load_dwordx4 v8, s[68:71], s41 offen offset:0 sc1 lds
    v_mfma_f32_16x16x32_bf16 v[64:67], v[88:91], v[128:131], v[64:67]
    ds_read_b128 v[84:87], v8 offset:33792
    v_mfma_f32_16x16x32_bf16 v[68:71], v[88:91], v[132:135], v[68:71]
    v_mfma_f32_16x16x32_bf16 v[72:75], v[92:95], v[128:131], v[72:75]
    ds_read_b128 v[88:91], v8 offset:34816
    v_mfma_f32_16x16x32_bf16 v[76:79], v[92:95], v[132:135], v[76:79]
    buffer_store_dwordx4 v[16:19], v8, s[52:55], 0 offen offset:0 sc1
    buffer_load_dwordx4 v8, s[68:71], s41 offen offset:1024 sc1 lds
    s_waitcnt lgkmcnt(3)
    v_mfma_f32_16x16x32_bf16 v[48:51], a[240:243], v[136:139], v[48:51]
    ds_read_b128 v[92:95], v8 offset:35840
    v_mfma_f32_16x16x32_bf16 v[52:55], a[240:243], v[140:143], v[52:55]
    buffer_load_dwordx4 v8, s[68:71], s41 offen offset:2048 sc1 lds
    s_add_u32 s41, s41, 12288
    v_mfma_f32_16x16x32_bf16 v[56:59], a[244:247], v[136:139], v[56:59]
    ds_read_b128 a[240:243], v8 offset:36864
    v_mfma_f32_16x16x32_bf16 v[60:63], a[244:247], v[140:143], v[60:63]
    v_pk_mul_f32 v[4:5], v[20:21], v[20:21]
    v_pk_mul_f32 v[36:37], v[20:21], v[36:37]
    v_pk_fma_f32 v[4:5], v[4:5], v[6:7], v[6:7] op_sel:[0,1,0] op_sel_hi:[1,1,0]
    v_pk_mul_f32 v[20:21], v[4:5], v[20:21]
    v_exp_f32 v20, v20
    v_exp_f32 v21, v21
    v_mfma_f32_16x16x32_bf16 v[64:67], a[248:251], v[136:139], v[64:67]
    ds_read_b128 a[244:247], v8 offset:37888
    v_mfma_f32_16x16x32_bf16 v[68:71], a[248:251], v[140:143], v[68:71]
    buffer_load_dwordx4 a[60:63], v8, s[56:59], s38 offen offset:1024 sc1
    v_mfma_f32_16x16x32_bf16 v[72:75], a[252:255], v[136:139], v[72:75]
    ds_read_b128 a[248:251], v8 offset:38912
    v_mfma_f32_16x16x32_bf16 v[76:79], a[252:255], v[140:143], v[76:79]
    v_pk_add_f32 v[20:21], v[20:21], s[98:99] op_sel_hi:[1,0]
    v_rcp_f32 v20, v20
    v_rcp_f32 v21, v21
    s_waitcnt lgkmcnt(3)
    v_mfma_f32_16x16x32_bf16 v[48:51], v[80:83], v[144:147], v[48:51]
    ds_read_b128 a[252:255], v8 offset:39936
    v_mfma_f32_16x16x32_bf16 v[52:55], v[80:83], v[148:151], v[52:55]
    buffer_load_dwordx4 a[64:67], v8, s[56:59], s38 offen offset:2048 sc1
    v_mfma_f32_16x16x32_bf16 v[56:59], v[84:87], v[144:147], v[56:59]
    ds_read_b128 v[80:83], v8 offset:40960
    v_mfma_f32_16x16x32_bf16 v[60:63], v[84:87], v[148:151], v[60:63]
    v_pk_mul_f32 v[4:5], v[22:23], v[22:23]
    v_pk_mul_f32 v[38:39], v[22:23], v[38:39]
    v_pk_fma_f32 v[4:5], v[4:5], v[6:7], v[6:7] op_sel:[0,1,0] op_sel_hi:[1,1,0]
    v_pk_mul_f32 v[22:23], v[4:5], v[22:23]
    v_exp_f32 v22, v22
    v_exp_f32 v23, v23
    v_mfma_f32_16x16x32_bf16 v[64:67], v[88:91], v[144:147], v[64:67]
    ds_read_b128 v[84:87], v8 offset:41984
    v_mfma_f32_16x16x32_bf16 v[68:71], v[88:91], v[148:151], v[68:71]
    buffer_load_dwordx4 a[68:71], v8, s[56:59], s38 offen offset:3072 sc1
    s_mov_b32 s38, 49152
    v_mfma_f32_16x16x32_bf16 v[72:75], v[92:95], v[144:147], v[72:75]
    ds_read_b128 v[88:91], v8 offset:43008
    v_mfma_f32_16x16x32_bf16 v[76:79], v[92:95], v[148:151], v[76:79]
    v_pk_add_f32 v[22:23], v[22:23], s[98:99] op_sel_hi:[1,0]
    v_pk_mul_f32 v[20:21], v[36:37], v[20:21]
    v_rcp_f32 v22, v22
    v_rcp_f32 v23, v23
    s_waitcnt lgkmcnt(3)
    v_mfma_f32_16x16x32_bf16 v[48:51], a[240:243], v[152:155], v[48:51]
    ds_read_b128 v[92:95], v8 offset:44032
    v_mfma_f32_16x16x32_bf16 v[52:55], a[240:243], v[156:159], v[52:55]
    buffer_load_dwordx4 a[72:75], v8, s[56:59], s38 offen offset:0 sc1
    v_mfma_f32_16x16x32_bf16 v[56:59], a[244:247], v[152:155], v[56:59]
    ds_read_b128 a[240:243], v8 offset:45056
    v_mfma_f32_16x16x32_bf16 v[60:63], a[244:247], v[156:159], v[60:63]
    v_pk_mul_f32 v[4:5], v[28:29], v[28:29]
    v_pk_mul_f32 v[44:45], v[28:29], v[44:45]
    v_pk_fma_f32 v[4:5], v[4:5], v[6:7], v[6:7] op_sel:[0,1,0] op_sel_hi:[1,1,0]
    v_pk_mul_f32 v[28:29], v[4:5], v[28:29]
    v_exp_f32 v28, v28
    v_exp_f32 v29, v29
    buffer_load_dwordx4 a[76:79], v8, s[56:59], s38 offen offset:1024 sc1
    s_mov_b32 s38, 4096
    v_mfma_f32_16x16x32_bf16 v[64:67], a[248:251], v[152:155], v[64:67]
    ds_read_b128 a[244:247], v8 offset:46080
    v_mfma_f32_16x16x32_bf16 v[68:71], a[248:251], v[156:159], v[68:71]
    v_mfma_f32_16x16x32_bf16 v[72:75], a[252:255], v[152:155], v[72:75]
    ds_read_b128 a[248:251], v8 offset:47104
    v_mfma_f32_16x16x32_bf16 v[76:79], a[252:255], v[156:159], v[76:79]
    v_pk_add_f32 v[28:29], v[28:29], s[98:99] op_sel_hi:[1,0]
    v_pk_mul_f32 v[22:23], v[38:39], v[22:23]
    v_rcp_f32 v28, v28
    v_rcp_f32 v29, v29
    buffer_load_dwordx4 a[80:83], v8, s[56:59], s38 offen offset:1024 sc1
    s_waitcnt lgkmcnt(3)
    v_mfma_f32_16x16x32_bf16 v[48:51], v[80:83], v[160:163], v[48:51]
    ds_read_b128 a[252:255], v8 offset:48128
    v_mfma_f32_16x16x32_bf16 v[52:55], v[80:83], v[164:167], v[52:55]
    v_mfma_f32_16x16x32_bf16 v[56:59], v[84:87], v[160:163], v[56:59]
    s_barrier
    ds_read_b128 v[80:83], v2 offset:0
    v_mfma_f32_16x16x32_bf16 v[60:63], v[84:87], v[164:167], v[60:63]
    v_pk_mul_f32 v[4:5], v[30:31], v[30:31]
    v_pk_mul_f32 v[46:47], v[30:31], v[46:47]
    v_pk_fma_f32 v[4:5], v[4:5], v[6:7], v[6:7] op_sel:[0,1,0] op_sel_hi:[1,1,0]
    v_pk_mul_f32 v[30:31], v[4:5], v[30:31]
    v_exp_f32 v30, v30
    v_exp_f32 v31, v31
    buffer_load_dwordx4 a[84:87], v8, s[56:59], s38 offen offset:2048 sc1
    v_mfma_f32_16x16x32_bf16 v[64:67], v[88:91], v[160:163], v[64:67]
    ds_read_b128 v[84:87], v2 offset:1024
    v_mfma_f32_16x16x32_bf16 v[68:71], v[88:91], v[164:167], v[68:71]
    v_mfma_f32_16x16x32_bf16 v[72:75], v[92:95], v[160:163], v[72:75]
    ds_read_b128 v[88:91], v2 offset:2048
    s_add_u32 m0, s50, 0
    v_mfma_f32_16x16x32_bf16 v[76:79], v[92:95], v[164:167], v[76:79]
    v_pk_add_f32 v[30:31], v[30:31], s[98:99] op_sel_hi:[1,0]
    v_pk_mul_f32 v[28:29], v[44:45], v[28:29]
    v_rcp_f32 v30, v30
    v_rcp_f32 v31, v31
    buffer_load_dwordx4 v8, s[68:71], s41 offen offset:0 sc1 lds
    s_waitcnt lgkmcnt(3)
    v_mfma_f32_16x16x32_bf16 v[48:51], a[240:243], v[168:171], v[48:51]
    ds_read_b128 v[92:95], v2 offset:3072
    v_mfma_f32_16x16x32_bf16 v[52:55], a[240:243], v[172:175], v[52:55]
    v_mfma_f32_16x16x32_bf16 v[56:59], a[244:247], v[168:171], v[56:59]
    ds_read_b128 a[240:243], v2 offset:4096
    v_mfma_f32_16x16x32_bf16 v[60:63], a[244:247], v[172:175], v[60:63]
    v_pk_mul_f32 v[30:31], v[46:47], v[30:31]
    v_cvt_pk_bf16_f32 v20, v20, v21
    v_cvt_pk_bf16_f32 v21, v22, v23
    v_cvt_pk_bf16_f32 v22, v28, v29
    v_cvt_pk_bf16_f32 v23, v30, v31
    buffer_load_dwordx4 v8, s[68:71], s41 offen offset:1024 sc1 lds
    v_mfma_f32_16x16x32_bf16 v[64:67], a[248:251], v[168:171], v[64:67]
    ds_read_b128 a[244:247], v2 offset:5120
    v_mfma_f32_16x16x32_bf16 v[68:71], a[248:251], v[172:175], v[68:71]
    buffer_load_dwordx4 v8, s[68:71], s41 offen offset:2048 sc1 lds
    s_add_u32 s41, s41, 12288
    v_mfma_f32_16x16x32_bf16 v[72:75], a[252:255], v[168:171], v[72:75]
    ds_read_b128 a[248:251], v2 offset:6144
    v_mfma_f32_16x16x32_bf16 v[76:79], a[252:255], v[172:175], v[76:79]
    buffer_store_dwordx4 v[20:23], v8, s[52:55], s97 offen offset:0 sc1
    s_waitcnt lgkmcnt(3)
    v_mfma_f32_16x16x32_bf16 v[48:51], v[80:83], v[176:179], v[48:51]
    ds_read_b128 a[252:255], v2 offset:7168
    s_add_u32 m0, s50, 12288
    v_mfma_f32_16x16x32_bf16 v[52:55], v[80:83], v[180:183], v[52:55]
    buffer_load_dwordx4 v8, s[68:71], s41 offen offset:0 sc1 lds
    v_mfma_f32_16x16x32_bf16 v[56:59], v[84:87], v[176:179], v[56:59]
    ds_read_b128 v[80:83], v2 offset:8192
    v_mfma_f32_16x16x32_bf16 v[60:63], v[84:87], v[180:183], v[60:63]
    v_mfma_f32_16x16x32_bf16 v[64:67], v[88:91], v[176:179], v[64:67]
    ds_read_b128 v[84:87], v2 offset:9216
    v_mfma_f32_16x16x32_bf16 v[68:71], v[88:91], v[180:183], v[68:71]
    buffer_load_dwordx4 v8, s[68:71], s41 offen offset:1024 sc1 lds
    v_mfma_f32_16x16x32_bf16 v[72:75], v[92:95], v[176:179], v[72:75]
    ds_read_b128 v[88:91], v2 offset:10240
    v_mfma_f32_16x16x32_bf16 v[76:79], v[92:95], v[180:183], v[76:79]
    s_waitcnt lgkmcnt(3)
    v_mfma_f32_16x16x32_bf16 v[48:51], a[240:243], v[184:187], v[48:51]
    ds_read_b128 v[92:95], v2 offset:11264
    v_mfma_f32_16x16x32_bf16 v[52:55], a[240:243], v[188:191], v[52:55]
    buffer_load_dwordx4 v8, s[68:71], s41 offen offset:2048 sc1 lds
    s_add_u32 s41, s41, 12288
    v_mfma_f32_16x16x32_bf16 v[56:59], a[244:247], v[184:187], v[56:59]
    ds_read_b128 a[240:243], v2 offset:12288
    v_mfma_f32_16x16x32_bf16 v[60:63], a[244:247], v[188:191], v[60:63]
    v_mfma_f32_16x16x32_bf16 v[64:67], a[248:251], v[184:187], v[64:67]
    ds_read_b128 a[244:247], v2 offset:13312
    v_mfma_f32_16x16x32_bf16 v[68:71], a[248:251], v[188:191], v[68:71]
    buffer_load_dwordx4 a[88:91], v8, s[56:59], s38 offen offset:3072 sc1
    s_mov_b32 s38, 8192
    v_mfma_f32_16x16x32_bf16 v[72:75], a[252:255], v[184:187], v[72:75]
    ds_read_b128 a[248:251], v2 offset:14336
    v_mfma_f32_16x16x32_bf16 v[76:79], a[252:255], v[188:191], v[76:79]
    buffer_load_dwordx4 a[92:95], v8, s[56:59], s38 offen offset:0 sc1
    s_waitcnt lgkmcnt(3)
    v_mfma_f32_16x16x32_bf16 v[48:51], v[80:83], v[192:195], v[48:51]
    ds_read_b128 a[252:255], v2 offset:15360
    v_mfma_f32_16x16x32_bf16 v[52:55], v[80:83], v[196:199], v[52:55]
    v_mfma_f32_16x16x32_bf16 v[56:59], v[84:87], v[192:195], v[56:59]
    ds_read_b128 v[80:83], v2 offset:16384
    v_mfma_f32_16x16x32_bf16 v[60:63], v[84:87], v[196:199], v[60:63]
    buffer_load_dwordx4 a[96:99], v8, s[56:59], s38 offen offset:1024 sc1
    s_mov_b32 s38, 20480
    v_mfma_f32_16x16x32_bf16 v[64:67], v[88:91], v[192:195], v[64:67]
    ds_read_b128 v[84:87], v2 offset:17408
    v_mfma_f32_16x16x32_bf16 v[68:71], v[88:91], v[196:199], v[68:71]
    v_mfma_f32_16x16x32_bf16 v[72:75], v[92:95], v[192:195], v[72:75]
    ds_read_b128 v[88:91], v2 offset:18432
    v_mfma_f32_16x16x32_bf16 v[76:79], v[92:95], v[196:199], v[76:79]
    buffer_load_dwordx4 a[100:103], v8, s[56:59], s38 offen offset:0 sc1
    s_waitcnt lgkmcnt(3)
    v_mfma_f32_16x16x32_bf16 v[48:51], a[240:243], v[200:203], v[48:51]
    ds_read_b128 v[92:95], v2 offset:19456
    v_mfma_f32_16x16x32_bf16 v[52:55], a[240:243], v[204:207], v[52:55]
    v_mfma_f32_16x16x32_bf16 v[56:59], a[244:247], v[200:203], v[56:59]
    ds_read_b128 a[240:243], v2 offset:20480
    v_mfma_f32_16x16x32_bf16 v[60:63], a[244:247], v[204:207], v[60:63]
    buffer_load_dwordx4 a[104:107], v8, s[56:59], s38 offen offset:1024 sc1
    v_mfma_f32_16x16x32_bf16 v[64:67], a[248:251], v[200:203], v[64:67]
    ds_read_b128 a[244:247], v2 offset:21504
    v_mfma_f32_16x16x32_bf16 v[68:71], a[248:251], v[204:207], v[68:71]
    v_mfma_f32_16x16x32_bf16 v[72:75], a[252:255], v[200:203], v[72:75]
    ds_read_b128 a[248:251], v2 offset:22528
    v_mfma_f32_16x16x32_bf16 v[76:79], a[252:255], v[204:207], v[76:79]
    buffer_load_dwordx4 a[108:111], v8, s[56:59], s38 offen offset:2048 sc1
    s_waitcnt lgkmcnt(3)
    v_mfma_f32_16x16x32_bf16 v[48:51], v[80:83], v[208:211], v[48:51]
    ds_read_b128 a[252:255], v2 offset:23552
    v_mfma_f32_16x16x32_bf16 v[52:55], v[80:83], v[212:215], v[52:55]
    buffer_load_dwordx4 a[112:115], v8, s[56:59], s38 offen offset:3072 sc1
    s_mov_b32 s38, 24576
    v_mfma_f32_16x16x32_bf16 v[56:59], v[84:87], v[208:211], v[56:59]
    s_waitcnt vmcnt(49)
    s_barrier
    ds_read_b128 v[80:83], v2 offset:24576
    v_mfma_f32_16x16x32_bf16 v[60:63], v[84:87], v[212:215], v[60:63]
    v_mfma_f32_16x16x32_bf16 v[64:67], v[88:91], v[208:211], v[64:67]
    ds_read_b128 v[84:87], v2 offset:25600
    v_mfma_f32_16x16x32_bf16 v[68:71], v[88:91], v[212:215], v[68:71]
    buffer_load_dwordx4 a[116:119], v8, s[56:59], s38 offen offset:0 sc1
    s_mov_b32 s38, 32768
    v_mfma_f32_16x16x32_bf16 v[72:75], v[92:95], v[208:211], v[72:75]
    ds_read_b128 v[88:91], v2 offset:26624
    v_mfma_f32_16x16x32_bf16 v[76:79], v[92:95], v[212:215], v[76:79]
    s_waitcnt lgkmcnt(3)
    v_mfma_f32_16x16x32_bf16 v[48:51], a[240:243], v[216:219], v[48:51]
    ds_read_b128 v[92:95], v2 offset:27648
    v_mfma_f32_16x16x32_bf16 v[52:55], a[240:243], v[220:223], v[52:55]
    buffer_load_dwordx4 a[120:123], v8, s[56:59], s38 offen offset:3072 sc1
    s_mov_b32 s38, 36864
    v_mfma_f32_16x16x32_bf16 v[56:59], a[244:247], v[216:219], v[56:59]
    ds_read_b128 a[240:243], v2 offset:28672
    v_mfma_f32_16x16x32_bf16 v[60:63], a[244:247], v[220:223], v[60:63]
    v_mfma_f32_16x16x32_bf16 v[64:67], a[248:251], v[216:219], v[64:67]
    ds_read_b128 a[244:247], v2 offset:29696
    v_mfma_f32_16x16x32_bf16 v[68:71], a[248:251], v[220:223], v[68:71]
    buffer_load_dwordx4 a[124:127], v8, s[56:59], s38 offen offset:0 sc1
    v_mfma_f32_16x16x32_bf16 v[72:75], a[252:255], v[216:219], v[72:75]
    ds_read_b128 a[248:251], v2 offset:30720
    v_mfma_f32_16x16x32_bf16 v[76:79], a[252:255], v[220:223], v[76:79]
    s_waitcnt lgkmcnt(3)
    v_mfma_f32_16x16x32_bf16 v[48:51], v[80:83], v[224:227], v[48:51]
    ds_read_b128 a[252:255], v2 offset:31744
    v_mfma_f32_16x16x32_bf16 v[52:55], v[80:83], v[228:231], v[52:55]
    buffer_load_dwordx4 a[128:131], v8, s[56:59], s38 offen offset:1024 sc1
    v_mfma_f32_16x16x32_bf16 v[56:59], v[84:87], v[224:227], v[56:59]
    ds_read_b128 v[80:83], v2 offset:32768
    v_mfma_f32_16x16x32_bf16 v[60:63], v[84:87], v[228:231], v[60:63]
    buffer_load_dwordx4 a[132:135], v8, s[56:59], s38 offen offset:2048 sc1
    v_mfma_f32_16x16x32_bf16 v[64:67], v[88:91], v[224:227], v[64:67]
    ds_read_b128 v[84:87], v2 offset:33792
    v_mfma_f32_16x16x32_bf16 v[68:71], v[88:91], v[228:231], v[68:71]
    v_mfma_f32_16x16x32_bf16 v[72:75], v[92:95], v[224:227], v[72:75]
    ds_read_b128 v[88:91], v2 offset:34816
    v_mfma_f32_16x16x32_bf16 v[76:79], v[92:95], v[228:231], v[76:79]
    buffer_load_dwordx4 a[136:139], v8, s[56:59], s38 offen offset:3072 sc1
    s_mov_b32 s38, 49152
    s_waitcnt lgkmcnt(3)
    v_mfma_f32_16x16x32_bf16 v[48:51], a[240:243], v[232:235], v[48:51]
    ds_read_b128 v[92:95], v2 offset:35840
    v_mfma_f32_16x16x32_bf16 v[52:55], a[240:243], v[236:239], v[52:55]
    v_mfma_f32_16x16x32_bf16 v[56:59], a[244:247], v[232:235], v[56:59]
    ds_read_b128 a[240:243], v2 offset:36864
    v_mfma_f32_16x16x32_bf16 v[60:63], a[244:247], v[236:239], v[60:63]
    buffer_load_dwordx4 a[140:143], v8, s[56:59], s38 offen offset:2048 sc1
    v_mfma_f32_16x16x32_bf16 v[64:67], a[248:251], v[232:235], v[64:67]
    ds_read_b128 a[244:247], v2 offset:37888
    s_waitcnt vmcnt(17)
    buffer_store_byte v15, v14, s[76:79], s0 offen sc1
    v_mfma_f32_16x16x32_bf16 v[68:71], a[248:251], v[236:239], v[68:71]
    v_mfma_f32_16x16x32_bf16 v[72:75], a[252:255], v[232:235], v[72:75]
    ds_read_b128 a[248:251], v2 offset:38912
    v_mov_b32 v15, 2
    v_mfma_f32_16x16x32_bf16 v[76:79], a[252:255], v[236:239], v[76:79]
    buffer_load_dwordx4 a[144:147], v8, s[56:59], s38 offen offset:3072 sc1
    s_mov_b32 s38, 53248
    s_waitcnt lgkmcnt(3)
    v_mfma_f32_16x16x32_bf16 v[48:51], v[80:83], v[240:243], v[48:51]
    ds_read_b128 a[252:255], v2 offset:39936
    v_mfma_f32_16x16x32_bf16 v[52:55], v[80:83], v[244:247], v[52:55]
    v_mfma_f32_16x16x32_bf16 v[56:59], v[84:87], v[240:243], v[56:59]
    ds_read_b128 v[80:83], v2 offset:40960
    v_mfma_f32_16x16x32_bf16 v[60:63], v[84:87], v[244:247], v[60:63]
    buffer_load_dwordx4 a[148:151], v8, s[56:59], s38 offen offset:0 sc1
    v_mfma_f32_16x16x32_bf16 v[64:67], v[88:91], v[240:243], v[64:67]
    ds_read_b128 v[84:87], v2 offset:41984
    v_mfma_f32_16x16x32_bf16 v[68:71], v[88:91], v[244:247], v[68:71]
    buffer_load_dwordx4 a[152:155], v8, s[56:59], s38 offen offset:1024 sc1
    v_mfma_f32_16x16x32_bf16 v[72:75], v[92:95], v[240:243], v[72:75]
    ds_read_b128 v[88:91], v2 offset:43008
    v_mfma_f32_16x16x32_bf16 v[76:79], v[92:95], v[244:247], v[76:79]
    s_waitcnt lgkmcnt(3)
    v_mfma_f32_16x16x32_bf16 v[48:51], a[240:243], v[248:251], v[48:51]
    ds_read_b128 v[92:95], v2 offset:44032
    v_mfma_f32_16x16x32_bf16 v[52:55], a[240:243], v[252:255], v[52:55]
    buffer_load_dwordx4 a[156:159], v8, s[56:59], s38 offen offset:2048 sc1
    s_mov_b32 s38, 8192
    v_mfma_f32_16x16x32_bf16 v[56:59], a[244:247], v[248:251], v[56:59]
    ds_read_b128 a[240:243], v2 offset:45056
    v_mfma_f32_16x16x32_bf16 v[60:63], a[244:247], v[252:255], v[60:63]
    v_mfma_f32_16x16x32_bf16 v[64:67], a[248:251], v[248:251], v[64:67]
    ds_read_b128 a[244:247], v2 offset:46080
    v_mfma_f32_16x16x32_bf16 v[68:71], a[248:251], v[252:255], v[68:71]
    buffer_load_dwordx4 a[160:163], v8, s[56:59], s38 offen offset:2048 sc1
    v_mfma_f32_16x16x32_bf16 v[72:75], a[252:255], v[248:251], v[72:75]
    ds_read_b128 a[248:251], v2 offset:47104
    v_mfma_f32_16x16x32_bf16 v[76:79], a[252:255], v[252:255], v[76:79]
    s_waitcnt lgkmcnt(3)
    v_mfma_f32_16x16x32_bf16 v[16:19], v[80:83], v[96:99], 0
    ds_read_b128 a[252:255], v2 offset:48128
    v_mfma_f32_16x16x32_bf16 v[20:23], v[80:83], v[100:103], 0
    buffer_load_dwordx4 a[164:167], v8, s[56:59], s38 offen offset:3072 sc1
    s_mov_b32 s38, 12288
    v_mfma_f32_16x16x32_bf16 v[24:27], v[84:87], v[96:99], 0
    s_barrier
    ds_read_b128 v[80:83], v3 offset:0
    v_mfma_f32_16x16x32_bf16 v[28:31], v[84:87], v[100:103], 0
    v_pk_mul_f32 v[4:5], v[48:49], v[48:49]
    v_pk_mul_f32 v[64:65], v[48:49], v[64:65]
    v_pk_fma_f32 v[4:5], v[4:5], v[6:7], v[6:7] op_sel:[0,1,0] op_sel_hi:[1,1,0]
    v_pk_mul_f32 v[48:49], v[4:5], v[48:49]
    v_exp_f32 v48, v48
    v_exp_f32 v49, v49
    v_mfma_f32_16x16x32_bf16 v[32:35], v[88:91], v[96:99], 0
    ds_read_b128 v[84:87], v3 offset:1024
    v_mfma_f32_16x16x32_bf16 v[36:39], v[88:91], v[100:103], 0
    buffer_load_dwordx4 a[168:171], v8, s[56:59], s38 offen offset:0 sc1
    v_mfma_f32_16x16x32_bf16 v[40:43], v[92:95], v[96:99], 0
    v_pk_add_f32 v[48:49], v[48:49], s[98:99] op_sel_hi:[1,0]
    v_rcp_f32 v48, v48
    v_rcp_f32 v49, v49
    ds_read_b128 v[88:91], v3 offset:2048
    v_mfma_f32_16x16x32_bf16 v[44:47], v[92:95], v[100:103], 0
    buffer_load_dwordx4 a[172:175], v8, s[56:59], s38 offen offset:1024 sc1
    s_waitcnt lgkmcnt(3)
    v_mfma_f32_16x16x32_bf16 v[16:19], a[240:243], v[104:107], v[16:19]
    ds_read_b128 v[92:95], v3 offset:3072
    v_mfma_f32_16x16x32_bf16 v[20:23], a[240:243], v[108:111], v[20:23]
    v_pk_mul_f32 v[4:5], v[50:51], v[50:51]
    v_pk_mul_f32 v[66:67], v[50:51], v[66:67]
    v_pk_fma_f32 v[4:5], v[4:5], v[6:7], v[6:7] op_sel:[0,1,0] op_sel_hi:[1,1,0]
    v_pk_mul_f32 v[50:51], v[4:5], v[50:51]
    v_exp_f32 v50, v50
    v_exp_f32 v51, v51
    v_mfma_f32_16x16x32_bf16 v[24:27], a[244:247], v[104:107], v[24:27]
    ds_read_b128 a[240:243], v3 offset:4096
    v_mfma_f32_16x16x32_bf16 v[28:31], a[244:247], v[108:111], v[28:31]
    buffer_load_dwordx4 a[176:179], v8, s[56:59], s38 offen offset:2048 sc1
    s_mov_b32 s38, 24576
    v_mfma_f32_16x16x32_bf16 v[32:35], a[248:251], v[104:107], v[32:35]
    v_pk_add_f32 v[50:51], v[50:51], s[98:99] op_sel_hi:[1,0]
    v_pk_mul_f32 v[48:49], v[64:65], v[48:49]
    v_rcp_f32 v50, v50
    v_rcp_f32 v51, v51
    ds_read_b128 a[244:247], v3 offset:5120
    v_mfma_f32_16x16x32_bf16 v[36:39], a[248:251], v[108:111], v[36:39]
    v_mfma_f32_16x16x32_bf16 v[40:43], a[252:255], v[104:107], v[40:43]
    ds_read_b128 a[248:251], v3 offset:6144
    v_mfma_f32_16x16x32_bf16 v[44:47], a[252:255], v[108:111], v[44:47]
    v_pk_mul_f32 v[4:5], v[56:57], v[56:57]
    v_pk_mul_f32 v[72:73], v[56:57], v[72:73]
    v_pk_fma_f32 v[4:5], v[4:5], v[6:7], v[6:7] op_sel:[0,1,0] op_sel_hi:[1,1,0]
    v_pk_mul_f32 v[56:57], v[4:5], v[56:57]
    v_exp_f32 v56, v56
    v_exp_f32 v57, v57
    buffer_load_dwordx4 a[180:183], v8, s[56:59], s38 offen offset:1024 sc1
    s_waitcnt lgkmcnt(3)
    v_mfma_f32_16x16x32_bf16 v[16:19], v[80:83], v[112:115], v[16:19]
    ds_read_b128 a[252:255], v3 offset:7168
    v_mfma_f32_16x16x32_bf16 v[20:23], v[80:83], v[116:119], v[20:23]
    v_mfma_f32_16x16x32_bf16 v[24:27], v[84:87], v[112:115], v[24:27]
    v_pk_add_f32 v[56:57], v[56:57], s[98:99] op_sel_hi:[1,0]
    v_pk_mul_f32 v[50:51], v[66:67], v[50:51]
    v_rcp_f32 v56, v56
    v_rcp_f32 v57, v57
    ds_read_b128 v[80:83], v3 offset:8192
    v_mfma_f32_16x16x32_bf16 v[28:31], v[84:87], v[116:119], v[28:31]
    buffer_load_dwordx4 a[184:187], v8, s[56:59], s38 offen offset:2048 sc1
    v_mfma_f32_16x16x32_bf16 v[32:35], v[88:91], v[112:115], v[32:35]
    ds_read_b128 v[84:87], v3 offset:9216
    v_mfma_f32_16x16x32_bf16 v[36:39], v[88:91], v[116:119], v[36:39]
    v_pk_mul_f32 v[4:5], v[58:59], v[58:59]
    v_pk_mul_f32 v[74:75], v[58:59], v[74:75]
    v_pk_fma_f32 v[4:5], v[4:5], v[6:7], v[6:7] op_sel:[0,1,0] op_sel_hi:[1,1,0]
    v_pk_mul_f32 v[58:59], v[4:5], v[58:59]
    v_exp_f32 v58, v58
    v_exp_f32 v59, v59
    v_mfma_f32_16x16x32_bf16 v[40:43], v[92:95], v[112:115], v[40:43]
    ds_read_b128 v[88:91], v3 offset:10240
    v_mfma_f32_16x16x32_bf16 v[44:47], v[92:95], v[116:119], v[44:47]
    buffer_load_dwordx4 a[188:191], v8, s[56:59], s38 offen offset:3072 sc1
    s_mov_b32 s38, 28672
    s_waitcnt lgkmcnt(3)
    v_mfma_f32_16x16x32_bf16 v[16:19], a[240:243], v[120:123], v[16:19]
    v_pk_add_f32 v[58:59], v[58:59], s[98:99] op_sel_hi:[1,0]
    v_pk_mul_f32 v[56:57], v[72:73], v[56:57]
    v_rcp_f32 v58, v58
    v_rcp_f32 v59, v59
    ds_read_b128 v[92:95], v3 offset:11264
    v_mfma_f32_16x16x32_bf16 v[20:23], a[240:243], v[124:127], v[20:23]
    buffer_load_dwordx4 a[192:195], v8, s[56:59], s38 offen offset:0 sc1
    v_mfma_f32_16x16x32_bf16 v[24:27], a[244:247], v[120:123], v[24:27]
    ds_read_b128 a[240:243], v3 offset:12288
    v_mfma_f32_16x16x32_bf16 v[28:31], a[244:247], v[124:127], v[28:31]
    v_pk_mul_f32 v[58:59], v[74:75], v[58:59]
    v_cvt_pk_bf16_f32 v48, v48, v49
    v_cvt_pk_bf16_f32 v49, v50, v51
    v_cvt_pk_bf16_f32 v50, v56, v57
    v_cvt_pk_bf16_f32 v51, v58, v59
    v_mfma_f32_16x16x32_bf16 v[32:35], a[248:251], v[120:123], v[32:35]
    ds_read_b128 a[244:247], v3 offset:13312
    v_mfma_f32_16x16x32_bf16 v[36:39], a[248:251], v[124:127], v[36:39]
    buffer_load_dwordx4 a[196:199], v8, s[56:59], s38 offen offset:1024 sc1
    s_mov_b32 s38, 40960
    v_mfma_f32_16x16x32_bf16 v[40:43], a[252:255], v[120:123], v[40:43]
    buffer_store_dwordx4 v[48:51], v8, s[52:55], 0 offen offset:1024 sc1
    ds_read_b128 a[248:251], v3 offset:14336
    v_mfma_f32_16x16x32_bf16 v[44:47], a[252:255], v[124:127], v[44:47]
    s_waitcnt lgkmcnt(3)
    v_mfma_f32_16x16x32_bf16 v[16:19], v[80:83], v[128:131], v[16:19]
    ds_read_b128 a[252:255], v3 offset:15360
    v_mfma_f32_16x16x32_bf16 v[20:23], v[80:83], v[132:135], v[20:23]
    v_pk_mul_f32 v[4:5], v[52:53], v[52:53]
    v_pk_mul_f32 v[68:69], v[52:53], v[68:69]
    v_pk_fma_f32 v[4:5], v[4:5], v[6:7], v[6:7] op_sel:[0,1,0] op_sel_hi:[1,1,0]
    v_pk_mul_f32 v[52:53], v[4:5], v[52:53]
    v_exp_f32 v52, v52
    v_exp_f32 v53, v53
    v_mfma_f32_16x16x32_bf16 v[24:27], v[84:87], v[128:131], v[24:27]
    ds_read_b128 v[80:83], v3 offset:16384
    v_mfma_f32_16x16x32_bf16 v[28:31], v[84:87], v[132:135], v[28:31]
    v_mfma_f32_16x16x32_bf16 v[32:35], v[88:91], v[128:131], v[32:35]
    v_pk_add_f32 v[52:53], v[52:53], s[98:99] op_sel_hi:[1,0]
    v_rcp_f32 v52, v52
    v_rcp_f32 v53, v53
    ds_read_b128 v[84:87], v3 offset:17408
    v_mfma_f32_16x16x32_bf16 v[36:39], v[88:91], v[132:135], v[36:39]
    v_mfma_f32_16x16x32_bf16 v[40:43], v[92:95], v[128:131], v[40:43]
    ds_read_b128 v[88:91], v3 offset:18432
    v_mfma_f32_16x16x32_bf16 v[44:47], v[92:95], v[132:135], v[44:47]
    v_pk_mul_f32 v[4:5], v[54:55], v[54:55]
    v_pk_mul_f32 v[70:71], v[54:55], v[70:71]
    v_pk_fma_f32 v[4:5], v[4:5], v[6:7], v[6:7] op_sel:[0,1,0] op_sel_hi:[1,1,0]
    v_pk_mul_f32 v[54:55], v[4:5], v[54:55]
    v_exp_f32 v54, v54
    v_exp_f32 v55, v55
    s_waitcnt lgkmcnt(3)
    v_mfma_f32_16x16x32_bf16 v[16:19], a[240:243], v[136:139], v[16:19]
    ds_read_b128 v[92:95], v3 offset:19456
    buffer_load_ubyte v11, v0, s[76:79], s39 offen sc1
    v_mfma_f32_16x16x32_bf16 v[20:23], a[240:243], v[140:143], v[20:23]
    v_mfma_f32_16x16x32_bf16 v[24:27], a[244:247], v[136:139], v[24:27]
    v_pk_add_f32 v[54:55], v[54:55], s[98:99] op_sel_hi:[1,0]
    v_pk_mul_f32 v[52:53], v[68:69], v[52:53]
    v_rcp_f32 v54, v54
    v_rcp_f32 v55, v55
    ds_read_b128 a[240:243], v3 offset:20480
    v_mfma_f32_16x16x32_bf16 v[28:31], a[244:247], v[140:143], v[28:31]
    v_mfma_f32_16x16x32_bf16 v[32:35], a[248:251], v[136:139], v[32:35]
    ds_read_b128 a[244:247], v3 offset:21504
    v_mfma_f32_16x16x32_bf16 v[36:39], a[248:251], v[140:143], v[36:39]
    v_pk_mul_f32 v[4:5], v[60:61], v[60:61]
    v_pk_mul_f32 v[76:77], v[60:61], v[76:77]
    v_pk_fma_f32 v[4:5], v[4:5], v[6:7], v[6:7] op_sel:[0,1,0] op_sel_hi:[1,1,0]
    v_pk_mul_f32 v[60:61], v[4:5], v[60:61]
    v_exp_f32 v60, v60
    v_exp_f32 v61, v61
    v_mfma_f32_16x16x32_bf16 v[40:43], a[252:255], v[136:139], v[40:43]
    ds_read_b128 a[248:251], v3 offset:22528
    v_mfma_f32_16x16x32_bf16 v[44:47], a[252:255], v[140:143], v[44:47]
    s_waitcnt lgkmcnt(3)
    v_mfma_f32_16x16x32_bf16 v[16:19], v[80:83], v[144:147], v[16:19]
    v_pk_add_f32 v[60:61], v[60:61], s[98:99] op_sel_hi:[1,0]
    v_pk_mul_f32 v[54:55], v[70:71], v[54:55]
    v_rcp_f32 v60, v60
    v_rcp_f32 v61, v61
    ds_read_b128 a[252:255], v3 offset:23552
    v_mfma_f32_16x16x32_bf16 v[20:23], v[80:83], v[148:151], v[20:23]
    v_mfma_f32_16x16x32_bf16 v[24:27], v[84:87], v[144:147], v[24:27]
    s_barrier
    ds_read_b128 v[80:83], v3 offset:24576
    v_mfma_f32_16x16x32_bf16 v[28:31], v[84:87], v[148:151], v[28:31]
    v_pk_mul_f32 v[4:5], v[62:63], v[62:63]
    v_pk_mul_f32 v[78:79], v[62:63], v[78:79]
    v_pk_fma_f32 v[4:5], v[4:5], v[6:7], v[6:7] op_sel:[0,1,0] op_sel_hi:[1,1,0]
    v_pk_mul_f32 v[62:63], v[4:5], v[62:63]
    v_exp_f32 v62, v62
    v_exp_f32 v63, v63
    v_mfma_f32_16x16x32_bf16 v[32:35], v[88:91], v[144:147], v[32:35]
    ds_read_b128 v[84:87], v3 offset:25600
    v_mfma_f32_16x16x32_bf16 v[36:39], v[88:91], v[148:151], v[36:39]
    v_mfma_f32_16x16x32_bf16 v[40:43], v[92:95], v[144:147], v[40:43]
    v_pk_add_f32 v[62:63], v[62:63], s[98:99] op_sel_hi:[1,0]
    v_pk_mul_f32 v[60:61], v[76:77], v[60:61]
    v_rcp_f32 v62, v62
    v_rcp_f32 v63, v63
    ds_read_b128 v[88:91], v3 offset:26624
    v_mfma_f32_16x16x32_bf16 v[44:47], v[92:95], v[148:151], v[44:47]
    s_waitcnt lgkmcnt(3)
    v_mfma_f32_16x16x32_bf16 v[16:19], a[240:243], v[152:155], v[16:19]
    ds_read_b128 v[92:95], v3 offset:27648
    v_mfma_f32_16x16x32_bf16 v[20:23], a[240:243], v[156:159], v[20:23]
    v_pk_mul_f32 v[62:63], v[78:79], v[62:63]
    v_cvt_pk_bf16_f32 v52, v52, v53
    v_cvt_pk_bf16_f32 v53, v54, v55
    v_cvt_pk_bf16_f32 v54, v60, v61
    v_cvt_pk_bf16_f32 v55, v62, v63
    v_mfma_f32_16x16x32_bf16 v[24:27], a[244:247], v[152:155], v[24:27]
    ds_read_b128 a[240:243], v3 offset:28672
    v_mfma_f32_16x16x32_bf16 v[28:31], a[244:247], v[156:159], v[28:31]
    v_mfma_f32_16x16x32_bf16 v[32:35], a[248:251], v[152:155], v[32:35]
    buffer_store_dwordx4 v[52:55], v8, s[52:55], s97 offen offset:1024 sc1
    ds_read_b128 a[244:247], v3 offset:29696
    v_mfma_f32_16x16x32_bf16 v[36:39], a[248:251], v[156:159], v[36:39]
    v_mfma_f32_16x16x32_bf16 v[40:43], a[252:255], v[152:155], v[40:43]
    ds_read_b128 a[248:251], v3 offset:30720
    v_mfma_f32_16x16x32_bf16 v[44:47], a[252:255], v[156:159], v[44:47]
    s_waitcnt lgkmcnt(3)
    v_mfma_f32_16x16x32_bf16 v[16:19], v[80:83], v[160:163], v[16:19]
    ds_read_b128 a[252:255], v3 offset:31744
    v_mfma_f32_16x16x32_bf16 v[20:23], v[80:83], v[164:167], v[20:23]
    v_mfma_f32_16x16x32_bf16 v[24:27], v[84:87], v[160:163], v[24:27]
    ds_read_b128 v[80:83], v3 offset:32768
    v_mfma_f32_16x16x32_bf16 v[28:31], v[84:87], v[164:167], v[28:31]
    v_mfma_f32_16x16x32_bf16 v[32:35], v[88:91], v[160:163], v[32:35]
    ds_read_b128 v[84:87], v3 offset:33792
    v_mfma_f32_16x16x32_bf16 v[36:39], v[88:91], v[164:167], v[36:39]
    v_mfma_f32_16x16x32_bf16 v[40:43], v[92:95], v[160:163], v[40:43]
    ds_read_b128 v[88:91], v3 offset:34816
    v_mfma_f32_16x16x32_bf16 v[44:47], v[92:95], v[164:167], v[44:47]
    s_waitcnt lgkmcnt(3)
    v_mfma_f32_16x16x32_bf16 v[16:19], a[240:243], v[168:171], v[16:19]
    ds_read_b128 v[92:95], v3 offset:35840
    v_mfma_f32_16x16x32_bf16 v[20:23], a[240:243], v[172:175], v[20:23]
    v_mfma_f32_16x16x32_bf16 v[24:27], a[244:247], v[168:171], v[24:27]
    ds_read_b128 a[240:243], v3 offset:36864
    v_mfma_f32_16x16x32_bf16 v[28:31], a[244:247], v[172:175], v[28:31]
    v_mfma_f32_16x16x32_bf16 v[32:35], a[248:251], v[168:171], v[32:35]
    ds_read_b128 a[244:247], v3 offset:37888
    v_mfma_f32_16x16x32_bf16 v[36:39], a[248:251], v[172:175], v[36:39]
    v_mfma_f32_16x16x32_bf16 v[40:43], a[252:255], v[168:171], v[40:43]
    ds_read_b128 a[248:251], v3 offset:38912
    v_mfma_f32_16x16x32_bf16 v[44:47], a[252:255], v[172:175], v[44:47]
    s_waitcnt lgkmcnt(3)
    v_mfma_f32_16x16x32_bf16 v[16:19], v[80:83], v[176:179], v[16:19]
    ds_read_b128 a[252:255], v3 offset:39936
    v_mfma_f32_16x16x32_bf16 v[20:23], v[80:83], v[180:183], v[20:23]
    v_mfma_f32_16x16x32_bf16 v[24:27], v[84:87], v[176:179], v[24:27]
    ds_read_b128 v[80:83], v3 offset:40960
    v_mfma_f32_16x16x32_bf16 v[28:31], v[84:87], v[180:183], v[28:31]
    v_mfma_f32_16x16x32_bf16 v[32:35], v[88:91], v[176:179], v[32:35]
    ds_read_b128 v[84:87], v3 offset:41984
    v_mfma_f32_16x16x32_bf16 v[36:39], v[88:91], v[180:183], v[36:39]
    v_mfma_f32_16x16x32_bf16 v[40:43], v[92:95], v[176:179], v[40:43]
    ds_read_b128 v[88:91], v3 offset:43008
    v_mfma_f32_16x16x32_bf16 v[44:47], v[92:95], v[180:183], v[44:47]
    s_waitcnt lgkmcnt(3)
    v_mfma_f32_16x16x32_bf16 v[16:19], a[240:243], v[184:187], v[16:19]
    ds_read_b128 v[92:95], v3 offset:44032
    v_mfma_f32_16x16x32_bf16 v[20:23], a[240:243], v[188:191], v[20:23]
    v_mfma_f32_16x16x32_bf16 v[24:27], a[244:247], v[184:187], v[24:27]
    ds_read_b128 a[240:243], v3 offset:45056
    v_mfma_f32_16x16x32_bf16 v[28:31], a[244:247], v[188:191], v[28:31]
    v_mfma_f32_16x16x32_bf16 v[32:35], a[248:251], v[184:187], v[32:35]
    ds_read_b128 a[244:247], v3 offset:46080
    v_mfma_f32_16x16x32_bf16 v[36:39], a[248:251], v[188:191], v[36:39]
    v_mfma_f32_16x16x32_bf16 v[40:43], a[252:255], v[184:187], v[40:43]
    ds_read_b128 a[248:251], v3 offset:47104
    v_mfma_f32_16x16x32_bf16 v[44:47], a[252:255], v[188:191], v[44:47]
    s_waitcnt vmcnt(1)
    v_cmp_gt_u32 vcc, 1, v11
    s_cbranch_vccnz MA1_spin
MA1_ok:
    s_waitcnt lgkmcnt(3)
    v_mfma_f32_16x16x32_bf16 v[16:19], v[80:83], v[192:195], v[16:19]
    ds_read_b128 a[252:255], v3 offset:48128
    v_mfma_f32_16x16x32_bf16 v[20:23], v[80:83], v[196:199], v[20:23]
    buffer_load_dwordx4 v[100:103], v8, s[16:19], s24 offen offset:0 sc1
    v_mfma_f32_16x16x32_bf16 v[24:27], v[84:87], v[192:195], v[24:27]
    s_barrier
    ds_read_b128 v[80:83], v8 offset:0
    v_mfma_f32_16x16x32_bf16 v[28:31], v[84:87], v[196:199], v[28:31]
    v_mfma_f32_16x16x32_bf16 v[32:35], v[88:91], v[192:195], v[32:35]
    ds_read_b128 v[84:87], v8 offset:1024
    v_mfma_f32_16x16x32_bf16 v[36:39], v[88:91], v[196:199], v[36:39]
    buffer_load_dwordx4 v[104:107], v8, s[16:19], s64 offen offset:0 sc1
    v_mfma_f32_16x16x32_bf16 v[40:43], v[92:95], v[192:195], v[40:43]
    ds_read_b128 v[88:91], v8 offset:2048
    v_mfma_f32_16x16x32_bf16 v[44:47], v[92:95], v[196:199], v[44:47]
    s_waitcnt lgkmcnt(3)
    v_mfma_f32_16x16x32_bf16 v[16:19], a[240:243], v[200:203], v[16:19]
    ds_read_b128 v[92:95], v8 offset:3072
    v_mfma_f32_16x16x32_bf16 v[20:23], a[240:243], v[204:207], v[20:23]
    buffer_load_dwordx4 v[108:111], v8, s[16:19], s88 offen offset:0 sc1
    v_mfma_f32_16x16x32_bf16 v[24:27], a[244:247], v[200:203], v[24:27]
    ds_read_b128 a[240:243], v8 offset:4096
    v_mfma_f32_16x16x32_bf16 v[28:31], a[244:247], v[204:207], v[28:31]
    buffer_load_dwordx4 v[96:99], v8, s[16:19], s12 offen offset:0 sc1
    v_mfma_f32_16x16x32_bf16 v[32:35], a[248:251], v[200:203], v[32:35]
    ds_read_b128 a[244:247], v8 offset:5120
    v_mfma_f32_16x16x32_bf16 v[36:39], a[248:251], v[204:207], v[36:39]
    v_mfma_f32_16x16x32_bf16 v[40:43], a[252:255], v[200:203], v[40:43]
    ds_read_b128 a[248:251], v8 offset:6144
    v_mfma_f32_16x16x32_bf16 v[44:47], a[252:255], v[204:207], v[44:47]
    buffer_load_dwordx4 v[116:119], v8, s[16:19], s25 offen offset:0 sc1
    s_waitcnt lgkmcnt(3)
    v_mfma_f32_16x16x32_bf16 v[16:19], v[80:83], v[208:211], v[16:19]
    ds_read_b128 a[252:255], v8 offset:7168
    v_mfma_f32_16x16x32_bf16 v[20:23], v[80:83], v[212:215], v[20:23]
    v_mfma_f32_16x16x32_bf16 v[24:27], v[84:87], v[208:211], v[24:27]
    ds_read_b128 v[80:83], v8 offset:8192
    v_mfma_f32_16x16x32_bf16 v[28:31], v[84:87], v[212:215], v[28:31]
    buffer_load_dwordx4 v[120:123], v8, s[16:19], s65 offen offset:0 sc1
    v_mfma_f32_16x16x32_bf16 v[32:35], v[88:91], v[208:211], v[32:35]
    ds_read_b128 v[84:87], v8 offset:9216
    v_mfma_f32_16x16x32_bf16 v[36:39], v[88:91], v[212:215], v[36:39]
    v_mfma_f32_16x16x32_bf16 v[40:43], v[92:95], v[208:211], v[40:43]
    ds_read_b128 v[88:91], v8 offset:10240
    v_mfma_f32_16x16x32_bf16 v[44:47], v[92:95], v[212:215], v[44:47]
    buffer_load_dwordx4 v[124:127], v8, s[16:19], s89 offen offset:0 sc1
    s_waitcnt lgkmcnt(3)
    v_mfma_f32_16x16x32_bf16 v[16:19], a[240:243], v[216:219], v[16:19]
    ds_read_b128 v[92:95], v8 offset:11264
    v_mfma_f32_16x16x32_bf16 v[20:23], a[240:243], v[220:223], v[20:23]
    v_mfma_f32_16x16x32_bf16 v[24:27], a[244:247], v[216:219], v[24:27]
    ds_read_b128 a[240:243], v8 offset:12288
    v_mfma_f32_16x16x32_bf16 v[28:31], a[244:247], v[220:223], v[28:31]
    buffer_load_dwordx4 v[112:115], v8, s[16:19], s13 offen offset:0 sc1
    v_mfma_f32_16x16x32_bf16 v[32:35], a[248:251], v[216:219], v[32:35]
    ds_read_b128 a[244:247], v8 offset:13312
    v_mfma_f32_16x16x32_bf16 v[36:39], a[248:251], v[220:223], v[36:39]
    buffer_load_dwordx4 v[132:135], v8, s[16:19], s26 offen offset:0 sc1
    s_waitcnt vmcnt(9)
    buffer_store_byte v15, v14, s[76:79], s0 offen sc1
    v_mfma_f32_16x16x32_bf16 v[40:43], a[252:255], v[216:219], v[40:43]
    ds_read_b128 a[248:251], v8 offset:14336
    v_mfma_f32_16x16x32_bf16 v[44:47], a[252:255], v[220:223], v[44:47]
    v_mov_b32 v15, 3
    s_waitcnt lgkmcnt(3)
    v_mfma_f32_16x16x32_bf16 v[16:19], v[80:83], v[224:227], v[16:19]
    ds_read_b128 a[252:255], v8 offset:15360
    v_mfma_f32_16x16x32_bf16 v[20:23], v[80:83], v[228:231], v[20:23]
    buffer_load_dwordx4 v[136:139], v8, s[16:19], s66 offen offset:0 sc1
    v_mfma_f32_16x16x32_bf16 v[24:27], v[84:87], v[224:227], v[24:27]
    ds_read_b128 v[80:83], v8 offset:16384
    v_mfma_f32_16x16x32_bf16 v[28:31], v[84:87], v[228:231], v[28:31]
    v_mfma_f32_16x16x32_bf16 v[32:35], v[88:91], v[224:227], v[32:35]
    ds_read_b128 v[84:87], v8 offset:17408
    v_mfma_f32_16x16x32_bf16 v[36:39], v[88:91], v[228:231], v[36:39]
    buffer_load_dwordx4 v[140:143], v8, s[16:19], s90 offen offset:0 sc1
    v_mfma_f32_16x16x32_bf16 v[40:43], v[92:95], v[224:227], v[40:43]
    ds_read_b128 v[88:91], v8 offset:18432
    v_mfma_f32_16x16x32_bf16 v[44:47], v[92:95], v[228:231], v[44:47]
    s_waitcnt lgkmcnt(3)
    v_mfma_f32_16x16x32_bf16 v[16:19], a[240:243], v[232:235], v[16:19]
    ds_read_b128 v[92:95], v8 offset:19456
    v_mfma_f32_16x16x32_bf16 v[20:23], a[240:243], v[236:239], v[20:23]
    buffer_load_dwordx4 v[128:131], v8, s[16:19], s14 offen offset:0 sc1
    v_mfma_f32_16x16x32_bf16 v[24:27], a[244:247], v[232:235], v[24:27]
    ds_read_b128 a[240:243], v8 offset:20480
    v_mfma_f32_16x16x32_bf16 v[28:31], a[244:247], v[236:239], v[28:31]
    v_mfma_f32_16x16x32_bf16 v[32:35], a[248:251], v[232:235], v[32:35]
    ds_read_b128 a[244:247], v8 offset:21504
    v_mfma_f32_16x16x32_bf16 v[36:39], a[248:251], v[236:239], v[36:39]
    buffer_load_dwordx4 v[148:151], v8, s[16:19], s27 offen offset:0 sc1
    v_mfma_f32_16x16x32_bf16 v[40:43], a[252:255], v[232:235], v[40:43]
    ds_read_b128 a[248:251], v8 offset:22528
    v_mfma_f32_16x16x32_bf16 v[44:47], a[252:255], v[236:239], v[44:47]
    buffer_load_dwordx4 v[152:155], v8, s[16:19], s67 offen offset:0 sc1
    s_waitcnt lgkmcnt(3)
    v_mfma_f32_16x16x32_bf16 v[16:19], v[80:83], v[240:243], v[16:19]
    ds_read_b128 a[252:255], v8 offset:23552
    v_mfma_f32_16x16x32_bf16 v[20:23], v[80:83], v[244:247], v[20:23]
    v_mfma_f32_16x16x32_bf16 v[24:27], v[84:87], v[240:243], v[24:27]
    v_mfma_f32_16x16x32_bf16 v[28:31], v[84:87], v[244:247], v[28:31]
    buffer_load_dwordx4 v[156:159], v8, s[16:19], s91 offen offset:0 sc1
    v_mfma_f32_16x16x32_bf16 v[32:35], v[88:91], v[240:243], v[32:35]
    v_mfma_f32_16x16x32_bf16 v[36:39], v[88:91], v[244:247], v[36:39]
    v_mfma_f32_16x16x32_bf16 v[40:43], v[92:95], v[240:243], v[40:43]
    v_mfma_f32_16x16x32_bf16 v[44:47], v[92:95], v[244:247], v[44:47]
    buffer_load_dwordx4 v[144:147], v8, s[16:19], s15 offen offset:0 sc1
    s_waitcnt lgkmcnt(0)
    v_mfma_f32_16x16x32_bf16 v[16:19], a[240:243], v[248:251], v[16:19]
    v_mfma_f32_16x16x32_bf16 v[20:23], a[240:243], v[252:255], v[20:23]
    v_mfma_f32_16x16x32_bf16 v[24:27], a[244:247], v[248:251], v[24:27]
    v_mfma_f32_16x16x32_bf16 v[28:31], a[244:247], v[252:255], v[28:31]
    v_mfma_f32_16x16x32_bf16 v[32:35], a[248:251], v[248:251], v[32:35]
    v_mfma_f32_16x16x32_bf16 v[36:39], a[248:251], v[252:255], v[36:39]
    v_mfma_f32_16x16x32_bf16 v[40:43], a[252:255], v[248:251], v[40:43]
    v_mfma_f32_16x16x32_bf16 v[44:47], a[252:255], v[252:255], v[44:47]
    s_nop 0
    v_pk_mul_f32 v[80:81], v[16:17], v[16:17]
    v_pk_mul_f32 v[88:89], v[20:21], v[20:21]
    v_pk_mul_f32 v[82:83], v[18:19], v[18:19]
    v_pk_mul_f32 v[90:91], v[22:23], v[22:23]
    v_pk_mul_f32 v[84:85], v[24:25], v[24:25]
    v_pk_mul_f32 v[92:93], v[28:29], v[28:29]
    v_pk_mul_f32 v[86:87], v[26:27], v[26:27]
    v_pk_mul_f32 v[94:95], v[30:31], v[30:31]
    v_pk_fma_f32 v[80:81], v[80:81], v[6:7], v[6:7] op_sel:[0,1,0] op_sel_hi:[1,1,0]
    v_pk_fma_f32 v[88:89], v[88:89], v[6:7], v[6:7] op_sel:[0,1,0] op_sel_hi:[1,1,0]
    v_pk_fma_f32 v[82:83], v[82:83], v[6:7], v[6:7] op_sel:[0,1,0] op_sel_hi:[1,1,0]
    v_pk_fma_f32 v[90:91], v[90:91], v[6:7], v[6:7] op_sel:[0,1,0] op_sel_hi:[1,1,0]
    v_pk_fma_f32 v[84:85], v[84:85], v[6:7], v[6:7] op_sel:[0,1,0] op_sel_hi:[1,1,0]
    v_pk_fma_f32 v[92:93], v[92:93], v[6:7], v[6:7] op_sel:[0,1,0] op_sel_hi:[1,1,0]
    v_pk_fma_f32 v[86:87], v[86:87], v[6:7], v[6:7] op_sel:[0,1,0] op_sel_hi:[1,1,0]
    v_pk_fma_f32 v[94:95], v[94:95], v[6:7], v[6:7] op_sel:[0,1,0] op_sel_hi:[1,1,0]
    v_pk_mul_f32 v[80:81], v[80:81], v[16:17]
    v_pk_mul_f32 v[88:89], v[88:89], v[20:21]
    v_pk_mul_f32 v[82:83], v[82:83], v[18:19]
    v_pk_mul_f32 v[90:91], v[90:91], v[22:23]
    buffer_load_ubyte v11, v0, s[76:79], s39 offen sc1
    v_pk_mul_f32 v[84:85], v[84:85], v[24:25]
    v_pk_mul_f32 v[92:93], v[92:93], v[28:29]
    v_pk_mul_f32 v[86:87], v[86:87], v[26:27]
    v_pk_mul_f32 v[94:95], v[94:95], v[30:31]
    v_exp_f32 v80, v80
    v_exp_f32 v88, v88
    v_exp_f32 v81, v81
    v_exp_f32 v89, v89
    v_exp_f32 v82, v82
    v_exp_f32 v90, v90
    v_exp_f32 v83, v83
    v_exp_f32 v91, v91
    v_exp_f32 v84, v84
    v_exp_f32 v92, v92
    v_exp_f32 v85, v85
    v_exp_f32 v93, v93
    v_exp_f32 v86, v86
    v_exp_f32 v94, v94
    v_exp_f32 v87, v87
    v_exp_f32 v95, v95
    v_pk_mul_f32 v[16:17], v[16:17], v[32:33]
    v_pk_mul_f32 v[20:21], v[20:21], v[36:37]
    v_pk_mul_f32 v[18:19], v[18:19], v[34:35]
    v_pk_mul_f32 v[22:23], v[22:23], v[38:39]
    v_pk_mul_f32 v[24:25], v[24:25], v[40:41]
    v_pk_mul_f32 v[28:29], v[28:29], v[44:45]
    v_pk_mul_f32 v[26:27], v[26:27], v[42:43]
    v_pk_mul_f32 v[30:31], v[30:31], v[46:47]
    v_pk_add_f32 v[80:81], v[80:81], s[98:99] op_sel_hi:[1,0]
    v_pk_add_f32 v[88:89], v[88:89], s[98:99] op_sel_hi:[1,0]
    v_pk_add_f32 v[82:83], v[82:83], s[98:99] op_sel_hi:[1,0]
    v_pk_add_f32 v[90:91], v[90:91], s[98:99] op_sel_hi:[1,0]
    v_pk_add_f32 v[84:85], v[84:85], s[98:99] op_sel_hi:[1,0]
    v_pk_add_f32 v[92:93], v[92:93], s[98:99] op_sel_hi:[1,0]
    v_pk_add_f32 v[86:87], v[86:87], s[98:99] op_sel_hi:[1,0]
    v_pk_add_f32 v[94:95], v[94:95], s[98:99] op_sel_hi:[1,0]
    v_rcp_f32 v80, v80
    v_rcp_f32 v88, v88
    v_rcp_f32 v81, v81
    v_rcp_f32 v89, v89
    v_rcp_f32 v82, v82
    v_rcp_f32 v90, v90
    v_rcp_f32 v83, v83
    v_rcp_f32 v91, v91
    v_rcp_f32 v84, v84
    v_rcp_f32 v92, v92
    v_rcp_f32 v85, v85
    v_rcp_f32 v93, v93
    v_rcp_f32 v86, v86
    v_rcp_f32 v94, v94
    v_rcp_f32 v87, v87
    v_rcp_f32 v95, v95
    v_pk_mul_f32 v[16:17], v[16:17], v[80:81]
    v_pk_mul_f32 v[20:21], v[20:21], v[88:89]
    v_pk_mul_f32 v[18:19], v[18:19], v[82:83]
    v_pk_mul_f32 v[22:23], v[22:23], v[90:91]
    v_pk_mul_f32 v[24:25], v[24:25], v[84:85]
    v_pk_mul_f32 v[28:29], v[28:29], v[92:93]
    v_pk_mul_f32 v[26:27], v[26:27], v[86:87]
    v_pk_mul_f32 v[30:31], v[30:31], v[94:95]
    v_cvt_pk_bf16_f32 v16, v16, v17
    v_cvt_pk_bf16_f32 v20, v20, v21
    v_cvt_pk_bf16_f32 v17, v18, v19
    v_cvt_pk_bf16_f32 v21, v22, v23
    v_cvt_pk_bf16_f32 v18, v24, v25
    v_cvt_pk_bf16_f32 v22, v28, v29
    v_cvt_pk_bf16_f32 v19, v26, v27
    v_cvt_pk_bf16_f32 v23, v30, v31
    buffer_store_dwordx4 v[16:19], v8, s[52:55], 0 offen offset:2048 sc1
    buffer_store_dwordx4 v[20:23], v8, s[52:55], s97 offen offset:2048 sc1
    s_mul_i32 s46, s32, 15360
    v_add_u32 v6, s46, v8
    s_sub_u32 s46, s32, 1
    s_and_b32 s46, s46, 3
    s_mul_i32 s46, s46, 15360
    v_add_u32 v1, s46, v8
    s_sub_u32 s46, s32, 2
    s_and_b32 s46, s46, 3
    s_mul_i32 s46, s46, 15360
    v_add_u32 v2, s46, v8
    s_sub_u32 s46, s32, 3
    s_and_b32 s46, s46, 3
    s_mul_i32 s46, s46, 15360
    v_add_u32 v3, s46, v8
    v_lshrrev_b32 v7, 8, v8
    v_bfe_u32 v12, v8, 4, 4
    v_mul_u32_u24 v12, 1280, v12
    v_lshl_add_u32 v12, v7, 3, v12
    v_lshlrev_b32 v7, 4, v7
    v_add_u32 v7, s40, v7
    s_waitcnt vmcnt(19)
    v_mfma_f32_16x16x32_bf16 v[36:39], a[0:3], v[100:103], 0
    s_waitcnt vmcnt(18)
    v_mfma_f32_16x16x32_bf16 v[56:59], a[0:3], v[104:107], 0
    s_waitcnt vmcnt(17)
    v_mfma_f32_16x16x32_bf16 v[76:79], a[0:3], v[108:111], 0
    s_waitcnt vmcnt(16)
    v_mfma_f32_16x16x32_bf16 v[16:19], a[0:3], v[96:99], 0
    v_mfma_f32_16x16x32_bf16 v[40:43], a[4:7], v[100:103], 0
    v_mfma_f32_16x16x32_bf16 v[60:63], a[4:7], v[104:107], 0
    v_mfma_f32_16x16x32_bf16 v[80:83], a[4:7], v[108:111], 0
    v_mfma_f32_16x16x32_bf16 v[20:23], a[4:7], v[96:99], 0
    v_mfma_f32_16x16x32_bf16 v[44:47], a[8:11], v[100:103], 0
    v_mfma_f32_16x16x32_bf16 v[64:67], a[8:11], v[104:107], 0
    v_mfma_f32_16x16x32_bf16 v[84:87], a[8:11], v[108:111], 0
    v_mfma_f32_16x16x32_bf16 v[24:27], a[8:11], v[96:99], 0
    v_mfma_f32_16x16x32_bf16 v[48:51], a[12:15], v[100:103], 0
    v_mfma_f32_16x16x32_bf16 v[68:71], a[12:15], v[104:107], 0
    v_mfma_f32_16x16x32_bf16 v[88:91], a[12:15], v[108:111], 0
    v_mfma_f32_16x16x32_bf16 v[28:31], a[12:15], v[96:99], 0
    v_mfma_f32_16x16x32_bf16 v[52:55], a[16:19], v[100:103], 0
    v_mfma_f32_16x16x32_bf16 v[72:75], a[16:19], v[104:107], 0
    v_mfma_f32_16x16x32_bf16 v[92:95], a[16:19], v[108:111], 0
    v_mfma_f32_16x16x32_bf16 v[32:35], a[16:19], v[96:99], 0
    s_waitcnt vmcnt(15)
    v_mfma_f32_16x16x32_bf16 v[36:39], a[20:23], v[116:119], v[36:39]
    s_waitcnt vmcnt(14)
    v_mfma_f32_16x16x32_bf16 v[56:59], a[20:23], v[120:123], v[56:59]
    s_waitcnt vmcnt(13)
    v_mfma_f32_16x16x32_bf16 v[76:79], a[20:23], v[124:127], v[76:79]
    s_waitcnt vmcnt(12)
    v_mfma_f32_16x16x32_bf16 v[16:19], a[20:23], v[112:115], v[16:19]
    v_mfma_f32_16x16x32_bf16 v[40:43], a[24:27], v[116:119], v[40:43]
    s_waitcnt vmcnt(0)
    buffer_store_byte v15, v14, s[76:79], s0 offen sc1
    v_mfma_f32_16x16x32_bf16 v[60:63], a[24:27], v[120:123], v[60:63]
    v_cmp_gt_u32 vcc, 2, v11
    s_cbranch_vccnz MA2_spin
MA2_ok:
    buffer_load_dwordx4 v[164:167], v8, s[16:19], s24 offen offset:1024 sc1
    v_mfma_f32_16x16x32_bf16 v[80:83], a[24:27], v[124:127], v[80:83]
    v_mfma_f32_16x16x32_bf16 v[20:23], a[24:27], v[112:115], v[20:23]
    v_mfma_f32_16x16x32_bf16 v[44:47], a[28:31], v[116:119], v[44:47]
    buffer_load_dwordx4 v[168:171], v8, s[16:19], s64 offen offset:1024 sc1
    v_mfma_f32_16x16x32_bf16 v[64:67], a[28:31], v[120:123], v[64:67]
    v_mfma_f32_16x16x32_bf16 v[84:87], a[28:31], v[124:127], v[84:87]
    v_mfma_f32_16x16x32_bf16 v[24:27], a[28:31], v[112:115], v[24:27]
    buffer_load_dwordx4 v[172:175], v8, s[16:19], s88 offen offset:1024 sc1
    v_mfma_f32_16x16x32_bf16 v[48:51], a[32:35], v[116:119], v[48:51]
    v_mfma_f32_16x16x32_bf16 v[68:71], a[32:35], v[120:123], v[68:71]
    v_mfma_f32_16x16x32_bf16 v[88:91], a[32:35], v[124:127], v[88:91]
    buffer_load_dwordx4 v[160:163], v8, s[16:19], s12 offen offset:1024 sc1
    v_mfma_f32_16x16x32_bf16 v[28:31], a[32:35], v[112:115], v[28:31]
    v_mfma_f32_16x16x32_bf16 v[52:55], a[36:39], v[116:119], v[52:55]
    v_mfma_f32_16x16x32_bf16 v[72:75], a[36:39], v[120:123], v[72:75]
    buffer_load_dwordx4 v[180:183], v8, s[16:19], s25 offen offset:1024 sc1
    v_mfma_f32_16x16x32_bf16 v[92:95], a[36:39], v[124:127], v[92:95]
    v_mfma_f32_16x16x32_bf16 v[32:35], a[36:39], v[112:115], v[32:35]
    v_mfma_f32_16x16x32_bf16 v[36:39], a[40:43], v[132:135], v[36:39]
    buffer_load_dwordx4 v[184:187], v8, s[16:19], s65 offen offset:1024 sc1
    v_mfma_f32_16x16x32_bf16 v[56:59], a[40:43], v[136:139], v[56:59]
    v_mfma_f32_16x16x32_bf16 v[76:79], a[40:43], v[140:143], v[76:79]
    v_mfma_f32_16x16x32_bf16 v[16:19], a[40:43], v[128:131], v[16:19]
    buffer_load_dwordx4 v[188:191], v8, s[16:19], s89 offen offset:1024 sc1
    v_mfma_f32_16x16x32_bf16 v[40:43], a[44:47], v[132:135], v[40:43]
    v_mfma_f32_16x16x32_bf16 v[60:63], a[44:47], v[136:139], v[60:63]
    v_mfma_f32_16x16x32_bf16 v[80:83], a[44:47], v[140:143], v[80:83]
    buffer_load_dwordx4 v[176:179], v8, s[16:19], s13 offen offset:1024 sc1
    v_mfma_f32_16x16x32_bf16 v[20:23], a[44:47], v[128:131], v[20:23]
    v_mfma_f32_16x16x32_bf16 v[44:47], a[48:51], v[132:135], v[44:47]
    v_mfma_f32_16x16x32_bf16 v[64:67], a[48:51], v[136:139], v[64:67]
    buffer_load_dwordx4 v[196:199], v8, s[16:19], s26 offen offset:1024 sc1
    v_mfma_f32_16x16x32_bf16 v[84:87], a[48:51], v[140:143], v[84:87]
    v_mfma_f32_16x16x32_bf16 v[24:27], a[48:51], v[128:131], v[24:27]
    v_mfma_f32_16x16x32_bf16 v[48:51], a[52:55], v[132:135], v[48:51]
    buffer_load_dwordx4 v[200:203], v8, s[16:19], s66 offen offset:1024 sc1
    v_mfma_f32_16x16x32_bf16 v[68:71], a[52:55], v[136:139], v[68:71]
    v_mfma_f32_16x16x32_bf16 v[88:91], a[52:55], v[140:143], v[88:91]
    v_mfma_f32_16x16x32_bf16 v[28:31], a[52:55], v[128:131], v[28:31]
    buffer_load_dwordx4 v[204:207], v8, s[16:19], s90 offen offset:1024 sc1
    v_mfma_f32_16x16x32_bf16 v[52:55], a[56:59], v[132:135], v[52:55]
    v_mfma_f32_16x16x32_bf16 v[72:75], a[56:59], v[136:139], v[72:75]
    v_mfma_f32_16x16x32_bf16 v[92:95], a[56:59], v[140:143], v[92:95]
    buffer_load_dwordx4 v[192:195], v8, s[16:19], s14 offen offset:1024 sc1
    v_mfma_f32_16x16x32_bf16 v[32:35], a[56:59], v[128:131], v[32:35]
    v_mfma_f32_16x16x32_bf16 v[36:39], a[60:63], v[148:151], v[36:39]
    v_mfma_f32_16x16x32_bf16 v[56:59], a[60:63], v[152:155], v[56:59]
    buffer_load_dwordx4 v[212:215], v8, s[16:19], s27 offen offset:1024 sc1
    v_mfma_f32_16x16x32_bf16 v[76:79], a[60:63], v[156:159], v[76:79]
    v_mfma_f32_16x16x32_bf16 v[16:19], a[60:63], v[144:147], v[16:19]
    v_mfma_f32_16x16x32_bf16 v[40:43], a[64:67], v[148:151], v[40:43]
    buffer_load_dwordx4 v[216:219], v8, s[16:19], s67 offen offset:1024 sc1
    v_mfma_f32_16x16x32_bf16 v[60:63], a[64:67], v[152:155], v[60:63]
    v_mfma_f32_16x16x32_bf16 v[80:83], a[64:67], v[156:159], v[80:83]
    v_mfma_f32_16x16x32_bf16 v[20:23], a[64:67], v[144:147], v[20:23]
    buffer_load_dwordx4 v[220:223], v8, s[16:19], s91 offen offset:1024 sc1
    v_mfma_f32_16x16x32_bf16 v[44:47], a[68:71], v[148:151], v[44:47]
    v_mfma_f32_16x16x32_bf16 v[64:67], a[68:71], v[152:155], v[64:67]
    v_mfma_f32_16x16x32_bf16 v[84:87], a[68:71], v[156:159], v[84:87]
    buffer_load_dwordx4 v[208:211], v8, s[16:19], s15 offen offset:1024 sc1
    v_mfma_f32_16x16x32_bf16 v[24:27], a[68:71], v[144:147], v[24:27]
    v_mfma_f32_16x16x32_bf16 v[48:51], a[72:75], v[148:151], v[48:51]
    v_mfma_f32_16x16x32_bf16 v[68:71], a[72:75], v[152:155], v[68:71]
    v_mfma_f32_16x16x32_bf16 v[88:91], a[72:75], v[156:159], v[88:91]
    v_mfma_f32_16x16x32_bf16 v[28:31], a[72:75], v[144:147], v[28:31]
    buffer_load_ubyte v11, v0, s[76:79], s39 offen sc1
    v_mfma_f32_16x16x32_bf16 v[52:55], a[76:79], v[148:151], v[52:55]
    v_mfma_f32_16x16x32_bf16 v[72:75], a[76:79], v[152:155], v[72:75]
    buffer_load_dwordx4 a[200:203], v8, s[56:59], s38 offen offset:0 sc1
    v_mfma_f32_16x16x32_bf16 v[92:95], a[76:79], v[156:159], v[92:95]
    v_mfma_f32_16x16x32_bf16 v[32:35], a[76:79], v[144:147], v[32:35]
    s_waitcnt vmcnt(17)
    v_mfma_f32_16x16x32_bf16 v[36:39], a[80:83], v[164:167], v[36:39]
    s_waitcnt vmcnt(16)
    v_mfma_f32_16x16x32_bf16 v[56:59], a[80:83], v[168:171], v[56:59]
    buffer_load_dwordx4 a[204:207], v8, s[56:59], s38 offen offset:1024 sc1
    s_waitcnt vmcnt(16)
    v_mfma_f32_16x16x32_bf16 v[76:79], a[80:83], v[172:175], v[76:79]
    s_waitcnt vmcnt(15)
    v_mfma_f32_16x16x32_bf16 v[16:19], a[80:83], v[160:163], v[16:19]
    v_mfma_f32_16x16x32_bf16 v[40:43], a[84:87], v[164:167], v[40:43]
    v_mfma_f32_16x16x32_bf16 v[60:63], a[84:87], v[168:171], v[60:63]
    buffer_load_dwordx4 a[208:211], v8, s[56:59], s38 offen offset:2048 sc1
    v_mfma_f32_16x16x32_bf16 v[80:83], a[84:87], v[172:175], v[80:83]
    v_mfma_f32_16x16x32_bf16 v[20:23], a[84:87], v[160:163], v[20:23]
    v_mfma_f32_16x16x32_bf16 v[44:47], a[88:91], v[164:167], v[44:47]
    v_mfma_f32_16x16x32_bf16 v[64:67], a[88:91], v[168:171], v[64:67]
    buffer_load_dwordx4 a[212:215], v8, s[56:59], s38 offen offset:3072 sc1
    s_mov_b32 s38, 45056
    v_mfma_f32_16x16x32_bf16 v[84:87], a[88:91], v[172:175], v[84:87]
    v_mfma_f32_16x16x32_bf16 v[24:27], a[88:91], v[160:163], v[24:27]
    v_mfma_f32_16x16x32_bf16 v[48:51], a[92:95], v[164:167], v[48:51]
    v_mfma_f32_16x16x32_bf16 v[68:71], a[92:95], v[168:171], v[68:71]
    buffer_load_dwordx4 a[216:219], v8, s[56:59], s38 offen offset:0 sc1
    s_mov_b32 s38, 53248
    v_mfma_f32_16x16x32_bf16 v[88:91], a[92:95], v[172:175], v[88:91]
    v_mfma_f32_16x16x32_bf16 v[28:31], a[92:95], v[160:163], v[28:31]
    v_mfma_f32_16x16x32_bf16 v[52:55], a[96:99], v[164:167], v[52:55]
    v_mfma_f32_16x16x32_bf16 v[72:75], a[96:99], v[168:171], v[72:75]
    buffer_load_dwordx4 a[220:223], v8, s[56:59], s38 offen offset:3072 sc1
    s_mov_b32 s38, 57344
    v_mfma_f32_16x16x32_bf16 v[92:95], a[96:99], v[172:175], v[92:95]
    v_mfma_f32_16x16x32_bf16 v[32:35], a[96:99], v[160:163], v[32:35]
    s_waitcnt vmcnt(18)
    v_mfma_f32_16x16x32_bf16 v[36:39], a[100:103], v[180:183], v[36:39]
    s_waitcnt vmcnt(17)
    v_mfma_f32_16x16x32_bf16 v[56:59], a[100:103], v[184:187], v[56:59]
    buffer_load_dwordx4 a[224:227], v8, s[56:59], s38 offen offset:0 sc1
    s_waitcnt vmcnt(17)
    v_mfma_f32_16x16x32_bf16 v[76:79], a[100:103], v[188:191], v[76:79]
    s_waitcnt vmcnt(16)
    v_mfma_f32_16x16x32_bf16 v[16:19], a[100:103], v[176:179], v[16:19]
    v_mfma_f32_16x16x32_bf16 v[40:43], a[104:107], v[180:183], v[40:43]
    v_mfma_f32_16x16x32_bf16 v[60:63], a[104:107], v[184:187], v[60:63]
    buffer_load_dwordx4 a[228:231], v8, s[56:59], s38 offen offset:1024 sc1
    v_mfma_f32_16x16x32_bf16 v[80:83], a[104:107], v[188:191], v[80:83]
    v_mfma_f32_16x16x32_bf16 v[20:23], a[104:107], v[176:179], v[20:23]
    v_mfma_f32_16x16x32_bf16 v[44:47], a[108:111], v[180:183], v[44:47]
    v_mfma_f32_16x16x32_bf16 v[64:67], a[108:111], v[184:187], v[64:67]
    buffer_load_dwordx4 a[232:235], v8, s[56:59], s38 offen offset:2048 sc1
    v_mfma_f32_16x16x32_bf16 v[84:87], a[108:111], v[188:191], v[84:87]
    v_mfma_f32_16x16x32_bf16 v[24:27], a[108:111], v[176:179], v[24:27]
    v_mfma_f32_16x16x32_bf16 v[48:51], a[112:115], v[180:183], v[48:51]
    v_mfma_f32_16x16x32_bf16 v[68:71], a[112:115], v[184:187], v[68:71]
    buffer_load_dwordx4 a[236:239], v8, s[56:59], s38 offen offset:3072 sc1
    v_mfma_f32_16x16x32_bf16 v[88:91], a[112:115], v[188:191], v[88:91]
    v_mfma_f32_16x16x32_bf16 v[28:31], a[112:115], v[176:179], v[28:31]
    s_waitcnt vmcnt(10)
    v_cmp_gt_u32 vcc, 3, v11
    s_cbranch_vccnz MA3_spin
MA3_ok:
    v_mfma_f32_16x16x32_bf16 v[52:55], a[116:119], v[180:183], v[52:55]
    v_mfma_f32_16x16x32_bf16 v[72:75], a[116:119], v[184:187], v[72:75]
    buffer_load_dwordx4 v[100:103], v8, s[16:19], s24 offen offset:2048 sc1
    v_mfma_f32_16x16x32_bf16 v[92:95], a[116:119], v[188:191], v[92:95]
    v_mfma_f32_16x16x32_bf16 v[32:35], a[116:119], v[176:179], v[32:35]
    v_mfma_f32_16x16x32_bf16 v[36:39], a[120:123], v[196:199], v[36:39]
    buffer_load_dwordx4 v[104:107], v8, s[16:19], s64 offen offset:2048 sc1
    v_mfma_f32_16x16x32_bf16 v[56:59], a[120:123], v[200:203], v[56:59]
    v_mfma_f32_16x16x32_bf16 v[76:79], a[120:123], v[204:207], v[76:79]
    v_mfma_f32_16x16x32_bf16 v[16:19], a[120:123], v[192:195], v[16:19]
    buffer_load_dwordx4 v[108:111], v8, s[16:19], s88 offen offset:2048 sc1
    v_mfma_f32_16x16x32_bf16 v[40:43], a[124:127], v[196:199], v[40:43]
    v_mfma_f32_16x16x32_bf16 v[60:63], a[124:127], v[200:203], v[60:63]
    v_mfma_f32_16x16x32_bf16 v[80:83], a[124:127], v[204:207], v[80:83]
    buffer_load_dwordx4 v[96:99], v8, s[16:19], s12 offen offset:2048 sc1
    v_mfma_f32_16x16x32_bf16 v[20:23], a[124:127], v[192:195], v[20:23]
    v_mfma_f32_16x16x32_bf16 v[44:47], a[128:131], v[196:199], v[44:47]
    v_mfma_f32_16x16x32_bf16 v[64:67], a[128:131], v[200:203], v[64:67]
    buffer_load_dwordx4 v[116:119], v8, s[16:19], s25 offen offset:2048 sc1
    v_mfma_f32_16x16x32_bf16 v[84:87], a[128:131], v[204:207], v[84:87]
    v_mfma_f32_16x16x32_bf16 v[24:27], a[128:131], v[192:195], v[24:27]
    v_mfma_f32_16x16x32_bf16 v[48:51], a[132:135], v[196:199], v[48:51]
    buffer_load_dwordx4 v[120:123], v8, s[16:19], s65 offen offset:2048 sc1
    v_mfma_f32_16x16x32_bf16 v[68:71], a[132:135], v[200:203], v[68:71]
    v_mfma_f32_16x16x32_bf16 v[88:91], a[132:135], v[204:207], v[88:91]
    v_mfma_f32_16x16x32_bf16 v[28:31], a[132:135], v[192:195], v[28:31]
    buffer_load_dwordx4 v[124:127], v8, s[16:19], s89 offen offset:2048 sc1
    v_mfma_f32_16x16x32_bf16 v[52:55], a[136:139], v[196:199], v[52:55]
    v_mfma_f32_16x16x32_bf16 v[72:75], a[136:139], v[200:203], v[72:75]
    v_mfma_f32_16x16x32_bf16 v[92:95], a[136:139], v[204:207], v[92:95]
    buffer_load_dwordx4 v[112:115], v8, s[16:19], s13 offen offset:2048 sc1
    v_mfma_f32_16x16x32_bf16 v[32:35], a[136:139], v[192:195], v[32:35]
    v_mfma_f32_16x16x32_bf16 v[36:39], a[140:143], v[212:215], v[36:39]
    v_mfma_f32_16x16x32_bf16 v[56:59], a[140:143], v[216:219], v[56:59]
    buffer_load_dwordx4 v[132:135], v8, s[16:19], s26 offen offset:2048 sc1
    v_mfma_f32_16x16x32_bf16 v[76:79], a[140:143], v[220:223], v[76:79]
    v_mfma_f32_16x16x32_bf16 v[16:19], a[140:143], v[208:211], v[16:19]
    v_mfma_f32_16x16x32_bf16 v[40:43], a[144:147], v[212:215], v[40:43]
    buffer_load_dwordx4 v[136:139], v8, s[16:19], s66 offen offset:2048 sc1
    v_mfma_f32_16x16x32_bf16 v[60:63], a[144:147], v[216:219], v[60:63]
    v_mfma_f32_16x16x32_bf16 v[80:83], a[144:147], v[220:223], v[80:83]
    v_mfma_f32_16x16x32_bf16 v[20:23], a[144:147], v[208:211], v[20:23]
    buffer_load_dwordx4 v[140:143], v8, s[16:19], s90 offen offset:2048 sc1
    v_mfma_f32_16x16x32_bf16 v[44:47], a[148:151], v[212:215], v[44:47]
    v_mfma_f32_16x16x32_bf16 v[64:67], a[148:151], v[216:219], v[64:67]
    v_mfma_f32_16x16x32_bf16 v[84:87], a[148:151], v[220:223], v[84:87]
    s_barrier
    buffer_load_dwordx4 v[128:131], v8, s[16:19], s14 offen offset:2048 sc1
    v_mfma_f32_16x16x32_bf16 v[24:27], a[148:151], v[208:211], v[24:27]
    v_mfma_f32_16x16x32_bf16 v[48:51], a[152:155], v[212:215], v[48:51]
    v_mfma_f32_16x16x32_bf16 v[68:71], a[152:155], v[216:219], v[68:71]
    buffer_load_dwordx4 v[148:151], v8, s[16:19], s27 offen offset:2048 sc1
    v_mfma_f32_16x16x32_bf16 v[88:91], a[152:155], v[220:223], v[88:91]
    v_mfma_f32_16x16x32_bf16 v[28:31], a[152:155], v[208:211], v[28:31]
    v_mfma_f32_16x16x32_bf16 v[52:55], a[156:159], v[212:215], v[52:55]
    buffer_load_dwordx4 v[152:155], v8, s[16:19], s67 offen offset:2048 sc1
    v_mfma_f32_16x16x32_bf16 v[72:75], a[156:159], v[216:219], v[72:75]
    v_mfma_f32_16x16x32_bf16 v[92:95], a[156:159], v[220:223], v[92:95]
    v_mfma_f32_16x16x32_bf16 v[32:35], a[156:159], v[208:211], v[32:35]
    buffer_load_dwordx4 v[156:159], v8, s[16:19], s91 offen offset:2048 sc1
    s_waitcnt vmcnt(14)
    v_mfma_f32_16x16x32_bf16 v[36:39], a[160:163], v[100:103], v[36:39]
    s_waitcnt vmcnt(13)
    v_mfma_f32_16x16x32_bf16 v[56:59], a[160:163], v[104:107], v[56:59]
    s_waitcnt vmcnt(12)
    v_mfma_f32_16x16x32_bf16 v[76:79], a[160:163], v[108:111], v[76:79]
    buffer_load_dwordx4 v[144:147], v8, s[16:19], s15 offen offset:2048 sc1
    s_waitcnt vmcnt(12)
    v_mfma_f32_16x16x32_bf16 v[16:19], a[160:163], v[96:99], v[16:19]
    v_mfma_f32_16x16x32_bf16 v[40:43], a[164:167], v[100:103], v[40:43]
    v_mfma_f32_16x16x32_bf16 v[60:63], a[164:167], v[104:107], v[60:63]
    buffer_load_dwordx2 v[224:225], v8, s[20:23], s92 offen sc1
    v_mfma_f32_16x16x32_bf16 v[80:83], a[164:167], v[108:111], v[80:83]
    v_mfma_f32_16x16x32_bf16 v[20:23], a[164:167], v[96:99], v[20:23]
    v_mfma_f32_16x16x32_bf16 v[44:47], a[168:171], v[100:103], v[44:47]
    buffer_load_dwordx2 v[226:227], v8, s[20:23], s93 offen sc1
    v_mfma_f32_16x16x32_bf16 v[64:67], a[168:171], v[104:107], v[64:67]
    v_mfma_f32_16x16x32_bf16 v[84:87], a[168:171], v[108:111], v[84:87]
    v_mfma_f32_16x16x32_bf16 v[24:27], a[168:171], v[96:99], v[24:27]
    buffer_load_dwordx2 v[228:229], v8, s[20:23], s94 offen sc1
    v_mfma_f32_16x16x32_bf16 v[48:51], a[172:175], v[100:103], v[48:51]
    v_mfma_f32_16x16x32_bf16 v[68:71], a[172:175], v[104:107], v[68:71]
    v_mfma_f32_16x16x32_bf16 v[88:91], a[172:175], v[108:111], v[88:91]
    buffer_load_dwordx2 v[230:231], v8, s[20:23], s95 offen sc1
    v_mfma_f32_16x16x32_bf16 v[28:31], a[172:175], v[96:99], v[28:31]
    v_mfma_f32_16x16x32_bf16 v[52:55], a[176:179], v[100:103], v[52:55]
    v_mfma_f32_16x16x32_bf16 v[72:75], a[176:179], v[104:107], v[72:75]
    buffer_load_dwordx2 v[232:233], v8, s[20:23], s96 offen sc1
    v_mfma_f32_16x16x32_bf16 v[92:95], a[176:179], v[108:111], v[92:95]
    v_mfma_f32_16x16x32_bf16 v[32:35], a[176:179], v[96:99], v[32:35]
    s_waitcnt vmcnt(16)
    v_mfma_f32_16x16x32_bf16 v[36:39], a[180:183], v[116:119], v[36:39]
    s_waitcnt vmcnt(15)
    v_mfma_f32_16x16x32_bf16 v[56:59], a[180:183], v[120:123], v[56:59]
    s_waitcnt vmcnt(14)
    v_mfma_f32_16x16x32_bf16 v[76:79], a[180:183], v[124:127], v[76:79]
    s_waitcnt vmcnt(13)
    v_mfma_f32_16x16x32_bf16 v[16:19], a[180:183], v[112:115], v[16:19]
    ds_read_b128 v[236:239], v7 offset:0
    v_mfma_f32_16x16x32_bf16 v[40:43], a[184:187], v[116:119], v[40:43]
    v_mfma_f32_16x16x32_bf16 v[60:63], a[184:187], v[120:123], v[60:63]
    v_mfma_f32_16x16x32_bf16 v[80:83], a[184:187], v[124:127], v[80:83]
    v_mfma_f32_16x16x32_bf16 v[20:23], a[184:187], v[112:115], v[20:23]
    ds_read_b128 v[240:243], v7 offset:64
    v_mfma_f32_16x16x32_bf16 v[44:47], a[188:191], v[116:119], v[44:47]
    v_mfma_f32_16x16x32_bf16 v[64:67], a[188:191], v[120:123], v[64:67]
    v_mfma_f32_16x16x32_bf16 v[84:87], a[188:191], v[124:127], v[84:87]
    v_mfma_f32_16x16x32_bf16 v[24:27], a[188:191], v[112:115], v[24:27]
    ds_read_b128 v[244:247], v7 offset:128
    v_mfma_f32_16x16x32_bf16 v[48:51], a[192:195], v[116:119], v[48:51]
    v_mfma_f32_16x16x32_bf16 v[68:71], a[192:195], v[120:123], v[68:71]
    v_mfma_f32_16x16x32_bf16 v[88:91], a[192:195], v[124:127], v[88:91]
    v_mfma_f32_16x16x32_bf16 v[28:31], a[192:195], v[112:115], v[28:31]
    ds_read_b128 v[248:251], v7 offset:192
    v_mfma_f32_16x16x32_bf16 v[52:55], a[196:199], v[116:119], v[52:55]
    v_mfma_f32_16x16x32_bf16 v[72:75], a[196:199], v[120:123], v[72:75]
    v_mfma_f32_16x16x32_bf16 v[92:95], a[196:199], v[124:127], v[92:95]
    v_mfma_f32_16x16x32_bf16 v[32:35], a[196:199], v[112:115], v[32:35]
    ds_read_b128 v[252:255], v7 offset:256
    s_waitcnt vmcnt(12)
    v_mfma_f32_16x16x32_bf16 v[36:39], a[200:203], v[132:135], v[36:39]
    s_waitcnt vmcnt(11)
    v_mfma_f32_16x16x32_bf16 v[56:59], a[200:203], v[136:139], v[56:59]
    s_waitcnt vmcnt(10)
    v_mfma_f32_16x16x32_bf16 v[76:79], a[200:203], v[140:143], v[76:79]
    s_waitcnt vmcnt(9)
    v_mfma_f32_16x16x32_bf16 v[16:19], a[200:203], v[128:131], v[16:19]
    s_waitcnt vmcnt(8)
    v_mfma_f32_16x16x32_bf16 v[36:39], a[220:223], v[148:151], v[36:39]
    s_waitcnt vmcnt(7)
    v_mfma_f32_16x16x32_bf16 v[56:59], a[220:223], v[152:155], v[56:59]
    s_waitcnt vmcnt(6)
    v_mfma_f32_16x16x32_bf16 v[76:79], a[220:223], v[156:159], v[76:79]
    s_waitcnt vmcnt(5)
    v_mfma_f32_16x16x32_bf16 v[16:19], a[220:223], v[144:147], v[16:19]
    v_mfma_f32_16x16x32_bf16 v[40:43], a[204:207], v[132:135], v[40:43]
    v_mfma_f32_16x16x32_bf16 v[60:63], a[204:207], v[136:139], v[60:63]
    ds_write_b128 v6, v[36:39] offset:0
    v_mfma_f32_16x16x32_bf16 v[80:83], a[204:207], v[140:143], v[80:83]
    ds_write_b128 v6, v[56:59] offset:5120
    v_mfma_f32_16x16x32_bf16 v[20:23], a[204:207], v[128:131], v[20:23]
    ds_write_b128 v6, v[76:79] offset:10240
    v_mfma_f32_16x16x32_bf16 v[40:43], a[224:227], v[148:151], v[40:43]
    v_mfma_f32_16x16x32_bf16 v[60:63], a[224:227], v[152:155], v[60:63]
    v_mfma_f32_16x16x32_bf16 v[80:83], a[224:227], v[156:159], v[80:83]
    s_waitcnt vmcnt(0)
    v_mfma_f32_16x16x32_bf16 v[20:23], a[224:227], v[144:147], v[20:23]
    v_lshlrev_b32 v160, 16, v224
    v_mfma_f32_16x16x32_bf16 v[44:47], a[208:211], v[132:135], v[44:47]
    v_and_b32 v161, 0xffff0000, v224
    v_mfma_f32_16x16x32_bf16 v[64:67], a[208:211], v[136:139], v[64:67]
    ds_write_b128 v6, v[40:43] offset:1024
    v_lshlrev_b32 v162, 16, v225
    v_mfma_f32_16x16x32_bf16 v[84:87], a[208:211], v[140:143], v[84:87]
    ds_write_b128 v6, v[60:63] offset:6144
    v_and_b32 v163, 0xffff0000, v225
    v_mfma_f32_16x16x32_bf16 v[24:27], a[208:211], v[128:131], v[24:27]
    ds_write_b128 v6, v[80:83] offset:11264
    v_lshlrev_b32 v164, 16, v226
    v_mfma_f32_16x16x32_bf16 v[44:47], a[228:231], v[148:151], v[44:47]
    v_and_b32 v165, 0xffff0000, v226
    v_mfma_f32_16x16x32_bf16 v[64:67], a[228:231], v[152:155], v[64:67]
    v_lshlrev_b32 v166, 16, v227
    v_mfma_f32_16x16x32_bf16 v[84:87], a[228:231], v[156:159], v[84:87]
    v_and_b32 v167, 0xffff0000, v227
    v_mfma_f32_16x16x32_bf16 v[24:27], a[228:231], v[144:147], v[24:27]
    v_lshlrev_b32 v168, 16, v228
    v_mfma_f32_16x16x32_bf16 v[48:51], a[212:215], v[132:135], v[48:51]
    v_and_b32 v169, 0xffff0000, v228
    v_mfma_f32_16x16x32_bf16 v[68:71], a[212:215], v[136:139], v[68:71]
    ds_write_b128 v6, v[44:47] offset:2048
    v_lshlrev_b32 v170, 16, v229
    v_mfma_f32_16x16x32_bf16 v[88:91], a[212:215], v[140:143], v[88:91]
    ds_write_b128 v6, v[64:67] offset:7168
    v_and_b32 v171, 0xffff0000, v229
    v_mfma_f32_16x16x32_bf16 v[28:31], a[212:215], v[128:131], v[28:31]
    ds_write_b128 v6, v[84:87] offset:12288
    v_lshlrev_b32 v172, 16, v230
    v_mfma_f32_16x16x32_bf16 v[48:51], a[232:235], v[148:151], v[48:51]
    v_and_b32 v173, 0xffff0000, v230
    v_mfma_f32_16x16x32_bf16 v[68:71], a[232:235], v[152:155], v[68:71]
    s_waitcnt lgkmcnt(0)
    s_barrier
    ds_read_b128 v[36:39], v1 offset:0
    ds_read_b128 v[56:59], v2 offset:5120
    v_lshlrev_b32 v174, 16, v231
    v_mfma_f32_16x16x32_bf16 v[88:91], a[232:235], v[156:159], v[88:91]
    ds_read_b128 v[76:79], v3 offset:10240
    ds_read_b128 v[40:43], v1 offset:1024
    v_and_b32 v175, 0xffff0000, v231
    v_mfma_f32_16x16x32_bf16 v[28:31], a[232:235], v[144:147], v[28:31]
    ds_read_b128 v[60:63], v2 offset:6144
    ds_read_b128 v[80:83], v3 offset:11264
    v_lshlrev_b32 v176, 16, v232
    v_mfma_f32_16x16x32_bf16 v[52:55], a[216:219], v[132:135], v[52:55]
    ds_read_b128 v[44:47], v1 offset:2048
    ds_read_b128 v[64:67], v2 offset:7168
    v_and_b32 v177, 0xffff0000, v232
    v_mfma_f32_16x16x32_bf16 v[72:75], a[216:219], v[136:139], v[72:75]
    ds_read_b128 v[84:87], v3 offset:12288
    ds_write_b128 v6, v[48:51] offset:3072
    v_lshlrev_b32 v178, 16, v233
    v_mfma_f32_16x16x32_bf16 v[92:95], a[216:219], v[140:143], v[92:95]
    ds_write_b128 v6, v[68:71] offset:8192
    v_and_b32 v179, 0xffff0000, v233
    v_mfma_f32_16x16x32_bf16 v[32:35], a[216:219], v[128:131], v[32:35]
    ds_write_b128 v6, v[88:91] offset:13312
    v_mfma_f32_16x16x32_bf16 v[52:55], a[236:239], v[148:151], v[52:55]
    v_mfma_f32_16x16x32_bf16 v[72:75], a[236:239], v[152:155], v[72:75]
    v_mfma_f32_16x16x32_bf16 v[92:95], a[236:239], v[156:159], v[92:95]
    v_mfma_f32_16x16x32_bf16 v[32:35], a[236:239], v[144:147], v[32:35]
    s_nop 7
    ds_write_b128 v6, v[52:55] offset:4096
    ds_write_b128 v6, v[72:75] offset:9216
    ds_write_b128 v6, v[92:95] offset:14336
    s_waitcnt lgkmcnt(12)
    v_pk_add_f32 v[16:17], v[16:17], v[36:37]
    v_pk_add_f32 v[18:19], v[18:19], v[38:39]
    v_pk_add_f32 v[56:57], v[56:57], v[76:77]
    v_pk_add_f32 v[58:59], v[58:59], v[78:79]
    v_pk_add_f32 v[16:17], v[16:17], v[56:57]
    v_pk_add_f32 v[18:19], v[18:19], v[58:59]
    v_pk_fma_f32 v[160:161], v[16:17], v[236:237], v[160:161]
    v_pk_fma_f32 v[162:163], v[18:19], v[238:239], v[162:163]
    v_cvt_pk_bf16_f32 v160, v160, v161
    v_cvt_pk_bf16_f32 v161, v162, v163
    buffer_store_dwordx2 v[160:161], v12, s[84:87], 0 offen offset:0
    s_waitcnt lgkmcnt(0)
    s_barrier
    ds_read_b128 v[48:51], v1 offset:3072
    ds_read_b128 v[68:71], v2 offset:8192
    ds_read_b128 v[88:91], v3 offset:13312
    ds_read_b128 v[52:55], v1 offset:4096
    ds_read_b128 v[72:75], v2 offset:9216
    ds_read_b128 v[92:95], v3 offset:14336
    v_pk_add_f32 v[20:21], v[20:21], v[40:41]
    v_pk_add_f32 v[22:23], v[22:23], v[42:43]
    v_pk_add_f32 v[60:61], v[60:61], v[80:81]
    v_pk_add_f32 v[62:63], v[62:63], v[82:83]
    v_pk_add_f32 v[20:21], v[20:21], v[60:61]
    v_pk_add_f32 v[22:23], v[22:23], v[62:63]
    v_pk_fma_f32 v[164:165], v[20:21], v[240:241], v[164:165]
    v_pk_fma_f32 v[166:167], v[22:23], v[242:243], v[166:167]
    v_cvt_pk_bf16_f32 v164, v164, v165
    v_cvt_pk_bf16_f32 v165, v166, v167
    buffer_store_dwordx2 v[164:165], v12, s[84:87], 0 offen offset:32
    v_pk_add_f32 v[24:25], v[24:25], v[44:45]
    v_pk_add_f32 v[26:27], v[26:27], v[46:47]
    v_pk_add_f32 v[64:65], v[64:65], v[84:85]
    v_pk_add_f32 v[66:67], v[66:67], v[86:87]
    v_pk_add_f32 v[24:25], v[24:25], v[64:65]
    v_pk_add_f32 v[26:27], v[26:27], v[66:67]
    v_pk_fma_f32 v[168:169], v[24:25], v[244:245], v[168:169]
    v_pk_fma_f32 v[170:171], v[26:27], v[246:247], v[170:171]
    v_cvt_pk_bf16_f32 v168, v168, v169
    v_cvt_pk_bf16_f32 v169, v170, v171
    buffer_store_dwordx2 v[168:169], v12, s[84:87], 0 offen offset:64
    s_waitcnt lgkmcnt(3)
    v_pk_add_f32 v[28:29], v[28:29], v[48:49]
    v_pk_add_f32 v[30:31], v[30:31], v[50:51]
    v_pk_add_f32 v[68:69], v[68:69], v[88:89]
    v_pk_add_f32 v[70:71], v[70:71], v[90:91]
    v_pk_add_f32 v[28:29], v[28:29], v[68:69]
    v_pk_add_f32 v[30:31], v[30:31], v[70:71]
    v_pk_fma_f32 v[172:173], v[28:29], v[248:249], v[172:173]
    v_pk_fma_f32 v[174:175], v[30:31], v[250:251], v[174:175]
    v_cvt_pk_bf16_f32 v172, v172, v173
    v_cvt_pk_bf16_f32 v173, v174, v175
    buffer_store_dwordx2 v[172:173], v12, s[84:87], 0 offen offset:96
    s_waitcnt lgkmcnt(0)
    v_pk_add_f32 v[32:33], v[32:33], v[52:53]
    v_pk_add_f32 v[34:35], v[34:35], v[54:55]
    v_pk_add_f32 v[72:73], v[72:73], v[92:93]
    v_pk_add_f32 v[74:75], v[74:75], v[94:95]
    v_pk_add_f32 v[32:33], v[32:33], v[72:73]
    v_pk_add_f32 v[34:35], v[34:35], v[74:75]
    v_pk_fma_f32 v[176:177], v[32:33], v[252:253], v[176:177]
    v_pk_fma_f32 v[178:179], v[34:35], v[254:255], v[178:179]
    v_cvt_pk_bf16_f32 v176, v176, v177
    v_cvt_pk_bf16_f32 v177, v178, v179
    buffer_store_dwordx2 v[176:177], v12, s[84:87], 0 offen offset:128
M_end:
    s_endpgm
P0_we:
    s_cmp_lt_u32 s6, 16
    s_cbranch_scc1 P0_we2
    s_add_u32 m0, s40, 0
    s_nop 0
    buffer_load_dwordx4 v9, s[12:15], s35 offen offset:0 nt lds
    s_add_u32 m0, s40, 1920
    s_nop 0
    buffer_load_dwordx4 v9, s[12:15], s35 offen offset:128 nt lds
    s_add_u32 m0, s40, 3840
    s_nop 0
    buffer_load_dwordx4 v9, s[12:15], s35 offen offset:256 nt lds
    s_add_u32 s35, s35, 393216
    s_add_u32 m0, s40, 6144
    s_nop 0
    buffer_load_dwordx4 v9, s[12:15], s35 offen offset:0 nt lds
    s_add_u32 m0, s40, 8064
    s_nop 0
    buffer_load_dwordx4 v9, s[12:15], s35 offen offset:128 nt lds
    s_add_u32 m0, s40, 9984
    s_nop 0
    buffer_load_dwordx4 v9, s[12:15], s35 offen offset:256 nt lds
    s_add_u32 s35, s35, 393216
    s_add_u32 m0, s40, 12288
    s_nop 0
    buffer_load_dwordx4 v9, s[12:15], s35 offen offset:0 nt lds
    s_add_u32 m0, s40, 14208
    s_nop 0
    buffer_load_dwordx4 v9, s[12:15], s35 offen offset:128 nt lds
    s_add_u32 m0, s40, 16128
    s_nop 0
    buffer_load_dwordx4 v9, s[12:15], s35 offen offset:256 nt lds
    s_add_u32 s35, s35, 393216
    s_add_u32 m0, s40, 18432
    s_nop 0
    buffer_load_dwordx4 v9, s[12:15], s35 offen offset:0 nt lds
    s_add_u32 m0, s40, 20352
    s_nop 0
    buffer_load_dwordx4 v9, s[12:15], s35 offen offset:128 nt lds
    s_add_u32 m0, s40, 22272
    s_nop 0
    buffer_load_dwordx4 v9, s[12:15], s35 offen offset:256 nt lds
    s_add_u32 s35, s35, 393216
    s_branch P0_wer
P0_we2:
    s_waitcnt vmcnt(0)
    s_branch P0_wer
P0_sk0:
    s_waitcnt vmcnt(0)
    s_branch P0_skr0
P0_g:
    s_cmpk_ge_u32 s2, 80
    s_cbranch_scc1 P0_gr
    v_lshlrev_b32 v91, 16, v84
    v_lshlrev_b32 v92, 16, v85
    v_lshlrev_b32 v93, 16, v86
    v_lshlrev_b32 v94, 16, v87
    v_lshlrev_b32 v95, 16, v88
    v_and_b32 v12, 0x300, v8
    v_and_b32 v13, 0x70, v8
    v_lshl_add_u32 v12, v13, 1, v12
    s_lshl_b32 s3, s32, 10
    s_add_u32 s3, s3, 151040
    v_add_u32 v12, s3, v12
    s_waitcnt vmcnt(4)
    v_dot2c_f32_bf16 v16, v84, v24
    v_dot2c_f32_bf16 v17, v91, v24
    v_dot2c_f32_bf16 v18, v84, v25
    v_dot2c_f32_bf16 v19, v91, v25
    v_dot2c_f32_bf16 v20, v84, v26
    v_dot2c_f32_bf16 v21, v91, v26
    v_dot2c_f32_bf16 v22, v84, v27
    v_dot2c_f32_bf16 v23, v91, v27
    s_waitcnt vmcnt(3)
    v_dot2c_f32_bf16 v16, v85, v28
    v_dot2c_f32_bf16 v17, v92, v28
    v_dot2c_f32_bf16 v18, v85, v29
    v_dot2c_f32_bf16 v19, v92, v29
    v_dot2c_f32_bf16 v20, v85, v30
    v_dot2c_f32_bf16 v21, v92, v30
    v_dot2c_f32_bf16 v22, v85, v31
    v_dot2c_f32_bf16 v23, v92, v31
    s_waitcnt vmcnt(2)
    v_dot2c_f32_bf16 v16, v86, v32
    v_dot2c_f32_bf16 v17, v93, v32
    v_dot2c_f32_bf16 v18, v86, v33
    v_dot2c_f32_bf16 v19, v93, v33
    v_dot2c_f32_bf16 v20, v86, v34
    v_dot2c_f32_bf16 v21, v93, v34
    v_dot2c_f32_bf16 v22, v86, v35
    v_dot2c_f32_bf16 v23, v93, v35
    s_waitcnt vmcnt(1)
    v_dot2c_f32_bf16 v16, v87, v36
    v_dot2c_f32_bf16 v17, v94, v36
    v_dot2c_f32_bf16 v18, v87, v37
    v_dot2c_f32_bf16 v19, v94, v37
    v_dot2c_f32_bf16 v20, v87, v38
    v_dot2c_f32_bf16 v21, v94, v38
    v_dot2c_f32_bf16 v22, v87, v39
    v_dot2c_f32_bf16 v23, v94, v39
    s_waitcnt vmcnt(0)
    v_dot2c_f32_bf16 v16, v88, v40
    v_dot2c_f32_bf16 v17, v95, v40
    v_dot2c_f32_bf16 v18, v88, v41
    v_dot2c_f32_bf16 v19, v95, v41
    v_dot2c_f32_bf16 v20, v88, v42
    v_dot2c_f32_bf16 v21, v95, v42
    v_dot2c_f32_bf16 v22, v88, v43
    v_dot2c_f32_bf16 v23, v95, v43
    s_nop 0
    v_add_f32_dpp v16, v16, v16 row_ror:8 row_mask:0xf bank_mask:0xf
    v_add_f32_dpp v17, v17, v17 row_ror:8 row_mask:0xf bank_mask:0xf
    v_add_f32_dpp v18, v18, v18 row_ror:8 row_mask:0xf bank_mask:0xf
    v_add_f32_dpp v19, v19, v19 row_ror:8 row_mask:0xf bank_mask:0xf
    v_add_f32_dpp v20, v20, v20 row_ror:8 row_mask:0xf bank_mask:0xf
    v_add_f32_dpp v21, v21, v21 row_ror:8 row_mask:0xf bank_mask:0xf
    v_add_f32_dpp v22, v22, v22 row_ror:8 row_mask:0xf bank_mask:0xf
    v_add_f32_dpp v23, v23, v23 row_ror:8 row_mask:0xf bank_mask:0xf
    ds_write_b128 v12, v[16:19]
    ds_write_b128 v12, v[20:23] offset:16
    s_waitcnt lgkmcnt(0)
    s_barrier
    s_cmp_lg_u32 s32, 0
    s_cbranch_scc1 P0_gr
    v_lshrrev_b32 v12, 2, v8
    v_add_u32 v13, 151040, v12
    ds_read2st64_b32 v[24:25], v13 offset0:0 offset1:1
    ds_read2st64_b32 v[26:27], v13 offset0:2 offset1:3
    ds_read2st64_b32 v[28:29], v13 offset0:4 offset1:5
    ds_read2st64_b32 v[30:31], v13 offset0:6 offset1:7
    ds_read2st64_b32 v[32:33], v13 offset0:8 offset1:9
    ds_read2st64_b32 v[34:35], v13 offset0:10 offset1:11
    ds_read2st64_b32 v[36:37], v13 offset0:12 offset1:13
    ds_read2st64_b32 v[38:39], v13 offset0:14 offset1:15
    s_and_b32 s3, s2, 3
    s_mul_i32 s3, s3, 15360
    s_lshr_b32 s28, s2, 2
    s_lshl_b32 s28, s28, 8
    s_add_u32 s3, s28, s3
    s_add_u32 s28, s10, 262144
    s_addc_u32 s29, s11, 0
    s_mov_b32 s30, 61440
    s_mov_b32 s31, 0x00020000
    s_waitcnt lgkmcnt(0)
    v_pk_add_f32 v[24:25], v[24:25], v[32:33]
    v_pk_add_f32 v[26:27], v[26:27], v[34:35]
    v_pk_add_f32 v[28:29], v[28:29], v[36:37]
    v_pk_add_f32 v[30:31], v[30:31], v[38:39]
    v_pk_add_f32 v[24:25], v[24:25], v[28:29]
    v_pk_add_f32 v[26:27], v[26:27], v[30:31]
    v_pk_add_f32 v[24:25], v[24:25], v[26:27]
    v_add_f32 v24, v24, v25
    buffer_store_dword v24, v12, s[28:31], s3 offen sc1
    s_branch P0_gr
K2_sw:
    s_cmp_eq_u32 s41, 3
    s_cbranch_scc1 K2_sw4
    s_sub_u32 s3, s2, 80
    s_cmp_ge_u32 s3, 160
    s_cbranch_scc1 K2_swr
    s_cmp_eq_u32 s41, 4
    s_cbranch_scc1 K2_g2
    v_accvgpr_read_b32 v228, a52
    v_accvgpr_read_b32 v229, a53
    v_accvgpr_read_b32 v230, a54
    v_accvgpr_read_b32 v231, a55
    v_accvgpr_read_b32 v232, a56
    v_lshlrev_b32 v233, 16, v228
    v_lshlrev_b32 v234, 16, v229
    v_lshlrev_b32 v235, 16, v230
    v_lshlrev_b32 v236, 16, v231
    v_lshlrev_b32 v237, 16, v232
    v_mov_b32 v240, 0
    v_mov_b32 v241, 0
    v_mov_b32 v242, 0
    v_mov_b32 v243, 0
    v_mov_b32 v244, 0
    v_mov_b32 v245, 0
    v_mov_b32 v246, 0
    v_mov_b32 v247, 0
    v_and_b32 v238, 0x300, v8
    v_and_b32 v239, 0x70, v8
    v_lshl_add_u32 v238, v239, 1, v238
    s_lshl_b32 s3, s32, 10
    s_add_u32 s3, s3, 0
    v_add_u32 v238, s3, v238
    v_dot2c_f32_bf16 v240, v228, v208
    v_dot2c_f32_bf16 v241, v233, v208
    v_dot2c_f32_bf16 v242, v228, v209
    v_dot2c_f32_bf16 v243, v233, v209
    v_dot2c_f32_bf16 v244, v228, v210
    v_dot2c_f32_bf16 v245, v233, v210
    v_dot2c_f32_bf16 v246, v228, v211
    v_dot2c_f32_bf16 v247, v233, v211
    v_dot2c_f32_bf16 v240, v229, v212
    v_dot2c_f32_bf16 v241, v234, v212
    v_dot2c_f32_bf16 v242, v229, v213
    v_dot2c_f32_bf16 v243, v234, v213
    v_dot2c_f32_bf16 v244, v229, v214
    v_dot2c_f32_bf16 v245, v234, v214
    v_dot2c_f32_bf16 v246, v229, v215
    v_dot2c_f32_bf16 v247, v234, v215
    v_dot2c_f32_bf16 v240, v230, v216
    v_dot2c_f32_bf16 v241, v235, v216
    v_dot2c_f32_bf16 v242, v230, v217
    v_dot2c_f32_bf16 v243, v235, v217
    v_dot2c_f32_bf16 v244, v230, v218
    v_dot2c_f32_bf16 v245, v235, v218
    v_dot2c_f32_bf16 v246, v230, v219
    v_dot2c_f32_bf16 v247, v235, v219
    v_dot2c_f32_bf16 v240, v231, v220
    v_dot2c_f32_bf16 v241, v236, v220
    v_dot2c_f32_bf16 v242, v231, v221
    v_dot2c_f32_bf16 v243, v236, v221
    v_dot2c_f32_bf16 v244, v231, v222
    v_dot2c_f32_bf16 v245, v236, v222
    v_dot2c_f32_bf16 v246, v231, v223
    v_dot2c_f32_bf16 v247, v236, v223
    v_dot2c_f32_bf16 v240, v232, v224
    v_dot2c_f32_bf16 v241, v237, v224
    v_dot2c_f32_bf16 v242, v232, v225
    v_dot2c_f32_bf16 v243, v237, v225
    v_dot2c_f32_bf16 v244, v232, v226
    v_dot2c_f32_bf16 v245, v237, v226
    v_dot2c_f32_bf16 v246, v232, v227
    v_dot2c_f32_bf16 v247, v237, v227
    s_nop 0
    v_add_f32_dpp v240, v240, v240 row_ror:8 row_mask:0xf bank_mask:0xf
    v_add_f32_dpp v241, v241, v241 row_ror:8 row_mask:0xf bank_mask:0xf
    v_add_f32_dpp v242, v242, v242 row_ror:8 row_mask:0xf bank_mask:0xf
    v_add_f32_dpp v243, v243, v243 row_ror:8 row_mask:0xf bank_mask:0xf
    v_add_f32_dpp v244, v244, v244 row_ror:8 row_mask:0xf bank_mask:0xf
    v_add_f32_dpp v245, v245, v245 row_ror:8 row_mask:0xf bank_mask:0xf
    v_add_f32_dpp v246, v246, v246 row_ror:8 row_mask:0xf bank_mask:0xf
    v_add_f32_dpp v247, v247, v247 row_ror:8 row_mask:0xf bank_mask:0xf
    ds_write_b128 v238, v[240:243]
    ds_write_b128 v238, v[244:247] offset:16
    s_waitcnt lgkmcnt(0)
    s_branch K2_swr
K2_g2:
    s_cmp_lg_u32 s32, 0
    s_cbranch_scc1 K2_swr
    v_lshrrev_b32 v238, 2, v8
    v_add_u32 v239, 0, v238
    ds_read2st64_b32 v[208:209], v239 offset0:0 offset1:1
    ds_read2st64_b32 v[210:211], v239 offset0:2 offset1:3
    ds_read2st64_b32 v[212:213], v239 offset0:4 offset1:5
    ds_read2st64_b32 v[214:215], v239 offset0:6 offset1:7
    ds_read2st64_b32 v[216:217], v239 offset0:8 offset1:9
    ds_read2st64_b32 v[218:219], v239 offset0:10 offset1:11
    ds_read2st64_b32 v[220:221], v239 offset0:12 offset1:13
    ds_read2st64_b32 v[222:223], v239 offset0:14 offset1:15
    s_and_b32 s3, s2, 3
    s_mul_i32 s3, s3, 15360
    s_lshr_b32 s96, s2, 2
    s_lshl_b32 s96, s96, 8
    s_add_u32 s3, s96, s3
    s_add_u32 s96, s10, 262144
    s_addc_u32 s97, s11, 0
    s_mov_b32 s98, 61440
    s_mov_b32 s99, 0x00020000
    s_waitcnt lgkmcnt(0)
    v_pk_add_f32 v[208:209], v[208:209], v[216:217]
    v_pk_add_f32 v[210:211], v[210:211], v[218:219]
    v_pk_add_f32 v[212:213], v[212:213], v[220:221]
    v_pk_add_f32 v[214:215], v[214:215], v[222:223]
    v_pk_add_f32 v[208:209], v[208:209], v[212:213]
    v_pk_add_f32 v[210:211], v[210:211], v[214:215]
    v_pk_add_f32 v[208:209], v[208:209], v[210:211]
    v_add_f32 v208, v208, v209
    buffer_store_dword v208, v238, s[96:99], s3 offen sc1
    s_branch K2_swr
K2_sw4:
    s_mov_b32 s84, s64
    s_mov_b32 s85, s65
    s_mov_b32 s86, s66
    s_mov_b32 s88, s67
    s_mov_b32 s89, s68
    s_mov_b32 s90, s71
    s_mov_b32 s92, s69
    s_mov_b32 s93, s70
    s_mov_b32 s94, s71
    s_mov_b32 s54, s72
    s_mov_b32 s55, s73
    s_mov_b32 s56, s74
    s_mov_b32 s57, 0
    s_mov_b32 s58, 0
    v_mov_b32 v0, v21
    s_branch K2_swr
K2_r1spin:
    s_mov_b32 s3, 0
K2_r1l:
    s_add_u32 s3, s3, 1
    s_cmp_gt_u32 s3, 200000
    s_cbranch_scc1 K2_r1ok
    buffer_load_dword v22, v23, s[76:79], 0 offen sc1
    s_waitcnt vmcnt(0)
    v_cmp_ne_u32 vcc, 16, v22
    s_cbranch_vccnz K2_r1l
    s_branch K2_r1ok
MO1_spin:
    s_mov_b32 s3, 0
MO1_l:
    s_add_u32 s3, s3, 1
    s_cmp_gt_u32 s3, 200000
    s_cbranch_scc1 MO1_ok
    buffer_load_dword v11, v0, s[76:79], s51 offen sc1
    s_waitcnt vmcnt(0)
    v_cmp_gt_u32 vcc, 3, v11
    s_cbranch_vccnz MO1_l
    s_branch MO1_ok
MO_spin:
    s_mov_b32 s3, 0
MO_l:
    s_add_u32 s3, s3, 1
    s_cmp_gt_u32 s3, 200000
    s_cbranch_scc1 MO_ok
    buffer_load_dword v11, v0, s[76:79], s51 offen sc1
    s_waitcnt vmcnt(0)
    v_cmp_gt_u32 vcc, 4, v11
    s_cbranch_vccnz MO_l
    s_branch MO_ok
MR_spin:
    s_mov_b32 s3, 0
MR_l:
    s_add_u32 s3, s3, 1
    s_cmp_gt_u32 s3, 200000
    s_cbranch_scc1 MR_ok
    buffer_load_dword v11, v12, s[76:79], 0 offen sc1
    s_waitcnt vmcnt(0)
    v_cmp_ne_u32 vcc, 16, v11
    s_cbranch_vccnz MR_l
    s_branch MR_ok
MH_spin:
    s_mov_b32 s3, 0
MH_l:
    s_add_u32 s3, s3, 1
    s_cmp_gt_u32 s3, 200000
    s_cbranch_scc1 MH_ok
    buffer_load_dword v11, v0, s[76:79], s42 offen sc1
    s_waitcnt vmcnt(0)
    v_cmp_gt_u32 vcc, 7, v11
    s_cbranch_vccnz MH_l
    s_branch MH_ok
MA1_spin:
    s_mov_b32 s3, 0
MA1_l:
    s_add_u32 s3, s3, 1
    s_cmp_gt_u32 s3, 200000
    s_cbranch_scc1 MA1_ok
    buffer_load_ubyte v11, v0, s[76:79], s39 offen sc1
    s_waitcnt vmcnt(0)
    v_cmp_gt_u32 vcc, 1, v11
    s_cbranch_vccnz MA1_l
    s_branch MA1_ok
MA2_spin:
    s_mov_b32 s3, 0
MA2_l:
    s_add_u32 s3, s3, 1
    s_cmp_gt_u32 s3, 200000
    s_cbranch_scc1 MA2_ok
    buffer_load_ubyte v11, v0, s[76:79], s39 offen sc1
    s_waitcnt vmcnt(0)
    v_cmp_gt_u32 vcc, 2, v11
    s_cbranch_vccnz MA2_l
    s_branch MA2_ok
MA3_spin:
    s_mov_b32 s3, 0
MA3_l:
    s_add_u32 s3, s3, 1
    s_cmp_gt_u32 s3, 200000
    s_cbranch_scc1 MA3_ok
    buffer_load_ubyte v11, v0, s[76:79], s39 offen sc1
    s_waitcnt vmcnt(0)
    v_cmp_gt_u32 vcc, 3, v11
    s_cbranch_vccnz MA3_l
    s_branch MA3_ok
P0R_spin:
    s_mov_b32 s3, 0
P0R_l:
    s_add_u32 s3, s3, 1
    s_cmp_gt_u32 s3, 200000
    s_cbranch_scc1 P0R_ok
    global_load_dword v89, v90, s[50:51] sc1
    s_waitcnt vmcnt(0)
    v_cmp_eq_u32 vcc, 0, v89
    s_cbranch_vccnz P0R_l
    s_branch P0R_ok
P0M_spin:
    s_mov_b32 s3, 0
P0M_l:
    s_add_u32 s3, s3, 1
    s_cmp_gt_u32 s3, 200000
    s_cbranch_scc1 P0M_ok
    buffer_load_dword v89, v93, s[76:79], s1 offen sc1
    s_waitcnt vmcnt(0)
    v_cmp_gt_u32 vcc, v95, v89
    s_cbranch_vccnz P0M_l
    s_branch P0M_ok
P0X_spin:
    s_mov_b32 s3, 0
P0X_l:
    s_add_u32 s3, s3, 1
    s_cmp_gt_u32 s3, 200000
    s_cbranch_scc1 P0X_ok
    buffer_load_dword v89, v93, s[76:79], s1 offen sc1
    s_waitcnt vmcnt(0)
    v_cmp_eq_u32 vcc, 0, v89
    s_cbranch_vccnz P0X_l
    s_branch P0X_ok
QH_spin:
    s_mov_b32 s3, 0
QH_l:
    s_add_u32 s3, s3, 1
    s_cmp_gt_u32 s3, 200000
    s_cbranch_scc1 QH_ok
    buffer_load_dword v91, v90, s[76:79], s46 offen sc1
    s_waitcnt vmcnt(0)
    v_cmp_gt_u32 vcc, 2, v91
    s_cbranch_vccnz QH_l
    s_branch QH_ok
M_last:
K2_slow:
    s_waitcnt vmcnt(0) lgkmcnt(0)
    s_nop 15
    s_mov_b32 s67, m0
    v_accvgpr_write_b32 a58, v1
    v_accvgpr_write_b32 a59, v2
    v_accvgpr_write_b32 a60, v3
    v_accvgpr_write_b32 a61, v4
    s_lshl_b32 s64, s32, 12
    v_lshrrev_b32 v0, 4, v8
    v_lshrrev_b32 v16, 2, v0
    v_lshlrev_b32 v16, 7, v16
    v_bfe_u32 v17, v0, 3, 2
    v_lshl_add_u32 v16, v17, 5, v16
    v_and_b32 v17, 3, v0
    v_lshl_add_u32 v16, v17, 3, v16
    v_add_u32 v1, s64, v16
    v_xor_b32 v17, 32, v16
    v_add_u32 v2, s64, v17
    v_xor_b32 v17, 64, v16
    v_add_u32 v3, s64, v17
    v_xor_b32 v17, 96, v16
    v_add_u32 v4, s64, v17
    v_and_b32 v16, 15, v0
    v_lshlrev_b32 v16, 7, v16
    v_bfe_u32 v17, v0, 1, 3
    v_lshlrev_b32 v17, 4, v17
    v_add_u32 v16, v16, v17
    v_and_b32 v17, 48, v0
    v_xor_b32 v16, v16, v17
    v_add_u32 v5, s64, v16
    v_xor_b32 v16, 64, v16
    v_add_u32 v6, s64, v16
    v_lshrrev_b32 v16, 3, v0
    v_and_b32 v17, 7, v0
    v_mul_u32_u24 v18, 384, v16
    v_lshrrev_b32 v19, 1, v16
    v_xor_b32 v19, v19, v17
    v_lshl_add_u32 v20, v19, 4, v18
    v_xor_b32 v19, 4, v19
    v_lshl_add_u32 v21, v19, 4, v18
    v_and_b32 v19, 6, v16
    v_xor_b32 v19, v19, v17
    v_lshl_add_u32 v22, v19, 4, v18
    v_mov_b32 v192, 0xff800000
    v_mov_b32 v196, 0xff800000
    v_mov_b32 v200, 0xff800000
    v_mov_b32 v204, 0xff800000
    s_mov_b32 s65, 0
K2_slowA:
    s_add_u32 s66, s65, 0
    s_add_u32 m0, s64, 0
    s_nop 0
    buffer_load_dwordx4 v20, s[16:19], s66 offen lds
    s_add_u32 s66, s65, 3072
    s_add_u32 m0, s64, 1024
    s_nop 0
    buffer_load_dwordx4 v21, s[16:19], s66 offen lds
    s_add_u32 s66, s65, 6144
    s_add_u32 m0, s64, 2048
    s_nop 0
    buffer_load_dwordx4 v20, s[16:19], s66 offen lds
    s_add_u32 s66, s65, 9216
    s_add_u32 m0, s64, 3072
    s_nop 0
    buffer_load_dwordx4 v21, s[16:19], s66 offen lds
    s_waitcnt vmcnt(0)
    ds_read_b128 a[0:3], v5 offset:0
    ds_read_b128 a[4:7], v6 offset:0
    ds_read_b128 a[8:11], v5 offset:2048
    ds_read_b128 a[12:15], v6 offset:2048
    s_waitcnt lgkmcnt(0)
    v_mfma_f32_16x16x32_bf16 v[24:27], a[0:3], v[96:99], 0
    v_mfma_f32_16x16x32_bf16 v[32:35], a[0:3], v[100:103], 0
    v_mfma_f32_16x16x32_bf16 v[40:43], a[0:3], v[104:107], 0
    v_mfma_f32_16x16x32_bf16 v[48:51], a[0:3], v[108:111], 0
    v_mfma_f32_16x16x32_bf16 v[28:31], a[8:11], v[96:99], 0
    v_mfma_f32_16x16x32_bf16 v[36:39], a[8:11], v[100:103], 0
    v_mfma_f32_16x16x32_bf16 v[44:47], a[8:11], v[104:107], 0
    v_mfma_f32_16x16x32_bf16 v[52:55], a[8:11], v[108:111], 0
    v_mfma_f32_16x16x32_bf16 v[24:27], a[4:7], v[112:115], v[24:27]
    v_mfma_f32_16x16x32_bf16 v[32:35], a[4:7], v[116:119], v[32:35]
    v_mfma_f32_16x16x32_bf16 v[40:43], a[4:7], v[120:123], v[40:43]
    v_mfma_f32_16x16x32_bf16 v[48:51], a[4:7], v[124:127], v[48:51]
    v_mfma_f32_16x16x32_bf16 v[28:31], a[12:15], v[112:115], v[28:31]
    v_mfma_f32_16x16x32_bf16 v[36:39], a[12:15], v[116:119], v[36:39]
    v_mfma_f32_16x16x32_bf16 v[44:47], a[12:15], v[120:123], v[44:47]
    v_mfma_f32_16x16x32_bf16 v[52:55], a[12:15], v[124:127], v[52:55]
    s_add_u32 s66, s65, 128
    s_add_u32 m0, s64, 0
    s_nop 0
    buffer_load_dwordx4 v20, s[16:19], s66 offen lds
    s_add_u32 s66, s65, 3200
    s_add_u32 m0, s64, 1024
    s_nop 0
    buffer_load_dwordx4 v21, s[16:19], s66 offen lds
    s_add_u32 s66, s65, 6272
    s_add_u32 m0, s64, 2048
    s_nop 0
    buffer_load_dwordx4 v20, s[16:19], s66 offen lds
    s_add_u32 s66, s65, 9344
    s_add_u32 m0, s64, 3072
    s_nop 0
    buffer_load_dwordx4 v21, s[16:19], s66 offen lds
    s_waitcnt vmcnt(0)
    ds_read_b128 a[16:19], v5 offset:0
    ds_read_b128 a[20:23], v6 offset:0
    ds_read_b128 a[24:27], v5 offset:2048
    ds_read_b128 a[28:31], v6 offset:2048
    s_waitcnt lgkmcnt(0)
    v_mfma_f32_16x16x32_bf16 v[24:27], a[16:19], v[128:131], v[24:27]
    v_mfma_f32_16x16x32_bf16 v[32:35], a[16:19], v[132:135], v[32:35]
    v_mfma_f32_16x16x32_bf16 v[40:43], a[16:19], v[136:139], v[40:43]
    v_mfma_f32_16x16x32_bf16 v[48:51], a[16:19], v[140:143], v[48:51]
    v_mfma_f32_16x16x32_bf16 v[28:31], a[24:27], v[128:131], v[28:31]
    v_mfma_f32_16x16x32_bf16 v[36:39], a[24:27], v[132:135], v[36:39]
    v_mfma_f32_16x16x32_bf16 v[44:47], a[24:27], v[136:139], v[44:47]
    v_mfma_f32_16x16x32_bf16 v[52:55], a[24:27], v[140:143], v[52:55]
    v_mfma_f32_16x16x32_bf16 v[24:27], a[20:23], v[144:147], v[24:27]
    v_mfma_f32_16x16x32_bf16 v[32:35], a[20:23], v[148:151], v[32:35]
    v_mfma_f32_16x16x32_bf16 v[40:43], a[20:23], v[152:155], v[40:43]
    v_mfma_f32_16x16x32_bf16 v[48:51], a[20:23], v[156:159], v[48:51]
    v_mfma_f32_16x16x32_bf16 v[28:31], a[28:31], v[144:147], v[28:31]
    v_mfma_f32_16x16x32_bf16 v[36:39], a[28:31], v[148:151], v[36:39]
    v_mfma_f32_16x16x32_bf16 v[44:47], a[28:31], v[152:155], v[44:47]
    v_mfma_f32_16x16x32_bf16 v[52:55], a[28:31], v[156:159], v[52:55]
    s_add_u32 s66, s65, 256
    s_add_u32 m0, s64, 0
    s_nop 0
    buffer_load_dwordx4 v20, s[16:19], s66 offen lds
    s_add_u32 s66, s65, 3328
    s_add_u32 m0, s64, 1024
    s_nop 0
    buffer_load_dwordx4 v21, s[16:19], s66 offen lds
    s_add_u32 s66, s65, 6400
    s_add_u32 m0, s64, 2048
    s_nop 0
    buffer_load_dwordx4 v20, s[16:19], s66 offen lds
    s_add_u32 s66, s65, 9472
    s_add_u32 m0, s64, 3072
    s_nop 0
    buffer_load_dwordx4 v21, s[16:19], s66 offen lds
    s_waitcnt vmcnt(0)
    ds_read_b128 a[0:3], v5 offset:0
    ds_read_b128 a[4:7], v6 offset:0
    ds_read_b128 a[8:11], v5 offset:2048
    ds_read_b128 a[12:15], v6 offset:2048
    s_waitcnt lgkmcnt(0)
    v_mfma_f32_16x16x32_bf16 v[24:27], a[0:3], v[160:163], v[24:27]
    v_mfma_f32_16x16x32_bf16 v[32:35], a[0:3], v[164:167], v[32:35]
    v_mfma_f32_16x16x32_bf16 v[40:43], a[0:3], v[168:171], v[40:43]
    v_mfma_f32_16x16x32_bf16 v[48:51], a[0:3], v[172:175], v[48:51]
    v_mfma_f32_16x16x32_bf16 v[28:31], a[8:11], v[160:163], v[28:31]
    v_mfma_f32_16x16x32_bf16 v[36:39], a[8:11], v[164:167], v[36:39]
    v_mfma_f32_16x16x32_bf16 v[44:47], a[8:11], v[168:171], v[44:47]
    v_mfma_f32_16x16x32_bf16 v[52:55], a[8:11], v[172:175], v[52:55]
    v_mfma_f32_16x16x32_bf16 v[24:27], a[4:7], v[176:179], v[24:27]
    v_mfma_f32_16x16x32_bf16 v[32:35], a[4:7], v[180:183], v[32:35]
    v_mfma_f32_16x16x32_bf16 v[40:43], a[4:7], v[184:187], v[40:43]
    v_mfma_f32_16x16x32_bf16 v[48:51], a[4:7], v[188:191], v[48:51]
    v_mfma_f32_16x16x32_bf16 v[28:31], a[12:15], v[176:179], v[28:31]
    v_mfma_f32_16x16x32_bf16 v[36:39], a[12:15], v[180:183], v[36:39]
    v_mfma_f32_16x16x32_bf16 v[44:47], a[12:15], v[184:187], v[44:47]
    v_mfma_f32_16x16x32_bf16 v[52:55], a[12:15], v[188:191], v[52:55]
    s_nop 7
    v_max3_f32 v192, v192, v24, v25
    v_max3_f32 v192, v192, v26, v27
    v_max3_f32 v192, v192, v28, v29
    v_max3_f32 v192, v192, v30, v31
    v_max3_f32 v196, v196, v32, v33
    v_max3_f32 v196, v196, v34, v35
    v_max3_f32 v196, v196, v36, v37
    v_max3_f32 v196, v196, v38, v39
    v_max3_f32 v200, v200, v40, v41
    v_max3_f32 v200, v200, v42, v43
    v_max3_f32 v200, v200, v44, v45
    v_max3_f32 v200, v200, v46, v47
    v_max3_f32 v204, v204, v48, v49
    v_max3_f32 v204, v204, v50, v51
    v_max3_f32 v204, v204, v52, v53
    v_max3_f32 v204, v204, v54, v55
    s_add_u32 s65, s65, 12288
    s_cmp_lt_u32 s65, 196608
    s_cbranch_scc1 K2_slowA
    v_mov_b32 v193, v192
    v_mov_b32 v197, v196
    v_mov_b32 v201, v200
    v_mov_b32 v205, v204
    v_permlane16_swap_b32 v192, v193
    v_permlane16_swap_b32 v196, v197
    v_permlane16_swap_b32 v200, v201
    v_permlane16_swap_b32 v204, v205
    v_max_f32 v192, v192, v193
    v_max_f32 v196, v196, v197
    v_max_f32 v200, v200, v201
    v_max_f32 v204, v204, v205
    v_mov_b32 v193, v192
    v_mov_b32 v197, v196
    v_mov_b32 v201, v200
    v_mov_b32 v205, v204
    v_permlane32_swap_b32 v192, v193
    v_permlane32_swap_b32 v196, v197
    v_permlane32_swap_b32 v200, v201
    v_permlane32_swap_b32 v204, v205
    v_max_f32 v192, v192, v193
    v_max_f32 v196, v196, v197
    v_max_f32 v200, v200, v201
    v_max_f32 v204, v204, v205
    v_sub_f32 v193, 0, v192
    v_sub_f32 v194, 0, v192
    v_sub_f32 v195, 0, v192
    v_sub_f32 v192, 0, v192
    v_sub_f32 v197, 0, v196
    v_sub_f32 v198, 0, v196
    v_sub_f32 v199, 0, v196
    v_sub_f32 v196, 0, v196
    v_sub_f32 v201, 0, v200
    v_sub_f32 v202, 0, v200
    v_sub_f32 v203, 0, v200
    v_sub_f32 v200, 0, v200
    v_sub_f32 v205, 0, v204
    v_sub_f32 v206, 0, v204
    v_sub_f32 v207, 0, v204
    v_sub_f32 v204, 0, v204
    v_accvgpr_write_b32 a32, 0
    v_accvgpr_write_b32 a33, 0
    v_accvgpr_write_b32 a34, 0
    v_accvgpr_write_b32 a35, 0
    v_accvgpr_write_b32 a36, 0
    v_accvgpr_write_b32 a37, 0
    v_accvgpr_write_b32 a38, 0
    v_accvgpr_write_b32 a39, 0
    v_accvgpr_write_b32 a40, 0
    v_accvgpr_write_b32 a41, 0
    v_accvgpr_write_b32 a42, 0
    v_accvgpr_write_b32 a43, 0
    v_accvgpr_write_b32 a44, 0
    v_accvgpr_write_b32 a45, 0
    v_accvgpr_write_b32 a46, 0
    v_accvgpr_write_b32 a47, 0
    v_accvgpr_write_b32 a64, 0
    v_accvgpr_write_b32 a65, 0
    v_accvgpr_write_b32 a66, 0
    v_accvgpr_write_b32 a67, 0
    v_accvgpr_write_b32 a68, 0
    v_accvgpr_write_b32 a69, 0
    v_accvgpr_write_b32 a70, 0
    v_accvgpr_write_b32 a71, 0
    v_accvgpr_write_b32 a72, 0
    v_accvgpr_write_b32 a73, 0
    v_accvgpr_write_b32 a74, 0
    v_accvgpr_write_b32 a75, 0
    v_accvgpr_write_b32 a76, 0
    v_accvgpr_write_b32 a77, 0
    v_accvgpr_write_b32 a78, 0
    v_accvgpr_write_b32 a79, 0
    v_accvgpr_write_b32 a80, 0
    v_accvgpr_write_b32 a81, 0
    v_accvgpr_write_b32 a82, 0
    v_accvgpr_write_b32 a83, 0
    v_accvgpr_write_b32 a84, 0
    v_accvgpr_write_b32 a85, 0
    v_accvgpr_write_b32 a86, 0
    v_accvgpr_write_b32 a87, 0
    v_accvgpr_write_b32 a88, 0
    v_accvgpr_write_b32 a89, 0
    v_accvgpr_write_b32 a90, 0
    v_accvgpr_write_b32 a91, 0
    v_accvgpr_write_b32 a92, 0
    v_accvgpr_write_b32 a93, 0
    v_accvgpr_write_b32 a94, 0
    v_accvgpr_write_b32 a95, 0
    v_accvgpr_write_b32 a96, 0
    v_accvgpr_write_b32 a97, 0
    v_accvgpr_write_b32 a98, 0
    v_accvgpr_write_b32 a99, 0
    v_accvgpr_write_b32 a100, 0
    v_accvgpr_write_b32 a101, 0
    v_accvgpr_write_b32 a102, 0
    v_accvgpr_write_b32 a103, 0
    v_accvgpr_write_b32 a104, 0
    v_accvgpr_write_b32 a105, 0
    v_accvgpr_write_b32 a106, 0
    v_accvgpr_write_b32 a107, 0
    v_accvgpr_write_b32 a108, 0
    v_accvgpr_write_b32 a109, 0
    v_accvgpr_write_b32 a110, 0
    v_accvgpr_write_b32 a111, 0
    v_accvgpr_write_b32 a112, 0
    v_accvgpr_write_b32 a113, 0
    v_accvgpr_write_b32 a114, 0
    v_accvgpr_write_b32 a115, 0
    v_accvgpr_write_b32 a116, 0
    v_accvgpr_write_b32 a117, 0
    v_accvgpr_write_b32 a118, 0
    v_accvgpr_write_b32 a119, 0
    v_accvgpr_write_b32 a120, 0
    v_accvgpr_write_b32 a121, 0
    v_accvgpr_write_b32 a122, 0
    v_accvgpr_write_b32 a123, 0
    v_accvgpr_write_b32 a124, 0
    v_accvgpr_write_b32 a125, 0
    v_accvgpr_write_b32 a126, 0
    v_accvgpr_write_b32 a127, 0
    v_accvgpr_write_b32 a128, 0
    v_accvgpr_write_b32 a129, 0
    v_accvgpr_write_b32 a130, 0
    v_accvgpr_write_b32 a131, 0
    v_accvgpr_write_b32 a132, 0
    v_accvgpr_write_b32 a133, 0
    v_accvgpr_write_b32 a134, 0
    v_accvgpr_write_b32 a135, 0
    v_accvgpr_write_b32 a136, 0
    v_accvgpr_write_b32 a137, 0
    v_accvgpr_write_b32 a138, 0
    v_accvgpr_write_b32 a139, 0
    v_accvgpr_write_b32 a140, 0
    v_accvgpr_write_b32 a141, 0
    v_accvgpr_write_b32 a142, 0
    v_accvgpr_write_b32 a143, 0
    v_accvgpr_write_b32 a144, 0
    v_accvgpr_write_b32 a145, 0
    v_accvgpr_write_b32 a146, 0
    v_accvgpr_write_b32 a147, 0
    v_accvgpr_write_b32 a148, 0
    v_accvgpr_write_b32 a149, 0
    v_accvgpr_write_b32 a150, 0
    v_accvgpr_write_b32 a151, 0
    v_accvgpr_write_b32 a152, 0
    v_accvgpr_write_b32 a153, 0
    v_accvgpr_write_b32 a154, 0
    v_accvgpr_write_b32 a155, 0
    v_accvgpr_write_b32 a156, 0
    v_accvgpr_write_b32 a157, 0
    v_accvgpr_write_b32 a158, 0
    v_accvgpr_write_b32 a159, 0
    v_accvgpr_write_b32 a160, 0
    v_accvgpr_write_b32 a161, 0
    v_accvgpr_write_b32 a162, 0
    v_accvgpr_write_b32 a163, 0
    v_accvgpr_write_b32 a164, 0
    v_accvgpr_write_b32 a165, 0
    v_accvgpr_write_b32 a166, 0
    v_accvgpr_write_b32 a167, 0
    v_accvgpr_write_b32 a168, 0
    v_accvgpr_write_b32 a169, 0
    v_accvgpr_write_b32 a170, 0
    v_accvgpr_write_b32 a171, 0
    v_accvgpr_write_b32 a172, 0
    v_accvgpr_write_b32 a173, 0
    v_accvgpr_write_b32 a174, 0
    v_accvgpr_write_b32 a175, 0
    v_accvgpr_write_b32 a176, 0
    v_accvgpr_write_b32 a177, 0
    v_accvgpr_write_b32 a178, 0
    v_accvgpr_write_b32 a179, 0
    v_accvgpr_write_b32 a180, 0
    v_accvgpr_write_b32 a181, 0
    v_accvgpr_write_b32 a182, 0
    v_accvgpr_write_b32 a183, 0
    v_accvgpr_write_b32 a184, 0
    v_accvgpr_write_b32 a185, 0
    v_accvgpr_write_b32 a186, 0
    v_accvgpr_write_b32 a187, 0
    v_accvgpr_write_b32 a188, 0
    v_accvgpr_write_b32 a189, 0
    v_accvgpr_write_b32 a190, 0
    v_accvgpr_write_b32 a191, 0
    v_accvgpr_write_b32 a192, 0
    v_accvgpr_write_b32 a193, 0
    v_accvgpr_write_b32 a194, 0
    v_accvgpr_write_b32 a195, 0
    v_accvgpr_write_b32 a196, 0
    v_accvgpr_write_b32 a197, 0
    v_accvgpr_write_b32 a198, 0
    v_accvgpr_write_b32 a199, 0
    v_accvgpr_write_b32 a200, 0
    v_accvgpr_write_b32 a201, 0
    v_accvgpr_write_b32 a202, 0
    v_accvgpr_write_b32 a203, 0
    v_accvgpr_write_b32 a204, 0
    v_accvgpr_write_b32 a205, 0
    v_accvgpr_write_b32 a206, 0
    v_accvgpr_write_b32 a207, 0
    v_accvgpr_write_b32 a208, 0
    v_accvgpr_write_b32 a209, 0
    v_accvgpr_write_b32 a210, 0
    v_accvgpr_write_b32 a211, 0
    v_accvgpr_write_b32 a212, 0
    v_accvgpr_write_b32 a213, 0
    v_accvgpr_write_b32 a214, 0
    v_accvgpr_write_b32 a215, 0
    v_accvgpr_write_b32 a216, 0
    v_accvgpr_write_b32 a217, 0
    v_accvgpr_write_b32 a218, 0
    v_accvgpr_write_b32 a219, 0
    v_accvgpr_write_b32 a220, 0
    v_accvgpr_write_b32 a221, 0
    v_accvgpr_write_b32 a222, 0
    v_accvgpr_write_b32 a223, 0
    v_accvgpr_write_b32 a224, 0
    v_accvgpr_write_b32 a225, 0
    v_accvgpr_write_b32 a226, 0
    v_accvgpr_write_b32 a227, 0
    v_accvgpr_write_b32 a228, 0
    v_accvgpr_write_b32 a229, 0
    v_accvgpr_write_b32 a230, 0
    v_accvgpr_write_b32 a231, 0
    v_accvgpr_write_b32 a232, 0
    v_accvgpr_write_b32 a233, 0
    v_accvgpr_write_b32 a234, 0
    v_accvgpr_write_b32 a235, 0
    v_accvgpr_write_b32 a236, 0
    v_accvgpr_write_b32 a237, 0
    v_accvgpr_write_b32 a238, 0
    v_accvgpr_write_b32 a239, 0
    v_accvgpr_write_b32 a240, 0
    v_accvgpr_write_b32 a241, 0
    v_accvgpr_write_b32 a242, 0
    v_accvgpr_write_b32 a243, 0
    v_accvgpr_write_b32 a244, 0
    v_accvgpr_write_b32 a245, 0
    v_accvgpr_write_b32 a246, 0
    v_accvgpr_write_b32 a247, 0
    v_accvgpr_write_b32 a248, 0
    v_accvgpr_write_b32 a249, 0
    v_accvgpr_write_b32 a250, 0
    v_accvgpr_write_b32 a251, 0
    v_accvgpr_write_b32 a252, 0
    v_accvgpr_write_b32 a253, 0
    v_accvgpr_write_b32 a254, 0
    v_accvgpr_write_b32 a255, 0
    s_mov_b32 s65, 0
K2_slowB:
    s_add_u32 s66, s65, 0
    s_add_u32 m0, s64, 0
    s_nop 0
    buffer_load_dwordx4 v20, s[16:19], s66 offen lds
    s_add_u32 s66, s65, 3072
    s_add_u32 m0, s64, 1024
    s_nop 0
    buffer_load_dwordx4 v21, s[16:19], s66 offen lds
    s_add_u32 s66, s65, 6144
    s_add_u32 m0, s64, 2048
    s_nop 0
    buffer_load_dwordx4 v20, s[16:19], s66 offen lds
    s_add_u32 s66, s65, 9216
    s_add_u32 m0, s64, 3072
    s_nop 0
    buffer_load_dwordx4 v21, s[16:19], s66 offen lds
    s_waitcnt vmcnt(0)
    ds_read_b128 a[0:3], v5 offset:0
    ds_read_b128 a[4:7], v6 offset:0
    ds_read_b128 a[8:11], v5 offset:2048
    ds_read_b128 a[12:15], v6 offset:2048
    s_waitcnt lgkmcnt(0)
    v_mfma_f32_16x16x32_bf16 v[24:27], a[0:3], v[96:99], v[192:195]
    v_mfma_f32_16x16x32_bf16 v[32:35], a[0:3], v[100:103], v[196:199]
    v_mfma_f32_16x16x32_bf16 v[40:43], a[0:3], v[104:107], v[200:203]
    v_mfma_f32_16x16x32_bf16 v[48:51], a[0:3], v[108:111], v[204:207]
    v_mfma_f32_16x16x32_bf16 v[28:31], a[8:11], v[96:99], v[192:195]
    v_mfma_f32_16x16x32_bf16 v[36:39], a[8:11], v[100:103], v[196:199]
    v_mfma_f32_16x16x32_bf16 v[44:47], a[8:11], v[104:107], v[200:203]
    v_mfma_f32_16x16x32_bf16 v[52:55], a[8:11], v[108:111], v[204:207]
    v_mfma_f32_16x16x32_bf16 v[24:27], a[4:7], v[112:115], v[24:27]
    v_mfma_f32_16x16x32_bf16 v[32:35], a[4:7], v[116:119], v[32:35]
    v_mfma_f32_16x16x32_bf16 v[40:43], a[4:7], v[120:123], v[40:43]
    v_mfma_f32_16x16x32_bf16 v[48:51], a[4:7], v[124:127], v[48:51]
    v_mfma_f32_16x16x32_bf16 v[28:31], a[12:15], v[112:115], v[28:31]
    v_mfma_f32_16x16x32_bf16 v[36:39], a[12:15], v[116:119], v[36:39]
    v_mfma_f32_16x16x32_bf16 v[44:47], a[12:15], v[120:123], v[44:47]
    v_mfma_f32_16x16x32_bf16 v[52:55], a[12:15], v[124:127], v[52:55]
    s_add_u32 s66, s65, 128
    s_add_u32 m0, s64, 0
    s_nop 0
    buffer_load_dwordx4 v20, s[16:19], s66 offen lds
    s_add_u32 s66, s65, 3200
    s_add_u32 m0, s64, 1024
    s_nop 0
    buffer_load_dwordx4 v21, s[16:19], s66 offen lds
    s_add_u32 s66, s65, 6272
    s_add_u32 m0, s64, 2048
    s_nop 0
    buffer_load_dwordx4 v20, s[16:19], s66 offen lds
    s_add_u32 s66, s65, 9344
    s_add_u32 m0, s64, 3072
    s_nop 0
    buffer_load_dwordx4 v21, s[16:19], s66 offen lds
    s_waitcnt vmcnt(0)
    ds_read_b128 a[16:19], v5 offset:0
    ds_read_b128 a[20:23], v6 offset:0
    ds_read_b128 a[24:27], v5 offset:2048
    ds_read_b128 a[28:31], v6 offset:2048
    s_waitcnt lgkmcnt(0)
    v_mfma_f32_16x16x32_bf16 v[24:27], a[16:19], v[128:131], v[24:27]
    v_mfma_f32_16x16x32_bf16 v[32:35], a[16:19], v[132:135], v[32:35]
    v_mfma_f32_16x16x32_bf16 v[40:43], a[16:19], v[136:139], v[40:43]
    v_mfma_f32_16x16x32_bf16 v[48:51], a[16:19], v[140:143], v[48:51]
    v_mfma_f32_16x16x32_bf16 v[28:31], a[24:27], v[128:131], v[28:31]
    v_mfma_f32_16x16x32_bf16 v[36:39], a[24:27], v[132:135], v[36:39]
    v_mfma_f32_16x16x32_bf16 v[44:47], a[24:27], v[136:139], v[44:47]
    v_mfma_f32_16x16x32_bf16 v[52:55], a[24:27], v[140:143], v[52:55]
    v_mfma_f32_16x16x32_bf16 v[24:27], a[20:23], v[144:147], v[24:27]
    v_mfma_f32_16x16x32_bf16 v[32:35], a[20:23], v[148:151], v[32:35]
    v_mfma_f32_16x16x32_bf16 v[40:43], a[20:23], v[152:155], v[40:43]
    v_mfma_f32_16x16x32_bf16 v[48:51], a[20:23], v[156:159], v[48:51]
    v_mfma_f32_16x16x32_bf16 v[28:31], a[28:31], v[144:147], v[28:31]
    v_mfma_f32_16x16x32_bf16 v[36:39], a[28:31], v[148:151], v[36:39]
    v_mfma_f32_16x16x32_bf16 v[44:47], a[28:31], v[152:155], v[44:47]
    v_mfma_f32_16x16x32_bf16 v[52:55], a[28:31], v[156:159], v[52:55]
    s_add_u32 s66, s65, 256
    s_add_u32 m0, s64, 0
    s_nop 0
    buffer_load_dwordx4 v20, s[16:19], s66 offen lds
    s_add_u32 s66, s65, 3328
    s_add_u32 m0, s64, 1024
    s_nop 0
    buffer_load_dwordx4 v21, s[16:19], s66 offen lds
    s_add_u32 s66, s65, 6400
    s_add_u32 m0, s64, 2048
    s_nop 0
    buffer_load_dwordx4 v20, s[16:19], s66 offen lds
    s_add_u32 s66, s65, 9472
    s_add_u32 m0, s64, 3072
    s_nop 0
    buffer_load_dwordx4 v21, s[16:19], s66 offen lds
    s_waitcnt vmcnt(0)
    ds_read_b128 a[0:3], v5 offset:0
    ds_read_b128 a[4:7], v6 offset:0
    ds_read_b128 a[8:11], v5 offset:2048
    ds_read_b128 a[12:15], v6 offset:2048
    s_waitcnt lgkmcnt(0)
    v_mfma_f32_16x16x32_bf16 v[24:27], a[0:3], v[160:163], v[24:27]
    v_mfma_f32_16x16x32_bf16 v[32:35], a[0:3], v[164:167], v[32:35]
    v_mfma_f32_16x16x32_bf16 v[40:43], a[0:3], v[168:171], v[40:43]
    v_mfma_f32_16x16x32_bf16 v[48:51], a[0:3], v[172:175], v[48:51]
    v_mfma_f32_16x16x32_bf16 v[28:31], a[8:11], v[160:163], v[28:31]
    v_mfma_f32_16x16x32_bf16 v[36:39], a[8:11], v[164:167], v[36:39]
    v_mfma_f32_16x16x32_bf16 v[44:47], a[8:11], v[168:171], v[44:47]
    v_mfma_f32_16x16x32_bf16 v[52:55], a[8:11], v[172:175], v[52:55]
    v_mfma_f32_16x16x32_bf16 v[24:27], a[4:7], v[176:179], v[24:27]
    v_mfma_f32_16x16x32_bf16 v[32:35], a[4:7], v[180:183], v[32:35]
    v_mfma_f32_16x16x32_bf16 v[40:43], a[4:7], v[184:187], v[40:43]
    v_mfma_f32_16x16x32_bf16 v[48:51], a[4:7], v[188:191], v[48:51]
    v_mfma_f32_16x16x32_bf16 v[28:31], a[12:15], v[176:179], v[28:31]
    v_mfma_f32_16x16x32_bf16 v[36:39], a[12:15], v[180:183], v[36:39]
    v_mfma_f32_16x16x32_bf16 v[44:47], a[12:15], v[184:187], v[44:47]
    v_mfma_f32_16x16x32_bf16 v[52:55], a[12:15], v[188:191], v[52:55]
    s_nop 7
    v_exp_f32 v24, v24
    v_exp_f32 v25, v25
    v_exp_f32 v26, v26
    v_cvt_pk_bf16_f32 v24, v24, v25
    v_exp_f32 v27, v27
    v_exp_f32 v32, v32
    v_cvt_pk_bf16_f32 v25, v26, v27
    v_exp_f32 v33, v33
    v_exp_f32 v34, v34
    v_cvt_pk_bf16_f32 v32, v32, v33
    v_exp_f32 v35, v35
    v_exp_f32 v40, v40
    v_cvt_pk_bf16_f32 v33, v34, v35
    v_exp_f32 v41, v41
    v_exp_f32 v42, v42
    v_cvt_pk_bf16_f32 v40, v40, v41
    v_exp_f32 v43, v43
    v_exp_f32 v48, v48
    v_cvt_pk_bf16_f32 v41, v42, v43
    v_exp_f32 v49, v49
    v_exp_f32 v50, v50
    v_cvt_pk_bf16_f32 v48, v48, v49
    v_exp_f32 v51, v51
    v_exp_f32 v28, v28
    v_cvt_pk_bf16_f32 v49, v50, v51
    v_exp_f32 v29, v29
    v_exp_f32 v30, v30
    v_cvt_pk_bf16_f32 v26, v28, v29
    v_exp_f32 v31, v31
    v_exp_f32 v36, v36
    v_cvt_pk_bf16_f32 v27, v30, v31
    v_exp_f32 v37, v37
    v_exp_f32 v38, v38
    v_cvt_pk_bf16_f32 v34, v36, v37
    v_exp_f32 v39, v39
    v_exp_f32 v44, v44
    v_cvt_pk_bf16_f32 v35, v38, v39
    v_exp_f32 v45, v45
    v_exp_f32 v46, v46
    v_cvt_pk_bf16_f32 v42, v44, v45
    v_exp_f32 v47, v47
    v_exp_f32 v52, v52
    v_cvt_pk_bf16_f32 v43, v46, v47
    v_exp_f32 v53, v53
    v_exp_f32 v54, v54
    v_cvt_pk_bf16_f32 v50, v52, v53
    v_exp_f32 v55, v55
    s_nop 0
    v_cvt_pk_bf16_f32 v51, v54, v55
    s_nop 1
    v_mfma_f32_16x16x32_bf16 a[32:35], a[48:51], v[24:27], a[32:35]
    v_mfma_f32_16x16x32_bf16 a[36:39], a[48:51], v[32:35], a[36:39]
    v_mfma_f32_16x16x32_bf16 a[40:43], a[48:51], v[40:43], a[40:43]
    v_mfma_f32_16x16x32_bf16 a[44:47], a[48:51], v[48:51], a[44:47]
    s_add_u32 s66, s65, 0
    s_add_u32 m0, s64, 0
    s_nop 0
    buffer_load_dwordx4 v22, s[20:23], s66 offen lds
    s_add_u32 s66, s65, 3072
    s_add_u32 m0, s64, 1024
    s_nop 0
    buffer_load_dwordx4 v22, s[20:23], s66 offen lds
    s_add_u32 s66, s65, 6144
    s_add_u32 m0, s64, 2048
    s_nop 0
    buffer_load_dwordx4 v22, s[20:23], s66 offen lds
    s_add_u32 s66, s65, 9216
    s_add_u32 m0, s64, 3072
    s_nop 0
    buffer_load_dwordx4 v22, s[20:23], s66 offen lds
    s_waitcnt vmcnt(0)
    ds_read_b64_tr_b16 a[16:17], v1 offset:0
    ds_read_b64_tr_b16 a[18:19], v1 offset:2048
    ds_read_b64_tr_b16 a[20:21], v2 offset:0
    ds_read_b64_tr_b16 a[22:23], v2 offset:2048
    ds_read_b64_tr_b16 a[24:25], v3 offset:0
    ds_read_b64_tr_b16 a[26:27], v3 offset:2048
    ds_read_b64_tr_b16 a[28:29], v4 offset:0
    ds_read_b64_tr_b16 a[30:31], v4 offset:2048
    s_waitcnt lgkmcnt(0)
    v_mfma_f32_16x16x32_bf16 a[64:67], a[16:19], v[24:27], a[64:67]
    v_mfma_f32_16x16x32_bf16 a[72:75], a[16:19], v[32:35], a[72:75]
    v_mfma_f32_16x16x32_bf16 a[80:83], a[16:19], v[40:43], a[80:83]
    v_mfma_f32_16x16x32_bf16 a[88:91], a[16:19], v[48:51], a[88:91]
    v_mfma_f32_16x16x32_bf16 a[68:71], a[20:23], v[24:27], a[68:71]
    v_mfma_f32_16x16x32_bf16 a[76:79], a[20:23], v[32:35], a[76:79]
    v_mfma_f32_16x16x32_bf16 a[84:87], a[20:23], v[40:43], a[84:87]
    v_mfma_f32_16x16x32_bf16 a[92:95], a[20:23], v[48:51], a[92:95]
    v_mfma_f32_16x16x32_bf16 a[96:99], a[24:27], v[24:27], a[96:99]
    v_mfma_f32_16x16x32_bf16 a[104:107], a[24:27], v[32:35], a[104:107]
    v_mfma_f32_16x16x32_bf16 a[112:115], a[24:27], v[40:43], a[112:115]
    v_mfma_f32_16x16x32_bf16 a[120:123], a[24:27], v[48:51], a[120:123]
    v_mfma_f32_16x16x32_bf16 a[100:103], a[28:31], v[24:27], a[100:103]
    v_mfma_f32_16x16x32_bf16 a[108:111], a[28:31], v[32:35], a[108:111]
    v_mfma_f32_16x16x32_bf16 a[116:119], a[28:31], v[40:43], a[116:119]
    v_mfma_f32_16x16x32_bf16 a[124:127], a[28:31], v[48:51], a[124:127]
    s_add_u32 s66, s65, 128
    s_add_u32 m0, s64, 0
    s_nop 0
    buffer_load_dwordx4 v22, s[20:23], s66 offen lds
    s_add_u32 s66, s65, 3200
    s_add_u32 m0, s64, 1024
    s_nop 0
    buffer_load_dwordx4 v22, s[20:23], s66 offen lds
    s_add_u32 s66, s65, 6272
    s_add_u32 m0, s64, 2048
    s_nop 0
    buffer_load_dwordx4 v22, s[20:23], s66 offen lds
    s_add_u32 s66, s65, 9344
    s_add_u32 m0, s64, 3072
    s_nop 0
    buffer_load_dwordx4 v22, s[20:23], s66 offen lds
    s_waitcnt vmcnt(0)
    ds_read_b64_tr_b16 a[0:1], v1 offset:0
    ds_read_b64_tr_b16 a[2:3], v1 offset:2048
    ds_read_b64_tr_b16 a[4:5], v2 offset:0
    ds_read_b64_tr_b16 a[6:7], v2 offset:2048
    ds_read_b64_tr_b16 a[8:9], v3 offset:0
    ds_read_b64_tr_b16 a[10:11], v3 offset:2048
    ds_read_b64_tr_b16 a[12:13], v4 offset:0
    ds_read_b64_tr_b16 a[14:15], v4 offset:2048
    s_waitcnt lgkmcnt(0)
    v_mfma_f32_16x16x32_bf16 a[128:131], a[0:3], v[24:27], a[128:131]
    v_mfma_f32_16x16x32_bf16 a[136:139], a[0:3], v[32:35], a[136:139]
    v_mfma_f32_16x16x32_bf16 a[144:147], a[0:3], v[40:43], a[144:147]
    v_mfma_f32_16x16x32_bf16 a[152:155], a[0:3], v[48:51], a[152:155]
    v_mfma_f32_16x16x32_bf16 a[132:135], a[4:7], v[24:27], a[132:135]
    v_mfma_f32_16x16x32_bf16 a[140:143], a[4:7], v[32:35], a[140:143]
    v_mfma_f32_16x16x32_bf16 a[148:151], a[4:7], v[40:43], a[148:151]
    v_mfma_f32_16x16x32_bf16 a[156:159], a[4:7], v[48:51], a[156:159]
    v_mfma_f32_16x16x32_bf16 a[160:163], a[8:11], v[24:27], a[160:163]
    v_mfma_f32_16x16x32_bf16 a[168:171], a[8:11], v[32:35], a[168:171]
    v_mfma_f32_16x16x32_bf16 a[176:179], a[8:11], v[40:43], a[176:179]
    v_mfma_f32_16x16x32_bf16 a[184:187], a[8:11], v[48:51], a[184:187]
    v_mfma_f32_16x16x32_bf16 a[164:167], a[12:15], v[24:27], a[164:167]
    v_mfma_f32_16x16x32_bf16 a[172:175], a[12:15], v[32:35], a[172:175]
    v_mfma_f32_16x16x32_bf16 a[180:183], a[12:15], v[40:43], a[180:183]
    v_mfma_f32_16x16x32_bf16 a[188:191], a[12:15], v[48:51], a[188:191]
    s_add_u32 s66, s65, 256
    s_add_u32 m0, s64, 0
    s_nop 0
    buffer_load_dwordx4 v22, s[20:23], s66 offen lds
    s_add_u32 s66, s65, 3328
    s_add_u32 m0, s64, 1024
    s_nop 0
    buffer_load_dwordx4 v22, s[20:23], s66 offen lds
    s_add_u32 s66, s65, 6400
    s_add_u32 m0, s64, 2048
    s_nop 0
    buffer_load_dwordx4 v22, s[20:23], s66 offen lds
    s_add_u32 s66, s65, 9472
    s_add_u32 m0, s64, 3072
    s_nop 0
    buffer_load_dwordx4 v22, s[20:23], s66 offen lds
    s_waitcnt vmcnt(0)
    ds_read_b64_tr_b16 a[16:17], v1 offset:0
    ds_read_b64_tr_b16 a[18:19], v1 offset:2048
    ds_read_b64_tr_b16 a[20:21], v2 offset:0
    ds_read_b64_tr_b16 a[22:23], v2 offset:2048
    ds_read_b64_tr_b16 a[24:25], v3 offset:0
    ds_read_b64_tr_b16 a[26:27], v3 offset:2048
    ds_read_b64_tr_b16 a[28:29], v4 offset:0
    ds_read_b64_tr_b16 a[30:31], v4 offset:2048
    s_waitcnt lgkmcnt(0)
    v_mfma_f32_16x16x32_bf16 a[192:195], a[16:19], v[24:27], a[192:195]
    v_mfma_f32_16x16x32_bf16 a[200:203], a[16:19], v[32:35], a[200:203]
    v_mfma_f32_16x16x32_bf16 a[208:211], a[16:19], v[40:43], a[208:211]
    v_mfma_f32_16x16x32_bf16 a[216:219], a[16:19], v[48:51], a[216:219]
    v_mfma_f32_16x16x32_bf16 a[196:199], a[20:23], v[24:27], a[196:199]
    v_mfma_f32_16x16x32_bf16 a[204:207], a[20:23], v[32:35], a[204:207]
    v_mfma_f32_16x16x32_bf16 a[212:215], a[20:23], v[40:43], a[212:215]
    v_mfma_f32_16x16x32_bf16 a[220:223], a[20:23], v[48:51], a[220:223]
    v_mfma_f32_16x16x32_bf16 a[224:227], a[24:27], v[24:27], a[224:227]
    v_mfma_f32_16x16x32_bf16 a[232:235], a[24:27], v[32:35], a[232:235]
    v_mfma_f32_16x16x32_bf16 a[240:243], a[24:27], v[40:43], a[240:243]
    v_mfma_f32_16x16x32_bf16 a[248:251], a[24:27], v[48:51], a[248:251]
    v_mfma_f32_16x16x32_bf16 a[228:231], a[28:31], v[24:27], a[228:231]
    v_mfma_f32_16x16x32_bf16 a[236:239], a[28:31], v[32:35], a[236:239]
    v_mfma_f32_16x16x32_bf16 a[244:247], a[28:31], v[40:43], a[244:247]
    v_mfma_f32_16x16x32_bf16 a[252:255], a[28:31], v[48:51], a[252:255]
    s_add_u32 s65, s65, 12288
    s_cmp_lt_u32 s65, 196608
    s_cbranch_scc1 K2_slowB
    s_nop 7
    v_accvgpr_read_b32 v192, a32
    v_accvgpr_read_b32 v194, a36
    v_accvgpr_read_b32 v196, a40
    v_accvgpr_read_b32 v198, a44
    v_accvgpr_read_b32 v1, a58
    v_accvgpr_read_b32 v2, a59
    v_accvgpr_read_b32 v3, a60
    v_accvgpr_read_b32 v4, a61
    v_mov_b32 v56, 0
    v_mov_b32 v57, 0
    v_mov_b32 v58, 0
    v_mov_b32 v59, 0
    v_mov_b32 v64, 0
    v_mov_b32 v65, 0
    v_mov_b32 v66, 0
    v_mov_b32 v67, 0
    v_mov_b32 v72, 0
    v_mov_b32 v73, 0
    v_mov_b32 v74, 0
    v_mov_b32 v75, 0
    v_mov_b32 v80, 0
    v_mov_b32 v81, 0
    v_mov_b32 v82, 0
    v_mov_b32 v83, 0
    v_mov_b32 v24, 0
    v_mov_b32 v25, 0
    v_mov_b32 v26, 0
    v_mov_b32 v27, 0
    v_mov_b32 v32, 0
    v_mov_b32 v33, 0
    v_mov_b32 v34, 0
    v_mov_b32 v35, 0
    v_mov_b32 v40, 0
    v_mov_b32 v41, 0
    v_mov_b32 v42, 0
    v_mov_b32 v43, 0
    v_mov_b32 v48, 0
    v_mov_b32 v49, 0
    v_mov_b32 v50, 0
    v_mov_b32 v51, 0
    v_mov_b32 v208, 0
    v_mov_b32 v209, 0
    v_mov_b32 v210, 0
    v_mov_b32 v211, 0
    v_mov_b32 v212, 0
    v_mov_b32 v213, 0
    v_mov_b32 v214, 0
    v_mov_b32 v215, 0
    v_mov_b32 v216, 0
    v_mov_b32 v217, 0
    v_mov_b32 v218, 0
    v_mov_b32 v219, 0
    v_mov_b32 v220, 0
    v_mov_b32 v221, 0
    v_mov_b32 v222, 0
    v_mov_b32 v223, 0
    v_mov_b32 v240, 0
    v_mov_b32 v241, 0
    v_mov_b32 v242, 0
    v_mov_b32 v243, 0
    v_mov_b32 v244, 0
    v_mov_b32 v245, 0
    v_mov_b32 v246, 0
    v_mov_b32 v247, 0
    v_mov_b32 v248, 0
    v_mov_b32 v249, 0
    v_mov_b32 v250, 0
    v_mov_b32 v251, 0
    v_mov_b32 v252, 0
    v_mov_b32 v253, 0
    v_mov_b32 v254, 0
    v_mov_b32 v255, 0
    v_mov_b32 v28, 0
    v_mov_b32 v29, 0
    v_mov_b32 v30, 0
    v_mov_b32 v31, 0
    v_mov_b32 v36, 0
    v_mov_b32 v37, 0
    v_mov_b32 v38, 0
    v_mov_b32 v39, 0
    v_mov_b32 v44, 0
    v_mov_b32 v45, 0
    v_mov_b32 v46, 0
    v_mov_b32 v47, 0
    v_mov_b32 v52, 0
    v_mov_b32 v53, 0
    v_mov_b32 v54, 0
    v_mov_b32 v55, 0
    s_mov_b32 m0, s67
    s_nop 1
    s_branch K2_back
.section .rodata,"a"
.p2align 6
.amdhsa_kernel adaLN_cond__sliding_block_cached__geglu_ffn__prompt_kernel
  .amdhsa_next_free_vgpr 512
  .amdhsa_next_free_sgpr 102
  .amdhsa_accum_offset 256
  .amdhsa_group_segment_fixed_size 0
  .amdhsa_kernarg_size 112
  .amdhsa_user_sgpr_count 2
  .amdhsa_user_sgpr_kernarg_segment_ptr 1
  .amdhsa_system_sgpr_workgroup_id_x 1
  .amdhsa_float_denorm_mode_32 3
.end_amdhsa_kernel
```
